```python
import torch

def _softmax(x, axis=-1):
    return torch.softmax(x, dim=axis)
def _gelu(x):
    return torch.nn.functional.gelu(x, approximate="tanh")
def _silu(x):
    return torch.nn.functional.silu(x)
def _sigmoid(x):
    return torch.sigmoid(x)
def _layernorm(x, axis=-1, eps=1e-5):
    m = x.mean(dim=axis, keepdim=True)
    v = x.var(dim=axis, keepdim=True, unbiased=False)
    return (x - m) / torch.sqrt(v + eps)
def _scatter_add(tgt, idx, src, axis=0):
    return tgt.clone().index_add_(axis, idx, src)
def _segment_sum(src, seg, n):
    out = torch.zeros((n,) + src.shape[1:], dtype=src.dtype)
    return out.index_add_(0, seg, src)
def _pad(x, pw):
    flat = tuple(v for pair in reversed(pw) for v in pair)
    return torch.nn.functional.pad(x, flat)

kernel_name = 'concat_heads__mha_block_cached__mha_block_cached__near_ridge'

def setup_inputs():

    _w = (lambda a: (lambda t: t.to(torch.bfloat16) if t.is_floating_point() else t)(torch.as_tensor(a)))
    def _A_setup():
        B, Sq, D = 8, 144, 640
        H, Sk, Dh = 32, 512, 128
        return {
            "x": _w((lambda *s: torch.randn(*s, dtype=torch.bfloat16) * 0.8)(B, Sq, D)),
            "k_cache": _w((lambda *s: torch.randn(*s, dtype=torch.bfloat16) * 0.8)(B, H, Sk, Dh)),
            "v_cache": _w((lambda *s: torch.randn(*s, dtype=torch.bfloat16) * 0.05)(B, H, Sk, Dh)),
            "wq": _w((lambda *s: torch.randn(*s, dtype=torch.bfloat16) * 0.8)(D, H * Dh) * (D ** -0.5)),
            "wo": _w((lambda *s: torch.randn(*s, dtype=torch.bfloat16) * 0.05)(H * Dh, D) * ((H * Dh) ** -0.5)),
        }
    _A_in = _A_setup()

    def _B_setup():
        B, Sq, D = 8, 144, 640
        H, Sk, Dh = 32, 512, 128
        return {
            "x": _w((lambda *s: torch.randn(*s, dtype=torch.bfloat16) * 0.8)(B, Sq, D)),
            "k_cache": _w((lambda *s: torch.randn(*s, dtype=torch.bfloat16) * 0.8)(B, H, Sk, Dh)),
            "v_cache": _w((lambda *s: torch.randn(*s, dtype=torch.bfloat16) * 0.05)(B, H, Sk, Dh)),
            "wq": _w((lambda *s: torch.randn(*s, dtype=torch.bfloat16) * 0.8)(D, H * Dh) * (D ** -0.5)),
            "wo": _w((lambda *s: torch.randn(*s, dtype=torch.bfloat16) * 0.05)(H * Dh, D) * ((H * Dh) ** -0.5)),
        }
    _B_in = _B_setup()

    return {
        "A_x": _A_in["x"],
        "A_k_cache": _A_in["k_cache"],
        "A_v_cache": _A_in["v_cache"],
        "A_wq": _A_in["wq"],
        "A_wo": _A_in["wo"],
        "B_x": _B_in["x"],
        "B_k_cache": _B_in["k_cache"],
        "B_v_cache": _B_in["v_cache"],
        "B_wq": _B_in["wq"],
        "B_wo": _B_in["wo"],
    }

def reference(A_x, A_k_cache, A_v_cache, A_wq, A_wo, B_x, B_k_cache, B_v_cache, B_wq, B_wo):
    def _A_ref(x, k_cache, v_cache, wq, wo):
        B, Sq, D = x.shape
        H, Dh = 32, 128
        q = (lambda x, *d: x.permute(*d))((x @ wq).reshape(B, Sq, H, Dh), 0, 2, 1, 3)
        scores = torch.einsum("bhqd,bhkd->bhqk", q, k_cache) * (Dh ** -0.5)
        p = _softmax(scores, axis=-1)
        o = torch.einsum("bhqk,bhkd->bhqd", p, v_cache)
        return (lambda x, *d: x.permute(*d))(o, 0, 2, 1, 3).reshape(B, Sq, H * Dh) @ wo

    def _B_ref(x, k_cache, v_cache, wq, wo):
        B, Sq, D = x.shape
        H, Dh = 32, 128
        q = (lambda x, *d: x.permute(*d))((x @ wq).reshape(B, Sq, H, Dh), 0, 2, 1, 3)
        scores = torch.einsum("bhqd,bhkd->bhqk", q, k_cache) * (Dh ** -0.5)
        p = _softmax(scores, axis=-1)
        o = torch.einsum("bhqk,bhkd->bhqd", p, v_cache)
        return (lambda x, *d: x.permute(*d))(o, 0, 2, 1, 3).reshape(B, Sq, H * Dh) @ wo

    a = _A_ref(A_x, A_k_cache, A_v_cache, A_wq, A_wo)
    b = _B_ref(B_x, B_k_cache, B_v_cache, B_wq, B_wo)
    return torch.concatenate([a, b], axis=-1)
```

```asm
; @launch grid=(256,1,1) block=(512,1,1) lds=163840
.amdgcn_target "amdgcn-amd-amdhsa--gfx950"
.text
.globl concat_heads__mha_block_cached__mha_block_cached__near_ridge_kernel
.p2align 8
.type concat_heads__mha_block_cached__mha_block_cached__near_ridge_kernel,@function
concat_heads__mha_block_cached__mha_block_cached__near_ridge_kernel:
    s_cmp_ge_u32 s2, 256
    s_cbranch_scc1 L_end
    s_getpc_b64 s[90:91]
    v_lshlrev_b32 v2, 7, v0
    global_load_dword a159, v2, s[90:91]
    v_add_u32 v2, 0x10000, v2
    v_cmp_gt_u32 vcc, 113664, v2
    s_and_saveexec_b64 s[92:93], vcc
    global_load_dword a159, v2, s[90:91]
    s_mov_b64 exec, s[92:93]
    s_load_dwordx8 s[8:15], s[0:1], 0
    s_load_dwordx8 s[16:23], s[0:1], 40
    s_load_dwordx2 s[4:5], s[0:1], 96
    s_load_dwordx2 s[94:95], s[0:1], 88
    v_and_b32 v1, 63, v0
    v_lshrrev_b32 v3, 6, v0
    s_nop 0
    v_readfirstlane_b32 s7, v3
    s_and_b32 s3, s7, 3
    s_lshr_b32 s6, s7, 2
    s_and_b32 s84, s2, 7
    s_lshr_b32 s85, s2, 3
    s_lshr_b32 s86, s84, 2
    s_add_u32 s87, s84, 0
    s_and_b32 s87, s87, 3
    s_and_b32 s89, s85, 3
    s_lshl_b32 s87, s87, 3
    s_add_u32 s87, s87, s89
    s_lshl_b32 s89, s6, 2
    s_add_u32 s87, s87, s89
    s_lshr_b32 s88, s85, 2
    v_and_b32 v20, 15, v1
    v_lshrrev_b32 v21, 4, v1
    v_bfe_u32 v22, v1, 2, 2
    v_and_b32 v23, 3, v1
    s_lshl_b32 s57, s3, 12
    v_lshlrev_b32 v3, 1, v21
    v_xor_b32 v3, v20, v3
    v_lshlrev_b32 v3, 4, v3
    v_lshl_add_u32 v16, v21, 8, v3
    v_xor_b32 v17, 128, v16
    v_lshl_add_u32 v18, v21, 13, v3
    v_xor_b32 v19, 128, v18
    v_lshl_add_u32 v3, v21, 2, v22
    v_lshlrev_b32 v0, 8, v3
    v_lshl_add_u32 v0, v23, 3, v0
    v_and_b32 v3, 7, v3
    s_lshl_b32 s92, s6, 13
    s_add_u32 s92, s92, 70656
    v_add_u32 v0, s92, v0
    s_lshl_b32 s90, s3, 1
    s_add_u32 s91, s90, 0
    s_and_b32 s91, s91, 7
    v_xor_b32 v4, s91, v3
    v_lshl_add_u32 v4, v4, 5, v0
    s_add_u32 s91, s90, 1
    s_and_b32 s91, s91, 7
    v_xor_b32 v5, s91, v3
    v_lshl_add_u32 v5, v5, 5, v0
    s_add_u32 s91, s90, 2
    s_and_b32 s91, s91, 7
    v_xor_b32 v6, s91, v3
    v_lshl_add_u32 v6, v6, 5, v0
    s_add_u32 s91, s90, 3
    s_and_b32 s91, s91, 7
    v_xor_b32 v7, s91, v3
    v_lshl_add_u32 v7, v7, 5, v0
    s_add_u32 s91, s90, 4
    s_and_b32 s91, s91, 7
    v_xor_b32 v8, s91, v3
    v_lshl_add_u32 v8, v8, 5, v0
    s_add_u32 s91, s90, 5
    s_and_b32 s91, s91, 7
    v_xor_b32 v9, s91, v3
    v_lshl_add_u32 v9, v9, 5, v0
    s_add_u32 s91, s90, 6
    s_and_b32 s91, s91, 7
    v_xor_b32 v10, s91, v3
    v_lshl_add_u32 v10, v10, 5, v0
    s_add_u32 s91, s90, 7
    s_and_b32 s91, s91, 7
    v_xor_b32 v11, s91, v3
    v_lshl_add_u32 v11, v11, 5, v0
    v_lshrrev_b32 v3, 5, v1
    v_lshlrev_b32 v3, 1, v3
    v_xor_b32 v3, v23, v3
    v_lshlrev_b32 v3, 4, v3
    v_lshrrev_b32 v0, 2, v1
    v_mul_u32_u24 v0, 1280, v0
    v_add_u32 v22, v0, v3
    v_lshrrev_b32 v3, 3, v20
    v_lshlrev_b32 v3, 1, v3
    v_xor_b32 v3, v21, v3
    v_lshlrev_b32 v3, 4, v3
    v_lshl_add_u32 v3, v20, 6, v3
    s_lshl_b32 s90, s3, 11
    s_add_u32 s90, s90, 61440
    v_add_u32 v12, s90, v3
    v_add_u32 v13, 69632, v3
    s_mul_i32 s65, s7, 20480
    s_lshl_b32 s66, s7, 10
    s_and_b32 s90, s3, 1
    s_lshl_b32 s90, s90, 17
    s_lshr_b32 s91, s3, 1
    s_lshl_b32 s91, s91, 15
    s_add_u32 s56, s90, s91
    s_lshl_b32 s67, s6, 13
    s_lshl_b32 s90, s3, 11
    s_add_u32 s67, s67, s90
    s_mul_i32 s90, s88, 5
    s_lshr_b32 s90, s90, 1
    s_and_b32 s91, s85, 3
    s_mul_i32 s91, s91, 5
    s_add_u32 s54, s90, s91
    s_cmp_ge_u32 s54, 20
    s_cselect_b32 s90, 20, 0
    s_sub_u32 s54, s54, s90
    s_lshl_b32 s55, s54, 6
    s_add_u32 s55, s55, s65
    s_lshl_b32 s46, s54, 18
    s_add_u32 s46, s46, s56
    s_add_u32 s54, s56, 5242880
    s_mov_b32 s50, 0x3e0293ee
    s_mov_b32 s52, 0x40004000
    s_waitcnt lgkmcnt(0)
    s_cmp_eq_u32 s86, 0
    s_cselect_b32 s8, s8, s16
    s_cselect_b32 s9, s9, s17
    s_cselect_b32 s10, s10, s18
    s_cselect_b32 s11, s11, s19
    s_cselect_b32 s12, s12, s20
    s_cselect_b32 s13, s13, s21
    s_cselect_b32 s14, s14, s22
    s_cselect_b32 s15, s15, s23
    s_mul_i32 s90, s88, 184320
    s_add_u32 s24, s8, s90
    s_addc_u32 s25, s9, 0
    s_mov_b32 s26, 184320
    s_mov_b32 s27, 0x20000
    s_lshl_b32 s90, s87, 8
    s_add_u32 s28, s14, s90
    s_addc_u32 s29, s15, 0
    s_sub_u32 s30, 5242880, s90
    s_mov_b32 s31, 0x20000
    s_lshl_b32 s90, s6, 10
    s_sub_u32 s16, s28, s90
    s_subb_u32 s17, s29, 0
    s_add_u32 s18, s30, s90
    s_mov_b32 s19, 0x20000
    s_lshl_b32 s90, s88, 5
    s_add_u32 s90, s90, s87
    s_lshl_b32 s91, s90, 17
    s_add_u32 s32, s10, s91
    s_addc_u32 s33, s11, 0
    s_mov_b32 s34, 131072
    s_mov_b32 s35, 0x20000
    s_add_u32 s36, s12, s91
    s_addc_u32 s37, s13, 0
    s_mov_b32 s38, 131072
    s_mov_b32 s39, 0x20000
    s_add_u32 s60, s32, 524288
    s_addc_u32 s61, s33, 0
    s_add_u32 s62, s36, 524288
    s_addc_u32 s63, s37, 0
    s_mov_b32 s64, 0
    s_lshl_b32 s91, s86, 8
    s_add_u32 s90, s90, s91
    s_mul_i32 s90, s90, 36864
    s_add_u32 s40, s4, s90
    s_addc_u32 s41, s5, 0
    s_mov_b32 s42, 36864
    s_mov_b32 s43, 0x20000
    s_lshl_b32 s90, s6, 19
    s_sub_u32 s8, s32, s90
    s_subb_u32 s9, s33, 0
    s_mov_b32 s10, 131072
    s_mov_b32 s11, 0x20000
    s_sub_u32 s12, s36, s90
    s_subb_u32 s13, s37, 0
    s_mov_b32 s14, 131072
    s_mov_b32 s15, 0x20000
    s_lshl_b32 s20, s7, 11
    s_mov_b32 s22, s94
    s_mov_b32 s23, s95
    s_mov_b32 s21, 0
    s_cmp_eq_u32 s7, 0
    s_cselect_b64 vcc, -1, 0
    s_cbranch_vccz LX0ai
    s_mov_b32 m0, 69632
    s_add_u32 s48, s55, 163840
    buffer_load_dwordx4 v22, s[24:27], s48 offen lds
LX0ai:
    s_add_u32 m0, s66, 61440
    s_add_u32 s48, s46, 65536
    buffer_load_dwordx4 v22, s[24:27], s55 offen lds
    s_add_u32 m0, s67, 70656
    s_add_u32 s55, s55, 64
    buffer_load_dwordx4 v18, s[28:31], s46 offen lds
    s_add_u32 m0, s67, 71680
    s_add_u32 s46, s46, 262144
    buffer_load_dwordx4 v19, s[28:31], s48 offen lds
    s_cmp_eq_u32 s46, s54
    s_cselect_b32 s46, s56, s46
    s_cselect_b32 s55, s65, s55
    s_cbranch_vccz LX1ai
    s_mov_b32 m0, 95232
    s_add_u32 s48, s55, 163840
    buffer_load_dwordx4 v22, s[24:27], s48 offen lds
LX1ai:
    s_add_u32 m0, s66, 87040
    s_add_u32 s48, s46, 65536
    buffer_load_dwordx4 v22, s[24:27], s55 offen lds
    s_add_u32 m0, s67, 96256
    s_add_u32 s55, s55, 64
    buffer_load_dwordx4 v18, s[28:31], s46 offen lds
    s_add_u32 m0, s67, 97280
    s_add_u32 s46, s46, 262144
    buffer_load_dwordx4 v19, s[28:31], s48 offen lds
    s_cmp_eq_u32 s46, s54
    s_cselect_b32 s46, s56, s46
    s_cselect_b32 s55, s65, s55
    s_cbranch_vccz LX2ai
    s_mov_b32 m0, 120832
    s_add_u32 s48, s55, 163840
    buffer_load_dwordx4 v22, s[24:27], s48 offen lds
LX2ai:
    s_add_u32 m0, s66, 112640
    s_add_u32 s48, s46, 65536
    buffer_load_dwordx4 v22, s[24:27], s55 offen lds
    s_add_u32 m0, s67, 121856
    s_add_u32 s55, s55, 64
    buffer_load_dwordx4 v18, s[28:31], s46 offen lds
    s_add_u32 m0, s67, 122880
    s_add_u32 s46, s46, 262144
    buffer_load_dwordx4 v19, s[28:31], s48 offen lds
    s_cmp_eq_u32 s46, s54
    s_cselect_b32 s46, s56, s46
    s_cselect_b32 s55, s65, s55
    s_cbranch_vccz LX3ai
    s_mov_b32 m0, 146432
    s_add_u32 s48, s55, 163840
    buffer_load_dwordx4 v22, s[24:27], s48 offen lds
LX3ai:
    s_add_u32 m0, s66, 138240
    s_add_u32 s48, s46, 65536
    buffer_load_dwordx4 v22, s[24:27], s55 offen lds
    s_add_u32 m0, s67, 147456
    s_add_u32 s55, s55, 64
    buffer_load_dwordx4 v18, s[28:31], s46 offen lds
    s_add_u32 m0, s67, 148480
    s_add_u32 s46, s46, 262144
    buffer_load_dwordx4 v19, s[28:31], s48 offen lds
    s_cmp_eq_u32 s46, s54
    s_cselect_b32 s46, s56, s46
    s_cselect_b32 s55, s65, s55
    v_mov_b32 v24, 0
    v_mov_b32 v25, 0
    v_mov_b32 v26, 0
    v_mov_b32 v27, 0
    v_mov_b32 v28, 0
    v_mov_b32 v29, 0
    v_mov_b32 v30, 0
    v_mov_b32 v31, 0
    v_mov_b32 v32, 0
    v_mov_b32 v33, 0
    v_mov_b32 v34, 0
    v_mov_b32 v35, 0
    v_mov_b32 v36, 0
    v_mov_b32 v37, 0
    v_mov_b32 v38, 0
    v_mov_b32 v39, 0
    v_mov_b32 v40, 0
    v_mov_b32 v41, 0
    v_mov_b32 v42, 0
    v_mov_b32 v43, 0
    v_mov_b32 v44, 0
    v_mov_b32 v45, 0
    v_mov_b32 v46, 0
    v_mov_b32 v47, 0
    v_mov_b32 v48, 0
    v_mov_b32 v49, 0
    v_mov_b32 v50, 0
    v_mov_b32 v51, 0
    v_mov_b32 v52, 0
    v_mov_b32 v53, 0
    v_mov_b32 v54, 0
    v_mov_b32 v55, 0
    v_mov_b32 v56, 0
    v_mov_b32 v57, 0
    v_mov_b32 v58, 0
    v_mov_b32 v59, 0
    v_mov_b32 v60, 0
    v_mov_b32 v61, 0
    v_mov_b32 v62, 0
    v_mov_b32 v63, 0
    v_mov_b32 v64, 0
    v_mov_b32 v65, 0
    v_mov_b32 v66, 0
    v_mov_b32 v67, 0
    v_mov_b32 v68, 0
    v_mov_b32 v69, 0
    v_mov_b32 v70, 0
    v_mov_b32 v71, 0
    v_mov_b32 v72, 0
    v_mov_b32 v73, 0
    v_mov_b32 v74, 0
    v_mov_b32 v75, 0
    v_mov_b32 v76, 0
    v_mov_b32 v77, 0
    v_mov_b32 v78, 0
    v_mov_b32 v79, 0
    v_mov_b32 v80, 0
    v_mov_b32 v81, 0
    v_mov_b32 v82, 0
    v_mov_b32 v83, 0
    v_mov_b32 v84, 0
    v_mov_b32 v85, 0
    v_mov_b32 v86, 0
    v_mov_b32 v87, 0
    v_mov_b32 v88, 0
    v_mov_b32 v89, 0
    v_mov_b32 v90, 0
    v_mov_b32 v91, 0
    v_mov_b32 v92, 0
    v_mov_b32 v93, 0
    v_mov_b32 v94, 0
    v_mov_b32 v95, 0
    v_accvgpr_write_b32 a24, 0
    v_accvgpr_write_b32 a25, 0
    v_accvgpr_write_b32 a26, 0
    v_accvgpr_write_b32 a27, 0
    v_accvgpr_write_b32 a28, 0
    v_accvgpr_write_b32 a29, 0
    v_accvgpr_write_b32 a30, 0
    v_accvgpr_write_b32 a31, 0
    v_accvgpr_write_b32 a32, 0
    v_accvgpr_write_b32 a33, 0
    v_accvgpr_write_b32 a34, 0
    v_accvgpr_write_b32 a35, 0
    v_accvgpr_write_b32 a36, 0
    v_accvgpr_write_b32 a37, 0
    v_accvgpr_write_b32 a38, 0
    v_accvgpr_write_b32 a39, 0
    v_accvgpr_write_b32 a40, 0
    v_accvgpr_write_b32 a41, 0
    v_accvgpr_write_b32 a42, 0
    v_accvgpr_write_b32 a43, 0
    v_accvgpr_write_b32 a44, 0
    v_accvgpr_write_b32 a45, 0
    v_accvgpr_write_b32 a46, 0
    v_accvgpr_write_b32 a47, 0
    v_accvgpr_write_b32 a48, 0
    v_accvgpr_write_b32 a49, 0
    v_accvgpr_write_b32 a50, 0
    v_accvgpr_write_b32 a51, 0
    v_accvgpr_write_b32 a52, 0
    v_accvgpr_write_b32 a53, 0
    v_accvgpr_write_b32 a54, 0
    v_accvgpr_write_b32 a55, 0
    v_accvgpr_write_b32 a56, 0
    v_accvgpr_write_b32 a57, 0
    v_accvgpr_write_b32 a58, 0
    v_accvgpr_write_b32 a59, 0
    v_accvgpr_write_b32 a60, 0
    v_accvgpr_write_b32 a61, 0
    v_accvgpr_write_b32 a62, 0
    v_accvgpr_write_b32 a63, 0
    v_accvgpr_write_b32 a64, 0
    v_accvgpr_write_b32 a65, 0
    v_accvgpr_write_b32 a66, 0
    v_accvgpr_write_b32 a67, 0
    v_accvgpr_write_b32 a68, 0
    v_accvgpr_write_b32 a69, 0
    v_accvgpr_write_b32 a70, 0
    v_accvgpr_write_b32 a71, 0
    v_accvgpr_write_b32 a72, 0
    v_accvgpr_write_b32 a73, 0
    v_accvgpr_write_b32 a74, 0
    v_accvgpr_write_b32 a75, 0
    v_accvgpr_write_b32 a76, 0
    v_accvgpr_write_b32 a77, 0
    v_accvgpr_write_b32 a78, 0
    v_accvgpr_write_b32 a79, 0
    v_accvgpr_write_b32 a80, 0
    v_accvgpr_write_b32 a81, 0
    v_accvgpr_write_b32 a82, 0
    v_accvgpr_write_b32 a83, 0
    v_accvgpr_write_b32 a84, 0
    v_accvgpr_write_b32 a85, 0
    v_accvgpr_write_b32 a86, 0
    v_accvgpr_write_b32 a87, 0
    v_accvgpr_write_b32 a88, 0
    v_accvgpr_write_b32 a89, 0
    v_accvgpr_write_b32 a90, 0
    v_accvgpr_write_b32 a91, 0
    v_accvgpr_write_b32 a92, 0
    v_accvgpr_write_b32 a93, 0
    v_accvgpr_write_b32 a94, 0
    v_accvgpr_write_b32 a95, 0
    v_accvgpr_write_b32 a96, 0
    v_accvgpr_write_b32 a97, 0
    v_accvgpr_write_b32 a98, 0
    v_accvgpr_write_b32 a99, 0
    v_accvgpr_write_b32 a100, 0
    v_accvgpr_write_b32 a101, 0
    v_accvgpr_write_b32 a102, 0
    v_accvgpr_write_b32 a103, 0
    v_accvgpr_write_b32 a104, 0
    v_accvgpr_write_b32 a105, 0
    v_accvgpr_write_b32 a106, 0
    v_accvgpr_write_b32 a107, 0
    v_mov_b32 v3, 0x3f803f80
    v_accvgpr_write_b32 a108, v3
    v_accvgpr_write_b32 a109, v3
    v_accvgpr_write_b32 a110, v3
    v_accvgpr_write_b32 a111, v3
    s_mov_b32 s44, 0
    s_waitcnt vmcnt(9)
    s_barrier
    ds_read_b128 a[0:3], v12 offset:0
    ds_read_b128 a[4:7], v12 offset:1024
    ds_read_b128 a[8:11], v13 offset:0
    ds_read_b64_tr_b16 a[120:121], v4 offset:0
    ds_read_b64_tr_b16 a[122:123], v4 offset:4096
    ds_read_b64_tr_b16 a[124:125], v5 offset:0
    ds_read_b64_tr_b16 a[126:127], v5 offset:4096
    ds_read_b64_tr_b16 a[128:129], v6 offset:0
    ds_read_b64_tr_b16 a[130:131], v6 offset:4096
    ds_read_b64_tr_b16 a[132:133], v7 offset:0
    ds_read_b64_tr_b16 a[134:135], v7 offset:4096
    ds_read_b64_tr_b16 a[136:137], v8 offset:0
    ds_read_b64_tr_b16 a[138:139], v8 offset:4096
    ds_read_b64_tr_b16 a[140:141], v9 offset:0
    ds_read_b64_tr_b16 a[142:143], v9 offset:4096
L_qp:
    s_waitcnt lgkmcnt(8)
    v_mfma_f32_16x16x32_bf16 v[24:27], a[120:123], a[0:3], v[24:27]
    ds_read_b64_tr_b16 a[144:145], v10 offset:0
    ds_read_b64_tr_b16 a[146:147], v10 offset:4096
    v_mfma_f32_16x16x32_bf16 v[28:31], a[120:123], a[4:7], v[28:31]
    v_mfma_f32_16x16x32_bf16 v[88:91], a[120:123], a[8:11], v[88:91]
    v_mfma_f32_16x16x32_bf16 v[32:35], a[124:127], a[0:3], v[32:35]
    ds_read_b64_tr_b16 a[148:149], v11 offset:0
    ds_read_b64_tr_b16 a[150:151], v11 offset:4096
    v_mfma_f32_16x16x32_bf16 v[36:39], a[124:127], a[4:7], v[36:39]
    v_mfma_f32_16x16x32_bf16 v[92:95], a[124:127], a[8:11], v[92:95]
    s_waitcnt lgkmcnt(8)
    v_mfma_f32_16x16x32_bf16 v[40:43], a[128:131], a[0:3], v[40:43]
    v_mfma_f32_16x16x32_bf16 v[44:47], a[128:131], a[4:7], v[44:47]
    v_mfma_f32_16x16x32_bf16 v[48:51], a[132:135], a[0:3], v[48:51]
    v_mfma_f32_16x16x32_bf16 v[52:55], a[132:135], a[4:7], v[52:55]
    s_waitcnt vmcnt(6) lgkmcnt(0)
    s_barrier
    v_mfma_f32_16x16x32_bf16 v[56:59], a[136:139], a[0:3], v[56:59]
    ds_read_b128 a[12:15], v12 offset:25600
    ds_read_b128 a[16:19], v12 offset:26624
    ds_read_b128 a[20:23], v13 offset:25600
    v_mfma_f32_16x16x32_bf16 v[60:63], a[136:139], a[4:7], v[60:63]
    ds_read_b64_tr_b16 a[120:121], v4 offset:25600
    ds_read_b64_tr_b16 a[122:123], v4 offset:29696
    v_add_u32 v4, 0xc800, v4
    v_mfma_f32_16x16x32_bf16 v[64:67], a[140:143], a[0:3], v[64:67]
    v_add_u32 v12, 0xc800, v12
    v_add_u32 v13, 0xc800, v13
    ds_read_b64_tr_b16 a[124:125], v5 offset:25600
    v_mfma_f32_16x16x32_bf16 v[68:71], a[140:143], a[4:7], v[68:71]
    ds_read_b64_tr_b16 a[126:127], v5 offset:29696
    v_add_u32 v5, 0xc800, v5
    ds_read_b64_tr_b16 a[128:129], v6 offset:25600
    v_mfma_f32_16x16x32_bf16 v[72:75], a[144:147], a[0:3], v[72:75]
    ds_read_b64_tr_b16 a[130:131], v6 offset:29696
    v_add_u32 v6, 0xc800, v6
    s_cbranch_vccz LX0al
    s_mov_b32 m0, 69632
    s_add_u32 s48, s55, 163840
    buffer_load_dwordx4 v22, s[24:27], s48 offen lds
LX0al:
    v_mfma_f32_16x16x32_bf16 v[76:79], a[144:147], a[4:7], v[76:79]
    ds_read_b64_tr_b16 a[132:133], v7 offset:25600
    ds_read_b64_tr_b16 a[134:135], v7 offset:29696
    v_mfma_f32_16x16x32_bf16 v[80:83], a[148:151], a[0:3], v[80:83]
    v_add_u32 v7, 0xc800, v7
    s_add_u32 m0, s66, 61440
    s_add_u32 s48, s46, 65536
    buffer_load_dwordx4 v22, s[24:27], s55 offen lds
    v_mfma_f32_16x16x32_bf16 v[84:87], a[148:151], a[4:7], v[84:87]
    ds_read_b64_tr_b16 a[136:137], v8 offset:25600
    ds_read_b64_tr_b16 a[138:139], v8 offset:29696
    s_waitcnt lgkmcnt(6)
    v_mfma_f32_16x16x32_bf16 v[24:27], a[120:123], a[12:15], v[24:27]
    v_add_u32 v8, 0xc800, v8
    s_add_u32 m0, s67, 70656
    s_add_u32 s55, s55, 64
    buffer_load_dwordx4 v18, s[28:31], s46 offen lds
    v_mfma_f32_16x16x32_bf16 v[28:31], a[120:123], a[16:19], v[28:31]
    ds_read_b64_tr_b16 a[140:141], v9 offset:25600
    ds_read_b64_tr_b16 a[142:143], v9 offset:29696
    v_mfma_f32_16x16x32_bf16 v[88:91], a[120:123], a[20:23], v[88:91]
    v_add_u32 v9, 0xc800, v9
    s_add_u32 m0, s67, 71680
    s_add_u32 s46, s46, 262144
    buffer_load_dwordx4 v19, s[28:31], s48 offen lds
    v_mfma_f32_16x16x32_bf16 v[32:35], a[124:127], a[12:15], v[32:35]
    ds_read_b64_tr_b16 a[144:145], v10 offset:25600
    ds_read_b64_tr_b16 a[146:147], v10 offset:29696
    v_mfma_f32_16x16x32_bf16 v[36:39], a[124:127], a[16:19], v[36:39]
    v_add_u32 v10, 0xc800, v10
    s_cmp_eq_u32 s46, s54
    s_cselect_b32 s46, s56, s46
    s_cselect_b32 s55, s65, s55
    v_mfma_f32_16x16x32_bf16 v[92:95], a[124:127], a[20:23], v[92:95]
    ds_read_b64_tr_b16 a[148:149], v11 offset:25600
    ds_read_b64_tr_b16 a[150:151], v11 offset:29696
    s_waitcnt lgkmcnt(8)
    v_mfma_f32_16x16x32_bf16 v[40:43], a[128:131], a[12:15], v[40:43]
    v_add_u32 v11, 0xc800, v11
    s_cmp_lg_u32 s44, 1
    s_cbranch_scc1 L_trk0
    s_add_u32 m0, s20, 0
    s_add_u32 s48, s20, 0
    buffer_load_dwordx4 v16, s[8:11], s48 offen nt lds
    s_add_u32 m0, s20, 1024
    s_add_u32 s48, s20, 1024
    buffer_load_dwordx4 v17, s[8:11], s48 offen nt lds
L_trk0:
    v_mfma_f32_16x16x32_bf16 v[44:47], a[128:131], a[16:19], v[44:47]
    s_cmp_lg_u32 s44, 2
    s_cbranch_scc1 L_trk2
    s_add_u32 m0, s20, 32768
    s_add_u32 s48, s20, 16384
    buffer_load_dwordx4 v16, s[8:11], s48 offen nt lds
    s_add_u32 m0, s20, 33792
    s_add_u32 s48, s20, 17408
    buffer_load_dwordx4 v17, s[8:11], s48 offen nt lds
L_trk2:
    v_mfma_f32_16x16x32_bf16 v[48:51], a[132:135], a[12:15], v[48:51]
    v_mfma_f32_16x16x32_bf16 v[52:55], a[132:135], a[16:19], v[52:55]
    s_waitcnt vmcnt(6) lgkmcnt(0)
    s_barrier
    v_mfma_f32_16x16x32_bf16 v[56:59], a[136:139], a[12:15], v[56:59]
    ds_read_b128 a[0:3], v12 offset:0
    ds_read_b128 a[4:7], v12 offset:1024
    v_mfma_f32_16x16x32_bf16 v[60:63], a[136:139], a[16:19], v[60:63]
    ds_read_b128 a[8:11], v13 offset:0
    ds_read_b64_tr_b16 a[120:121], v4 offset:0
    v_mfma_f32_16x16x32_bf16 v[64:67], a[140:143], a[12:15], v[64:67]
    ds_read_b64_tr_b16 a[122:123], v4 offset:4096
    ds_read_b64_tr_b16 a[124:125], v5 offset:0
    ds_read_b64_tr_b16 a[126:127], v5 offset:4096
    v_mfma_f32_16x16x32_bf16 v[68:71], a[140:143], a[16:19], v[68:71]
    ds_read_b64_tr_b16 a[128:129], v6 offset:0
    ds_read_b64_tr_b16 a[130:131], v6 offset:4096
    v_mfma_f32_16x16x32_bf16 v[72:75], a[144:147], a[12:15], v[72:75]
    s_cbranch_vccz LX1al
    s_mov_b32 m0, 95232
    s_add_u32 s48, s55, 163840
    buffer_load_dwordx4 v22, s[24:27], s48 offen lds
LX1al:
    v_mfma_f32_16x16x32_bf16 v[76:79], a[144:147], a[16:19], v[76:79]
    ds_read_b64_tr_b16 a[132:133], v7 offset:0
    ds_read_b64_tr_b16 a[134:135], v7 offset:4096
    v_mfma_f32_16x16x32_bf16 v[80:83], a[148:151], a[12:15], v[80:83]
    s_add_u32 m0, s66, 87040
    s_add_u32 s48, s46, 65536
    buffer_load_dwordx4 v22, s[24:27], s55 offen lds
    v_mfma_f32_16x16x32_bf16 v[84:87], a[148:151], a[16:19], v[84:87]
    ds_read_b64_tr_b16 a[136:137], v8 offset:0
    ds_read_b64_tr_b16 a[138:139], v8 offset:4096
    s_waitcnt lgkmcnt(6)
    v_mfma_f32_16x16x32_bf16 v[24:27], a[120:123], a[0:3], v[24:27]
    s_add_u32 m0, s67, 96256
    s_add_u32 s55, s55, 64
    buffer_load_dwordx4 v18, s[28:31], s46 offen lds
    v_mfma_f32_16x16x32_bf16 v[28:31], a[120:123], a[4:7], v[28:31]
    ds_read_b64_tr_b16 a[140:141], v9 offset:0
    ds_read_b64_tr_b16 a[142:143], v9 offset:4096
    v_mfma_f32_16x16x32_bf16 v[88:91], a[120:123], a[8:11], v[88:91]
    s_add_u32 m0, s67, 97280
    s_add_u32 s46, s46, 262144
    buffer_load_dwordx4 v19, s[28:31], s48 offen lds
    v_mfma_f32_16x16x32_bf16 v[32:35], a[124:127], a[0:3], v[32:35]
    ds_read_b64_tr_b16 a[144:145], v10 offset:0
    ds_read_b64_tr_b16 a[146:147], v10 offset:4096
    v_mfma_f32_16x16x32_bf16 v[36:39], a[124:127], a[4:7], v[36:39]
    s_cmp_eq_u32 s46, s54
    s_cselect_b32 s46, s56, s46
    s_cselect_b32 s55, s65, s55
    v_mfma_f32_16x16x32_bf16 v[92:95], a[124:127], a[8:11], v[92:95]
    ds_read_b64_tr_b16 a[148:149], v11 offset:0
    ds_read_b64_tr_b16 a[150:151], v11 offset:4096
    s_waitcnt lgkmcnt(8)
    v_mfma_f32_16x16x32_bf16 v[40:43], a[128:131], a[0:3], v[40:43]
    v_mfma_f32_16x16x32_bf16 v[44:47], a[128:131], a[4:7], v[44:47]
    v_mfma_f32_16x16x32_bf16 v[48:51], a[132:135], a[0:3], v[48:51]
    v_mfma_f32_16x16x32_bf16 v[52:55], a[132:135], a[4:7], v[52:55]
    s_waitcnt vmcnt(6) lgkmcnt(0)
    s_barrier
    v_mfma_f32_16x16x32_bf16 v[56:59], a[136:139], a[0:3], v[56:59]
    ds_read_b128 a[12:15], v12 offset:25600
    ds_read_b128 a[16:19], v12 offset:26624
    ds_read_b128 a[20:23], v13 offset:25600
    v_mfma_f32_16x16x32_bf16 v[60:63], a[136:139], a[4:7], v[60:63]
    ds_read_b64_tr_b16 a[120:121], v4 offset:25600
    ds_read_b64_tr_b16 a[122:123], v4 offset:29696
    v_add_u32 v4, 0xffff3800, v4
    v_mfma_f32_16x16x32_bf16 v[64:67], a[140:143], a[0:3], v[64:67]
    v_add_u32 v12, 0xffff3800, v12
    v_add_u32 v13, 0xffff3800, v13
    ds_read_b64_tr_b16 a[124:125], v5 offset:25600
    v_mfma_f32_16x16x32_bf16 v[68:71], a[140:143], a[4:7], v[68:71]
    ds_read_b64_tr_b16 a[126:127], v5 offset:29696
    v_add_u32 v5, 0xffff3800, v5
    ds_read_b64_tr_b16 a[128:129], v6 offset:25600
    v_mfma_f32_16x16x32_bf16 v[72:75], a[144:147], a[0:3], v[72:75]
    ds_read_b64_tr_b16 a[130:131], v6 offset:29696
    v_add_u32 v6, 0xffff3800, v6
    s_cbranch_vccz LX2al
    s_mov_b32 m0, 120832
    s_add_u32 s48, s55, 163840
    buffer_load_dwordx4 v22, s[24:27], s48 offen lds
LX2al:
    v_mfma_f32_16x16x32_bf16 v[76:79], a[144:147], a[4:7], v[76:79]
    ds_read_b64_tr_b16 a[132:133], v7 offset:25600
    ds_read_b64_tr_b16 a[134:135], v7 offset:29696
    v_mfma_f32_16x16x32_bf16 v[80:83], a[148:151], a[0:3], v[80:83]
    v_add_u32 v7, 0xffff3800, v7
    s_add_u32 m0, s66, 112640
    s_add_u32 s48, s46, 65536
    buffer_load_dwordx4 v22, s[24:27], s55 offen lds
    v_mfma_f32_16x16x32_bf16 v[84:87], a[148:151], a[4:7], v[84:87]
    ds_read_b64_tr_b16 a[136:137], v8 offset:25600
    ds_read_b64_tr_b16 a[138:139], v8 offset:29696
    s_waitcnt lgkmcnt(6)
    v_mfma_f32_16x16x32_bf16 v[24:27], a[120:123], a[12:15], v[24:27]
    v_add_u32 v8, 0xffff3800, v8
    s_add_u32 m0, s67, 121856
    s_add_u32 s55, s55, 64
    buffer_load_dwordx4 v18, s[28:31], s46 offen lds
    v_mfma_f32_16x16x32_bf16 v[28:31], a[120:123], a[16:19], v[28:31]
    ds_read_b64_tr_b16 a[140:141], v9 offset:25600
    ds_read_b64_tr_b16 a[142:143], v9 offset:29696
    v_mfma_f32_16x16x32_bf16 v[88:91], a[120:123], a[20:23], v[88:91]
    v_add_u32 v9, 0xffff3800, v9
    s_add_u32 m0, s67, 122880
    s_add_u32 s46, s46, 262144
    buffer_load_dwordx4 v19, s[28:31], s48 offen lds
    v_mfma_f32_16x16x32_bf16 v[32:35], a[124:127], a[12:15], v[32:35]
    ds_read_b64_tr_b16 a[144:145], v10 offset:25600
    ds_read_b64_tr_b16 a[146:147], v10 offset:29696
    v_mfma_f32_16x16x32_bf16 v[36:39], a[124:127], a[16:19], v[36:39]
    v_add_u32 v10, 0xffff3800, v10
    s_cmp_eq_u32 s46, s54
    s_cselect_b32 s46, s56, s46
    s_cselect_b32 s55, s65, s55
    v_mfma_f32_16x16x32_bf16 v[92:95], a[124:127], a[20:23], v[92:95]
    ds_read_b64_tr_b16 a[148:149], v11 offset:25600
    ds_read_b64_tr_b16 a[150:151], v11 offset:29696
    s_waitcnt lgkmcnt(8)
    v_mfma_f32_16x16x32_bf16 v[40:43], a[128:131], a[12:15], v[40:43]
    v_add_u32 v11, 0xffff3800, v11
    s_cmp_lg_u32 s44, 1
    s_cbranch_scc1 L_trk1
    s_add_u32 m0, s20, 16384
    s_add_u32 s48, s20, 0
    buffer_load_dwordx4 v16, s[12:15], s48 offen nt lds
    s_add_u32 m0, s20, 17408
    s_add_u32 s48, s20, 1024
    buffer_load_dwordx4 v17, s[12:15], s48 offen nt lds
L_trk1:
    v_mfma_f32_16x16x32_bf16 v[44:47], a[128:131], a[16:19], v[44:47]
    v_mfma_f32_16x16x32_bf16 v[48:51], a[132:135], a[12:15], v[48:51]
    v_mfma_f32_16x16x32_bf16 v[52:55], a[132:135], a[16:19], v[52:55]
    s_waitcnt vmcnt(6) lgkmcnt(0)
    s_barrier
    v_mfma_f32_16x16x32_bf16 v[56:59], a[136:139], a[12:15], v[56:59]
    ds_read_b128 a[0:3], v12 offset:0
    ds_read_b128 a[4:7], v12 offset:1024
    v_mfma_f32_16x16x32_bf16 v[60:63], a[136:139], a[16:19], v[60:63]
    ds_read_b128 a[8:11], v13 offset:0
    ds_read_b64_tr_b16 a[120:121], v4 offset:0
    v_mfma_f32_16x16x32_bf16 v[64:67], a[140:143], a[12:15], v[64:67]
    ds_read_b64_tr_b16 a[122:123], v4 offset:4096
    ds_read_b64_tr_b16 a[124:125], v5 offset:0
    ds_read_b64_tr_b16 a[126:127], v5 offset:4096
    v_mfma_f32_16x16x32_bf16 v[68:71], a[140:143], a[16:19], v[68:71]
    ds_read_b64_tr_b16 a[128:129], v6 offset:0
    ds_read_b64_tr_b16 a[130:131], v6 offset:4096
    s_cbranch_vccz LX3al
    s_mov_b32 m0, 146432
    s_add_u32 s48, s55, 163840
    buffer_load_dwordx4 v22, s[24:27], s48 offen lds
LX3al:
    v_mfma_f32_16x16x32_bf16 v[72:75], a[144:147], a[12:15], v[72:75]
    ds_read_b64_tr_b16 a[132:133], v7 offset:0
    ds_read_b64_tr_b16 a[134:135], v7 offset:4096
    s_add_u32 m0, s66, 138240
    s_add_u32 s48, s46, 65536
    buffer_load_dwordx4 v22, s[24:27], s55 offen lds
    v_mfma_f32_16x16x32_bf16 v[76:79], a[144:147], a[16:19], v[76:79]
    ds_read_b64_tr_b16 a[136:137], v8 offset:0
    ds_read_b64_tr_b16 a[138:139], v8 offset:4096
    s_add_u32 m0, s67, 147456
    s_add_u32 s55, s55, 64
    buffer_load_dwordx4 v18, s[28:31], s46 offen lds
    v_mfma_f32_16x16x32_bf16 v[80:83], a[148:151], a[12:15], v[80:83]
    ds_read_b64_tr_b16 a[140:141], v9 offset:0
    ds_read_b64_tr_b16 a[142:143], v9 offset:4096
    s_add_u32 m0, s67, 148480
    s_add_u32 s46, s46, 262144
    buffer_load_dwordx4 v19, s[28:31], s48 offen lds
    v_mfma_f32_16x16x32_bf16 v[84:87], a[148:151], a[16:19], v[84:87]
    s_cmp_eq_u32 s46, s54
    s_cselect_b32 s46, s56, s46
    s_cselect_b32 s55, s65, s55
    s_add_u32 s44, s44, 1
    s_cmp_lt_u32 s44, 4
    s_cbranch_scc1 L_qp
    s_waitcnt lgkmcnt(8)
    v_mfma_f32_16x16x32_bf16 v[24:27], a[120:123], a[0:3], v[24:27]
    ds_read_b64_tr_b16 a[144:145], v10 offset:0
    ds_read_b64_tr_b16 a[146:147], v10 offset:4096
    v_mfma_f32_16x16x32_bf16 v[28:31], a[120:123], a[4:7], v[28:31]
    v_mfma_f32_16x16x32_bf16 v[88:91], a[120:123], a[8:11], v[88:91]
    v_mfma_f32_16x16x32_bf16 v[32:35], a[124:127], a[0:3], v[32:35]
    ds_read_b64_tr_b16 a[148:149], v11 offset:0
    ds_read_b64_tr_b16 a[150:151], v11 offset:4096
    v_mfma_f32_16x16x32_bf16 v[36:39], a[124:127], a[4:7], v[36:39]
    v_mfma_f32_16x16x32_bf16 v[92:95], a[124:127], a[8:11], v[92:95]
    s_waitcnt lgkmcnt(8)
    v_mfma_f32_16x16x32_bf16 v[40:43], a[128:131], a[0:3], v[40:43]
    v_mfma_f32_16x16x32_bf16 v[44:47], a[128:131], a[4:7], v[44:47]
    v_mfma_f32_16x16x32_bf16 v[48:51], a[132:135], a[0:3], v[48:51]
    v_mfma_f32_16x16x32_bf16 v[52:55], a[132:135], a[4:7], v[52:55]
    s_waitcnt vmcnt(6) lgkmcnt(0)
    s_barrier
    v_mfma_f32_16x16x32_bf16 v[56:59], a[136:139], a[0:3], v[56:59]
    ds_read_b128 a[12:15], v12 offset:25600
    ds_read_b128 a[16:19], v12 offset:26624
    ds_read_b128 a[20:23], v13 offset:25600
    v_mfma_f32_16x16x32_bf16 v[60:63], a[136:139], a[4:7], v[60:63]
    ds_read_b64_tr_b16 a[120:121], v4 offset:25600
    ds_read_b64_tr_b16 a[122:123], v4 offset:29696
    v_mfma_f32_16x16x32_bf16 v[64:67], a[140:143], a[0:3], v[64:67]
    v_add_u32 v4, 0xc800, v4
    v_add_u32 v12, 0xc800, v12
    v_mfma_f32_16x16x32_bf16 v[68:71], a[140:143], a[4:7], v[68:71]
    v_add_u32 v13, 0xc800, v13
    ds_read_b64_tr_b16 a[124:125], v5 offset:25600
    v_mfma_f32_16x16x32_bf16 v[72:75], a[144:147], a[0:3], v[72:75]
    ds_read_b64_tr_b16 a[126:127], v5 offset:29696
    v_add_u32 v5, 0xc800, v5
    v_mfma_f32_16x16x32_bf16 v[76:79], a[144:147], a[4:7], v[76:79]
    ds_read_b64_tr_b16 a[128:129], v6 offset:25600
    ds_read_b64_tr_b16 a[130:131], v6 offset:29696
    v_mfma_f32_16x16x32_bf16 v[80:83], a[148:151], a[0:3], v[80:83]
    v_add_u32 v6, 0xc800, v6
    ds_read_b64_tr_b16 a[132:133], v7 offset:25600
    v_mfma_f32_16x16x32_bf16 v[84:87], a[148:151], a[4:7], v[84:87]
    ds_read_b64_tr_b16 a[134:135], v7 offset:29696
    v_add_u32 v7, 0xc800, v7
    s_waitcnt lgkmcnt(4)
    v_mfma_f32_16x16x32_bf16 v[24:27], a[120:123], a[12:15], v[24:27]
    ds_read_b64_tr_b16 a[136:137], v8 offset:25600
    ds_read_b64_tr_b16 a[138:139], v8 offset:29696
    v_mfma_f32_16x16x32_bf16 v[28:31], a[120:123], a[16:19], v[28:31]
    v_add_u32 v8, 0xc800, v8
    ds_read_b64_tr_b16 a[140:141], v9 offset:25600
    v_mfma_f32_16x16x32_bf16 v[88:91], a[120:123], a[20:23], v[88:91]
    ds_read_b64_tr_b16 a[142:143], v9 offset:29696
    v_add_u32 v9, 0xc800, v9
    v_mfma_f32_16x16x32_bf16 v[32:35], a[124:127], a[12:15], v[32:35]
    ds_read_b64_tr_b16 a[144:145], v10 offset:25600
    ds_read_b64_tr_b16 a[146:147], v10 offset:29696
    v_mfma_f32_16x16x32_bf16 v[36:39], a[124:127], a[16:19], v[36:39]
    v_add_u32 v10, 0xc800, v10
    ds_read_b64_tr_b16 a[148:149], v11 offset:25600
    v_mfma_f32_16x16x32_bf16 v[92:95], a[124:127], a[20:23], v[92:95]
    ds_read_b64_tr_b16 a[150:151], v11 offset:29696
    v_add_u32 v11, 0xc800, v11
    s_waitcnt lgkmcnt(8)
    v_mfma_f32_16x16x32_bf16 v[40:43], a[128:131], a[12:15], v[40:43]
    v_mfma_f32_16x16x32_bf16 v[44:47], a[128:131], a[16:19], v[44:47]
    v_mfma_f32_16x16x32_bf16 v[48:51], a[132:135], a[12:15], v[48:51]
    v_mfma_f32_16x16x32_bf16 v[52:55], a[132:135], a[16:19], v[52:55]
    s_waitcnt vmcnt(3) lgkmcnt(0)
    s_barrier
    v_mfma_f32_16x16x32_bf16 v[56:59], a[136:139], a[12:15], v[56:59]
    ds_read_b128 a[0:3], v12 offset:0
    ds_read_b128 a[4:7], v12 offset:1024
    ds_read_b128 a[8:11], v13 offset:0
    ds_read_b64_tr_b16 a[120:121], v4 offset:0
    v_mfma_f32_16x16x32_bf16 v[60:63], a[136:139], a[16:19], v[60:63]
    ds_read_b64_tr_b16 a[122:123], v4 offset:4096
    ds_read_b64_tr_b16 a[124:125], v5 offset:0
    ds_read_b64_tr_b16 a[126:127], v5 offset:4096
    v_mfma_f32_16x16x32_bf16 v[64:67], a[140:143], a[12:15], v[64:67]
    ds_read_b64_tr_b16 a[128:129], v6 offset:0
    ds_read_b64_tr_b16 a[130:131], v6 offset:4096
    s_cmp_eq_u32 s6, 0
    s_cbranch_scc1 L_kvB
    s_add_u32 m0, s57, 49152
    s_add_u32 s48, s57, 16384
    buffer_load_dwordx4 v16, s[12:15], s48 offen offset:0 nt lds
    buffer_load_dwordx4 v17, s[12:15], s48 offen offset:1024 nt lds
    buffer_load_dwordx4 v16, s[12:15], s48 offen offset:2048 nt lds
    buffer_load_dwordx4 v17, s[12:15], s48 offen offset:3072 nt lds
    s_add_u32 m0, s57, 65536
    s_add_u32 s48, s57, 32768
    buffer_load_dwordx4 v16, s[8:11], s48 offen offset:0 nt lds
    buffer_load_dwordx4 v17, s[8:11], s48 offen offset:1024 nt lds
    buffer_load_dwordx4 v16, s[8:11], s48 offen offset:2048 nt lds
    buffer_load_dwordx4 v17, s[8:11], s48 offen offset:3072 nt lds
    s_add_u32 m0, s57, 81920
    s_add_u32 s48, s57, 32768
    buffer_load_dwordx4 v16, s[12:15], s48 offen offset:0 nt lds
    buffer_load_dwordx4 v17, s[12:15], s48 offen offset:1024 nt lds
    buffer_load_dwordx4 v16, s[12:15], s48 offen offset:2048 nt lds
    buffer_load_dwordx4 v17, s[12:15], s48 offen offset:3072 nt lds
L_kvB:
    v_mfma_f32_16x16x32_bf16 v[68:71], a[140:143], a[16:19], v[68:71]
    ds_read_b64_tr_b16 a[132:133], v7 offset:0
    ds_read_b64_tr_b16 a[134:135], v7 offset:4096
    v_mfma_f32_16x16x32_bf16 v[72:75], a[144:147], a[12:15], v[72:75]
    ds_read_b64_tr_b16 a[136:137], v8 offset:0
    ds_read_b64_tr_b16 a[138:139], v8 offset:4096
    v_mfma_f32_16x16x32_bf16 v[76:79], a[144:147], a[16:19], v[76:79]
    v_mfma_f32_16x16x32_bf16 v[80:83], a[148:151], a[12:15], v[80:83]
    ds_read_b64_tr_b16 a[140:141], v9 offset:0
    ds_read_b64_tr_b16 a[142:143], v9 offset:4096
    v_mfma_f32_16x16x32_bf16 v[84:87], a[148:151], a[16:19], v[84:87]
    s_waitcnt lgkmcnt(8)
    v_mfma_f32_16x16x32_bf16 v[24:27], a[120:123], a[0:3], v[24:27]
    ds_read_b64_tr_b16 a[144:145], v10 offset:0
    ds_read_b64_tr_b16 a[146:147], v10 offset:4096
    v_mfma_f32_16x16x32_bf16 v[28:31], a[120:123], a[4:7], v[28:31]
    v_mfma_f32_16x16x32_bf16 v[88:91], a[120:123], a[8:11], v[88:91]
    v_mfma_f32_16x16x32_bf16 v[32:35], a[124:127], a[0:3], v[32:35]
    ds_read_b64_tr_b16 a[148:149], v11 offset:0
    ds_read_b64_tr_b16 a[150:151], v11 offset:4096
    v_mfma_f32_16x16x32_bf16 v[36:39], a[124:127], a[4:7], v[36:39]
    v_mfma_f32_16x16x32_bf16 v[92:95], a[124:127], a[8:11], v[92:95]
    s_waitcnt lgkmcnt(8)
    v_mfma_f32_16x16x32_bf16 v[40:43], a[128:131], a[0:3], v[40:43]
    v_mfma_f32_16x16x32_bf16 v[44:47], a[128:131], a[4:7], v[44:47]
    v_mfma_f32_16x16x32_bf16 v[48:51], a[132:135], a[0:3], v[48:51]
    v_mfma_f32_16x16x32_bf16 v[52:55], a[132:135], a[4:7], v[52:55]
    s_cmp_eq_u32 s6, 0
    s_cbranch_scc1 L_b2a
    s_waitcnt vmcnt(12)
    s_branch L_b2b
L_b2a:
    s_waitcnt vmcnt(0)
L_b2b:
    s_waitcnt lgkmcnt(0)
    s_barrier
    v_mfma_f32_16x16x32_bf16 v[56:59], a[136:139], a[0:3], v[56:59]
    ds_read_b128 a[12:15], v12 offset:25600
    ds_read_b128 a[16:19], v12 offset:26624
    v_mfma_f32_16x16x32_bf16 v[60:63], a[136:139], a[4:7], v[60:63]
    ds_read_b128 a[20:23], v13 offset:25600
    ds_read_b64_tr_b16 a[120:121], v4 offset:25600
    v_mfma_f32_16x16x32_bf16 v[64:67], a[140:143], a[0:3], v[64:67]
    ds_read_b64_tr_b16 a[122:123], v4 offset:29696
    ds_read_b64_tr_b16 a[124:125], v5 offset:25600
    v_mfma_f32_16x16x32_bf16 v[68:71], a[140:143], a[4:7], v[68:71]
    ds_read_b64_tr_b16 a[126:127], v5 offset:29696
    ds_read_b64_tr_b16 a[128:129], v6 offset:25600
    v_mfma_f32_16x16x32_bf16 v[72:75], a[144:147], a[0:3], v[72:75]
    ds_read_b64_tr_b16 a[130:131], v6 offset:29696
    ds_read_b64_tr_b16 a[132:133], v7 offset:25600
    v_mfma_f32_16x16x32_bf16 v[76:79], a[144:147], a[4:7], v[76:79]
    ds_read_b64_tr_b16 a[134:135], v7 offset:29696
    ds_read_b64_tr_b16 a[136:137], v8 offset:25600
    v_mfma_f32_16x16x32_bf16 v[80:83], a[148:151], a[0:3], v[80:83]
    ds_read_b64_tr_b16 a[138:139], v8 offset:29696
    ds_read_b64_tr_b16 a[140:141], v9 offset:25600
    v_mfma_f32_16x16x32_bf16 v[84:87], a[148:151], a[4:7], v[84:87]
    ds_read_b64_tr_b16 a[142:143], v9 offset:29696
    s_waitcnt lgkmcnt(8)
    v_mfma_f32_16x16x32_bf16 v[24:27], a[120:123], a[12:15], v[24:27]
    ds_read_b64_tr_b16 a[144:145], v10 offset:25600
    ds_read_b64_tr_b16 a[146:147], v10 offset:29696
    v_mfma_f32_16x16x32_bf16 v[28:31], a[120:123], a[16:19], v[28:31]
    v_mfma_f32_16x16x32_bf16 v[88:91], a[120:123], a[20:23], v[88:91]
    v_mfma_f32_16x16x32_bf16 v[32:35], a[124:127], a[12:15], v[32:35]
    ds_read_b64_tr_b16 a[148:149], v11 offset:25600
    ds_read_b64_tr_b16 a[150:151], v11 offset:29696
    v_mfma_f32_16x16x32_bf16 v[36:39], a[124:127], a[16:19], v[36:39]
    v_mfma_f32_16x16x32_bf16 v[92:95], a[124:127], a[20:23], v[92:95]
    s_waitcnt lgkmcnt(8)
    v_mfma_f32_16x16x32_bf16 v[40:43], a[128:131], a[12:15], v[40:43]
    v_mfma_f32_16x16x32_bf16 v[44:47], a[128:131], a[16:19], v[44:47]
    v_mfma_f32_16x16x32_bf16 v[48:51], a[132:135], a[12:15], v[48:51]
    v_mfma_f32_16x16x32_bf16 v[52:55], a[132:135], a[16:19], v[52:55]
    s_waitcnt lgkmcnt(4)
    v_mfma_f32_16x16x32_bf16 v[56:59], a[136:139], a[12:15], v[56:59]
    v_mfma_f32_16x16x32_bf16 v[60:63], a[136:139], a[16:19], v[60:63]
    v_mfma_f32_16x16x32_bf16 v[64:67], a[140:143], a[12:15], v[64:67]
    v_mfma_f32_16x16x32_bf16 v[68:71], a[140:143], a[16:19], v[68:71]
    s_waitcnt lgkmcnt(0)
    v_mfma_f32_16x16x32_bf16 v[72:75], a[144:147], a[12:15], v[72:75]
    v_mfma_f32_16x16x32_bf16 v[76:79], a[144:147], a[16:19], v[76:79]
    v_mfma_f32_16x16x32_bf16 v[80:83], a[148:151], a[12:15], v[80:83]
    v_mfma_f32_16x16x32_bf16 v[84:87], a[148:151], a[16:19], v[84:87]
    s_waitcnt lgkmcnt(0)
    s_barrier
    s_cmp_eq_u32 s6, 0
    s_cbranch_scc1 L_g0
    s_add_u32 m0, s57, 98304
    s_add_u32 s48, s57, 49152
    buffer_load_dwordx4 v16, s[8:11], s48 offen offset:0 nt lds
    buffer_load_dwordx4 v17, s[8:11], s48 offen offset:1024 nt lds
    buffer_load_dwordx4 v16, s[8:11], s48 offen offset:2048 nt lds
    buffer_load_dwordx4 v17, s[8:11], s48 offen offset:3072 nt lds
    s_add_u32 m0, s57, 114688
    s_add_u32 s48, s57, 49152
    buffer_load_dwordx4 v16, s[12:15], s48 offen offset:0 nt lds
    buffer_load_dwordx4 v17, s[12:15], s48 offen offset:1024 nt lds
    buffer_load_dwordx4 v16, s[12:15], s48 offen offset:2048 nt lds
    buffer_load_dwordx4 v17, s[12:15], s48 offen offset:3072 nt lds
    s_barrier
    s_and_b32 s84, s2, 7
    s_lshr_b32 s60, s2, 3
    s_lshr_b32 s62, s84, 2
    s_add_u32 s61, s84, 0
    s_and_b32 s61, s61, 3
    s_load_dwordx2 s[16:17], s[0:1], 32
    s_load_dwordx2 s[18:19], s[0:1], 72
    s_mul_i32 s63, s60, 52
    s_lshr_b32 s63, s63, 8
    s_mul_i32 s64, s63, 5
    s_sub_u32 s64, s60, s64
    s_waitcnt lgkmcnt(0)
    s_cmp_eq_u32 s62, 0
    s_cselect_b32 s16, s16, s18
    s_cselect_b32 s17, s17, s19
    s_mul_i32 s84, s61, 1310720
    s_lshl_b32 s85, s64, 8
    s_add_u32 s84, s84, s85
    s_add_u32 s24, s16, s84
    s_addc_u32 s25, s17, 0
    s_sub_u32 s26, 5242880, s84
    s_mov_b32 s27, 0x20000
    s_mov_b32 s28, s4
    s_mov_b32 s29, s5
    s_mov_b32 s30, 18874368
    s_mov_b32 s31, 0x20000
    s_mul_i32 s84, s63, 12
    s_mul_i32 s85, s3, 3
    s_add_u32 s84, s84, s85
    s_add_u32 s85, s84, 0
    s_mul_i32 s86, s85, 57
    s_lshr_b32 s86, s86, 9
    s_mul_i32 s87, s86, 9
    s_sub_u32 s87, s85, s87
    s_lshl_b32 s88, s62, 3
    s_add_u32 s88, s88, s86
    s_lshl_b32 s88, s88, 5
    s_lshl_b32 s89, s61, 3
    s_add_u32 s88, s88, s89
    s_mul_i32 s88, s88, 36864
    s_lshl_b32 s87, s87, 12
    s_add_u32 s96, s88, s87
    s_add_u32 s85, s84, 1
    s_mul_i32 s86, s85, 57
    s_lshr_b32 s86, s86, 9
    s_mul_i32 s87, s86, 9
    s_sub_u32 s87, s85, s87
    s_lshl_b32 s88, s62, 3
    s_add_u32 s88, s88, s86
    s_lshl_b32 s88, s88, 5
    s_lshl_b32 s89, s61, 3
    s_add_u32 s88, s88, s89
    s_mul_i32 s88, s88, 36864
    s_lshl_b32 s87, s87, 12
    s_add_u32 s97, s88, s87
    s_add_u32 s85, s84, 2
    s_mul_i32 s86, s85, 57
    s_lshr_b32 s86, s86, 9
    s_mul_i32 s87, s86, 9
    s_sub_u32 s87, s85, s87
    s_lshl_b32 s88, s62, 3
    s_add_u32 s88, s88, s86
    s_lshl_b32 s88, s88, 5
    s_lshl_b32 s89, s61, 3
    s_add_u32 s88, s88, s89
    s_mul_i32 s88, s88, 36864
    s_lshl_b32 s87, s87, 12
    s_add_u32 s98, s88, s87
    s_mul_i32 s59, s7, 10240
    s_mul_i32 s99, s63, 3
    s_add_u32 s99, s99, s64
    s_and_b32 s99, s99, 7
    v_pk_mul_f32 v[88:89], v[88:89], s[50:51] op_sel_hi:[1,0]
    v_pk_mul_f32 v[90:91], v[90:91], s[50:51] op_sel_hi:[1,0]
    v_pk_mul_f32 v[92:93], v[92:93], s[50:51] op_sel_hi:[1,0]
    v_pk_mul_f32 v[94:95], v[94:95], s[50:51] op_sel_hi:[1,0]
    v_cvt_pk_bf16_f32 v20, v88, v89
    v_cvt_pk_bf16_f32 v21, v90, v91
    v_cvt_pk_bf16_f32 v22, v92, v93
    v_cvt_pk_bf16_f32 v23, v94, v95
    s_nop 0
    v_permlane32_swap_b32 v20, v22
    v_permlane32_swap_b32 v21, v23
    s_nop 0
    v_permlane16_swap_b32 v20, v22
    v_permlane16_swap_b32 v21, v23
    v_lshlrev_b32 v0, 4, v1
    s_lshl_b32 s48, s7, 10
    s_add_u32 s48, s48, 131072
    v_add_u32 v3, s48, v0
    ds_write_b128 v3, v[20:23]
    v_pk_mul_f32 v[24:25], v[24:25], s[50:51] op_sel_hi:[1,0]
    v_pk_mul_f32 v[26:27], v[26:27], s[50:51] op_sel_hi:[1,0]
    v_pk_mul_f32 v[32:33], v[32:33], s[50:51] op_sel_hi:[1,0]
    v_pk_mul_f32 v[34:35], v[34:35], s[50:51] op_sel_hi:[1,0]
    v_cvt_pk_bf16_f32 v20, v24, v25
    v_cvt_pk_bf16_f32 v21, v26, v27
    v_cvt_pk_bf16_f32 v22, v32, v33
    v_cvt_pk_bf16_f32 v23, v34, v35
    s_nop 0
    v_permlane32_swap_b32 v20, v22
    v_permlane32_swap_b32 v21, v23
    s_nop 0
    v_permlane16_swap_b32 v20, v22
    v_permlane16_swap_b32 v21, v23
    v_accvgpr_write_b32 a112, v20
    v_accvgpr_write_b32 a113, v21
    v_accvgpr_write_b32 a114, v22
    v_accvgpr_write_b32 a115, v23
    v_pk_mul_f32 v[40:41], v[40:41], s[50:51] op_sel_hi:[1,0]
    v_pk_mul_f32 v[42:43], v[42:43], s[50:51] op_sel_hi:[1,0]
    v_pk_mul_f32 v[48:49], v[48:49], s[50:51] op_sel_hi:[1,0]
    v_pk_mul_f32 v[50:51], v[50:51], s[50:51] op_sel_hi:[1,0]
    v_cvt_pk_bf16_f32 v20, v40, v41
    v_cvt_pk_bf16_f32 v21, v42, v43
    v_cvt_pk_bf16_f32 v22, v48, v49
    v_cvt_pk_bf16_f32 v23, v50, v51
    s_nop 0
    v_permlane32_swap_b32 v20, v22
    v_permlane32_swap_b32 v21, v23
    s_nop 0
    v_permlane16_swap_b32 v20, v22
    v_permlane16_swap_b32 v21, v23
    v_accvgpr_write_b32 a116, v20
    v_accvgpr_write_b32 a117, v21
    v_accvgpr_write_b32 a118, v22
    v_accvgpr_write_b32 a119, v23
    v_pk_mul_f32 v[56:57], v[56:57], s[50:51] op_sel_hi:[1,0]
    v_pk_mul_f32 v[58:59], v[58:59], s[50:51] op_sel_hi:[1,0]
    v_pk_mul_f32 v[64:65], v[64:65], s[50:51] op_sel_hi:[1,0]
    v_pk_mul_f32 v[66:67], v[66:67], s[50:51] op_sel_hi:[1,0]
    v_cvt_pk_bf16_f32 v20, v56, v57
    v_cvt_pk_bf16_f32 v21, v58, v59
    v_cvt_pk_bf16_f32 v22, v64, v65
    v_cvt_pk_bf16_f32 v23, v66, v67
    s_nop 0
    v_permlane32_swap_b32 v20, v22
    v_permlane32_swap_b32 v21, v23
    s_nop 0
    v_permlane16_swap_b32 v20, v22
    v_permlane16_swap_b32 v21, v23
    v_accvgpr_write_b32 a120, v20
    v_accvgpr_write_b32 a121, v21
    v_accvgpr_write_b32 a122, v22
    v_accvgpr_write_b32 a123, v23
    v_pk_mul_f32 v[72:73], v[72:73], s[50:51] op_sel_hi:[1,0]
    v_pk_mul_f32 v[74:75], v[74:75], s[50:51] op_sel_hi:[1,0]
    v_pk_mul_f32 v[80:81], v[80:81], s[50:51] op_sel_hi:[1,0]
    v_pk_mul_f32 v[82:83], v[82:83], s[50:51] op_sel_hi:[1,0]
    v_cvt_pk_bf16_f32 v20, v72, v73
    v_cvt_pk_bf16_f32 v21, v74, v75
    v_cvt_pk_bf16_f32 v22, v80, v81
    v_cvt_pk_bf16_f32 v23, v82, v83
    s_nop 0
    v_permlane32_swap_b32 v20, v22
    v_permlane32_swap_b32 v21, v23
    s_nop 0
    v_permlane16_swap_b32 v20, v22
    v_permlane16_swap_b32 v21, v23
    v_accvgpr_write_b32 a124, v20
    v_accvgpr_write_b32 a125, v21
    v_accvgpr_write_b32 a126, v22
    v_accvgpr_write_b32 a127, v23
    v_pk_mul_f32 v[28:29], v[28:29], s[50:51] op_sel_hi:[1,0]
    v_pk_mul_f32 v[30:31], v[30:31], s[50:51] op_sel_hi:[1,0]
    v_pk_mul_f32 v[36:37], v[36:37], s[50:51] op_sel_hi:[1,0]
    v_pk_mul_f32 v[38:39], v[38:39], s[50:51] op_sel_hi:[1,0]
    v_cvt_pk_bf16_f32 v20, v28, v29
    v_cvt_pk_bf16_f32 v21, v30, v31
    v_cvt_pk_bf16_f32 v22, v36, v37
    v_cvt_pk_bf16_f32 v23, v38, v39
    s_nop 0
    v_permlane32_swap_b32 v20, v22
    v_permlane32_swap_b32 v21, v23
    s_nop 0
    v_permlane16_swap_b32 v20, v22
    v_permlane16_swap_b32 v21, v23
    v_accvgpr_write_b32 a128, v20
    v_accvgpr_write_b32 a129, v21
    v_accvgpr_write_b32 a130, v22
    v_accvgpr_write_b32 a131, v23
    v_pk_mul_f32 v[44:45], v[44:45], s[50:51] op_sel_hi:[1,0]
    v_pk_mul_f32 v[46:47], v[46:47], s[50:51] op_sel_hi:[1,0]
    v_pk_mul_f32 v[52:53], v[52:53], s[50:51] op_sel_hi:[1,0]
    v_pk_mul_f32 v[54:55], v[54:55], s[50:51] op_sel_hi:[1,0]
    v_cvt_pk_bf16_f32 v20, v44, v45
    v_cvt_pk_bf16_f32 v21, v46, v47
    v_cvt_pk_bf16_f32 v22, v52, v53
    v_cvt_pk_bf16_f32 v23, v54, v55
    s_nop 0
    v_permlane32_swap_b32 v20, v22
    v_permlane32_swap_b32 v21, v23
    s_nop 0
    v_permlane16_swap_b32 v20, v22
    v_permlane16_swap_b32 v21, v23
    v_accvgpr_write_b32 a132, v20
    v_accvgpr_write_b32 a133, v21
    v_accvgpr_write_b32 a134, v22
    v_accvgpr_write_b32 a135, v23
    v_pk_mul_f32 v[60:61], v[60:61], s[50:51] op_sel_hi:[1,0]
    v_pk_mul_f32 v[62:63], v[62:63], s[50:51] op_sel_hi:[1,0]
    v_pk_mul_f32 v[68:69], v[68:69], s[50:51] op_sel_hi:[1,0]
    v_pk_mul_f32 v[70:71], v[70:71], s[50:51] op_sel_hi:[1,0]
    v_cvt_pk_bf16_f32 v20, v60, v61
    v_cvt_pk_bf16_f32 v21, v62, v63
    v_cvt_pk_bf16_f32 v22, v68, v69
    v_cvt_pk_bf16_f32 v23, v70, v71
    s_nop 0
    v_permlane32_swap_b32 v20, v22
    v_permlane32_swap_b32 v21, v23
    s_nop 0
    v_permlane16_swap_b32 v20, v22
    v_permlane16_swap_b32 v21, v23
    v_accvgpr_write_b32 a136, v20
    v_accvgpr_write_b32 a137, v21
    v_accvgpr_write_b32 a138, v22
    v_accvgpr_write_b32 a139, v23
    v_pk_mul_f32 v[76:77], v[76:77], s[50:51] op_sel_hi:[1,0]
    v_pk_mul_f32 v[78:79], v[78:79], s[50:51] op_sel_hi:[1,0]
    v_pk_mul_f32 v[84:85], v[84:85], s[50:51] op_sel_hi:[1,0]
    v_pk_mul_f32 v[86:87], v[86:87], s[50:51] op_sel_hi:[1,0]
    v_cvt_pk_bf16_f32 v20, v76, v77
    v_cvt_pk_bf16_f32 v21, v78, v79
    v_cvt_pk_bf16_f32 v22, v84, v85
    v_cvt_pk_bf16_f32 v23, v86, v87
    s_nop 0
    v_permlane32_swap_b32 v20, v22
    v_permlane32_swap_b32 v21, v23
    s_nop 0
    v_permlane16_swap_b32 v20, v22
    v_permlane16_swap_b32 v21, v23
    v_accvgpr_write_b32 a140, v20
    v_accvgpr_write_b32 a141, v21
    v_accvgpr_write_b32 a142, v22
    v_accvgpr_write_b32 a143, v23
    v_accvgpr_write_b32 a0, 0
    v_accvgpr_write_b32 a1, 0
    v_accvgpr_write_b32 a2, 0
    v_accvgpr_write_b32 a3, 0
    v_accvgpr_write_b32 a4, 0
    v_accvgpr_write_b32 a5, 0
    v_accvgpr_write_b32 a6, 0
    v_accvgpr_write_b32 a7, 0
    v_accvgpr_write_b32 a8, 0
    v_accvgpr_write_b32 a9, 0
    v_accvgpr_write_b32 a10, 0
    v_accvgpr_write_b32 a11, 0
    v_accvgpr_write_b32 a12, 0
    v_accvgpr_write_b32 a13, 0
    v_accvgpr_write_b32 a14, 0
    v_accvgpr_write_b32 a15, 0
    v_accvgpr_write_b32 a16, 0
    v_accvgpr_write_b32 a17, 0
    v_accvgpr_write_b32 a18, 0
    v_accvgpr_write_b32 a19, 0
    v_accvgpr_write_b32 a20, 0
    v_accvgpr_write_b32 a21, 0
    v_accvgpr_write_b32 a22, 0
    v_accvgpr_write_b32 a23, 0
    v_mov_b32 v24, 0
    v_mov_b32 v25, 0
    v_mov_b32 v26, 0
    v_mov_b32 v27, 0
    v_mov_b32 v28, 0
    v_mov_b32 v29, 0
    v_mov_b32 v30, 0
    v_mov_b32 v31, 0
    v_mov_b32 v32, 0
    v_mov_b32 v33, 0
    v_mov_b32 v34, 0
    v_mov_b32 v35, 0
    s_lshl_b32 s48, s6, 13
    s_add_u32 s48, s48, 121856
    s_sub_u32 s58, 16384, s48
    v_add_u32 v4, s58, v4
    v_add_u32 v5, s58, v5
    v_add_u32 v6, s58, v6
    v_add_u32 v7, s58, v7
    v_add_u32 v8, s58, v8
    v_add_u32 v9, s58, v9
    v_add_u32 v10, s58, v10
    v_add_u32 v11, s58, v11
    v_and_b32 v20, 15, v1
    v_lshrrev_b32 v21, 4, v1
    v_and_b32 v3, 7, v20
    v_lshlrev_b32 v3, 1, v3
    v_xor_b32 v3, v21, v3
    v_lshlrev_b32 v3, 4, v3
    v_lshl_add_u32 v12, v20, 8, v3
    v_xor_b32 v13, 64, v12
    v_xor_b32 v14, 128, v12
    v_xor_b32 v15, 192, v12
    s_mov_b32 s45, 0
    s_mov_b32 s68, 0
    s_add_u32 s47, s57, 65536
    s_mov_b32 s44, 0
    s_waitcnt lgkmcnt(0)
    s_waitcnt vmcnt(16)
    s_barrier
    s_add_u32 m0, s57, 0
    s_add_u32 s48, s57, 65536
    buffer_load_dwordx4 v16, s[8:11], s48 offen offset:0 nt lds
    buffer_load_dwordx4 v17, s[8:11], s48 offen offset:1024 nt lds
    buffer_load_dwordx4 v16, s[8:11], s48 offen offset:2048 nt lds
    buffer_load_dwordx4 v17, s[8:11], s48 offen offset:3072 nt lds
    s_add_u32 m0, s57, 16384
    s_add_u32 s48, s57, 65536
    buffer_load_dwordx4 v16, s[12:15], s48 offen offset:0 nt lds
    buffer_load_dwordx4 v17, s[12:15], s48 offen offset:1024 nt lds
    buffer_load_dwordx4 v16, s[12:15], s48 offen offset:2048 nt lds
    buffer_load_dwordx4 v17, s[12:15], s48 offen offset:3072 nt lds
    s_lshl_b32 s48, s6, 12
    s_add_u32 s48, s48, 131072
    v_add_u32 v3, s48, v0
    ds_read_b128 a[144:147], v3 offset:0
    ds_read_b128 a[148:151], v3 offset:1024
    ds_read_b128 a[152:155], v3 offset:2048
    ds_read_b128 a[156:159], v3 offset:3072
    s_waitcnt lgkmcnt(0)
    s_waitcnt vmcnt(16)
    s_barrier
    s_add_u32 m0, s57, 32768
    s_add_u32 s48, s57, 81920
    buffer_load_dwordx4 v16, s[8:11], s48 offen offset:0 nt lds
    buffer_load_dwordx4 v17, s[8:11], s48 offen offset:1024 nt lds
    buffer_load_dwordx4 v16, s[8:11], s48 offen offset:2048 nt lds
    buffer_load_dwordx4 v17, s[8:11], s48 offen offset:3072 nt lds
    s_add_u32 m0, s57, 49152
    s_add_u32 s48, s57, 81920
    buffer_load_dwordx4 v16, s[12:15], s48 offen offset:0 nt lds
    buffer_load_dwordx4 v17, s[12:15], s48 offen offset:1024 nt lds
    buffer_load_dwordx4 v16, s[12:15], s48 offen offset:2048 nt lds
    buffer_load_dwordx4 v17, s[12:15], s48 offen offset:3072 nt lds
    s_waitcnt vmcnt(16)
    s_barrier
    s_add_u32 m0, s57, 65536
    s_add_u32 s48, s57, 98304
    buffer_load_dwordx4 v16, s[8:11], s48 offen offset:0 nt lds
    buffer_load_dwordx4 v17, s[8:11], s48 offen offset:1024 nt lds
    buffer_load_dwordx4 v16, s[8:11], s48 offen offset:2048 nt lds
    buffer_load_dwordx4 v17, s[8:11], s48 offen offset:3072 nt lds
    s_add_u32 m0, s57, 81920
    s_add_u32 s48, s57, 98304
    buffer_load_dwordx4 v16, s[12:15], s48 offen offset:0 nt lds
    buffer_load_dwordx4 v17, s[12:15], s48 offen offset:1024 nt lds
    buffer_load_dwordx4 v16, s[12:15], s48 offen offset:2048 nt lds
    buffer_load_dwordx4 v17, s[12:15], s48 offen offset:3072 nt lds
    s_waitcnt vmcnt(16)
    s_barrier
    s_add_u32 m0, s57, 98304
    s_add_u32 s48, s57, 114688
    buffer_load_dwordx4 v16, s[8:11], s48 offen offset:0 nt lds
    buffer_load_dwordx4 v17, s[8:11], s48 offen offset:1024 nt lds
    buffer_load_dwordx4 v16, s[8:11], s48 offen offset:2048 nt lds
    buffer_load_dwordx4 v17, s[8:11], s48 offen offset:3072 nt lds
    s_add_u32 m0, s57, 114688
    s_add_u32 s48, s57, 114688
    buffer_load_dwordx4 v16, s[12:15], s48 offen offset:0 nt lds
    buffer_load_dwordx4 v17, s[12:15], s48 offen offset:1024 nt lds
    buffer_load_dwordx4 v16, s[12:15], s48 offen offset:2048 nt lds
    buffer_load_dwordx4 v17, s[12:15], s48 offen offset:3072 nt lds
    s_waitcnt vmcnt(16)
    s_barrier
    s_add_u32 m0, s57, 0
    s_add_u32 s48, s57, 0
    buffer_load_dwordx4 v16, s[32:35], s48 offen offset:0 nt lds
    buffer_load_dwordx4 v17, s[32:35], s48 offen offset:1024 nt lds
    buffer_load_dwordx4 v16, s[32:35], s48 offen offset:2048 nt lds
    buffer_load_dwordx4 v17, s[32:35], s48 offen offset:3072 nt lds
    s_add_u32 m0, s57, 16384
    s_add_u32 s48, s57, 0
    buffer_load_dwordx4 v16, s[36:39], s48 offen offset:0 nt lds
    buffer_load_dwordx4 v17, s[36:39], s48 offen offset:1024 nt lds
    buffer_load_dwordx4 v16, s[36:39], s48 offen offset:2048 nt lds
    buffer_load_dwordx4 v17, s[36:39], s48 offen offset:3072 nt lds
    s_waitcnt vmcnt(16)
    s_barrier
    s_add_u32 m0, s57, 32768
    s_add_u32 s48, s57, 16384
    buffer_load_dwordx4 v16, s[32:35], s48 offen offset:0 nt lds
    buffer_load_dwordx4 v17, s[32:35], s48 offen offset:1024 nt lds
    buffer_load_dwordx4 v16, s[32:35], s48 offen offset:2048 nt lds
    buffer_load_dwordx4 v17, s[32:35], s48 offen offset:3072 nt lds
    s_add_u32 m0, s57, 49152
    s_add_u32 s48, s57, 16384
    buffer_load_dwordx4 v16, s[36:39], s48 offen offset:0 nt lds
    buffer_load_dwordx4 v17, s[36:39], s48 offen offset:1024 nt lds
    buffer_load_dwordx4 v16, s[36:39], s48 offen offset:2048 nt lds
    buffer_load_dwordx4 v17, s[36:39], s48 offen offset:3072 nt lds
    s_waitcnt vmcnt(16)
    s_barrier
    s_add_u32 m0, s57, 65536
    s_add_u32 s48, s57, 32768
    buffer_load_dwordx4 v16, s[32:35], s48 offen offset:0 nt lds
    buffer_load_dwordx4 v17, s[32:35], s48 offen offset:1024 nt lds
    buffer_load_dwordx4 v16, s[32:35], s48 offen offset:2048 nt lds
    buffer_load_dwordx4 v17, s[32:35], s48 offen offset:3072 nt lds
    s_add_u32 m0, s57, 81920
    s_add_u32 s48, s57, 32768
    buffer_load_dwordx4 v16, s[36:39], s48 offen offset:0 nt lds
    buffer_load_dwordx4 v17, s[36:39], s48 offen offset:1024 nt lds
    buffer_load_dwordx4 v16, s[36:39], s48 offen offset:2048 nt lds
    buffer_load_dwordx4 v17, s[36:39], s48 offen offset:3072 nt lds
    s_waitcnt vmcnt(16)
    s_barrier
    s_add_u32 m0, s57, 98304
    s_add_u32 s48, s57, 49152
    buffer_load_dwordx4 v16, s[32:35], s48 offen offset:0 nt lds
    buffer_load_dwordx4 v17, s[32:35], s48 offen offset:1024 nt lds
    buffer_load_dwordx4 v16, s[32:35], s48 offen offset:2048 nt lds
    buffer_load_dwordx4 v17, s[32:35], s48 offen offset:3072 nt lds
    s_add_u32 m0, s57, 114688
    s_add_u32 s48, s57, 49152
    buffer_load_dwordx4 v16, s[36:39], s48 offen offset:0 nt lds
    buffer_load_dwordx4 v17, s[36:39], s48 offen offset:1024 nt lds
    buffer_load_dwordx4 v16, s[36:39], s48 offen offset:2048 nt lds
    buffer_load_dwordx4 v17, s[36:39], s48 offen offset:3072 nt lds
    s_mov_b32 s68, 2
    s_branch L_disp
L_g0:
    v_pk_mul_f32 v[88:89], v[88:89], s[50:51] op_sel_hi:[1,0]
    v_pk_mul_f32 v[90:91], v[90:91], s[50:51] op_sel_hi:[1,0]
    v_pk_mul_f32 v[92:93], v[92:93], s[50:51] op_sel_hi:[1,0]
    v_pk_mul_f32 v[94:95], v[94:95], s[50:51] op_sel_hi:[1,0]
    v_cvt_pk_bf16_f32 v20, v88, v89
    v_cvt_pk_bf16_f32 v21, v90, v91
    v_cvt_pk_bf16_f32 v22, v92, v93
    v_cvt_pk_bf16_f32 v23, v94, v95
    s_nop 0
    v_permlane32_swap_b32 v20, v22
    v_permlane32_swap_b32 v21, v23
    s_nop 0
    v_permlane16_swap_b32 v20, v22
    v_permlane16_swap_b32 v21, v23
    v_lshlrev_b32 v0, 4, v1
    s_lshl_b32 s48, s7, 10
    s_add_u32 s48, s48, 131072
    v_add_u32 v3, s48, v0
    ds_write_b128 v3, v[20:23]
    v_pk_mul_f32 v[24:25], v[24:25], s[50:51] op_sel_hi:[1,0]
    v_pk_mul_f32 v[26:27], v[26:27], s[50:51] op_sel_hi:[1,0]
    v_pk_mul_f32 v[32:33], v[32:33], s[50:51] op_sel_hi:[1,0]
    v_pk_mul_f32 v[34:35], v[34:35], s[50:51] op_sel_hi:[1,0]
    v_cvt_pk_bf16_f32 v20, v24, v25
    v_cvt_pk_bf16_f32 v21, v26, v27
    v_cvt_pk_bf16_f32 v22, v32, v33
    v_cvt_pk_bf16_f32 v23, v34, v35
    s_nop 0
    v_permlane32_swap_b32 v20, v22
    v_permlane32_swap_b32 v21, v23
    s_nop 0
    v_permlane16_swap_b32 v20, v22
    v_permlane16_swap_b32 v21, v23
    v_accvgpr_write_b32 a112, v20
    v_accvgpr_write_b32 a113, v21
    v_accvgpr_write_b32 a114, v22
    v_accvgpr_write_b32 a115, v23
    v_pk_mul_f32 v[40:41], v[40:41], s[50:51] op_sel_hi:[1,0]
    v_pk_mul_f32 v[42:43], v[42:43], s[50:51] op_sel_hi:[1,0]
    v_pk_mul_f32 v[48:49], v[48:49], s[50:51] op_sel_hi:[1,0]
    v_pk_mul_f32 v[50:51], v[50:51], s[50:51] op_sel_hi:[1,0]
    v_cvt_pk_bf16_f32 v20, v40, v41
    v_cvt_pk_bf16_f32 v21, v42, v43
    v_cvt_pk_bf16_f32 v22, v48, v49
    v_cvt_pk_bf16_f32 v23, v50, v51
    s_nop 0
    v_permlane32_swap_b32 v20, v22
    v_permlane32_swap_b32 v21, v23
    s_nop 0
    v_permlane16_swap_b32 v20, v22
    v_permlane16_swap_b32 v21, v23
    v_accvgpr_write_b32 a116, v20
    v_accvgpr_write_b32 a117, v21
    v_accvgpr_write_b32 a118, v22
    v_accvgpr_write_b32 a119, v23
    v_pk_mul_f32 v[56:57], v[56:57], s[50:51] op_sel_hi:[1,0]
    v_pk_mul_f32 v[58:59], v[58:59], s[50:51] op_sel_hi:[1,0]
    v_pk_mul_f32 v[64:65], v[64:65], s[50:51] op_sel_hi:[1,0]
    v_pk_mul_f32 v[66:67], v[66:67], s[50:51] op_sel_hi:[1,0]
    v_cvt_pk_bf16_f32 v20, v56, v57
    v_cvt_pk_bf16_f32 v21, v58, v59
    v_cvt_pk_bf16_f32 v22, v64, v65
    v_cvt_pk_bf16_f32 v23, v66, v67
    s_nop 0
    v_permlane32_swap_b32 v20, v22
    v_permlane32_swap_b32 v21, v23
    s_nop 0
    v_permlane16_swap_b32 v20, v22
    v_permlane16_swap_b32 v21, v23
    v_accvgpr_write_b32 a120, v20
    v_accvgpr_write_b32 a121, v21
    v_accvgpr_write_b32 a122, v22
    v_accvgpr_write_b32 a123, v23
    v_pk_mul_f32 v[72:73], v[72:73], s[50:51] op_sel_hi:[1,0]
    v_pk_mul_f32 v[74:75], v[74:75], s[50:51] op_sel_hi:[1,0]
    v_pk_mul_f32 v[80:81], v[80:81], s[50:51] op_sel_hi:[1,0]
    v_pk_mul_f32 v[82:83], v[82:83], s[50:51] op_sel_hi:[1,0]
    v_cvt_pk_bf16_f32 v20, v72, v73
    v_cvt_pk_bf16_f32 v21, v74, v75
    v_cvt_pk_bf16_f32 v22, v80, v81
    v_cvt_pk_bf16_f32 v23, v82, v83
    s_nop 0
    v_permlane32_swap_b32 v20, v22
    v_permlane32_swap_b32 v21, v23
    s_nop 0
    v_permlane16_swap_b32 v20, v22
    v_permlane16_swap_b32 v21, v23
    v_accvgpr_write_b32 a124, v20
    v_accvgpr_write_b32 a125, v21
    v_accvgpr_write_b32 a126, v22
    v_accvgpr_write_b32 a127, v23
    v_pk_mul_f32 v[28:29], v[28:29], s[50:51] op_sel_hi:[1,0]
    v_pk_mul_f32 v[30:31], v[30:31], s[50:51] op_sel_hi:[1,0]
    v_pk_mul_f32 v[36:37], v[36:37], s[50:51] op_sel_hi:[1,0]
    v_pk_mul_f32 v[38:39], v[38:39], s[50:51] op_sel_hi:[1,0]
    v_cvt_pk_bf16_f32 v20, v28, v29
    v_cvt_pk_bf16_f32 v21, v30, v31
    v_cvt_pk_bf16_f32 v22, v36, v37
    v_cvt_pk_bf16_f32 v23, v38, v39
    s_nop 0
    v_permlane32_swap_b32 v20, v22
    v_permlane32_swap_b32 v21, v23
    s_nop 0
    v_permlane16_swap_b32 v20, v22
    v_permlane16_swap_b32 v21, v23
    v_accvgpr_write_b32 a128, v20
    v_accvgpr_write_b32 a129, v21
    v_accvgpr_write_b32 a130, v22
    v_accvgpr_write_b32 a131, v23
    v_pk_mul_f32 v[44:45], v[44:45], s[50:51] op_sel_hi:[1,0]
    v_pk_mul_f32 v[46:47], v[46:47], s[50:51] op_sel_hi:[1,0]
    v_pk_mul_f32 v[52:53], v[52:53], s[50:51] op_sel_hi:[1,0]
    v_pk_mul_f32 v[54:55], v[54:55], s[50:51] op_sel_hi:[1,0]
    v_cvt_pk_bf16_f32 v20, v44, v45
    v_cvt_pk_bf16_f32 v21, v46, v47
    v_cvt_pk_bf16_f32 v22, v52, v53
    v_cvt_pk_bf16_f32 v23, v54, v55
    s_nop 0
    v_permlane32_swap_b32 v20, v22
    v_permlane32_swap_b32 v21, v23
    s_nop 0
    v_permlane16_swap_b32 v20, v22
    v_permlane16_swap_b32 v21, v23
    v_accvgpr_write_b32 a132, v20
    v_accvgpr_write_b32 a133, v21
    v_accvgpr_write_b32 a134, v22
    v_accvgpr_write_b32 a135, v23
    v_pk_mul_f32 v[60:61], v[60:61], s[50:51] op_sel_hi:[1,0]
    v_pk_mul_f32 v[62:63], v[62:63], s[50:51] op_sel_hi:[1,0]
    v_pk_mul_f32 v[68:69], v[68:69], s[50:51] op_sel_hi:[1,0]
    v_pk_mul_f32 v[70:71], v[70:71], s[50:51] op_sel_hi:[1,0]
    v_cvt_pk_bf16_f32 v20, v60, v61
    v_cvt_pk_bf16_f32 v21, v62, v63
    v_cvt_pk_bf16_f32 v22, v68, v69
    v_cvt_pk_bf16_f32 v23, v70, v71
    s_nop 0
    v_permlane32_swap_b32 v20, v22
    v_permlane32_swap_b32 v21, v23
    s_nop 0
    v_permlane16_swap_b32 v20, v22
    v_permlane16_swap_b32 v21, v23
    v_accvgpr_write_b32 a136, v20
    v_accvgpr_write_b32 a137, v21
    v_accvgpr_write_b32 a138, v22
    v_accvgpr_write_b32 a139, v23
    v_pk_mul_f32 v[76:77], v[76:77], s[50:51] op_sel_hi:[1,0]
    v_pk_mul_f32 v[78:79], v[78:79], s[50:51] op_sel_hi:[1,0]
    v_pk_mul_f32 v[84:85], v[84:85], s[50:51] op_sel_hi:[1,0]
    v_pk_mul_f32 v[86:87], v[86:87], s[50:51] op_sel_hi:[1,0]
    v_cvt_pk_bf16_f32 v20, v76, v77
    v_cvt_pk_bf16_f32 v21, v78, v79
    v_cvt_pk_bf16_f32 v22, v84, v85
    v_cvt_pk_bf16_f32 v23, v86, v87
    s_nop 0
    v_permlane32_swap_b32 v20, v22
    v_permlane32_swap_b32 v21, v23
    s_nop 0
    v_permlane16_swap_b32 v20, v22
    v_permlane16_swap_b32 v21, v23
    v_accvgpr_write_b32 a140, v20
    v_accvgpr_write_b32 a141, v21
    v_accvgpr_write_b32 a142, v22
    v_accvgpr_write_b32 a143, v23
    v_accvgpr_write_b32 a0, 0
    v_accvgpr_write_b32 a1, 0
    v_accvgpr_write_b32 a2, 0
    v_accvgpr_write_b32 a3, 0
    v_accvgpr_write_b32 a4, 0
    v_accvgpr_write_b32 a5, 0
    v_accvgpr_write_b32 a6, 0
    v_accvgpr_write_b32 a7, 0
    v_accvgpr_write_b32 a8, 0
    v_accvgpr_write_b32 a9, 0
    v_accvgpr_write_b32 a10, 0
    v_accvgpr_write_b32 a11, 0
    v_accvgpr_write_b32 a12, 0
    v_accvgpr_write_b32 a13, 0
    v_accvgpr_write_b32 a14, 0
    v_accvgpr_write_b32 a15, 0
    v_accvgpr_write_b32 a16, 0
    v_accvgpr_write_b32 a17, 0
    v_accvgpr_write_b32 a18, 0
    v_accvgpr_write_b32 a19, 0
    v_accvgpr_write_b32 a20, 0
    v_accvgpr_write_b32 a21, 0
    v_accvgpr_write_b32 a22, 0
    v_accvgpr_write_b32 a23, 0
    v_mov_b32 v24, 0
    v_mov_b32 v25, 0
    v_mov_b32 v26, 0
    v_mov_b32 v27, 0
    v_mov_b32 v28, 0
    v_mov_b32 v29, 0
    v_mov_b32 v30, 0
    v_mov_b32 v31, 0
    v_mov_b32 v32, 0
    v_mov_b32 v33, 0
    v_mov_b32 v34, 0
    v_mov_b32 v35, 0
    s_lshl_b32 s48, s6, 13
    s_add_u32 s48, s48, 121856
    s_sub_u32 s58, 16384, s48
    v_add_u32 v4, s58, v4
    v_add_u32 v5, s58, v5
    v_add_u32 v6, s58, v6
    v_add_u32 v7, s58, v7
    v_add_u32 v8, s58, v8
    v_add_u32 v9, s58, v9
    v_add_u32 v10, s58, v10
    v_add_u32 v11, s58, v11
    v_and_b32 v20, 15, v1
    v_lshrrev_b32 v21, 4, v1
    v_and_b32 v3, 7, v20
    v_lshlrev_b32 v3, 1, v3
    v_xor_b32 v3, v21, v3
    v_lshlrev_b32 v3, 4, v3
    v_lshl_add_u32 v12, v20, 8, v3
    v_xor_b32 v13, 64, v12
    v_xor_b32 v14, 128, v12
    v_xor_b32 v15, 192, v12
    s_mov_b32 s45, 0
    s_mov_b32 s68, 0
    s_add_u32 s47, s57, 65536
    s_mov_b32 s44, 0
    s_waitcnt lgkmcnt(0)
    s_barrier
    s_lshl_b32 s48, s6, 12
    s_add_u32 s48, s48, 131072
    v_add_u32 v3, s48, v0
    ds_read_b128 a[144:147], v3 offset:0
    ds_read_b128 a[148:151], v3 offset:1024
    ds_read_b128 a[152:155], v3 offset:2048
    ds_read_b128 a[156:159], v3 offset:3072
    s_waitcnt lgkmcnt(0)
L_disp:
    s_cmp_eq_u32 s3, 1
    s_cbranch_scc1 L_wave1
    s_cmp_eq_u32 s3, 2
    s_cbranch_scc1 L_wave2
    s_cmp_eq_u32 s3, 3
    s_cbranch_scc1 L_wave3
L_wave0:
    s_branch L_w0_first
L_w0_fake:
    ds_read_b128 v[72:75], v12 offset:0
    ds_read_b128 v[76:79], v13 offset:0
    ds_read_b128 v[80:83], v14 offset:0
    ds_read_b128 v[84:87], v15 offset:0
L_w0_loop:
    s_waitcnt lgkmcnt(3)
    v_mfma_f32_16x16x32_bf16 v[36:39], v[72:75], a[112:115], v[24:27]
    ds_read_b128 v[88:91], v12 offset:4096
    v_mfma_f32_16x16x32_bf16 v[44:47], v[72:75], a[128:131], v[28:31]
    v_mfma_f32_16x16x32_bf16 v[68:71], v[72:75], a[144:147], v[32:35]
    s_waitcnt lgkmcnt(3)
    v_mfma_f32_16x16x32_bf16 v[36:39], v[76:79], a[116:119], v[36:39]
    ds_read_b128 v[92:95], v13 offset:4096
    v_mfma_f32_16x16x32_bf16 v[44:47], v[76:79], a[132:135], v[44:47]
    v_mfma_f32_16x16x32_bf16 v[68:71], v[76:79], a[148:151], v[68:71]
    s_waitcnt lgkmcnt(3)
    v_mfma_f32_16x16x32_bf16 v[36:39], v[80:83], a[120:123], v[36:39]
    ds_read_b128 v[72:75], v14 offset:4096
    v_mfma_f32_16x16x32_bf16 v[44:47], v[80:83], a[136:139], v[44:47]
    v_mfma_f32_16x16x32_bf16 v[68:71], v[80:83], a[152:155], v[68:71]
    s_waitcnt lgkmcnt(3)
    v_mfma_f32_16x16x32_bf16 v[36:39], v[84:87], a[124:127], v[36:39]
    ds_read_b128 v[76:79], v15 offset:4096
    v_mfma_f32_16x16x32_bf16 v[44:47], v[84:87], a[140:143], v[44:47]
    v_mfma_f32_16x16x32_bf16 v[68:71], v[84:87], a[156:159], v[68:71]
    s_waitcnt lgkmcnt(3)
    v_mfma_f32_16x16x32_bf16 v[40:43], v[88:91], a[112:115], v[24:27]
    ds_read_b128 v[80:83], v12 offset:8192
    v_mfma_f32_16x16x32_bf16 v[48:51], v[88:91], a[128:131], v[28:31]
    s_waitcnt lgkmcnt(3)
    v_mfma_f32_16x16x32_bf16 v[40:43], v[92:95], a[116:119], v[40:43]
    ds_read_b128 v[84:87], v13 offset:8192
    v_exp_f32 v36, v36
    v_mfma_f32_16x16x32_bf16 v[48:51], v[92:95], a[132:135], v[48:51]
    v_exp_f32 v37, v37
    v_exp_f32 v38, v38
    s_waitcnt lgkmcnt(3)
    v_mfma_f32_16x16x32_bf16 v[40:43], v[72:75], a[120:123], v[40:43]
    ds_read_b128 v[88:91], v14 offset:8192
    v_exp_f32 v39, v39
    v_cvt_pk_bf16_f32 v36, v36, v37
    v_mfma_f32_16x16x32_bf16 v[48:51], v[72:75], a[136:139], v[48:51]
    v_cvt_pk_bf16_f32 v37, v38, v39
    v_or_b32 v20, v36, v37
    s_waitcnt lgkmcnt(3)
    v_mfma_f32_16x16x32_bf16 v[40:43], v[76:79], a[124:127], v[40:43]
    ds_read_b128 v[92:95], v15 offset:8192
    v_exp_f32 v44, v44
    v_mfma_f32_16x16x32_bf16 v[48:51], v[76:79], a[140:143], v[48:51]
    v_exp_f32 v45, v45
    s_waitcnt lgkmcnt(3)
    v_mfma_f32_16x16x32_bf16 v[52:55], v[80:83], a[112:115], v[24:27]
    ds_read_b128 v[72:75], v12 offset:12288
    v_exp_f32 v46, v46
    v_mfma_f32_16x16x32_bf16 v[60:63], v[80:83], a[128:131], v[28:31]
    v_exp_f32 v47, v47
    v_cvt_pk_bf16_f32 v44, v44, v45
    s_waitcnt lgkmcnt(3)
    v_mfma_f32_16x16x32_bf16 v[52:55], v[84:87], a[116:119], v[52:55]
    ds_read_b128 v[76:79], v13 offset:12288
    v_cvt_pk_bf16_f32 v45, v46, v47
    v_or3_b32 v20, v44, v45, v20
    v_mfma_f32_16x16x32_bf16 v[60:63], v[84:87], a[132:135], v[60:63]
    v_exp_f32 v68, v68
    v_exp_f32 v69, v69
    s_waitcnt lgkmcnt(3)
    v_mfma_f32_16x16x32_bf16 v[52:55], v[88:91], a[120:123], v[52:55]
    ds_read_b128 v[80:83], v14 offset:12288
    v_exp_f32 v70, v70
    v_mfma_f32_16x16x32_bf16 v[60:63], v[88:91], a[136:139], v[60:63]
    v_exp_f32 v71, v71
    v_cvt_pk_bf16_f32 v68, v68, v69
    v_cvt_pk_bf16_f32 v69, v70, v71
    s_waitcnt lgkmcnt(3)
    v_mfma_f32_16x16x32_bf16 v[52:55], v[92:95], a[124:127], v[52:55]
    ds_read_b128 v[84:87], v15 offset:12288
    v_or3_b32 v20, v68, v69, v20
    v_mfma_f32_16x16x32_bf16 v[60:63], v[92:95], a[140:143], v[60:63]
    v_exp_f32 v40, v40
    s_waitcnt lgkmcnt(3)
    v_mfma_f32_16x16x32_bf16 v[56:59], v[72:75], a[112:115], v[24:27]
    ds_read_b64_tr_b16 v[88:89], v4 offset:0
    ds_read_b64_tr_b16 v[90:91], v4 offset:4096
    v_mfma_f32_16x16x32_bf16 v[64:67], v[72:75], a[128:131], v[28:31]
    v_exp_f32 v41, v41
    s_waitcnt lgkmcnt(4)
    v_mfma_f32_16x16x32_bf16 v[56:59], v[76:79], a[116:119], v[56:59]
    ds_read_b64_tr_b16 v[72:73], v5 offset:0
    ds_read_b64_tr_b16 v[74:75], v5 offset:4096
    v_mfma_f32_16x16x32_bf16 v[64:67], v[76:79], a[132:135], v[64:67]
    v_exp_f32 v42, v42
    v_exp_f32 v43, v43
    s_waitcnt lgkmcnt(5)
    v_mfma_f32_16x16x32_bf16 v[56:59], v[80:83], a[120:123], v[56:59]
    ds_read_b64_tr_b16 v[76:77], v6 offset:0
    ds_read_b64_tr_b16 v[78:79], v6 offset:4096
    v_cvt_pk_bf16_f32 v38, v40, v41
    v_cvt_pk_bf16_f32 v39, v42, v43
    v_mfma_f32_16x16x32_bf16 v[64:67], v[80:83], a[136:139], v[64:67]
    v_or3_b32 v20, v38, v39, v20
    v_exp_f32 v48, v48
    s_waitcnt lgkmcnt(6)
    v_mfma_f32_16x16x32_bf16 v[56:59], v[84:87], a[124:127], v[56:59]
    ds_read_b64_tr_b16 v[80:81], v7 offset:0
    ds_read_b64_tr_b16 v[82:83], v7 offset:4096
    v_exp_f32 v49, v49
    v_mfma_f32_16x16x32_bf16 v[64:67], v[84:87], a[140:143], v[64:67]
    v_exp_f32 v50, v50
    v_exp_f32 v51, v51
    v_cvt_pk_bf16_f32 v46, v48, v49
    v_cvt_pk_bf16_f32 v47, v50, v51
    v_or3_b32 v20, v46, v47, v20
    v_and_b32 v20, s52, v20
    v_cmp_ne_u32 vcc, 0, v20
    s_cbranch_vccnz L_w0_rareA
L_w0_Aafter:
    v_mfma_f32_16x16x32_bf16 a[96:99], a[108:111], v[36:39], a[96:99]
    v_mfma_f32_16x16x32_bf16 a[100:103], a[108:111], v[44:47], a[100:103]
    v_mfma_f32_16x16x16_bf16 a[104:107], a[108:109], v[68:69], a[104:107]
    s_waitcnt lgkmcnt(6)
    v_mfma_f32_16x16x32_bf16 a[0:3], v[88:91], v[36:39], a[0:3]
    ds_read_b64_tr_b16 v[84:85], v8 offset:0
    ds_read_b64_tr_b16 v[86:87], v8 offset:4096
    v_mfma_f32_16x16x32_bf16 a[4:7], v[88:91], v[44:47], a[4:7]
    v_exp_f32 v52, v52
    v_mfma_f32_16x16x16_bf16 a[64:67], v[88:89], v[68:69], a[64:67]
    v_exp_f32 v53, v53
    s_waitcnt lgkmcnt(6)
    v_mfma_f32_16x16x32_bf16 a[8:11], v[72:75], v[36:39], a[8:11]
    ds_read_b64_tr_b16 v[88:89], v9 offset:0
    ds_read_b64_tr_b16 v[90:91], v9 offset:4096
    v_exp_f32 v54, v54
    v_mfma_f32_16x16x32_bf16 a[12:15], v[72:75], v[44:47], a[12:15]
    v_exp_f32 v55, v55
    v_cvt_pk_bf16_f32 v52, v52, v53
    v_cvt_pk_bf16_f32 v53, v54, v55
    v_mfma_f32_16x16x16_bf16 a[68:71], v[72:73], v[68:69], a[68:71]
    v_or_b32 v21, v52, v53
    v_exp_f32 v60, v60
    s_waitcnt lgkmcnt(6)
    v_mfma_f32_16x16x32_bf16 a[16:19], v[76:79], v[36:39], a[16:19]
    ds_read_b64_tr_b16 v[72:73], v10 offset:0
    ds_read_b64_tr_b16 v[74:75], v10 offset:4096
    v_exp_f32 v61, v61
    v_mfma_f32_16x16x32_bf16 a[20:23], v[76:79], v[44:47], a[20:23]
    v_exp_f32 v62, v62
    v_exp_f32 v63, v63
    v_mfma_f32_16x16x16_bf16 a[72:75], v[76:77], v[68:69], a[72:75]
    v_cvt_pk_bf16_f32 v60, v60, v61
    v_cvt_pk_bf16_f32 v61, v62, v63
    v_or3_b32 v21, v60, v61, v21
    s_waitcnt lgkmcnt(6)
    v_mfma_f32_16x16x32_bf16 a[24:27], v[80:83], v[36:39], a[24:27]
    ds_read_b64_tr_b16 v[76:77], v11 offset:0
    ds_read_b64_tr_b16 v[78:79], v11 offset:4096
    s_add_u32 s48, s45, 32768
    s_cmp_eq_u32 s48, 131072
    s_cselect_b32 s48, 0, s48
    s_sub_u32 s58, s48, s45
    v_mfma_f32_16x16x32_bf16 a[28:31], v[80:83], v[44:47], a[28:31]
    v_exp_f32 v56, v56
    v_mfma_f32_16x16x16_bf16 a[76:79], v[80:81], v[68:69], a[76:79]
    v_exp_f32 v57, v57
    s_waitcnt lgkmcnt(6)
    v_mfma_f32_16x16x32_bf16 a[32:35], v[84:87], v[36:39], a[32:35]
    ds_read_b64_tr_b16 v[80:81], v4 offset:8192
    ds_read_b64_tr_b16 v[82:83], v4 offset:12288
    v_mfma_f32_16x16x32_bf16 a[36:39], v[84:87], v[44:47], a[36:39]
    v_exp_f32 v58, v58
    v_mfma_f32_16x16x16_bf16 a[80:83], v[84:85], v[68:69], a[80:83]
    v_exp_f32 v59, v59
    v_cvt_pk_bf16_f32 v54, v56, v57
    s_waitcnt lgkmcnt(6)
    v_mfma_f32_16x16x32_bf16 a[40:43], v[88:91], v[36:39], a[40:43]
    ds_read_b64_tr_b16 v[84:85], v5 offset:8192
    ds_read_b64_tr_b16 v[86:87], v5 offset:12288
    v_cvt_pk_bf16_f32 v55, v58, v59
    v_mfma_f32_16x16x32_bf16 a[44:47], v[88:91], v[44:47], a[44:47]
    v_or3_b32 v21, v54, v55, v21
    v_mfma_f32_16x16x16_bf16 a[84:87], v[88:89], v[68:69], a[84:87]
    v_exp_f32 v64, v64
    s_waitcnt lgkmcnt(6)
    v_mfma_f32_16x16x32_bf16 a[48:51], v[72:75], v[36:39], a[48:51]
    ds_read_b64_tr_b16 v[88:89], v6 offset:8192
    ds_read_b64_tr_b16 v[90:91], v6 offset:12288
    v_mfma_f32_16x16x32_bf16 a[52:55], v[72:75], v[44:47], a[52:55]
    v_exp_f32 v65, v65
    v_mfma_f32_16x16x16_bf16 a[88:91], v[72:73], v[68:69], a[88:91]
    v_exp_f32 v66, v66
    s_waitcnt lgkmcnt(6)
    v_mfma_f32_16x16x32_bf16 a[56:59], v[76:79], v[36:39], a[56:59]
    ds_read_b64_tr_b16 v[72:73], v7 offset:8192
    ds_read_b64_tr_b16 v[74:75], v7 offset:12288
    v_mfma_f32_16x16x32_bf16 a[60:63], v[76:79], v[44:47], a[60:63]
    v_exp_f32 v67, v67
    v_cvt_pk_bf16_f32 v62, v64, v65
    v_cvt_pk_bf16_f32 v63, v66, v67
    v_mfma_f32_16x16x16_bf16 a[92:95], v[76:77], v[68:69], a[92:95]
    v_or3_b32 v21, v62, v63, v21
    v_and_b32 v21, s52, v21
    v_cmp_ne_u32 vcc, 0, v21
    s_cbranch_vccnz L_w0_rareB
L_w0_Bafter:
    v_mfma_f32_16x16x32_bf16 a[96:99], a[108:111], v[52:55], a[96:99]
    v_mfma_f32_16x16x32_bf16 a[100:103], a[108:111], v[60:63], a[100:103]
    s_waitcnt lgkmcnt(6)
    v_mfma_f32_16x16x32_bf16 a[0:3], v[80:83], v[52:55], a[0:3]
    ds_read_b64_tr_b16 v[76:77], v8 offset:8192
    ds_read_b64_tr_b16 v[78:79], v8 offset:12288
    v_mfma_f32_16x16x32_bf16 a[4:7], v[80:83], v[60:63], a[4:7]
    s_waitcnt lgkmcnt(6)
    v_mfma_f32_16x16x32_bf16 a[8:11], v[84:87], v[52:55], a[8:11]
    ds_read_b64_tr_b16 v[80:81], v9 offset:8192
    ds_read_b64_tr_b16 v[82:83], v9 offset:12288
    v_mfma_f32_16x16x32_bf16 a[12:15], v[84:87], v[60:63], a[12:15]
    s_waitcnt lgkmcnt(6)
    v_mfma_f32_16x16x32_bf16 a[16:19], v[88:91], v[52:55], a[16:19]
    ds_read_b64_tr_b16 v[84:85], v10 offset:8192
    ds_read_b64_tr_b16 v[86:87], v10 offset:12288
    v_mfma_f32_16x16x32_bf16 a[20:23], v[88:91], v[60:63], a[20:23]
    v_add_u32 v12, s58, v12
    v_add_u32 v13, s58, v13
    v_add_u32 v14, s58, v14
    v_add_u32 v15, s58, v15
    s_waitcnt lgkmcnt(6)
    v_mfma_f32_16x16x32_bf16 a[24:27], v[72:75], v[52:55], a[24:27]
    ds_read_b64_tr_b16 v[88:89], v11 offset:8192
    ds_read_b64_tr_b16 v[90:91], v11 offset:12288
    v_mfma_f32_16x16x32_bf16 a[28:31], v[72:75], v[60:63], a[28:31]
    s_cmp_eq_u32 s68, 0
    s_cbranch_scc1 L_w0_v0
    s_cmp_eq_u32 s68, 1
    s_cmp_eq_u32 s68, 1
    s_cbranch_scc1 L_w0_v8
    s_waitcnt vmcnt(16) lgkmcnt(0)
    s_mov_b32 s68, 1
    s_branch L_w0_v9
L_w0_v8:
    s_waitcnt vmcnt(8) lgkmcnt(0)
    s_mov_b32 s68, 0
    s_branch L_w0_v9
L_w0_v0:
    s_waitcnt vmcnt(0) lgkmcnt(0)
L_w0_v9:
    s_barrier
    v_mfma_f32_16x16x32_bf16 a[32:35], v[76:79], v[52:55], a[32:35]
    ds_read_b128 v[72:75], v12 offset:0
    v_mfma_f32_16x16x32_bf16 a[36:39], v[76:79], v[60:63], a[36:39]
    v_add_u32 v4, s58, v4
    v_add_u32 v5, s58, v5
    v_add_u32 v6, s58, v6
    v_add_u32 v7, s58, v7
    v_mfma_f32_16x16x32_bf16 a[40:43], v[80:83], v[52:55], a[40:43]
    ds_read_b128 v[76:79], v13 offset:0
    v_mfma_f32_16x16x32_bf16 a[44:47], v[80:83], v[60:63], a[44:47]
    v_add_u32 v8, s58, v8
    v_add_u32 v9, s58, v9
    v_add_u32 v10, s58, v10
    v_add_u32 v11, s58, v11
    v_mfma_f32_16x16x32_bf16 a[48:51], v[84:87], v[52:55], a[48:51]
    ds_read_b128 v[80:83], v14 offset:0
    v_mfma_f32_16x16x32_bf16 a[52:55], v[84:87], v[60:63], a[52:55]
    v_mfma_f32_16x16x32_bf16 a[56:59], v[88:91], v[52:55], a[56:59]
    ds_read_b128 v[84:87], v15 offset:0
    v_mfma_f32_16x16x32_bf16 a[60:63], v[88:91], v[60:63], a[60:63]
    s_add_u32 s45, s45, s58
    s_add_u32 s47, s47, 16384
    s_add_u32 s44, s44, 1
    s_cmp_lt_u32 s44, 8
    s_cbranch_scc1 L_w0_loop
    s_waitcnt lgkmcnt(0)
    s_branch L_w0_done
L_w0_first:
    ds_read_b128 v[72:75], v12 offset:0
    ds_read_b128 v[76:79], v13 offset:0
    ds_read_b128 v[80:83], v14 offset:0
    s_waitcnt lgkmcnt(2)
    v_mfma_f32_16x16x32_bf16 v[36:39], v[72:75], a[112:115], v[24:27]
    ds_read_b128 v[84:87], v15 offset:0
    ds_read_b128 v[88:91], v12 offset:4096
    v_mfma_f32_16x16x32_bf16 v[44:47], v[72:75], a[128:131], v[28:31]
    v_mfma_f32_16x16x32_bf16 v[68:71], v[72:75], a[144:147], v[32:35]
    s_waitcnt lgkmcnt(3)
    v_mfma_f32_16x16x32_bf16 v[36:39], v[76:79], a[116:119], v[36:39]
    ds_read_b128 v[92:95], v13 offset:4096
    v_mfma_f32_16x16x32_bf16 v[44:47], v[76:79], a[132:135], v[44:47]
    v_mfma_f32_16x16x32_bf16 v[68:71], v[76:79], a[148:151], v[68:71]
    s_waitcnt lgkmcnt(3)
    v_mfma_f32_16x16x32_bf16 v[36:39], v[80:83], a[120:123], v[36:39]
    ds_read_b128 v[72:75], v14 offset:4096
    v_mfma_f32_16x16x32_bf16 v[44:47], v[80:83], a[136:139], v[44:47]
    v_mfma_f32_16x16x32_bf16 v[68:71], v[80:83], a[152:155], v[68:71]
    s_waitcnt lgkmcnt(3)
    v_mfma_f32_16x16x32_bf16 v[36:39], v[84:87], a[124:127], v[36:39]
    ds_read_b128 v[76:79], v15 offset:4096
    v_mfma_f32_16x16x32_bf16 v[44:47], v[84:87], a[140:143], v[44:47]
    v_mfma_f32_16x16x32_bf16 v[68:71], v[84:87], a[156:159], v[68:71]
    s_waitcnt lgkmcnt(3)
    v_mfma_f32_16x16x32_bf16 v[40:43], v[88:91], a[112:115], v[24:27]
    ds_read_b128 v[80:83], v12 offset:8192
    v_mfma_f32_16x16x32_bf16 v[48:51], v[88:91], a[128:131], v[28:31]
    s_waitcnt lgkmcnt(3)
    v_mfma_f32_16x16x32_bf16 v[40:43], v[92:95], a[116:119], v[40:43]
    ds_read_b128 v[84:87], v13 offset:8192
    v_mfma_f32_16x16x32_bf16 v[48:51], v[92:95], a[132:135], v[48:51]
    s_waitcnt lgkmcnt(3)
    v_mfma_f32_16x16x32_bf16 v[40:43], v[72:75], a[120:123], v[40:43]
    ds_read_b128 v[88:91], v14 offset:8192
    v_mfma_f32_16x16x32_bf16 v[48:51], v[72:75], a[136:139], v[48:51]
    s_waitcnt lgkmcnt(3)
    v_mfma_f32_16x16x32_bf16 v[40:43], v[76:79], a[124:127], v[40:43]
    ds_read_b128 v[92:95], v15 offset:8192
    v_mfma_f32_16x16x32_bf16 v[48:51], v[76:79], a[140:143], v[48:51]
    s_waitcnt lgkmcnt(3)
    v_mfma_f32_16x16x32_bf16 v[52:55], v[80:83], a[112:115], v[24:27]
    ds_read_b128 v[72:75], v12 offset:12288
    v_mfma_f32_16x16x32_bf16 v[60:63], v[80:83], a[128:131], v[28:31]
    s_waitcnt lgkmcnt(3)
    v_mfma_f32_16x16x32_bf16 v[52:55], v[84:87], a[116:119], v[52:55]
    ds_read_b128 v[76:79], v13 offset:12288
    v_mfma_f32_16x16x32_bf16 v[60:63], v[84:87], a[132:135], v[60:63]
    s_waitcnt lgkmcnt(3)
    v_mfma_f32_16x16x32_bf16 v[52:55], v[88:91], a[120:123], v[52:55]
    ds_read_b128 v[80:83], v14 offset:12288
    v_mfma_f32_16x16x32_bf16 v[60:63], v[88:91], a[136:139], v[60:63]
    s_waitcnt lgkmcnt(3)
    v_mfma_f32_16x16x32_bf16 v[52:55], v[92:95], a[124:127], v[52:55]
    ds_read_b128 v[84:87], v15 offset:12288
    v_mfma_f32_16x16x32_bf16 v[60:63], v[92:95], a[140:143], v[60:63]
    s_waitcnt lgkmcnt(3)
    v_mfma_f32_16x16x32_bf16 v[56:59], v[72:75], a[112:115], v[24:27]
    ds_read_b64_tr_b16 v[88:89], v4 offset:0
    ds_read_b64_tr_b16 v[90:91], v4 offset:4096
    v_mfma_f32_16x16x32_bf16 v[64:67], v[72:75], a[128:131], v[28:31]
    s_waitcnt lgkmcnt(4)
    v_mfma_f32_16x16x32_bf16 v[56:59], v[76:79], a[116:119], v[56:59]
    ds_read_b64_tr_b16 v[72:73], v5 offset:0
    ds_read_b64_tr_b16 v[74:75], v5 offset:4096
    v_mfma_f32_16x16x32_bf16 v[64:67], v[76:79], a[132:135], v[64:67]
    s_waitcnt lgkmcnt(5)
    v_mfma_f32_16x16x32_bf16 v[56:59], v[80:83], a[120:123], v[56:59]
    ds_read_b64_tr_b16 v[76:77], v6 offset:0
    ds_read_b64_tr_b16 v[78:79], v6 offset:4096
    v_mfma_f32_16x16x32_bf16 v[64:67], v[80:83], a[136:139], v[64:67]
    s_waitcnt lgkmcnt(6)
    v_mfma_f32_16x16x32_bf16 v[56:59], v[84:87], a[124:127], v[56:59]
    ds_read_b64_tr_b16 v[80:81], v7 offset:0
    ds_read_b64_tr_b16 v[82:83], v7 offset:4096
    v_mfma_f32_16x16x32_bf16 v[64:67], v[84:87], a[140:143], v[64:67]
    s_nop 7
    s_mov_b32 s51, 0xff7fffff
    v_max3_f32 v20, v36, v37, v38
    v_max3_f32 v20, v20, v39, v40
    v_max3_f32 v20, v20, v41, v42
    v_max3_f32 v20, v20, v43, v52
    v_max3_f32 v20, v20, v53, v54
    v_max3_f32 v20, v20, v55, v56
    v_max3_f32 v20, v20, v57, v58
    v_max_f32 v20, v20, v59
    v_mov_b32 v23, v20
    s_nop 1
    v_permlane16_swap_b32 v20, v23
    v_max_f32 v20, v20, v23
    v_mov_b32 v23, v20
    s_nop 1
    v_permlane32_swap_b32 v20, v23
    v_max_f32 v20, v20, v23
    v_add_f32 v20, 0x40e00000, v20
    v_max_f32 v20, s51, v20
    v_sub_f32 v36, v36, v20
    v_sub_f32 v37, v37, v20
    v_sub_f32 v38, v38, v20
    v_sub_f32 v39, v39, v20
    v_sub_f32 v40, v40, v20
    v_sub_f32 v41, v41, v20
    v_sub_f32 v42, v42, v20
    v_sub_f32 v43, v43, v20
    v_sub_f32 v52, v52, v20
    v_sub_f32 v53, v53, v20
    v_sub_f32 v54, v54, v20
    v_sub_f32 v55, v55, v20
    v_sub_f32 v56, v56, v20
    v_sub_f32 v57, v57, v20
    v_sub_f32 v58, v58, v20
    v_sub_f32 v59, v59, v20
    v_sub_f32 v24, v24, v20
    v_sub_f32 v25, v25, v20
    v_sub_f32 v26, v26, v20
    v_sub_f32 v27, v27, v20
    v_max3_f32 v21, v44, v45, v46
    v_max3_f32 v21, v21, v47, v48
    v_max3_f32 v21, v21, v49, v50
    v_max3_f32 v21, v21, v51, v60
    v_max3_f32 v21, v21, v61, v62
    v_max3_f32 v21, v21, v63, v64
    v_max3_f32 v21, v21, v65, v66
    v_max_f32 v21, v21, v67
    v_mov_b32 v23, v21
    s_nop 1
    v_permlane16_swap_b32 v21, v23
    v_max_f32 v21, v21, v23
    v_mov_b32 v23, v21
    s_nop 1
    v_permlane32_swap_b32 v21, v23
    v_max_f32 v21, v21, v23
    v_add_f32 v21, 0x40e00000, v21
    v_max_f32 v21, s51, v21
    v_sub_f32 v44, v44, v21
    v_sub_f32 v45, v45, v21
    v_sub_f32 v46, v46, v21
    v_sub_f32 v47, v47, v21
    v_sub_f32 v48, v48, v21
    v_sub_f32 v49, v49, v21
    v_sub_f32 v50, v50, v21
    v_sub_f32 v51, v51, v21
    v_sub_f32 v60, v60, v21
    v_sub_f32 v61, v61, v21
    v_sub_f32 v62, v62, v21
    v_sub_f32 v63, v63, v21
    v_sub_f32 v64, v64, v21
    v_sub_f32 v65, v65, v21
    v_sub_f32 v66, v66, v21
    v_sub_f32 v67, v67, v21
    v_sub_f32 v28, v28, v21
    v_sub_f32 v29, v29, v21
    v_sub_f32 v30, v30, v21
    v_sub_f32 v31, v31, v21
    v_max3_f32 v22, v68, v69, v70
    v_max_f32 v22, v22, v71
    v_mov_b32 v23, v22
    s_nop 1
    v_permlane16_swap_b32 v22, v23
    v_max_f32 v22, v22, v23
    v_mov_b32 v23, v22
    s_nop 1
    v_permlane32_swap_b32 v22, v23
    v_max_f32 v22, v22, v23
    v_add_f32 v22, 0x40e00000, v22
    v_max_f32 v22, s51, v22
    v_sub_f32 v68, v68, v22
    v_sub_f32 v69, v69, v22
    v_sub_f32 v70, v70, v22
    v_sub_f32 v71, v71, v22
    v_sub_f32 v32, v32, v22
    v_sub_f32 v33, v33, v22
    v_sub_f32 v34, v34, v22
    v_sub_f32 v35, v35, v22
    v_exp_f32 v36, v36
    v_exp_f32 v37, v37
    v_exp_f32 v38, v38
    v_exp_f32 v39, v39
    v_cvt_pk_bf16_f32 v36, v36, v37
    v_cvt_pk_bf16_f32 v37, v38, v39
    v_exp_f32 v44, v44
    v_exp_f32 v45, v45
    v_exp_f32 v46, v46
    v_exp_f32 v47, v47
    v_cvt_pk_bf16_f32 v44, v44, v45
    v_cvt_pk_bf16_f32 v45, v46, v47
    v_exp_f32 v68, v68
    v_exp_f32 v69, v69
    v_exp_f32 v70, v70
    v_exp_f32 v71, v71
    v_cvt_pk_bf16_f32 v68, v68, v69
    v_cvt_pk_bf16_f32 v69, v70, v71
    v_exp_f32 v40, v40
    v_exp_f32 v41, v41
    v_exp_f32 v42, v42
    v_exp_f32 v43, v43
    v_cvt_pk_bf16_f32 v38, v40, v41
    v_cvt_pk_bf16_f32 v39, v42, v43
    v_exp_f32 v48, v48
    v_exp_f32 v49, v49
    v_exp_f32 v50, v50
    v_exp_f32 v51, v51
    v_cvt_pk_bf16_f32 v46, v48, v49
    v_cvt_pk_bf16_f32 v47, v50, v51
    s_waitcnt lgkmcnt(0)
    s_branch L_w0_Aafter
L_w0_rareA:
    s_waitcnt lgkmcnt(0)
    s_nop 7
    s_nop 7
    ds_read_b128 v[20:23], v12 offset:0
    s_waitcnt lgkmcnt(0)
    v_mfma_f32_16x16x32_bf16 v[36:39], v[20:23], a[112:115], v[24:27]
    v_mfma_f32_16x16x32_bf16 v[44:47], v[20:23], a[128:131], v[28:31]
    v_mfma_f32_16x16x32_bf16 v[68:71], v[20:23], a[144:147], v[32:35]
    s_nop 1
    ds_read_b128 v[20:23], v13 offset:0
    s_waitcnt lgkmcnt(0)
    v_mfma_f32_16x16x32_bf16 v[36:39], v[20:23], a[116:119], v[36:39]
    v_mfma_f32_16x16x32_bf16 v[44:47], v[20:23], a[132:135], v[44:47]
    v_mfma_f32_16x16x32_bf16 v[68:71], v[20:23], a[148:151], v[68:71]
    s_nop 1
    ds_read_b128 v[20:23], v14 offset:0
    s_waitcnt lgkmcnt(0)
    v_mfma_f32_16x16x32_bf16 v[36:39], v[20:23], a[120:123], v[36:39]
    v_mfma_f32_16x16x32_bf16 v[44:47], v[20:23], a[136:139], v[44:47]
    v_mfma_f32_16x16x32_bf16 v[68:71], v[20:23], a[152:155], v[68:71]
    s_nop 1
    ds_read_b128 v[20:23], v15 offset:0
    s_waitcnt lgkmcnt(0)
    v_mfma_f32_16x16x32_bf16 v[36:39], v[20:23], a[124:127], v[36:39]
    v_mfma_f32_16x16x32_bf16 v[44:47], v[20:23], a[140:143], v[44:47]
    v_mfma_f32_16x16x32_bf16 v[68:71], v[20:23], a[156:159], v[68:71]
    s_nop 1
    ds_read_b128 v[20:23], v12 offset:4096
    s_waitcnt lgkmcnt(0)
    v_mfma_f32_16x16x32_bf16 v[40:43], v[20:23], a[112:115], v[24:27]
    v_mfma_f32_16x16x32_bf16 v[48:51], v[20:23], a[128:131], v[28:31]
    s_nop 1
    ds_read_b128 v[20:23], v13 offset:4096
    s_waitcnt lgkmcnt(0)
    v_mfma_f32_16x16x32_bf16 v[40:43], v[20:23], a[116:119], v[40:43]
    v_mfma_f32_16x16x32_bf16 v[48:51], v[20:23], a[132:135], v[48:51]
    s_nop 1
    ds_read_b128 v[20:23], v14 offset:4096
    s_waitcnt lgkmcnt(0)
    v_mfma_f32_16x16x32_bf16 v[40:43], v[20:23], a[120:123], v[40:43]
    v_mfma_f32_16x16x32_bf16 v[48:51], v[20:23], a[136:139], v[48:51]
    s_nop 1
    ds_read_b128 v[20:23], v15 offset:4096
    s_waitcnt lgkmcnt(0)
    v_mfma_f32_16x16x32_bf16 v[40:43], v[20:23], a[124:127], v[40:43]
    v_mfma_f32_16x16x32_bf16 v[48:51], v[20:23], a[140:143], v[48:51]
    s_nop 1
    s_nop 7
    s_nop 3
    s_mov_b32 s51, 0
    v_max3_f32 v20, v36, v37, v38
    v_max3_f32 v20, v20, v39, v40
    v_max3_f32 v20, v20, v41, v42
    v_max3_f32 v20, v20, v43, v52
    v_max3_f32 v20, v20, v53, v54
    v_max3_f32 v20, v20, v55, v56
    v_max3_f32 v20, v20, v57, v58
    v_max_f32 v20, v20, v59
    v_mov_b32 v23, v20
    s_nop 1
    v_permlane16_swap_b32 v20, v23
    v_max_f32 v20, v20, v23
    v_mov_b32 v23, v20
    s_nop 1
    v_permlane32_swap_b32 v20, v23
    v_max_f32 v20, v20, v23
    v_add_f32 v20, 0x40e00000, v20
    v_max_f32 v20, s51, v20
    v_sub_f32 v36, v36, v20
    v_sub_f32 v37, v37, v20
    v_sub_f32 v38, v38, v20
    v_sub_f32 v39, v39, v20
    v_sub_f32 v40, v40, v20
    v_sub_f32 v41, v41, v20
    v_sub_f32 v42, v42, v20
    v_sub_f32 v43, v43, v20
    v_sub_f32 v52, v52, v20
    v_sub_f32 v53, v53, v20
    v_sub_f32 v54, v54, v20
    v_sub_f32 v55, v55, v20
    v_sub_f32 v56, v56, v20
    v_sub_f32 v57, v57, v20
    v_sub_f32 v58, v58, v20
    v_sub_f32 v59, v59, v20
    v_sub_f32 v24, v24, v20
    v_sub_f32 v25, v25, v20
    v_sub_f32 v26, v26, v20
    v_sub_f32 v27, v27, v20
    v_max3_f32 v21, v44, v45, v46
    v_max3_f32 v21, v21, v47, v48
    v_max3_f32 v21, v21, v49, v50
    v_max3_f32 v21, v21, v51, v60
    v_max3_f32 v21, v21, v61, v62
    v_max3_f32 v21, v21, v63, v64
    v_max3_f32 v21, v21, v65, v66
    v_max_f32 v21, v21, v67
    v_mov_b32 v23, v21
    s_nop 1
    v_permlane16_swap_b32 v21, v23
    v_max_f32 v21, v21, v23
    v_mov_b32 v23, v21
    s_nop 1
    v_permlane32_swap_b32 v21, v23
    v_max_f32 v21, v21, v23
    v_add_f32 v21, 0x40e00000, v21
    v_max_f32 v21, s51, v21
    v_sub_f32 v44, v44, v21
    v_sub_f32 v45, v45, v21
    v_sub_f32 v46, v46, v21
    v_sub_f32 v47, v47, v21
    v_sub_f32 v48, v48, v21
    v_sub_f32 v49, v49, v21
    v_sub_f32 v50, v50, v21
    v_sub_f32 v51, v51, v21
    v_sub_f32 v60, v60, v21
    v_sub_f32 v61, v61, v21
    v_sub_f32 v62, v62, v21
    v_sub_f32 v63, v63, v21
    v_sub_f32 v64, v64, v21
    v_sub_f32 v65, v65, v21
    v_sub_f32 v66, v66, v21
    v_sub_f32 v67, v67, v21
    v_sub_f32 v28, v28, v21
    v_sub_f32 v29, v29, v21
    v_sub_f32 v30, v30, v21
    v_sub_f32 v31, v31, v21
    v_max3_f32 v22, v68, v69, v70
    v_max_f32 v22, v22, v71
    v_mov_b32 v23, v22
    s_nop 1
    v_permlane16_swap_b32 v22, v23
    v_max_f32 v22, v22, v23
    v_mov_b32 v23, v22
    s_nop 1
    v_permlane32_swap_b32 v22, v23
    v_max_f32 v22, v22, v23
    v_add_f32 v22, 0x40e00000, v22
    v_max_f32 v22, s51, v22
    v_sub_f32 v68, v68, v22
    v_sub_f32 v69, v69, v22
    v_sub_f32 v70, v70, v22
    v_sub_f32 v71, v71, v22
    v_sub_f32 v32, v32, v22
    v_sub_f32 v33, v33, v22
    v_sub_f32 v34, v34, v22
    v_sub_f32 v35, v35, v22
    s_mov_b32 s53, 0
    s_branch L_w0_resc
L_w0_rareB:
    s_waitcnt lgkmcnt(0)
    s_nop 7
    s_nop 7
    ds_read_b128 v[20:23], v12 offset:8192
    s_waitcnt lgkmcnt(0)
    v_mfma_f32_16x16x32_bf16 v[52:55], v[20:23], a[112:115], v[24:27]
    v_mfma_f32_16x16x32_bf16 v[60:63], v[20:23], a[128:131], v[28:31]
    s_nop 1
    ds_read_b128 v[20:23], v13 offset:8192
    s_waitcnt lgkmcnt(0)
    v_mfma_f32_16x16x32_bf16 v[52:55], v[20:23], a[116:119], v[52:55]
    v_mfma_f32_16x16x32_bf16 v[60:63], v[20:23], a[132:135], v[60:63]
    s_nop 1
    ds_read_b128 v[20:23], v14 offset:8192
    s_waitcnt lgkmcnt(0)
    v_mfma_f32_16x16x32_bf16 v[52:55], v[20:23], a[120:123], v[52:55]
    v_mfma_f32_16x16x32_bf16 v[60:63], v[20:23], a[136:139], v[60:63]
    s_nop 1
    ds_read_b128 v[20:23], v15 offset:8192
    s_waitcnt lgkmcnt(0)
    v_mfma_f32_16x16x32_bf16 v[52:55], v[20:23], a[124:127], v[52:55]
    v_mfma_f32_16x16x32_bf16 v[60:63], v[20:23], a[140:143], v[60:63]
    s_nop 1
    ds_read_b128 v[20:23], v12 offset:12288
    s_waitcnt lgkmcnt(0)
    v_mfma_f32_16x16x32_bf16 v[56:59], v[20:23], a[112:115], v[24:27]
    v_mfma_f32_16x16x32_bf16 v[64:67], v[20:23], a[128:131], v[28:31]
    s_nop 1
    ds_read_b128 v[20:23], v13 offset:12288
    s_waitcnt lgkmcnt(0)
    v_mfma_f32_16x16x32_bf16 v[56:59], v[20:23], a[116:119], v[56:59]
    v_mfma_f32_16x16x32_bf16 v[64:67], v[20:23], a[132:135], v[64:67]
    s_nop 1
    ds_read_b128 v[20:23], v14 offset:12288
    s_waitcnt lgkmcnt(0)
    v_mfma_f32_16x16x32_bf16 v[56:59], v[20:23], a[120:123], v[56:59]
    v_mfma_f32_16x16x32_bf16 v[64:67], v[20:23], a[136:139], v[64:67]
    s_nop 1
    ds_read_b128 v[20:23], v15 offset:12288
    s_waitcnt lgkmcnt(0)
    v_mfma_f32_16x16x32_bf16 v[56:59], v[20:23], a[124:127], v[56:59]
    v_mfma_f32_16x16x32_bf16 v[64:67], v[20:23], a[140:143], v[64:67]
    s_nop 1
    s_nop 7
    s_nop 3
    s_mov_b32 s51, 0
    v_max3_f32 v20, v52, v53, v54
    v_max3_f32 v20, v20, v55, v56
    v_max3_f32 v20, v20, v57, v58
    v_max_f32 v20, v20, v59
    v_mov_b32 v23, v20
    s_nop 1
    v_permlane16_swap_b32 v20, v23
    v_max_f32 v20, v20, v23
    v_mov_b32 v23, v20
    s_nop 1
    v_permlane32_swap_b32 v20, v23
    v_max_f32 v20, v20, v23
    v_add_f32 v20, 0x40e00000, v20
    v_max_f32 v20, s51, v20
    v_sub_f32 v52, v52, v20
    v_sub_f32 v53, v53, v20
    v_sub_f32 v54, v54, v20
    v_sub_f32 v55, v55, v20
    v_sub_f32 v56, v56, v20
    v_sub_f32 v57, v57, v20
    v_sub_f32 v58, v58, v20
    v_sub_f32 v59, v59, v20
    v_sub_f32 v24, v24, v20
    v_sub_f32 v25, v25, v20
    v_sub_f32 v26, v26, v20
    v_sub_f32 v27, v27, v20
    v_max3_f32 v21, v60, v61, v62
    v_max3_f32 v21, v21, v63, v64
    v_max3_f32 v21, v21, v65, v66
    v_max_f32 v21, v21, v67
    v_mov_b32 v23, v21
    s_nop 1
    v_permlane16_swap_b32 v21, v23
    v_max_f32 v21, v21, v23
    v_mov_b32 v23, v21
    s_nop 1
    v_permlane32_swap_b32 v21, v23
    v_max_f32 v21, v21, v23
    v_add_f32 v21, 0x40e00000, v21
    v_max_f32 v21, s51, v21
    v_sub_f32 v60, v60, v21
    v_sub_f32 v61, v61, v21
    v_sub_f32 v62, v62, v21
    v_sub_f32 v63, v63, v21
    v_sub_f32 v64, v64, v21
    v_sub_f32 v65, v65, v21
    v_sub_f32 v66, v66, v21
    v_sub_f32 v67, v67, v21
    v_sub_f32 v28, v28, v21
    v_sub_f32 v29, v29, v21
    v_sub_f32 v30, v30, v21
    v_sub_f32 v31, v31, v21
    v_mov_b32 v22, 0
    s_mov_b32 s53, 1
L_w0_resc:
    v_exp_f32 v20, -v20
    v_exp_f32 v21, -v21
    v_exp_f32 v22, -v22
    v_accvgpr_read_b32 v23, a0
    v_mul_f32 v23, v23, v20
    v_accvgpr_write_b32 a0, v23
    v_accvgpr_read_b32 v23, a1
    v_mul_f32 v23, v23, v20
    v_accvgpr_write_b32 a1, v23
    v_accvgpr_read_b32 v23, a2
    v_mul_f32 v23, v23, v20
    v_accvgpr_write_b32 a2, v23
    v_accvgpr_read_b32 v23, a3
    v_mul_f32 v23, v23, v20
    v_accvgpr_write_b32 a3, v23
    v_accvgpr_read_b32 v23, a4
    v_mul_f32 v23, v23, v21
    v_accvgpr_write_b32 a4, v23
    v_accvgpr_read_b32 v23, a5
    v_mul_f32 v23, v23, v21
    v_accvgpr_write_b32 a5, v23
    v_accvgpr_read_b32 v23, a6
    v_mul_f32 v23, v23, v21
    v_accvgpr_write_b32 a6, v23
    v_accvgpr_read_b32 v23, a7
    v_mul_f32 v23, v23, v21
    v_accvgpr_write_b32 a7, v23
    v_accvgpr_read_b32 v23, a64
    v_mul_f32 v23, v23, v22
    v_accvgpr_write_b32 a64, v23
    v_accvgpr_read_b32 v23, a65
    v_mul_f32 v23, v23, v22
    v_accvgpr_write_b32 a65, v23
    v_accvgpr_read_b32 v23, a66
    v_mul_f32 v23, v23, v22
    v_accvgpr_write_b32 a66, v23
    v_accvgpr_read_b32 v23, a67
    v_mul_f32 v23, v23, v22
    v_accvgpr_write_b32 a67, v23
    v_accvgpr_read_b32 v23, a8
    v_mul_f32 v23, v23, v20
    v_accvgpr_write_b32 a8, v23
    v_accvgpr_read_b32 v23, a9
    v_mul_f32 v23, v23, v20
    v_accvgpr_write_b32 a9, v23
    v_accvgpr_read_b32 v23, a10
    v_mul_f32 v23, v23, v20
    v_accvgpr_write_b32 a10, v23
    v_accvgpr_read_b32 v23, a11
    v_mul_f32 v23, v23, v20
    v_accvgpr_write_b32 a11, v23
    v_accvgpr_read_b32 v23, a12
    v_mul_f32 v23, v23, v21
    v_accvgpr_write_b32 a12, v23
    v_accvgpr_read_b32 v23, a13
    v_mul_f32 v23, v23, v21
    v_accvgpr_write_b32 a13, v23
    v_accvgpr_read_b32 v23, a14
    v_mul_f32 v23, v23, v21
    v_accvgpr_write_b32 a14, v23
    v_accvgpr_read_b32 v23, a15
    v_mul_f32 v23, v23, v21
    v_accvgpr_write_b32 a15, v23
    v_accvgpr_read_b32 v23, a68
    v_mul_f32 v23, v23, v22
    v_accvgpr_write_b32 a68, v23
    v_accvgpr_read_b32 v23, a69
    v_mul_f32 v23, v23, v22
    v_accvgpr_write_b32 a69, v23
    v_accvgpr_read_b32 v23, a70
    v_mul_f32 v23, v23, v22
    v_accvgpr_write_b32 a70, v23
    v_accvgpr_read_b32 v23, a71
    v_mul_f32 v23, v23, v22
    v_accvgpr_write_b32 a71, v23
    v_accvgpr_read_b32 v23, a16
    v_mul_f32 v23, v23, v20
    v_accvgpr_write_b32 a16, v23
    v_accvgpr_read_b32 v23, a17
    v_mul_f32 v23, v23, v20
    v_accvgpr_write_b32 a17, v23
    v_accvgpr_read_b32 v23, a18
    v_mul_f32 v23, v23, v20
    v_accvgpr_write_b32 a18, v23
    v_accvgpr_read_b32 v23, a19
    v_mul_f32 v23, v23, v20
    v_accvgpr_write_b32 a19, v23
    v_accvgpr_read_b32 v23, a20
    v_mul_f32 v23, v23, v21
    v_accvgpr_write_b32 a20, v23
    v_accvgpr_read_b32 v23, a21
    v_mul_f32 v23, v23, v21
    v_accvgpr_write_b32 a21, v23
    v_accvgpr_read_b32 v23, a22
    v_mul_f32 v23, v23, v21
    v_accvgpr_write_b32 a22, v23
    v_accvgpr_read_b32 v23, a23
    v_mul_f32 v23, v23, v21
    v_accvgpr_write_b32 a23, v23
    v_accvgpr_read_b32 v23, a72
    v_mul_f32 v23, v23, v22
    v_accvgpr_write_b32 a72, v23
    v_accvgpr_read_b32 v23, a73
    v_mul_f32 v23, v23, v22
    v_accvgpr_write_b32 a73, v23
    v_accvgpr_read_b32 v23, a74
    v_mul_f32 v23, v23, v22
    v_accvgpr_write_b32 a74, v23
    v_accvgpr_read_b32 v23, a75
    v_mul_f32 v23, v23, v22
    v_accvgpr_write_b32 a75, v23
    v_accvgpr_read_b32 v23, a24
    v_mul_f32 v23, v23, v20
    v_accvgpr_write_b32 a24, v23
    v_accvgpr_read_b32 v23, a25
    v_mul_f32 v23, v23, v20
    v_accvgpr_write_b32 a25, v23
    v_accvgpr_read_b32 v23, a26
    v_mul_f32 v23, v23, v20
    v_accvgpr_write_b32 a26, v23
    v_accvgpr_read_b32 v23, a27
    v_mul_f32 v23, v23, v20
    v_accvgpr_write_b32 a27, v23
    v_accvgpr_read_b32 v23, a28
    v_mul_f32 v23, v23, v21
    v_accvgpr_write_b32 a28, v23
    v_accvgpr_read_b32 v23, a29
    v_mul_f32 v23, v23, v21
    v_accvgpr_write_b32 a29, v23
    v_accvgpr_read_b32 v23, a30
    v_mul_f32 v23, v23, v21
    v_accvgpr_write_b32 a30, v23
    v_accvgpr_read_b32 v23, a31
    v_mul_f32 v23, v23, v21
    v_accvgpr_write_b32 a31, v23
    v_accvgpr_read_b32 v23, a76
    v_mul_f32 v23, v23, v22
    v_accvgpr_write_b32 a76, v23
    v_accvgpr_read_b32 v23, a77
    v_mul_f32 v23, v23, v22
    v_accvgpr_write_b32 a77, v23
    v_accvgpr_read_b32 v23, a78
    v_mul_f32 v23, v23, v22
    v_accvgpr_write_b32 a78, v23
    v_accvgpr_read_b32 v23, a79
    v_mul_f32 v23, v23, v22
    v_accvgpr_write_b32 a79, v23
    v_accvgpr_read_b32 v23, a32
    v_mul_f32 v23, v23, v20
    v_accvgpr_write_b32 a32, v23
    v_accvgpr_read_b32 v23, a33
    v_mul_f32 v23, v23, v20
    v_accvgpr_write_b32 a33, v23
    v_accvgpr_read_b32 v23, a34
    v_mul_f32 v23, v23, v20
    v_accvgpr_write_b32 a34, v23
    v_accvgpr_read_b32 v23, a35
    v_mul_f32 v23, v23, v20
    v_accvgpr_write_b32 a35, v23
    v_accvgpr_read_b32 v23, a36
    v_mul_f32 v23, v23, v21
    v_accvgpr_write_b32 a36, v23
    v_accvgpr_read_b32 v23, a37
    v_mul_f32 v23, v23, v21
    v_accvgpr_write_b32 a37, v23
    v_accvgpr_read_b32 v23, a38
    v_mul_f32 v23, v23, v21
    v_accvgpr_write_b32 a38, v23
    v_accvgpr_read_b32 v23, a39
    v_mul_f32 v23, v23, v21
    v_accvgpr_write_b32 a39, v23
    v_accvgpr_read_b32 v23, a80
    v_mul_f32 v23, v23, v22
    v_accvgpr_write_b32 a80, v23
    v_accvgpr_read_b32 v23, a81
    v_mul_f32 v23, v23, v22
    v_accvgpr_write_b32 a81, v23
    v_accvgpr_read_b32 v23, a82
    v_mul_f32 v23, v23, v22
    v_accvgpr_write_b32 a82, v23
    v_accvgpr_read_b32 v23, a83
    v_mul_f32 v23, v23, v22
    v_accvgpr_write_b32 a83, v23
    v_accvgpr_read_b32 v23, a40
    v_mul_f32 v23, v23, v20
    v_accvgpr_write_b32 a40, v23
    v_accvgpr_read_b32 v23, a41
    v_mul_f32 v23, v23, v20
    v_accvgpr_write_b32 a41, v23
    v_accvgpr_read_b32 v23, a42
    v_mul_f32 v23, v23, v20
    v_accvgpr_write_b32 a42, v23
    v_accvgpr_read_b32 v23, a43
    v_mul_f32 v23, v23, v20
    v_accvgpr_write_b32 a43, v23
    v_accvgpr_read_b32 v23, a44
    v_mul_f32 v23, v23, v21
    v_accvgpr_write_b32 a44, v23
    v_accvgpr_read_b32 v23, a45
    v_mul_f32 v23, v23, v21
    v_accvgpr_write_b32 a45, v23
    v_accvgpr_read_b32 v23, a46
    v_mul_f32 v23, v23, v21
    v_accvgpr_write_b32 a46, v23
    v_accvgpr_read_b32 v23, a47
    v_mul_f32 v23, v23, v21
    v_accvgpr_write_b32 a47, v23
    v_accvgpr_read_b32 v23, a84
    v_mul_f32 v23, v23, v22
    v_accvgpr_write_b32 a84, v23
    v_accvgpr_read_b32 v23, a85
    v_mul_f32 v23, v23, v22
    v_accvgpr_write_b32 a85, v23
    v_accvgpr_read_b32 v23, a86
    v_mul_f32 v23, v23, v22
    v_accvgpr_write_b32 a86, v23
    v_accvgpr_read_b32 v23, a87
    v_mul_f32 v23, v23, v22
    v_accvgpr_write_b32 a87, v23
    v_accvgpr_read_b32 v23, a48
    v_mul_f32 v23, v23, v20
    v_accvgpr_write_b32 a48, v23
    v_accvgpr_read_b32 v23, a49
    v_mul_f32 v23, v23, v20
    v_accvgpr_write_b32 a49, v23
    v_accvgpr_read_b32 v23, a50
    v_mul_f32 v23, v23, v20
    v_accvgpr_write_b32 a50, v23
    v_accvgpr_read_b32 v23, a51
    v_mul_f32 v23, v23, v20
    v_accvgpr_write_b32 a51, v23
    v_accvgpr_read_b32 v23, a52
    v_mul_f32 v23, v23, v21
    v_accvgpr_write_b32 a52, v23
    v_accvgpr_read_b32 v23, a53
    v_mul_f32 v23, v23, v21
    v_accvgpr_write_b32 a53, v23
    v_accvgpr_read_b32 v23, a54
    v_mul_f32 v23, v23, v21
    v_accvgpr_write_b32 a54, v23
    v_accvgpr_read_b32 v23, a55
    v_mul_f32 v23, v23, v21
    v_accvgpr_write_b32 a55, v23
    v_accvgpr_read_b32 v23, a88
    v_mul_f32 v23, v23, v22
    v_accvgpr_write_b32 a88, v23
    v_accvgpr_read_b32 v23, a89
    v_mul_f32 v23, v23, v22
    v_accvgpr_write_b32 a89, v23
    v_accvgpr_read_b32 v23, a90
    v_mul_f32 v23, v23, v22
    v_accvgpr_write_b32 a90, v23
    v_accvgpr_read_b32 v23, a91
    v_mul_f32 v23, v23, v22
    v_accvgpr_write_b32 a91, v23
    v_accvgpr_read_b32 v23, a56
    v_mul_f32 v23, v23, v20
    v_accvgpr_write_b32 a56, v23
    v_accvgpr_read_b32 v23, a57
    v_mul_f32 v23, v23, v20
    v_accvgpr_write_b32 a57, v23
    v_accvgpr_read_b32 v23, a58
    v_mul_f32 v23, v23, v20
    v_accvgpr_write_b32 a58, v23
    v_accvgpr_read_b32 v23, a59
    v_mul_f32 v23, v23, v20
    v_accvgpr_write_b32 a59, v23
    v_accvgpr_read_b32 v23, a60
    v_mul_f32 v23, v23, v21
    v_accvgpr_write_b32 a60, v23
    v_accvgpr_read_b32 v23, a61
    v_mul_f32 v23, v23, v21
    v_accvgpr_write_b32 a61, v23
    v_accvgpr_read_b32 v23, a62
    v_mul_f32 v23, v23, v21
    v_accvgpr_write_b32 a62, v23
    v_accvgpr_read_b32 v23, a63
    v_mul_f32 v23, v23, v21
    v_accvgpr_write_b32 a63, v23
    v_accvgpr_read_b32 v23, a92
    v_mul_f32 v23, v23, v22
    v_accvgpr_write_b32 a92, v23
    v_accvgpr_read_b32 v23, a93
    v_mul_f32 v23, v23, v22
    v_accvgpr_write_b32 a93, v23
    v_accvgpr_read_b32 v23, a94
    v_mul_f32 v23, v23, v22
    v_accvgpr_write_b32 a94, v23
    v_accvgpr_read_b32 v23, a95
    v_mul_f32 v23, v23, v22
    v_accvgpr_write_b32 a95, v23
    v_accvgpr_read_b32 v23, a96
    v_mul_f32 v23, v23, v20
    v_accvgpr_write_b32 a96, v23
    v_accvgpr_read_b32 v23, a97
    v_mul_f32 v23, v23, v20
    v_accvgpr_write_b32 a97, v23
    v_accvgpr_read_b32 v23, a98
    v_mul_f32 v23, v23, v20
    v_accvgpr_write_b32 a98, v23
    v_accvgpr_read_b32 v23, a99
    v_mul_f32 v23, v23, v20
    v_accvgpr_write_b32 a99, v23
    v_accvgpr_read_b32 v23, a100
    v_mul_f32 v23, v23, v21
    v_accvgpr_write_b32 a100, v23
    v_accvgpr_read_b32 v23, a101
    v_mul_f32 v23, v23, v21
    v_accvgpr_write_b32 a101, v23
    v_accvgpr_read_b32 v23, a102
    v_mul_f32 v23, v23, v21
    v_accvgpr_write_b32 a102, v23
    v_accvgpr_read_b32 v23, a103
    v_mul_f32 v23, v23, v21
    v_accvgpr_write_b32 a103, v23
    v_accvgpr_read_b32 v23, a104
    v_mul_f32 v23, v23, v22
    v_accvgpr_write_b32 a104, v23
    v_accvgpr_read_b32 v23, a105
    v_mul_f32 v23, v23, v22
    v_accvgpr_write_b32 a105, v23
    v_accvgpr_read_b32 v23, a106
    v_mul_f32 v23, v23, v22
    v_accvgpr_write_b32 a106, v23
    v_accvgpr_read_b32 v23, a107
    v_mul_f32 v23, v23, v22
    v_accvgpr_write_b32 a107, v23
    s_cmp_eq_u32 s53, 1
    s_cbranch_scc1 L_w0_retB
    v_exp_f32 v36, v36
    v_exp_f32 v37, v37
    v_exp_f32 v38, v38
    v_exp_f32 v39, v39
    v_cvt_pk_bf16_f32 v36, v36, v37
    v_cvt_pk_bf16_f32 v37, v38, v39
    v_exp_f32 v44, v44
    v_exp_f32 v45, v45
    v_exp_f32 v46, v46
    v_exp_f32 v47, v47
    v_cvt_pk_bf16_f32 v44, v44, v45
    v_cvt_pk_bf16_f32 v45, v46, v47
    v_exp_f32 v68, v68
    v_exp_f32 v69, v69
    v_exp_f32 v70, v70
    v_exp_f32 v71, v71
    v_cvt_pk_bf16_f32 v68, v68, v69
    v_cvt_pk_bf16_f32 v69, v70, v71
    v_exp_f32 v40, v40
    v_exp_f32 v41, v41
    v_exp_f32 v42, v42
    v_exp_f32 v43, v43
    v_cvt_pk_bf16_f32 v38, v40, v41
    v_cvt_pk_bf16_f32 v39, v42, v43
    v_exp_f32 v48, v48
    v_exp_f32 v49, v49
    v_exp_f32 v50, v50
    v_exp_f32 v51, v51
    v_cvt_pk_bf16_f32 v46, v48, v49
    v_cvt_pk_bf16_f32 v47, v50, v51
    s_branch L_w0_Aafter
L_w0_retB:
    v_exp_f32 v52, v52
    v_exp_f32 v53, v53
    v_exp_f32 v54, v54
    v_exp_f32 v55, v55
    v_cvt_pk_bf16_f32 v52, v52, v53
    v_cvt_pk_bf16_f32 v53, v54, v55
    v_exp_f32 v60, v60
    v_exp_f32 v61, v61
    v_exp_f32 v62, v62
    v_exp_f32 v63, v63
    v_cvt_pk_bf16_f32 v60, v60, v61
    v_cvt_pk_bf16_f32 v61, v62, v63
    v_exp_f32 v56, v56
    v_exp_f32 v57, v57
    v_exp_f32 v58, v58
    v_exp_f32 v59, v59
    v_cvt_pk_bf16_f32 v54, v56, v57
    v_cvt_pk_bf16_f32 v55, v58, v59
    v_exp_f32 v64, v64
    v_exp_f32 v65, v65
    v_exp_f32 v66, v66
    v_exp_f32 v67, v67
    v_cvt_pk_bf16_f32 v62, v64, v65
    v_cvt_pk_bf16_f32 v63, v66, v67
    s_branch L_w0_Bafter
L_w0_done:
    s_add_u32 s8, s32, 524288
    s_addc_u32 s9, s33, 0
    s_mov_b32 s10, 131072
    s_mov_b32 s11, 0x20000
    s_add_u32 s12, s36, 524288
    s_addc_u32 s13, s37, 0
    s_mov_b32 s14, 131072
    s_mov_b32 s15, 0x20000
    s_nop 7
    v_lshlrev_b32 v0, 4, v1
    v_accvgpr_read_b32 v22, a104
    v_lshlrev_b32 v12, 2, v1
    v_add_u32 v12, 131072, v12
    ds_write_b32 v12, v32 offset:0
    ds_write_b32 v12, v22 offset:1024
    v_accvgpr_read_b32 v20, a96
    v_accvgpr_read_b32 v21, a100
    v_rcp_f32 v20, v20
    v_rcp_f32 v21, v21
    v_accvgpr_read_b32 v72, a0
    v_accvgpr_read_b32 v76, a8
    v_accvgpr_read_b32 v73, a1
    v_accvgpr_read_b32 v77, a9
    v_accvgpr_read_b32 v74, a2
    v_accvgpr_read_b32 v78, a10
    v_accvgpr_read_b32 v75, a3
    v_accvgpr_read_b32 v79, a11
    v_mul_f32 v72, v72, v20
    v_mul_f32 v73, v73, v20
    v_mul_f32 v74, v74, v20
    v_mul_f32 v75, v75, v20
    v_mul_f32 v76, v76, v20
    v_mul_f32 v77, v77, v20
    v_mul_f32 v78, v78, v20
    v_mul_f32 v79, v79, v20
    v_cvt_pk_bf16_f32 v72, v72, v73
    v_cvt_pk_bf16_f32 v73, v74, v75
    v_cvt_pk_bf16_f32 v74, v76, v77
    v_cvt_pk_bf16_f32 v75, v78, v79
    s_mov_b32 s48, 0
    buffer_store_dwordx4 v[72:75], v0, s[40:43], s48 offen sc1
    v_accvgpr_read_b32 v80, a16
    v_accvgpr_read_b32 v84, a24
    v_accvgpr_read_b32 v81, a17
    v_accvgpr_read_b32 v85, a25
    v_accvgpr_read_b32 v82, a18
    v_accvgpr_read_b32 v86, a26
    v_accvgpr_read_b32 v83, a19
    v_accvgpr_read_b32 v87, a27
    v_mul_f32 v80, v80, v20
    v_mul_f32 v81, v81, v20
    v_mul_f32 v82, v82, v20
    v_mul_f32 v83, v83, v20
    v_mul_f32 v84, v84, v20
    v_mul_f32 v85, v85, v20
    v_mul_f32 v86, v86, v20
    v_mul_f32 v87, v87, v20
    v_cvt_pk_bf16_f32 v80, v80, v81
    v_cvt_pk_bf16_f32 v81, v82, v83
    v_cvt_pk_bf16_f32 v82, v84, v85
    v_cvt_pk_bf16_f32 v83, v86, v87
    s_mov_b32 s48, 1024
    buffer_store_dwordx4 v[80:83], v0, s[40:43], s48 offen sc1
    v_accvgpr_read_b32 v88, a32
    v_accvgpr_read_b32 v92, a40
    v_accvgpr_read_b32 v89, a33
    v_accvgpr_read_b32 v93, a41
    v_accvgpr_read_b32 v90, a34
    v_accvgpr_read_b32 v94, a42
    v_accvgpr_read_b32 v91, a35
    v_accvgpr_read_b32 v95, a43
    v_mul_f32 v88, v88, v20
    v_mul_f32 v89, v89, v20
    v_mul_f32 v90, v90, v20
    v_mul_f32 v91, v91, v20
    v_mul_f32 v92, v92, v20
    v_mul_f32 v93, v93, v20
    v_mul_f32 v94, v94, v20
    v_mul_f32 v95, v95, v20
    v_cvt_pk_bf16_f32 v88, v88, v89
    v_cvt_pk_bf16_f32 v89, v90, v91
    v_cvt_pk_bf16_f32 v90, v92, v93
    v_cvt_pk_bf16_f32 v91, v94, v95
    s_mov_b32 s48, 2048
    buffer_store_dwordx4 v[88:91], v0, s[40:43], s48 offen sc1
    v_accvgpr_read_b32 v72, a48
    v_accvgpr_read_b32 v76, a56
    v_accvgpr_read_b32 v73, a49
    v_accvgpr_read_b32 v77, a57
    v_accvgpr_read_b32 v74, a50
    v_accvgpr_read_b32 v78, a58
    v_accvgpr_read_b32 v75, a51
    v_accvgpr_read_b32 v79, a59
    v_mul_f32 v72, v72, v20
    v_mul_f32 v73, v73, v20
    v_mul_f32 v74, v74, v20
    v_mul_f32 v75, v75, v20
    v_mul_f32 v76, v76, v20
    v_mul_f32 v77, v77, v20
    v_mul_f32 v78, v78, v20
    v_mul_f32 v79, v79, v20
    v_cvt_pk_bf16_f32 v72, v72, v73
    v_cvt_pk_bf16_f32 v73, v74, v75
    v_cvt_pk_bf16_f32 v74, v76, v77
    v_cvt_pk_bf16_f32 v75, v78, v79
    s_mov_b32 s48, 3072
    buffer_store_dwordx4 v[72:75], v0, s[40:43], s48 offen sc1
    v_accvgpr_read_b32 v80, a4
    v_accvgpr_read_b32 v84, a12
    v_accvgpr_read_b32 v81, a5
    v_accvgpr_read_b32 v85, a13
    v_accvgpr_read_b32 v82, a6
    v_accvgpr_read_b32 v86, a14
    v_accvgpr_read_b32 v83, a7
    v_accvgpr_read_b32 v87, a15
    v_mul_f32 v80, v80, v21
    v_mul_f32 v81, v81, v21
    v_mul_f32 v82, v82, v21
    v_mul_f32 v83, v83, v21
    v_mul_f32 v84, v84, v21
    v_mul_f32 v85, v85, v21
    v_mul_f32 v86, v86, v21
    v_mul_f32 v87, v87, v21
    v_cvt_pk_bf16_f32 v80, v80, v81
    v_cvt_pk_bf16_f32 v81, v82, v83
    v_cvt_pk_bf16_f32 v82, v84, v85
    v_cvt_pk_bf16_f32 v83, v86, v87
    s_mov_b32 s48, 4096
    buffer_store_dwordx4 v[80:83], v0, s[40:43], s48 offen sc1
    v_accvgpr_read_b32 v88, a20
    v_accvgpr_read_b32 v92, a28
    v_accvgpr_read_b32 v89, a21
    v_accvgpr_read_b32 v93, a29
    v_accvgpr_read_b32 v90, a22
    v_accvgpr_read_b32 v94, a30
    v_accvgpr_read_b32 v91, a23
    v_accvgpr_read_b32 v95, a31
    v_mul_f32 v88, v88, v21
    v_mul_f32 v89, v89, v21
    v_mul_f32 v90, v90, v21
    v_mul_f32 v91, v91, v21
    v_mul_f32 v92, v92, v21
    v_mul_f32 v93, v93, v21
    v_mul_f32 v94, v94, v21
    v_mul_f32 v95, v95, v21
    v_cvt_pk_bf16_f32 v88, v88, v89
    v_cvt_pk_bf16_f32 v89, v90, v91
    v_cvt_pk_bf16_f32 v90, v92, v93
    v_cvt_pk_bf16_f32 v91, v94, v95
    s_mov_b32 s48, 5120
    buffer_store_dwordx4 v[88:91], v0, s[40:43], s48 offen sc1
    v_accvgpr_read_b32 v72, a36
    v_accvgpr_read_b32 v76, a44
    v_accvgpr_read_b32 v73, a37
    v_accvgpr_read_b32 v77, a45
    v_accvgpr_read_b32 v74, a38
    v_accvgpr_read_b32 v78, a46
    v_accvgpr_read_b32 v75, a39
    v_accvgpr_read_b32 v79, a47
    v_mul_f32 v72, v72, v21
    v_mul_f32 v73, v73, v21
    v_mul_f32 v74, v74, v21
    v_mul_f32 v75, v75, v21
    v_mul_f32 v76, v76, v21
    v_mul_f32 v77, v77, v21
    v_mul_f32 v78, v78, v21
    v_mul_f32 v79, v79, v21
    v_cvt_pk_bf16_f32 v72, v72, v73
    v_cvt_pk_bf16_f32 v73, v74, v75
    v_cvt_pk_bf16_f32 v74, v76, v77
    v_cvt_pk_bf16_f32 v75, v78, v79
    s_mov_b32 s48, 6144
    buffer_store_dwordx4 v[72:75], v0, s[40:43], s48 offen sc1
    v_accvgpr_read_b32 v80, a52
    v_accvgpr_read_b32 v84, a60
    v_accvgpr_read_b32 v81, a53
    v_accvgpr_read_b32 v85, a61
    v_accvgpr_read_b32 v82, a54
    v_accvgpr_read_b32 v86, a62
    v_accvgpr_read_b32 v83, a55
    v_accvgpr_read_b32 v87, a63
    v_mul_f32 v80, v80, v21
    v_mul_f32 v81, v81, v21
    v_mul_f32 v82, v82, v21
    v_mul_f32 v83, v83, v21
    v_mul_f32 v84, v84, v21
    v_mul_f32 v85, v85, v21
    v_mul_f32 v86, v86, v21
    v_mul_f32 v87, v87, v21
    v_cvt_pk_bf16_f32 v80, v80, v81
    v_cvt_pk_bf16_f32 v81, v82, v83
    v_cvt_pk_bf16_f32 v82, v84, v85
    v_cvt_pk_bf16_f32 v83, v86, v87
    s_mov_b32 s48, 7168
    buffer_store_dwordx4 v[80:83], v0, s[40:43], s48 offen sc1
    s_waitcnt lgkmcnt(0)
    s_barrier
    s_cmp_lg_u32 s6, 0
    s_cbranch_scc1 L_h0_0
    s_add_u32 m0, s57, 0
    s_add_u32 s48, s57, 65536
    buffer_load_dwordx4 v16, s[8:11], s48 offen offset:0 nt lds
    buffer_load_dwordx4 v17, s[8:11], s48 offen offset:1024 nt lds
    buffer_load_dwordx4 v16, s[8:11], s48 offen offset:2048 nt lds
    buffer_load_dwordx4 v17, s[8:11], s48 offen offset:3072 nt lds
    s_add_u32 m0, s57, 16384
    s_add_u32 s48, s57, 65536
    buffer_load_dwordx4 v16, s[12:15], s48 offen offset:0 nt lds
    buffer_load_dwordx4 v17, s[12:15], s48 offen offset:1024 nt lds
    buffer_load_dwordx4 v16, s[12:15], s48 offen offset:2048 nt lds
    buffer_load_dwordx4 v17, s[12:15], s48 offen offset:3072 nt lds
L_h0_0:
    ds_read_b32 v24, v12 offset:0
    ds_read_b32 v28, v12 offset:1024
    ds_read_b32 v25, v12 offset:256
    ds_read_b32 v29, v12 offset:1280
    ds_read_b32 v26, v12 offset:512
    ds_read_b32 v30, v12 offset:1536
    ds_read_b32 v27, v12 offset:768
    ds_read_b32 v31, v12 offset:1792
    s_waitcnt lgkmcnt(5)
    v_min_f32 v22, v24, v25
    s_waitcnt lgkmcnt(1)
    v_min3_f32 v22, v22, v26, v27
    v_sub_f32 v24, v22, v24
    v_sub_f32 v25, v22, v25
    v_sub_f32 v26, v22, v26
    v_sub_f32 v27, v22, v27
    v_exp_f32 v24, v24
    v_exp_f32 v25, v25
    v_exp_f32 v26, v26
    v_exp_f32 v27, v27
    s_nop 0
    v_mul_f32 v22, v24, v28
    v_fmac_f32 v22, v25, v29
    v_fmac_f32 v22, v26, v30
    s_waitcnt lgkmcnt(0)
    v_fmac_f32 v22, v27, v31
    v_rcp_f32 v22, v22
    s_nop 0
    v_mul_f32 v22, v22, v24
    v_add_u32 v12, 133120, v0
    v_accvgpr_read_b32 v44, a72
    v_accvgpr_read_b32 v45, a73
    v_accvgpr_read_b32 v46, a74
    v_accvgpr_read_b32 v47, a75
    v_mul_f32 v44, v44, v22
    v_mul_f32 v45, v45, v22
    v_mul_f32 v46, v46, v22
    v_mul_f32 v47, v47, v22
    ds_write_b128 v12, v[44:47] offset:10240
    v_accvgpr_read_b32 v48, a76
    v_accvgpr_read_b32 v49, a77
    v_accvgpr_read_b32 v50, a78
    v_accvgpr_read_b32 v51, a79
    v_mul_f32 v48, v48, v22
    v_mul_f32 v49, v49, v22
    v_mul_f32 v50, v50, v22
    v_mul_f32 v51, v51, v22
    ds_write_b128 v12, v[48:51] offset:11264
    v_accvgpr_read_b32 v36, a80
    v_accvgpr_read_b32 v37, a81
    v_accvgpr_read_b32 v38, a82
    v_accvgpr_read_b32 v39, a83
    v_mul_f32 v36, v36, v22
    v_mul_f32 v37, v37, v22
    v_mul_f32 v38, v38, v22
    v_mul_f32 v39, v39, v22
    ds_write_b128 v12, v[36:39] offset:14336
    v_accvgpr_read_b32 v40, a84
    v_accvgpr_read_b32 v41, a85
    v_accvgpr_read_b32 v42, a86
    v_accvgpr_read_b32 v43, a87
    v_mul_f32 v40, v40, v22
    v_mul_f32 v41, v41, v22
    v_mul_f32 v42, v42, v22
    v_mul_f32 v43, v43, v22
    ds_write_b128 v12, v[40:43] offset:15360
    v_accvgpr_read_b32 v44, a88
    v_accvgpr_read_b32 v45, a89
    v_accvgpr_read_b32 v46, a90
    v_accvgpr_read_b32 v47, a91
    v_mul_f32 v44, v44, v22
    v_mul_f32 v45, v45, v22
    v_mul_f32 v46, v46, v22
    v_mul_f32 v47, v47, v22
    ds_write_b128 v12, v[44:47] offset:18432
    v_accvgpr_read_b32 v48, a92
    v_accvgpr_read_b32 v49, a93
    v_accvgpr_read_b32 v50, a94
    v_accvgpr_read_b32 v51, a95
    v_mul_f32 v48, v48, v22
    v_mul_f32 v49, v49, v22
    v_mul_f32 v50, v50, v22
    v_mul_f32 v51, v51, v22
    ds_write_b128 v12, v[48:51] offset:19456
    v_accvgpr_read_b32 v24, a64
    v_accvgpr_read_b32 v25, a65
    v_accvgpr_read_b32 v26, a66
    v_accvgpr_read_b32 v27, a67
    v_mul_f32 v24, v24, v22
    v_mul_f32 v25, v25, v22
    v_mul_f32 v26, v26, v22
    v_mul_f32 v27, v27, v22
    v_accvgpr_read_b32 v28, a68
    v_accvgpr_read_b32 v29, a69
    v_accvgpr_read_b32 v30, a70
    v_accvgpr_read_b32 v31, a71
    v_mul_f32 v28, v28, v22
    v_mul_f32 v29, v29, v22
    v_mul_f32 v30, v30, v22
    v_mul_f32 v31, v31, v22
    s_waitcnt lgkmcnt(0)
    s_barrier
    ds_read_b128 v[36:39], v12 offset:0
    ds_read_b128 v[40:43], v12 offset:1024
    ds_read_b128 v[44:47], v12 offset:2048
    ds_read_b128 v[48:51], v12 offset:3072
    ds_read_b128 v[52:55], v12 offset:4096
    ds_read_b128 v[56:59], v12 offset:5120
    s_waitcnt lgkmcnt(3)
    v_add_f32 v36, v36, v44
    s_waitcnt lgkmcnt(1)
    v_add_f32 v24, v24, v52
    v_add_f32 v36, v36, v24
    v_add_f32 v37, v37, v45
    v_add_f32 v25, v25, v53
    v_add_f32 v37, v37, v25
    v_add_f32 v38, v38, v46
    v_add_f32 v26, v26, v54
    v_add_f32 v38, v38, v26
    v_add_f32 v39, v39, v47
    v_add_f32 v27, v27, v55
    v_add_f32 v39, v39, v27
    v_add_f32 v40, v40, v48
    s_waitcnt lgkmcnt(0)
    v_add_f32 v28, v28, v56
    v_add_f32 v40, v40, v28
    v_add_f32 v41, v41, v49
    v_add_f32 v29, v29, v57
    v_add_f32 v41, v41, v29
    v_add_f32 v42, v42, v50
    v_add_f32 v30, v30, v58
    v_add_f32 v42, v42, v30
    v_add_f32 v43, v43, v51
    v_add_f32 v31, v31, v59
    v_add_f32 v43, v43, v31
    v_cvt_pk_bf16_f32 v36, v36, v37
    v_cvt_pk_bf16_f32 v37, v38, v39
    v_cvt_pk_bf16_f32 v38, v40, v41
    v_cvt_pk_bf16_f32 v39, v42, v43
    s_mov_b32 s48, 32768
    buffer_store_dwordx4 v[36:39], v0, s[40:43], s48 offen sc1
    s_cmp_lg_u32 s6, 0
    s_cbranch_scc1 L_h1_0
    s_add_u32 m0, s57, 32768
    s_add_u32 s48, s57, 81920
    buffer_load_dwordx4 v16, s[8:11], s48 offen offset:0 nt lds
    buffer_load_dwordx4 v17, s[8:11], s48 offen offset:1024 nt lds
    buffer_load_dwordx4 v16, s[8:11], s48 offen offset:2048 nt lds
    buffer_load_dwordx4 v17, s[8:11], s48 offen offset:3072 nt lds
    s_add_u32 m0, s57, 49152
    s_add_u32 s48, s57, 81920
    buffer_load_dwordx4 v16, s[12:15], s48 offen offset:0 nt lds
    buffer_load_dwordx4 v17, s[12:15], s48 offen offset:1024 nt lds
    buffer_load_dwordx4 v16, s[12:15], s48 offen offset:2048 nt lds
    buffer_load_dwordx4 v17, s[12:15], s48 offen offset:3072 nt lds
L_h1_0:
    s_cmp_lg_u32 s6, 0
    s_cbranch_scc1 L_e3a_0
    s_waitcnt vmcnt(8)
    s_branch L_e3b_0
L_e3a_0:
    s_waitcnt vmcnt(0)
L_e3b_0:
    s_barrier
    s_branch L_fin
L_wave1:
    s_branch L_w1_first
L_w1_fake:
    ds_read_b128 v[72:75], v12 offset:0
    ds_read_b128 v[76:79], v13 offset:0
    ds_read_b128 v[80:83], v14 offset:0
    ds_read_b128 v[84:87], v15 offset:0
L_w1_loop:
    s_waitcnt lgkmcnt(3)
    v_mfma_f32_16x16x32_bf16 v[36:39], v[72:75], a[124:127], v[24:27]
    ds_read_b128 v[88:91], v12 offset:4096
    v_mfma_f32_16x16x32_bf16 v[44:47], v[72:75], a[140:143], v[28:31]
    s_waitcnt lgkmcnt(3)
    v_mfma_f32_16x16x32_bf16 v[36:39], v[76:79], a[112:115], v[36:39]
    ds_read_b128 v[92:95], v13 offset:4096
    v_mfma_f32_16x16x32_bf16 v[44:47], v[76:79], a[128:131], v[44:47]
    s_waitcnt lgkmcnt(3)
    v_mfma_f32_16x16x32_bf16 v[36:39], v[80:83], a[116:119], v[36:39]
    ds_read_b128 v[72:75], v14 offset:4096
    v_mfma_f32_16x16x32_bf16 v[44:47], v[80:83], a[132:135], v[44:47]
    s_waitcnt lgkmcnt(3)
    v_mfma_f32_16x16x32_bf16 v[36:39], v[84:87], a[120:123], v[36:39]
    ds_read_b128 v[76:79], v15 offset:4096
    v_mfma_f32_16x16x32_bf16 v[44:47], v[84:87], a[136:139], v[44:47]
    s_waitcnt lgkmcnt(3)
    v_mfma_f32_16x16x32_bf16 v[40:43], v[88:91], a[124:127], v[24:27]
    ds_read_b128 v[80:83], v12 offset:8192
    v_mfma_f32_16x16x32_bf16 v[48:51], v[88:91], a[140:143], v[28:31]
    v_mfma_f32_16x16x32_bf16 v[68:71], v[88:91], a[144:147], v[32:35]
    s_waitcnt lgkmcnt(3)
    v_mfma_f32_16x16x32_bf16 v[40:43], v[92:95], a[112:115], v[40:43]
    ds_read_b128 v[84:87], v13 offset:8192
    v_exp_f32 v36, v36
    v_mfma_f32_16x16x32_bf16 v[48:51], v[92:95], a[128:131], v[48:51]
    v_exp_f32 v37, v37
    v_mfma_f32_16x16x32_bf16 v[68:71], v[92:95], a[148:151], v[68:71]
    v_exp_f32 v38, v38
    s_waitcnt lgkmcnt(3)
    v_mfma_f32_16x16x32_bf16 v[40:43], v[72:75], a[116:119], v[40:43]
    ds_read_b128 v[88:91], v14 offset:8192
    v_exp_f32 v39, v39
    v_mfma_f32_16x16x32_bf16 v[48:51], v[72:75], a[132:135], v[48:51]
    v_cvt_pk_bf16_f32 v36, v36, v37
    v_cvt_pk_bf16_f32 v37, v38, v39
    v_or_b32 v20, v36, v37
    v_mfma_f32_16x16x32_bf16 v[68:71], v[72:75], a[152:155], v[68:71]
    v_exp_f32 v44, v44
    s_waitcnt lgkmcnt(3)
    v_mfma_f32_16x16x32_bf16 v[40:43], v[76:79], a[120:123], v[40:43]
    ds_read_b128 v[92:95], v15 offset:8192
    v_mfma_f32_16x16x32_bf16 v[48:51], v[76:79], a[136:139], v[48:51]
    v_exp_f32 v45, v45
    v_mfma_f32_16x16x32_bf16 v[68:71], v[76:79], a[156:159], v[68:71]
    v_exp_f32 v46, v46
    s_waitcnt lgkmcnt(3)
    v_mfma_f32_16x16x32_bf16 v[52:55], v[80:83], a[124:127], v[24:27]
    ds_read_b128 v[72:75], v12 offset:12288
    v_mfma_f32_16x16x32_bf16 v[60:63], v[80:83], a[140:143], v[28:31]
    v_exp_f32 v47, v47
    s_waitcnt lgkmcnt(3)
    v_mfma_f32_16x16x32_bf16 v[52:55], v[84:87], a[112:115], v[52:55]
    ds_read_b128 v[76:79], v13 offset:12288
    v_cvt_pk_bf16_f32 v44, v44, v45
    v_cvt_pk_bf16_f32 v45, v46, v47
    v_or3_b32 v20, v44, v45, v20
    v_mfma_f32_16x16x32_bf16 v[60:63], v[84:87], a[128:131], v[60:63]
    v_exp_f32 v40, v40
    v_exp_f32 v41, v41
    s_waitcnt lgkmcnt(3)
    v_mfma_f32_16x16x32_bf16 v[52:55], v[88:91], a[116:119], v[52:55]
    ds_read_b128 v[80:83], v14 offset:12288
    v_exp_f32 v42, v42
    v_mfma_f32_16x16x32_bf16 v[60:63], v[88:91], a[132:135], v[60:63]
    v_exp_f32 v43, v43
    v_cvt_pk_bf16_f32 v38, v40, v41
    v_cvt_pk_bf16_f32 v39, v42, v43
    s_waitcnt lgkmcnt(3)
    v_mfma_f32_16x16x32_bf16 v[52:55], v[92:95], a[120:123], v[52:55]
    ds_read_b128 v[84:87], v15 offset:12288
    v_or3_b32 v20, v38, v39, v20
    v_mfma_f32_16x16x32_bf16 v[60:63], v[92:95], a[136:139], v[60:63]
    v_exp_f32 v48, v48
    s_waitcnt lgkmcnt(3)
    v_mfma_f32_16x16x32_bf16 v[56:59], v[72:75], a[124:127], v[24:27]
    ds_read_b64_tr_b16 v[88:89], v4 offset:0
    ds_read_b64_tr_b16 v[90:91], v4 offset:4096
    v_mfma_f32_16x16x32_bf16 v[64:67], v[72:75], a[140:143], v[28:31]
    v_exp_f32 v49, v49
    s_waitcnt lgkmcnt(4)
    v_mfma_f32_16x16x32_bf16 v[56:59], v[76:79], a[112:115], v[56:59]
    ds_read_b64_tr_b16 v[72:73], v5 offset:0
    ds_read_b64_tr_b16 v[74:75], v5 offset:4096
    v_mfma_f32_16x16x32_bf16 v[64:67], v[76:79], a[128:131], v[64:67]
    v_exp_f32 v50, v50
    v_exp_f32 v51, v51
    s_waitcnt lgkmcnt(5)
    v_mfma_f32_16x16x32_bf16 v[56:59], v[80:83], a[116:119], v[56:59]
    ds_read_b64_tr_b16 v[76:77], v6 offset:0
    ds_read_b64_tr_b16 v[78:79], v6 offset:4096
    v_cvt_pk_bf16_f32 v46, v48, v49
    v_cvt_pk_bf16_f32 v47, v50, v51
    v_mfma_f32_16x16x32_bf16 v[64:67], v[80:83], a[132:135], v[64:67]
    v_or3_b32 v20, v46, v47, v20
    v_exp_f32 v68, v68
    s_waitcnt lgkmcnt(6)
    v_mfma_f32_16x16x32_bf16 v[56:59], v[84:87], a[120:123], v[56:59]
    ds_read_b64_tr_b16 v[80:81], v7 offset:0
    ds_read_b64_tr_b16 v[82:83], v7 offset:4096
    v_exp_f32 v69, v69
    v_mfma_f32_16x16x32_bf16 v[64:67], v[84:87], a[136:139], v[64:67]
    v_exp_f32 v70, v70
    v_exp_f32 v71, v71
    v_cvt_pk_bf16_f32 v68, v68, v69
    v_cvt_pk_bf16_f32 v69, v70, v71
    v_or3_b32 v20, v68, v69, v20
    v_and_b32 v20, s52, v20
    v_cmp_ne_u32 vcc, 0, v20
    s_cbranch_vccnz L_w1_rareA
L_w1_Aafter:
    v_mfma_f32_16x16x32_bf16 a[96:99], a[108:111], v[36:39], a[96:99]
    v_mfma_f32_16x16x32_bf16 a[100:103], a[108:111], v[44:47], a[100:103]
    v_mfma_f32_16x16x16_bf16 a[104:107], a[108:109], v[68:69], a[104:107]
    s_waitcnt lgkmcnt(6)
    v_mfma_f32_16x16x32_bf16 a[0:3], v[88:91], v[36:39], a[0:3]
    ds_read_b64_tr_b16 v[84:85], v8 offset:0
    ds_read_b64_tr_b16 v[86:87], v8 offset:4096
    v_mfma_f32_16x16x32_bf16 a[4:7], v[88:91], v[44:47], a[4:7]
    v_exp_f32 v52, v52
    v_mfma_f32_16x16x16_bf16 a[64:67], v[90:91], v[68:69], a[64:67]
    v_exp_f32 v53, v53
    s_waitcnt lgkmcnt(6)
    v_mfma_f32_16x16x32_bf16 a[8:11], v[72:75], v[36:39], a[8:11]
    ds_read_b64_tr_b16 v[88:89], v9 offset:0
    ds_read_b64_tr_b16 v[90:91], v9 offset:4096
    v_exp_f32 v54, v54
    v_mfma_f32_16x16x32_bf16 a[12:15], v[72:75], v[44:47], a[12:15]
    v_exp_f32 v55, v55
    v_cvt_pk_bf16_f32 v52, v52, v53
    v_cvt_pk_bf16_f32 v53, v54, v55
    v_mfma_f32_16x16x16_bf16 a[68:71], v[74:75], v[68:69], a[68:71]
    v_or_b32 v21, v52, v53
    v_exp_f32 v60, v60
    s_waitcnt lgkmcnt(6)
    v_mfma_f32_16x16x32_bf16 a[16:19], v[76:79], v[36:39], a[16:19]
    ds_read_b64_tr_b16 v[72:73], v10 offset:0
    ds_read_b64_tr_b16 v[74:75], v10 offset:4096
    v_exp_f32 v61, v61
    v_mfma_f32_16x16x32_bf16 a[20:23], v[76:79], v[44:47], a[20:23]
    v_exp_f32 v62, v62
    v_exp_f32 v63, v63
    v_mfma_f32_16x16x16_bf16 a[72:75], v[78:79], v[68:69], a[72:75]
    v_cvt_pk_bf16_f32 v60, v60, v61
    v_cvt_pk_bf16_f32 v61, v62, v63
    v_or3_b32 v21, v60, v61, v21
    s_waitcnt lgkmcnt(6)
    v_mfma_f32_16x16x32_bf16 a[24:27], v[80:83], v[36:39], a[24:27]
    ds_read_b64_tr_b16 v[76:77], v11 offset:0
    ds_read_b64_tr_b16 v[78:79], v11 offset:4096
    s_add_u32 s48, s45, 32768
    s_cmp_eq_u32 s48, 131072
    s_cselect_b32 s48, 0, s48
    s_sub_u32 s58, s48, s45
    v_mfma_f32_16x16x32_bf16 a[28:31], v[80:83], v[44:47], a[28:31]
    v_exp_f32 v56, v56
    v_mfma_f32_16x16x16_bf16 a[76:79], v[82:83], v[68:69], a[76:79]
    v_exp_f32 v57, v57
    s_waitcnt lgkmcnt(6)
    v_mfma_f32_16x16x32_bf16 a[32:35], v[84:87], v[36:39], a[32:35]
    ds_read_b64_tr_b16 v[80:81], v4 offset:8192
    ds_read_b64_tr_b16 v[82:83], v4 offset:12288
    v_mfma_f32_16x16x32_bf16 a[36:39], v[84:87], v[44:47], a[36:39]
    v_exp_f32 v58, v58
    v_mfma_f32_16x16x16_bf16 a[80:83], v[86:87], v[68:69], a[80:83]
    v_exp_f32 v59, v59
    v_cvt_pk_bf16_f32 v54, v56, v57
    s_waitcnt lgkmcnt(6)
    v_mfma_f32_16x16x32_bf16 a[40:43], v[88:91], v[36:39], a[40:43]
    ds_read_b64_tr_b16 v[84:85], v5 offset:8192
    ds_read_b64_tr_b16 v[86:87], v5 offset:12288
    v_cvt_pk_bf16_f32 v55, v58, v59
    v_mfma_f32_16x16x32_bf16 a[44:47], v[88:91], v[44:47], a[44:47]
    v_or3_b32 v21, v54, v55, v21
    v_mfma_f32_16x16x16_bf16 a[84:87], v[90:91], v[68:69], a[84:87]
    v_exp_f32 v64, v64
    s_waitcnt lgkmcnt(6)
    v_mfma_f32_16x16x32_bf16 a[48:51], v[72:75], v[36:39], a[48:51]
    ds_read_b64_tr_b16 v[88:89], v6 offset:8192
    ds_read_b64_tr_b16 v[90:91], v6 offset:12288
    v_mfma_f32_16x16x32_bf16 a[52:55], v[72:75], v[44:47], a[52:55]
    v_exp_f32 v65, v65
    v_mfma_f32_16x16x16_bf16 a[88:91], v[74:75], v[68:69], a[88:91]
    v_exp_f32 v66, v66
    s_waitcnt lgkmcnt(6)
    v_mfma_f32_16x16x32_bf16 a[56:59], v[76:79], v[36:39], a[56:59]
    ds_read_b64_tr_b16 v[72:73], v7 offset:8192
    ds_read_b64_tr_b16 v[74:75], v7 offset:12288
    v_mfma_f32_16x16x32_bf16 a[60:63], v[76:79], v[44:47], a[60:63]
    v_exp_f32 v67, v67
    v_cvt_pk_bf16_f32 v62, v64, v65
    v_cvt_pk_bf16_f32 v63, v66, v67
    v_mfma_f32_16x16x16_bf16 a[92:95], v[78:79], v[68:69], a[92:95]
    v_or3_b32 v21, v62, v63, v21
    v_and_b32 v21, s52, v21
    v_cmp_ne_u32 vcc, 0, v21
    s_cbranch_vccnz L_w1_rareB
L_w1_Bafter:
    v_mfma_f32_16x16x32_bf16 a[96:99], a[108:111], v[52:55], a[96:99]
    v_mfma_f32_16x16x32_bf16 a[100:103], a[108:111], v[60:63], a[100:103]
    s_waitcnt lgkmcnt(6)
    v_mfma_f32_16x16x32_bf16 a[0:3], v[80:83], v[52:55], a[0:3]
    ds_read_b64_tr_b16 v[76:77], v8 offset:8192
    ds_read_b64_tr_b16 v[78:79], v8 offset:12288
    v_mfma_f32_16x16x32_bf16 a[4:7], v[80:83], v[60:63], a[4:7]
    s_waitcnt lgkmcnt(6)
    v_mfma_f32_16x16x32_bf16 a[8:11], v[84:87], v[52:55], a[8:11]
    ds_read_b64_tr_b16 v[80:81], v9 offset:8192
    ds_read_b64_tr_b16 v[82:83], v9 offset:12288
    v_mfma_f32_16x16x32_bf16 a[12:15], v[84:87], v[60:63], a[12:15]
    s_waitcnt lgkmcnt(6)
    v_mfma_f32_16x16x32_bf16 a[16:19], v[88:91], v[52:55], a[16:19]
    ds_read_b64_tr_b16 v[84:85], v10 offset:8192
    ds_read_b64_tr_b16 v[86:87], v10 offset:12288
    v_mfma_f32_16x16x32_bf16 a[20:23], v[88:91], v[60:63], a[20:23]
    v_add_u32 v12, s58, v12
    v_add_u32 v13, s58, v13
    v_add_u32 v14, s58, v14
    v_add_u32 v15, s58, v15
    s_waitcnt lgkmcnt(6)
    v_mfma_f32_16x16x32_bf16 a[24:27], v[72:75], v[52:55], a[24:27]
    ds_read_b64_tr_b16 v[88:89], v11 offset:8192
    ds_read_b64_tr_b16 v[90:91], v11 offset:12288
    v_mfma_f32_16x16x32_bf16 a[28:31], v[72:75], v[60:63], a[28:31]
    s_cmp_eq_u32 s68, 0
    s_cbranch_scc1 L_w1_v0
    s_cmp_eq_u32 s68, 1
    s_cmp_eq_u32 s68, 1
    s_cbranch_scc1 L_w1_v8
    s_waitcnt vmcnt(16) lgkmcnt(0)
    s_mov_b32 s68, 1
    s_branch L_w1_v9
L_w1_v8:
    s_waitcnt vmcnt(8) lgkmcnt(0)
    s_mov_b32 s68, 0
    s_branch L_w1_v9
L_w1_v0:
    s_waitcnt vmcnt(0) lgkmcnt(0)
L_w1_v9:
    s_barrier
    v_mfma_f32_16x16x32_bf16 a[32:35], v[76:79], v[52:55], a[32:35]
    ds_read_b128 v[72:75], v12 offset:0
    v_mfma_f32_16x16x32_bf16 a[36:39], v[76:79], v[60:63], a[36:39]
    v_add_u32 v4, s58, v4
    v_add_u32 v5, s58, v5
    v_add_u32 v6, s58, v6
    v_add_u32 v7, s58, v7
    v_mfma_f32_16x16x32_bf16 a[40:43], v[80:83], v[52:55], a[40:43]
    ds_read_b128 v[76:79], v13 offset:0
    v_mfma_f32_16x16x32_bf16 a[44:47], v[80:83], v[60:63], a[44:47]
    v_add_u32 v8, s58, v8
    v_add_u32 v9, s58, v9
    v_add_u32 v10, s58, v10
    v_add_u32 v11, s58, v11
    v_mfma_f32_16x16x32_bf16 a[48:51], v[84:87], v[52:55], a[48:51]
    ds_read_b128 v[80:83], v14 offset:0
    v_mfma_f32_16x16x32_bf16 a[52:55], v[84:87], v[60:63], a[52:55]
    v_mfma_f32_16x16x32_bf16 a[56:59], v[88:91], v[52:55], a[56:59]
    ds_read_b128 v[84:87], v15 offset:0
    v_mfma_f32_16x16x32_bf16 a[60:63], v[88:91], v[60:63], a[60:63]
    s_add_u32 s45, s45, s58
    s_add_u32 s47, s47, 16384
    s_add_u32 s44, s44, 1
    s_cmp_lt_u32 s44, 8
    s_cbranch_scc1 L_w1_loop
    s_waitcnt lgkmcnt(0)
    s_branch L_w1_done
L_w1_first:
    ds_read_b128 v[72:75], v12 offset:0
    ds_read_b128 v[76:79], v13 offset:0
    ds_read_b128 v[80:83], v14 offset:0
    s_waitcnt lgkmcnt(2)
    v_mfma_f32_16x16x32_bf16 v[36:39], v[72:75], a[124:127], v[24:27]
    ds_read_b128 v[84:87], v15 offset:0
    ds_read_b128 v[88:91], v12 offset:4096
    v_mfma_f32_16x16x32_bf16 v[44:47], v[72:75], a[140:143], v[28:31]
    s_waitcnt lgkmcnt(3)
    v_mfma_f32_16x16x32_bf16 v[36:39], v[76:79], a[112:115], v[36:39]
    ds_read_b128 v[92:95], v13 offset:4096
    v_mfma_f32_16x16x32_bf16 v[44:47], v[76:79], a[128:131], v[44:47]
    s_waitcnt lgkmcnt(3)
    v_mfma_f32_16x16x32_bf16 v[36:39], v[80:83], a[116:119], v[36:39]
    ds_read_b128 v[72:75], v14 offset:4096
    v_mfma_f32_16x16x32_bf16 v[44:47], v[80:83], a[132:135], v[44:47]
    s_waitcnt lgkmcnt(3)
    v_mfma_f32_16x16x32_bf16 v[36:39], v[84:87], a[120:123], v[36:39]
    ds_read_b128 v[76:79], v15 offset:4096
    v_mfma_f32_16x16x32_bf16 v[44:47], v[84:87], a[136:139], v[44:47]
    s_waitcnt lgkmcnt(3)
    v_mfma_f32_16x16x32_bf16 v[40:43], v[88:91], a[124:127], v[24:27]
    ds_read_b128 v[80:83], v12 offset:8192
    v_mfma_f32_16x16x32_bf16 v[48:51], v[88:91], a[140:143], v[28:31]
    v_mfma_f32_16x16x32_bf16 v[68:71], v[88:91], a[144:147], v[32:35]
    s_waitcnt lgkmcnt(3)
    v_mfma_f32_16x16x32_bf16 v[40:43], v[92:95], a[112:115], v[40:43]
    ds_read_b128 v[84:87], v13 offset:8192
    v_mfma_f32_16x16x32_bf16 v[48:51], v[92:95], a[128:131], v[48:51]
    v_mfma_f32_16x16x32_bf16 v[68:71], v[92:95], a[148:151], v[68:71]
    s_waitcnt lgkmcnt(3)
    v_mfma_f32_16x16x32_bf16 v[40:43], v[72:75], a[116:119], v[40:43]
    ds_read_b128 v[88:91], v14 offset:8192
    v_mfma_f32_16x16x32_bf16 v[48:51], v[72:75], a[132:135], v[48:51]
    v_mfma_f32_16x16x32_bf16 v[68:71], v[72:75], a[152:155], v[68:71]
    s_waitcnt lgkmcnt(3)
    v_mfma_f32_16x16x32_bf16 v[40:43], v[76:79], a[120:123], v[40:43]
    ds_read_b128 v[92:95], v15 offset:8192
    v_mfma_f32_16x16x32_bf16 v[48:51], v[76:79], a[136:139], v[48:51]
    v_mfma_f32_16x16x32_bf16 v[68:71], v[76:79], a[156:159], v[68:71]
    s_waitcnt lgkmcnt(3)
    v_mfma_f32_16x16x32_bf16 v[52:55], v[80:83], a[124:127], v[24:27]
    ds_read_b128 v[72:75], v12 offset:12288
    v_mfma_f32_16x16x32_bf16 v[60:63], v[80:83], a[140:143], v[28:31]
    s_waitcnt lgkmcnt(3)
    v_mfma_f32_16x16x32_bf16 v[52:55], v[84:87], a[112:115], v[52:55]
    ds_read_b128 v[76:79], v13 offset:12288
    v_mfma_f32_16x16x32_bf16 v[60:63], v[84:87], a[128:131], v[60:63]
    s_waitcnt lgkmcnt(3)
    v_mfma_f32_16x16x32_bf16 v[52:55], v[88:91], a[116:119], v[52:55]
    ds_read_b128 v[80:83], v14 offset:12288
    v_mfma_f32_16x16x32_bf16 v[60:63], v[88:91], a[132:135], v[60:63]
    s_waitcnt lgkmcnt(3)
    v_mfma_f32_16x16x32_bf16 v[52:55], v[92:95], a[120:123], v[52:55]
    ds_read_b128 v[84:87], v15 offset:12288
    v_mfma_f32_16x16x32_bf16 v[60:63], v[92:95], a[136:139], v[60:63]
    s_waitcnt lgkmcnt(3)
    v_mfma_f32_16x16x32_bf16 v[56:59], v[72:75], a[124:127], v[24:27]
    ds_read_b64_tr_b16 v[88:89], v4 offset:0
    ds_read_b64_tr_b16 v[90:91], v4 offset:4096
    v_mfma_f32_16x16x32_bf16 v[64:67], v[72:75], a[140:143], v[28:31]
    s_waitcnt lgkmcnt(4)
    v_mfma_f32_16x16x32_bf16 v[56:59], v[76:79], a[112:115], v[56:59]
    ds_read_b64_tr_b16 v[72:73], v5 offset:0
    ds_read_b64_tr_b16 v[74:75], v5 offset:4096
    v_mfma_f32_16x16x32_bf16 v[64:67], v[76:79], a[128:131], v[64:67]
    s_waitcnt lgkmcnt(5)
    v_mfma_f32_16x16x32_bf16 v[56:59], v[80:83], a[116:119], v[56:59]
    ds_read_b64_tr_b16 v[76:77], v6 offset:0
    ds_read_b64_tr_b16 v[78:79], v6 offset:4096
    v_mfma_f32_16x16x32_bf16 v[64:67], v[80:83], a[132:135], v[64:67]
    s_waitcnt lgkmcnt(6)
    v_mfma_f32_16x16x32_bf16 v[56:59], v[84:87], a[120:123], v[56:59]
    ds_read_b64_tr_b16 v[80:81], v7 offset:0
    ds_read_b64_tr_b16 v[82:83], v7 offset:4096
    v_mfma_f32_16x16x32_bf16 v[64:67], v[84:87], a[136:139], v[64:67]
    s_nop 7
    s_mov_b32 s51, 0xff7fffff
    v_max3_f32 v20, v36, v37, v38
    v_max3_f32 v20, v20, v39, v40
    v_max3_f32 v20, v20, v41, v42
    v_max3_f32 v20, v20, v43, v52
    v_max3_f32 v20, v20, v53, v54
    v_max3_f32 v20, v20, v55, v56
    v_max3_f32 v20, v20, v57, v58
    v_max_f32 v20, v20, v59
    v_mov_b32 v23, v20
    s_nop 1
    v_permlane16_swap_b32 v20, v23
    v_max_f32 v20, v20, v23
    v_mov_b32 v23, v20
    s_nop 1
    v_permlane32_swap_b32 v20, v23
    v_max_f32 v20, v20, v23
    v_add_f32 v20, 0x40e00000, v20
    v_max_f32 v20, s51, v20
    v_sub_f32 v36, v36, v20
    v_sub_f32 v37, v37, v20
    v_sub_f32 v38, v38, v20
    v_sub_f32 v39, v39, v20
    v_sub_f32 v40, v40, v20
    v_sub_f32 v41, v41, v20
    v_sub_f32 v42, v42, v20
    v_sub_f32 v43, v43, v20
    v_sub_f32 v52, v52, v20
    v_sub_f32 v53, v53, v20
    v_sub_f32 v54, v54, v20
    v_sub_f32 v55, v55, v20
    v_sub_f32 v56, v56, v20
    v_sub_f32 v57, v57, v20
    v_sub_f32 v58, v58, v20
    v_sub_f32 v59, v59, v20
    v_sub_f32 v24, v24, v20
    v_sub_f32 v25, v25, v20
    v_sub_f32 v26, v26, v20
    v_sub_f32 v27, v27, v20
    v_max3_f32 v21, v44, v45, v46
    v_max3_f32 v21, v21, v47, v48
    v_max3_f32 v21, v21, v49, v50
    v_max3_f32 v21, v21, v51, v60
    v_max3_f32 v21, v21, v61, v62
    v_max3_f32 v21, v21, v63, v64
    v_max3_f32 v21, v21, v65, v66
    v_max_f32 v21, v21, v67
    v_mov_b32 v23, v21
    s_nop 1
    v_permlane16_swap_b32 v21, v23
    v_max_f32 v21, v21, v23
    v_mov_b32 v23, v21
    s_nop 1
    v_permlane32_swap_b32 v21, v23
    v_max_f32 v21, v21, v23
    v_add_f32 v21, 0x40e00000, v21
    v_max_f32 v21, s51, v21
    v_sub_f32 v44, v44, v21
    v_sub_f32 v45, v45, v21
    v_sub_f32 v46, v46, v21
    v_sub_f32 v47, v47, v21
    v_sub_f32 v48, v48, v21
    v_sub_f32 v49, v49, v21
    v_sub_f32 v50, v50, v21
    v_sub_f32 v51, v51, v21
    v_sub_f32 v60, v60, v21
    v_sub_f32 v61, v61, v21
    v_sub_f32 v62, v62, v21
    v_sub_f32 v63, v63, v21
    v_sub_f32 v64, v64, v21
    v_sub_f32 v65, v65, v21
    v_sub_f32 v66, v66, v21
    v_sub_f32 v67, v67, v21
    v_sub_f32 v28, v28, v21
    v_sub_f32 v29, v29, v21
    v_sub_f32 v30, v30, v21
    v_sub_f32 v31, v31, v21
    v_max3_f32 v22, v68, v69, v70
    v_max_f32 v22, v22, v71
    v_mov_b32 v23, v22
    s_nop 1
    v_permlane16_swap_b32 v22, v23
    v_max_f32 v22, v22, v23
    v_mov_b32 v23, v22
    s_nop 1
    v_permlane32_swap_b32 v22, v23
    v_max_f32 v22, v22, v23
    v_add_f32 v22, 0x40e00000, v22
    v_max_f32 v22, s51, v22
    v_sub_f32 v68, v68, v22
    v_sub_f32 v69, v69, v22
    v_sub_f32 v70, v70, v22
    v_sub_f32 v71, v71, v22
    v_sub_f32 v32, v32, v22
    v_sub_f32 v33, v33, v22
    v_sub_f32 v34, v34, v22
    v_sub_f32 v35, v35, v22
    v_exp_f32 v36, v36
    v_exp_f32 v37, v37
    v_exp_f32 v38, v38
    v_exp_f32 v39, v39
    v_cvt_pk_bf16_f32 v36, v36, v37
    v_cvt_pk_bf16_f32 v37, v38, v39
    v_exp_f32 v44, v44
    v_exp_f32 v45, v45
    v_exp_f32 v46, v46
    v_exp_f32 v47, v47
    v_cvt_pk_bf16_f32 v44, v44, v45
    v_cvt_pk_bf16_f32 v45, v46, v47
    v_exp_f32 v40, v40
    v_exp_f32 v41, v41
    v_exp_f32 v42, v42
    v_exp_f32 v43, v43
    v_cvt_pk_bf16_f32 v38, v40, v41
    v_cvt_pk_bf16_f32 v39, v42, v43
    v_exp_f32 v48, v48
    v_exp_f32 v49, v49
    v_exp_f32 v50, v50
    v_exp_f32 v51, v51
    v_cvt_pk_bf16_f32 v46, v48, v49
    v_cvt_pk_bf16_f32 v47, v50, v51
    v_exp_f32 v68, v68
    v_exp_f32 v69, v69
    v_exp_f32 v70, v70
    v_exp_f32 v71, v71
    v_cvt_pk_bf16_f32 v68, v68, v69
    v_cvt_pk_bf16_f32 v69, v70, v71
    s_waitcnt lgkmcnt(0)
    s_branch L_w1_Aafter
L_w1_rareA:
    s_waitcnt lgkmcnt(0)
    s_nop 7
    s_nop 7
    ds_read_b128 v[20:23], v12 offset:0
    s_waitcnt lgkmcnt(0)
    v_mfma_f32_16x16x32_bf16 v[36:39], v[20:23], a[124:127], v[24:27]
    v_mfma_f32_16x16x32_bf16 v[44:47], v[20:23], a[140:143], v[28:31]
    s_nop 1
    ds_read_b128 v[20:23], v13 offset:0
    s_waitcnt lgkmcnt(0)
    v_mfma_f32_16x16x32_bf16 v[36:39], v[20:23], a[112:115], v[36:39]
    v_mfma_f32_16x16x32_bf16 v[44:47], v[20:23], a[128:131], v[44:47]
    s_nop 1
    ds_read_b128 v[20:23], v14 offset:0
    s_waitcnt lgkmcnt(0)
    v_mfma_f32_16x16x32_bf16 v[36:39], v[20:23], a[116:119], v[36:39]
    v_mfma_f32_16x16x32_bf16 v[44:47], v[20:23], a[132:135], v[44:47]
    s_nop 1
    ds_read_b128 v[20:23], v15 offset:0
    s_waitcnt lgkmcnt(0)
    v_mfma_f32_16x16x32_bf16 v[36:39], v[20:23], a[120:123], v[36:39]
    v_mfma_f32_16x16x32_bf16 v[44:47], v[20:23], a[136:139], v[44:47]
    s_nop 1
    ds_read_b128 v[20:23], v12 offset:4096
    s_waitcnt lgkmcnt(0)
    v_mfma_f32_16x16x32_bf16 v[40:43], v[20:23], a[124:127], v[24:27]
    v_mfma_f32_16x16x32_bf16 v[48:51], v[20:23], a[140:143], v[28:31]
    v_mfma_f32_16x16x32_bf16 v[68:71], v[20:23], a[144:147], v[32:35]
    s_nop 1
    ds_read_b128 v[20:23], v13 offset:4096
    s_waitcnt lgkmcnt(0)
    v_mfma_f32_16x16x32_bf16 v[40:43], v[20:23], a[112:115], v[40:43]
    v_mfma_f32_16x16x32_bf16 v[48:51], v[20:23], a[128:131], v[48:51]
    v_mfma_f32_16x16x32_bf16 v[68:71], v[20:23], a[148:151], v[68:71]
    s_nop 1
    ds_read_b128 v[20:23], v14 offset:4096
    s_waitcnt lgkmcnt(0)
    v_mfma_f32_16x16x32_bf16 v[40:43], v[20:23], a[116:119], v[40:43]
    v_mfma_f32_16x16x32_bf16 v[48:51], v[20:23], a[132:135], v[48:51]
    v_mfma_f32_16x16x32_bf16 v[68:71], v[20:23], a[152:155], v[68:71]
    s_nop 1
    ds_read_b128 v[20:23], v15 offset:4096
    s_waitcnt lgkmcnt(0)
    v_mfma_f32_16x16x32_bf16 v[40:43], v[20:23], a[120:123], v[40:43]
    v_mfma_f32_16x16x32_bf16 v[48:51], v[20:23], a[136:139], v[48:51]
    v_mfma_f32_16x16x32_bf16 v[68:71], v[20:23], a[156:159], v[68:71]
    s_nop 1
    s_nop 7
    s_nop 3
    s_mov_b32 s51, 0
    v_max3_f32 v20, v36, v37, v38
    v_max3_f32 v20, v20, v39, v40
    v_max3_f32 v20, v20, v41, v42
    v_max3_f32 v20, v20, v43, v52
    v_max3_f32 v20, v20, v53, v54
    v_max3_f32 v20, v20, v55, v56
    v_max3_f32 v20, v20, v57, v58
    v_max_f32 v20, v20, v59
    v_mov_b32 v23, v20
    s_nop 1
    v_permlane16_swap_b32 v20, v23
    v_max_f32 v20, v20, v23
    v_mov_b32 v23, v20
    s_nop 1
    v_permlane32_swap_b32 v20, v23
    v_max_f32 v20, v20, v23
    v_add_f32 v20, 0x40e00000, v20
    v_max_f32 v20, s51, v20
    v_sub_f32 v36, v36, v20
    v_sub_f32 v37, v37, v20
    v_sub_f32 v38, v38, v20
    v_sub_f32 v39, v39, v20
    v_sub_f32 v40, v40, v20
    v_sub_f32 v41, v41, v20
    v_sub_f32 v42, v42, v20
    v_sub_f32 v43, v43, v20
    v_sub_f32 v52, v52, v20
    v_sub_f32 v53, v53, v20
    v_sub_f32 v54, v54, v20
    v_sub_f32 v55, v55, v20
    v_sub_f32 v56, v56, v20
    v_sub_f32 v57, v57, v20
    v_sub_f32 v58, v58, v20
    v_sub_f32 v59, v59, v20
    v_sub_f32 v24, v24, v20
    v_sub_f32 v25, v25, v20
    v_sub_f32 v26, v26, v20
    v_sub_f32 v27, v27, v20
    v_max3_f32 v21, v44, v45, v46
    v_max3_f32 v21, v21, v47, v48
    v_max3_f32 v21, v21, v49, v50
    v_max3_f32 v21, v21, v51, v60
    v_max3_f32 v21, v21, v61, v62
    v_max3_f32 v21, v21, v63, v64
    v_max3_f32 v21, v21, v65, v66
    v_max_f32 v21, v21, v67
    v_mov_b32 v23, v21
    s_nop 1
    v_permlane16_swap_b32 v21, v23
    v_max_f32 v21, v21, v23
    v_mov_b32 v23, v21
    s_nop 1
    v_permlane32_swap_b32 v21, v23
    v_max_f32 v21, v21, v23
    v_add_f32 v21, 0x40e00000, v21
    v_max_f32 v21, s51, v21
    v_sub_f32 v44, v44, v21
    v_sub_f32 v45, v45, v21
    v_sub_f32 v46, v46, v21
    v_sub_f32 v47, v47, v21
    v_sub_f32 v48, v48, v21
    v_sub_f32 v49, v49, v21
    v_sub_f32 v50, v50, v21
    v_sub_f32 v51, v51, v21
    v_sub_f32 v60, v60, v21
    v_sub_f32 v61, v61, v21
    v_sub_f32 v62, v62, v21
    v_sub_f32 v63, v63, v21
    v_sub_f32 v64, v64, v21
    v_sub_f32 v65, v65, v21
    v_sub_f32 v66, v66, v21
    v_sub_f32 v67, v67, v21
    v_sub_f32 v28, v28, v21
    v_sub_f32 v29, v29, v21
    v_sub_f32 v30, v30, v21
    v_sub_f32 v31, v31, v21
    v_max3_f32 v22, v68, v69, v70
    v_max_f32 v22, v22, v71
    v_mov_b32 v23, v22
    s_nop 1
    v_permlane16_swap_b32 v22, v23
    v_max_f32 v22, v22, v23
    v_mov_b32 v23, v22
    s_nop 1
    v_permlane32_swap_b32 v22, v23
    v_max_f32 v22, v22, v23
    v_add_f32 v22, 0x40e00000, v22
    v_max_f32 v22, s51, v22
    v_sub_f32 v68, v68, v22
    v_sub_f32 v69, v69, v22
    v_sub_f32 v70, v70, v22
    v_sub_f32 v71, v71, v22
    v_sub_f32 v32, v32, v22
    v_sub_f32 v33, v33, v22
    v_sub_f32 v34, v34, v22
    v_sub_f32 v35, v35, v22
    s_mov_b32 s53, 0
    s_branch L_w1_resc
L_w1_rareB:
    s_waitcnt lgkmcnt(0)
    s_nop 7
    s_nop 7
    ds_read_b128 v[20:23], v12 offset:8192
    s_waitcnt lgkmcnt(0)
    v_mfma_f32_16x16x32_bf16 v[52:55], v[20:23], a[124:127], v[24:27]
    v_mfma_f32_16x16x32_bf16 v[60:63], v[20:23], a[140:143], v[28:31]
    s_nop 1
    ds_read_b128 v[20:23], v13 offset:8192
    s_waitcnt lgkmcnt(0)
    v_mfma_f32_16x16x32_bf16 v[52:55], v[20:23], a[112:115], v[52:55]
    v_mfma_f32_16x16x32_bf16 v[60:63], v[20:23], a[128:131], v[60:63]
    s_nop 1
    ds_read_b128 v[20:23], v14 offset:8192
    s_waitcnt lgkmcnt(0)
    v_mfma_f32_16x16x32_bf16 v[52:55], v[20:23], a[116:119], v[52:55]
    v_mfma_f32_16x16x32_bf16 v[60:63], v[20:23], a[132:135], v[60:63]
    s_nop 1
    ds_read_b128 v[20:23], v15 offset:8192
    s_waitcnt lgkmcnt(0)
    v_mfma_f32_16x16x32_bf16 v[52:55], v[20:23], a[120:123], v[52:55]
    v_mfma_f32_16x16x32_bf16 v[60:63], v[20:23], a[136:139], v[60:63]
    s_nop 1
    ds_read_b128 v[20:23], v12 offset:12288
    s_waitcnt lgkmcnt(0)
    v_mfma_f32_16x16x32_bf16 v[56:59], v[20:23], a[124:127], v[24:27]
    v_mfma_f32_16x16x32_bf16 v[64:67], v[20:23], a[140:143], v[28:31]
    s_nop 1
    ds_read_b128 v[20:23], v13 offset:12288
    s_waitcnt lgkmcnt(0)
    v_mfma_f32_16x16x32_bf16 v[56:59], v[20:23], a[112:115], v[56:59]
    v_mfma_f32_16x16x32_bf16 v[64:67], v[20:23], a[128:131], v[64:67]
    s_nop 1
    ds_read_b128 v[20:23], v14 offset:12288
    s_waitcnt lgkmcnt(0)
    v_mfma_f32_16x16x32_bf16 v[56:59], v[20:23], a[116:119], v[56:59]
    v_mfma_f32_16x16x32_bf16 v[64:67], v[20:23], a[132:135], v[64:67]
    s_nop 1
    ds_read_b128 v[20:23], v15 offset:12288
    s_waitcnt lgkmcnt(0)
    v_mfma_f32_16x16x32_bf16 v[56:59], v[20:23], a[120:123], v[56:59]
    v_mfma_f32_16x16x32_bf16 v[64:67], v[20:23], a[136:139], v[64:67]
    s_nop 1
    s_nop 7
    s_nop 3
    s_mov_b32 s51, 0
    v_max3_f32 v20, v52, v53, v54
    v_max3_f32 v20, v20, v55, v56
    v_max3_f32 v20, v20, v57, v58
    v_max_f32 v20, v20, v59
    v_mov_b32 v23, v20
    s_nop 1
    v_permlane16_swap_b32 v20, v23
    v_max_f32 v20, v20, v23
    v_mov_b32 v23, v20
    s_nop 1
    v_permlane32_swap_b32 v20, v23
    v_max_f32 v20, v20, v23
    v_add_f32 v20, 0x40e00000, v20
    v_max_f32 v20, s51, v20
    v_sub_f32 v52, v52, v20
    v_sub_f32 v53, v53, v20
    v_sub_f32 v54, v54, v20
    v_sub_f32 v55, v55, v20
    v_sub_f32 v56, v56, v20
    v_sub_f32 v57, v57, v20
    v_sub_f32 v58, v58, v20
    v_sub_f32 v59, v59, v20
    v_sub_f32 v24, v24, v20
    v_sub_f32 v25, v25, v20
    v_sub_f32 v26, v26, v20
    v_sub_f32 v27, v27, v20
    v_max3_f32 v21, v60, v61, v62
    v_max3_f32 v21, v21, v63, v64
    v_max3_f32 v21, v21, v65, v66
    v_max_f32 v21, v21, v67
    v_mov_b32 v23, v21
    s_nop 1
    v_permlane16_swap_b32 v21, v23
    v_max_f32 v21, v21, v23
    v_mov_b32 v23, v21
    s_nop 1
    v_permlane32_swap_b32 v21, v23
    v_max_f32 v21, v21, v23
    v_add_f32 v21, 0x40e00000, v21
    v_max_f32 v21, s51, v21
    v_sub_f32 v60, v60, v21
    v_sub_f32 v61, v61, v21
    v_sub_f32 v62, v62, v21
    v_sub_f32 v63, v63, v21
    v_sub_f32 v64, v64, v21
    v_sub_f32 v65, v65, v21
    v_sub_f32 v66, v66, v21
    v_sub_f32 v67, v67, v21
    v_sub_f32 v28, v28, v21
    v_sub_f32 v29, v29, v21
    v_sub_f32 v30, v30, v21
    v_sub_f32 v31, v31, v21
    v_mov_b32 v22, 0
    s_mov_b32 s53, 1
L_w1_resc:
    v_exp_f32 v20, -v20
    v_exp_f32 v21, -v21
    v_exp_f32 v22, -v22
    v_accvgpr_read_b32 v23, a0
    v_mul_f32 v23, v23, v20
    v_accvgpr_write_b32 a0, v23
    v_accvgpr_read_b32 v23, a1
    v_mul_f32 v23, v23, v20
    v_accvgpr_write_b32 a1, v23
    v_accvgpr_read_b32 v23, a2
    v_mul_f32 v23, v23, v20
    v_accvgpr_write_b32 a2, v23
    v_accvgpr_read_b32 v23, a3
    v_mul_f32 v23, v23, v20
    v_accvgpr_write_b32 a3, v23
    v_accvgpr_read_b32 v23, a4
    v_mul_f32 v23, v23, v21
    v_accvgpr_write_b32 a4, v23
    v_accvgpr_read_b32 v23, a5
    v_mul_f32 v23, v23, v21
    v_accvgpr_write_b32 a5, v23
    v_accvgpr_read_b32 v23, a6
    v_mul_f32 v23, v23, v21
    v_accvgpr_write_b32 a6, v23
    v_accvgpr_read_b32 v23, a7
    v_mul_f32 v23, v23, v21
    v_accvgpr_write_b32 a7, v23
    v_accvgpr_read_b32 v23, a64
    v_mul_f32 v23, v23, v22
    v_accvgpr_write_b32 a64, v23
    v_accvgpr_read_b32 v23, a65
    v_mul_f32 v23, v23, v22
    v_accvgpr_write_b32 a65, v23
    v_accvgpr_read_b32 v23, a66
    v_mul_f32 v23, v23, v22
    v_accvgpr_write_b32 a66, v23
    v_accvgpr_read_b32 v23, a67
    v_mul_f32 v23, v23, v22
    v_accvgpr_write_b32 a67, v23
    v_accvgpr_read_b32 v23, a8
    v_mul_f32 v23, v23, v20
    v_accvgpr_write_b32 a8, v23
    v_accvgpr_read_b32 v23, a9
    v_mul_f32 v23, v23, v20
    v_accvgpr_write_b32 a9, v23
    v_accvgpr_read_b32 v23, a10
    v_mul_f32 v23, v23, v20
    v_accvgpr_write_b32 a10, v23
    v_accvgpr_read_b32 v23, a11
    v_mul_f32 v23, v23, v20
    v_accvgpr_write_b32 a11, v23
    v_accvgpr_read_b32 v23, a12
    v_mul_f32 v23, v23, v21
    v_accvgpr_write_b32 a12, v23
    v_accvgpr_read_b32 v23, a13
    v_mul_f32 v23, v23, v21
    v_accvgpr_write_b32 a13, v23
    v_accvgpr_read_b32 v23, a14
    v_mul_f32 v23, v23, v21
    v_accvgpr_write_b32 a14, v23
    v_accvgpr_read_b32 v23, a15
    v_mul_f32 v23, v23, v21
    v_accvgpr_write_b32 a15, v23
    v_accvgpr_read_b32 v23, a68
    v_mul_f32 v23, v23, v22
    v_accvgpr_write_b32 a68, v23
    v_accvgpr_read_b32 v23, a69
    v_mul_f32 v23, v23, v22
    v_accvgpr_write_b32 a69, v23
    v_accvgpr_read_b32 v23, a70
    v_mul_f32 v23, v23, v22
    v_accvgpr_write_b32 a70, v23
    v_accvgpr_read_b32 v23, a71
    v_mul_f32 v23, v23, v22
    v_accvgpr_write_b32 a71, v23
    v_accvgpr_read_b32 v23, a16
    v_mul_f32 v23, v23, v20
    v_accvgpr_write_b32 a16, v23
    v_accvgpr_read_b32 v23, a17
    v_mul_f32 v23, v23, v20
    v_accvgpr_write_b32 a17, v23
    v_accvgpr_read_b32 v23, a18
    v_mul_f32 v23, v23, v20
    v_accvgpr_write_b32 a18, v23
    v_accvgpr_read_b32 v23, a19
    v_mul_f32 v23, v23, v20
    v_accvgpr_write_b32 a19, v23
    v_accvgpr_read_b32 v23, a20
    v_mul_f32 v23, v23, v21
    v_accvgpr_write_b32 a20, v23
    v_accvgpr_read_b32 v23, a21
    v_mul_f32 v23, v23, v21
    v_accvgpr_write_b32 a21, v23
    v_accvgpr_read_b32 v23, a22
    v_mul_f32 v23, v23, v21
    v_accvgpr_write_b32 a22, v23
    v_accvgpr_read_b32 v23, a23
    v_mul_f32 v23, v23, v21
    v_accvgpr_write_b32 a23, v23
    v_accvgpr_read_b32 v23, a72
    v_mul_f32 v23, v23, v22
    v_accvgpr_write_b32 a72, v23
    v_accvgpr_read_b32 v23, a73
    v_mul_f32 v23, v23, v22
    v_accvgpr_write_b32 a73, v23
    v_accvgpr_read_b32 v23, a74
    v_mul_f32 v23, v23, v22
    v_accvgpr_write_b32 a74, v23
    v_accvgpr_read_b32 v23, a75
    v_mul_f32 v23, v23, v22
    v_accvgpr_write_b32 a75, v23
    v_accvgpr_read_b32 v23, a24
    v_mul_f32 v23, v23, v20
    v_accvgpr_write_b32 a24, v23
    v_accvgpr_read_b32 v23, a25
    v_mul_f32 v23, v23, v20
    v_accvgpr_write_b32 a25, v23
    v_accvgpr_read_b32 v23, a26
    v_mul_f32 v23, v23, v20
    v_accvgpr_write_b32 a26, v23
    v_accvgpr_read_b32 v23, a27
    v_mul_f32 v23, v23, v20
    v_accvgpr_write_b32 a27, v23
    v_accvgpr_read_b32 v23, a28
    v_mul_f32 v23, v23, v21
    v_accvgpr_write_b32 a28, v23
    v_accvgpr_read_b32 v23, a29
    v_mul_f32 v23, v23, v21
    v_accvgpr_write_b32 a29, v23
    v_accvgpr_read_b32 v23, a30
    v_mul_f32 v23, v23, v21
    v_accvgpr_write_b32 a30, v23
    v_accvgpr_read_b32 v23, a31
    v_mul_f32 v23, v23, v21
    v_accvgpr_write_b32 a31, v23
    v_accvgpr_read_b32 v23, a76
    v_mul_f32 v23, v23, v22
    v_accvgpr_write_b32 a76, v23
    v_accvgpr_read_b32 v23, a77
    v_mul_f32 v23, v23, v22
    v_accvgpr_write_b32 a77, v23
    v_accvgpr_read_b32 v23, a78
    v_mul_f32 v23, v23, v22
    v_accvgpr_write_b32 a78, v23
    v_accvgpr_read_b32 v23, a79
    v_mul_f32 v23, v23, v22
    v_accvgpr_write_b32 a79, v23
    v_accvgpr_read_b32 v23, a32
    v_mul_f32 v23, v23, v20
    v_accvgpr_write_b32 a32, v23
    v_accvgpr_read_b32 v23, a33
    v_mul_f32 v23, v23, v20
    v_accvgpr_write_b32 a33, v23
    v_accvgpr_read_b32 v23, a34
    v_mul_f32 v23, v23, v20
    v_accvgpr_write_b32 a34, v23
    v_accvgpr_read_b32 v23, a35
    v_mul_f32 v23, v23, v20
    v_accvgpr_write_b32 a35, v23
    v_accvgpr_read_b32 v23, a36
    v_mul_f32 v23, v23, v21
    v_accvgpr_write_b32 a36, v23
    v_accvgpr_read_b32 v23, a37
    v_mul_f32 v23, v23, v21
    v_accvgpr_write_b32 a37, v23
    v_accvgpr_read_b32 v23, a38
    v_mul_f32 v23, v23, v21
    v_accvgpr_write_b32 a38, v23
    v_accvgpr_read_b32 v23, a39
    v_mul_f32 v23, v23, v21
    v_accvgpr_write_b32 a39, v23
    v_accvgpr_read_b32 v23, a80
    v_mul_f32 v23, v23, v22
    v_accvgpr_write_b32 a80, v23
    v_accvgpr_read_b32 v23, a81
    v_mul_f32 v23, v23, v22
    v_accvgpr_write_b32 a81, v23
    v_accvgpr_read_b32 v23, a82
    v_mul_f32 v23, v23, v22
    v_accvgpr_write_b32 a82, v23
    v_accvgpr_read_b32 v23, a83
    v_mul_f32 v23, v23, v22
    v_accvgpr_write_b32 a83, v23
    v_accvgpr_read_b32 v23, a40
    v_mul_f32 v23, v23, v20
    v_accvgpr_write_b32 a40, v23
    v_accvgpr_read_b32 v23, a41
    v_mul_f32 v23, v23, v20
    v_accvgpr_write_b32 a41, v23
    v_accvgpr_read_b32 v23, a42
    v_mul_f32 v23, v23, v20
    v_accvgpr_write_b32 a42, v23
    v_accvgpr_read_b32 v23, a43
    v_mul_f32 v23, v23, v20
    v_accvgpr_write_b32 a43, v23
    v_accvgpr_read_b32 v23, a44
    v_mul_f32 v23, v23, v21
    v_accvgpr_write_b32 a44, v23
    v_accvgpr_read_b32 v23, a45
    v_mul_f32 v23, v23, v21
    v_accvgpr_write_b32 a45, v23
    v_accvgpr_read_b32 v23, a46
    v_mul_f32 v23, v23, v21
    v_accvgpr_write_b32 a46, v23
    v_accvgpr_read_b32 v23, a47
    v_mul_f32 v23, v23, v21
    v_accvgpr_write_b32 a47, v23
    v_accvgpr_read_b32 v23, a84
    v_mul_f32 v23, v23, v22
    v_accvgpr_write_b32 a84, v23
    v_accvgpr_read_b32 v23, a85
    v_mul_f32 v23, v23, v22
    v_accvgpr_write_b32 a85, v23
    v_accvgpr_read_b32 v23, a86
    v_mul_f32 v23, v23, v22
    v_accvgpr_write_b32 a86, v23
    v_accvgpr_read_b32 v23, a87
    v_mul_f32 v23, v23, v22
    v_accvgpr_write_b32 a87, v23
    v_accvgpr_read_b32 v23, a48
    v_mul_f32 v23, v23, v20
    v_accvgpr_write_b32 a48, v23
    v_accvgpr_read_b32 v23, a49
    v_mul_f32 v23, v23, v20
    v_accvgpr_write_b32 a49, v23
    v_accvgpr_read_b32 v23, a50
    v_mul_f32 v23, v23, v20
    v_accvgpr_write_b32 a50, v23
    v_accvgpr_read_b32 v23, a51
    v_mul_f32 v23, v23, v20
    v_accvgpr_write_b32 a51, v23
    v_accvgpr_read_b32 v23, a52
    v_mul_f32 v23, v23, v21
    v_accvgpr_write_b32 a52, v23
    v_accvgpr_read_b32 v23, a53
    v_mul_f32 v23, v23, v21
    v_accvgpr_write_b32 a53, v23
    v_accvgpr_read_b32 v23, a54
    v_mul_f32 v23, v23, v21
    v_accvgpr_write_b32 a54, v23
    v_accvgpr_read_b32 v23, a55
    v_mul_f32 v23, v23, v21
    v_accvgpr_write_b32 a55, v23
    v_accvgpr_read_b32 v23, a88
    v_mul_f32 v23, v23, v22
    v_accvgpr_write_b32 a88, v23
    v_accvgpr_read_b32 v23, a89
    v_mul_f32 v23, v23, v22
    v_accvgpr_write_b32 a89, v23
    v_accvgpr_read_b32 v23, a90
    v_mul_f32 v23, v23, v22
    v_accvgpr_write_b32 a90, v23
    v_accvgpr_read_b32 v23, a91
    v_mul_f32 v23, v23, v22
    v_accvgpr_write_b32 a91, v23
    v_accvgpr_read_b32 v23, a56
    v_mul_f32 v23, v23, v20
    v_accvgpr_write_b32 a56, v23
    v_accvgpr_read_b32 v23, a57
    v_mul_f32 v23, v23, v20
    v_accvgpr_write_b32 a57, v23
    v_accvgpr_read_b32 v23, a58
    v_mul_f32 v23, v23, v20
    v_accvgpr_write_b32 a58, v23
    v_accvgpr_read_b32 v23, a59
    v_mul_f32 v23, v23, v20
    v_accvgpr_write_b32 a59, v23
    v_accvgpr_read_b32 v23, a60
    v_mul_f32 v23, v23, v21
    v_accvgpr_write_b32 a60, v23
    v_accvgpr_read_b32 v23, a61
    v_mul_f32 v23, v23, v21
    v_accvgpr_write_b32 a61, v23
    v_accvgpr_read_b32 v23, a62
    v_mul_f32 v23, v23, v21
    v_accvgpr_write_b32 a62, v23
    v_accvgpr_read_b32 v23, a63
    v_mul_f32 v23, v23, v21
    v_accvgpr_write_b32 a63, v23
    v_accvgpr_read_b32 v23, a92
    v_mul_f32 v23, v23, v22
    v_accvgpr_write_b32 a92, v23
    v_accvgpr_read_b32 v23, a93
    v_mul_f32 v23, v23, v22
    v_accvgpr_write_b32 a93, v23
    v_accvgpr_read_b32 v23, a94
    v_mul_f32 v23, v23, v22
    v_accvgpr_write_b32 a94, v23
    v_accvgpr_read_b32 v23, a95
    v_mul_f32 v23, v23, v22
    v_accvgpr_write_b32 a95, v23
    v_accvgpr_read_b32 v23, a96
    v_mul_f32 v23, v23, v20
    v_accvgpr_write_b32 a96, v23
    v_accvgpr_read_b32 v23, a97
    v_mul_f32 v23, v23, v20
    v_accvgpr_write_b32 a97, v23
    v_accvgpr_read_b32 v23, a98
    v_mul_f32 v23, v23, v20
    v_accvgpr_write_b32 a98, v23
    v_accvgpr_read_b32 v23, a99
    v_mul_f32 v23, v23, v20
    v_accvgpr_write_b32 a99, v23
    v_accvgpr_read_b32 v23, a100
    v_mul_f32 v23, v23, v21
    v_accvgpr_write_b32 a100, v23
    v_accvgpr_read_b32 v23, a101
    v_mul_f32 v23, v23, v21
    v_accvgpr_write_b32 a101, v23
    v_accvgpr_read_b32 v23, a102
    v_mul_f32 v23, v23, v21
    v_accvgpr_write_b32 a102, v23
    v_accvgpr_read_b32 v23, a103
    v_mul_f32 v23, v23, v21
    v_accvgpr_write_b32 a103, v23
    v_accvgpr_read_b32 v23, a104
    v_mul_f32 v23, v23, v22
    v_accvgpr_write_b32 a104, v23
    v_accvgpr_read_b32 v23, a105
    v_mul_f32 v23, v23, v22
    v_accvgpr_write_b32 a105, v23
    v_accvgpr_read_b32 v23, a106
    v_mul_f32 v23, v23, v22
    v_accvgpr_write_b32 a106, v23
    v_accvgpr_read_b32 v23, a107
    v_mul_f32 v23, v23, v22
    v_accvgpr_write_b32 a107, v23
    s_cmp_eq_u32 s53, 1
    s_cbranch_scc1 L_w1_retB
    v_exp_f32 v36, v36
    v_exp_f32 v37, v37
    v_exp_f32 v38, v38
    v_exp_f32 v39, v39
    v_cvt_pk_bf16_f32 v36, v36, v37
    v_cvt_pk_bf16_f32 v37, v38, v39
    v_exp_f32 v44, v44
    v_exp_f32 v45, v45
    v_exp_f32 v46, v46
    v_exp_f32 v47, v47
    v_cvt_pk_bf16_f32 v44, v44, v45
    v_cvt_pk_bf16_f32 v45, v46, v47
    v_exp_f32 v40, v40
    v_exp_f32 v41, v41
    v_exp_f32 v42, v42
    v_exp_f32 v43, v43
    v_cvt_pk_bf16_f32 v38, v40, v41
    v_cvt_pk_bf16_f32 v39, v42, v43
    v_exp_f32 v48, v48
    v_exp_f32 v49, v49
    v_exp_f32 v50, v50
    v_exp_f32 v51, v51
    v_cvt_pk_bf16_f32 v46, v48, v49
    v_cvt_pk_bf16_f32 v47, v50, v51
    v_exp_f32 v68, v68
    v_exp_f32 v69, v69
    v_exp_f32 v70, v70
    v_exp_f32 v71, v71
    v_cvt_pk_bf16_f32 v68, v68, v69
    v_cvt_pk_bf16_f32 v69, v70, v71
    s_branch L_w1_Aafter
L_w1_retB:
    v_exp_f32 v52, v52
    v_exp_f32 v53, v53
    v_exp_f32 v54, v54
    v_exp_f32 v55, v55
    v_cvt_pk_bf16_f32 v52, v52, v53
    v_cvt_pk_bf16_f32 v53, v54, v55
    v_exp_f32 v60, v60
    v_exp_f32 v61, v61
    v_exp_f32 v62, v62
    v_exp_f32 v63, v63
    v_cvt_pk_bf16_f32 v60, v60, v61
    v_cvt_pk_bf16_f32 v61, v62, v63
    v_exp_f32 v56, v56
    v_exp_f32 v57, v57
    v_exp_f32 v58, v58
    v_exp_f32 v59, v59
    v_cvt_pk_bf16_f32 v54, v56, v57
    v_cvt_pk_bf16_f32 v55, v58, v59
    v_exp_f32 v64, v64
    v_exp_f32 v65, v65
    v_exp_f32 v66, v66
    v_exp_f32 v67, v67
    v_cvt_pk_bf16_f32 v62, v64, v65
    v_cvt_pk_bf16_f32 v63, v66, v67
    s_branch L_w1_Bafter
L_w1_done:
    s_add_u32 s8, s32, 524288
    s_addc_u32 s9, s33, 0
    s_mov_b32 s10, 131072
    s_mov_b32 s11, 0x20000
    s_add_u32 s12, s36, 524288
    s_addc_u32 s13, s37, 0
    s_mov_b32 s14, 131072
    s_mov_b32 s15, 0x20000
    s_nop 7
    v_lshlrev_b32 v0, 4, v1
    v_accvgpr_read_b32 v22, a104
    v_lshlrev_b32 v12, 2, v1
    v_add_u32 v12, 131072, v12
    ds_write_b32 v12, v32 offset:256
    ds_write_b32 v12, v22 offset:1280
    v_accvgpr_read_b32 v20, a96
    v_accvgpr_read_b32 v21, a100
    v_rcp_f32 v20, v20
    v_rcp_f32 v21, v21
    v_accvgpr_read_b32 v72, a0
    v_accvgpr_read_b32 v76, a8
    v_accvgpr_read_b32 v73, a1
    v_accvgpr_read_b32 v77, a9
    v_accvgpr_read_b32 v74, a2
    v_accvgpr_read_b32 v78, a10
    v_accvgpr_read_b32 v75, a3
    v_accvgpr_read_b32 v79, a11
    v_mul_f32 v72, v72, v20
    v_mul_f32 v73, v73, v20
    v_mul_f32 v74, v74, v20
    v_mul_f32 v75, v75, v20
    v_mul_f32 v76, v76, v20
    v_mul_f32 v77, v77, v20
    v_mul_f32 v78, v78, v20
    v_mul_f32 v79, v79, v20
    v_cvt_pk_bf16_f32 v72, v72, v73
    v_cvt_pk_bf16_f32 v73, v74, v75
    v_cvt_pk_bf16_f32 v74, v76, v77
    v_cvt_pk_bf16_f32 v75, v78, v79
    s_mov_b32 s48, 9216
    buffer_store_dwordx4 v[72:75], v0, s[40:43], s48 offen sc1
    v_accvgpr_read_b32 v80, a16
    v_accvgpr_read_b32 v84, a24
    v_accvgpr_read_b32 v81, a17
    v_accvgpr_read_b32 v85, a25
    v_accvgpr_read_b32 v82, a18
    v_accvgpr_read_b32 v86, a26
    v_accvgpr_read_b32 v83, a19
    v_accvgpr_read_b32 v87, a27
    v_mul_f32 v80, v80, v20
    v_mul_f32 v81, v81, v20
    v_mul_f32 v82, v82, v20
    v_mul_f32 v83, v83, v20
    v_mul_f32 v84, v84, v20
    v_mul_f32 v85, v85, v20
    v_mul_f32 v86, v86, v20
    v_mul_f32 v87, v87, v20
    v_cvt_pk_bf16_f32 v80, v80, v81
    v_cvt_pk_bf16_f32 v81, v82, v83
    v_cvt_pk_bf16_f32 v82, v84, v85
    v_cvt_pk_bf16_f32 v83, v86, v87
    s_mov_b32 s48, 10240
    buffer_store_dwordx4 v[80:83], v0, s[40:43], s48 offen sc1
    v_accvgpr_read_b32 v88, a32
    v_accvgpr_read_b32 v92, a40
    v_accvgpr_read_b32 v89, a33
    v_accvgpr_read_b32 v93, a41
    v_accvgpr_read_b32 v90, a34
    v_accvgpr_read_b32 v94, a42
    v_accvgpr_read_b32 v91, a35
    v_accvgpr_read_b32 v95, a43
    v_mul_f32 v88, v88, v20
    v_mul_f32 v89, v89, v20
    v_mul_f32 v90, v90, v20
    v_mul_f32 v91, v91, v20
    v_mul_f32 v92, v92, v20
    v_mul_f32 v93, v93, v20
    v_mul_f32 v94, v94, v20
    v_mul_f32 v95, v95, v20
    v_cvt_pk_bf16_f32 v88, v88, v89
    v_cvt_pk_bf16_f32 v89, v90, v91
    v_cvt_pk_bf16_f32 v90, v92, v93
    v_cvt_pk_bf16_f32 v91, v94, v95
    s_mov_b32 s48, 11264
    buffer_store_dwordx4 v[88:91], v0, s[40:43], s48 offen sc1
    v_accvgpr_read_b32 v72, a48
    v_accvgpr_read_b32 v76, a56
    v_accvgpr_read_b32 v73, a49
    v_accvgpr_read_b32 v77, a57
    v_accvgpr_read_b32 v74, a50
    v_accvgpr_read_b32 v78, a58
    v_accvgpr_read_b32 v75, a51
    v_accvgpr_read_b32 v79, a59
    v_mul_f32 v72, v72, v20
    v_mul_f32 v73, v73, v20
    v_mul_f32 v74, v74, v20
    v_mul_f32 v75, v75, v20
    v_mul_f32 v76, v76, v20
    v_mul_f32 v77, v77, v20
    v_mul_f32 v78, v78, v20
    v_mul_f32 v79, v79, v20
    v_cvt_pk_bf16_f32 v72, v72, v73
    v_cvt_pk_bf16_f32 v73, v74, v75
    v_cvt_pk_bf16_f32 v74, v76, v77
    v_cvt_pk_bf16_f32 v75, v78, v79
    s_mov_b32 s48, 8192
    buffer_store_dwordx4 v[72:75], v0, s[40:43], s48 offen sc1
    v_accvgpr_read_b32 v80, a4
    v_accvgpr_read_b32 v84, a12
    v_accvgpr_read_b32 v81, a5
    v_accvgpr_read_b32 v85, a13
    v_accvgpr_read_b32 v82, a6
    v_accvgpr_read_b32 v86, a14
    v_accvgpr_read_b32 v83, a7
    v_accvgpr_read_b32 v87, a15
    v_mul_f32 v80, v80, v21
    v_mul_f32 v81, v81, v21
    v_mul_f32 v82, v82, v21
    v_mul_f32 v83, v83, v21
    v_mul_f32 v84, v84, v21
    v_mul_f32 v85, v85, v21
    v_mul_f32 v86, v86, v21
    v_mul_f32 v87, v87, v21
    v_cvt_pk_bf16_f32 v80, v80, v81
    v_cvt_pk_bf16_f32 v81, v82, v83
    v_cvt_pk_bf16_f32 v82, v84, v85
    v_cvt_pk_bf16_f32 v83, v86, v87
    s_mov_b32 s48, 13312
    buffer_store_dwordx4 v[80:83], v0, s[40:43], s48 offen sc1
    v_accvgpr_read_b32 v88, a20
    v_accvgpr_read_b32 v92, a28
    v_accvgpr_read_b32 v89, a21
    v_accvgpr_read_b32 v93, a29
    v_accvgpr_read_b32 v90, a22
    v_accvgpr_read_b32 v94, a30
    v_accvgpr_read_b32 v91, a23
    v_accvgpr_read_b32 v95, a31
    v_mul_f32 v88, v88, v21
    v_mul_f32 v89, v89, v21
    v_mul_f32 v90, v90, v21
    v_mul_f32 v91, v91, v21
    v_mul_f32 v92, v92, v21
    v_mul_f32 v93, v93, v21
    v_mul_f32 v94, v94, v21
    v_mul_f32 v95, v95, v21
    v_cvt_pk_bf16_f32 v88, v88, v89
    v_cvt_pk_bf16_f32 v89, v90, v91
    v_cvt_pk_bf16_f32 v90, v92, v93
    v_cvt_pk_bf16_f32 v91, v94, v95
    s_mov_b32 s48, 14336
    buffer_store_dwordx4 v[88:91], v0, s[40:43], s48 offen sc1
    v_accvgpr_read_b32 v72, a36
    v_accvgpr_read_b32 v76, a44
    v_accvgpr_read_b32 v73, a37
    v_accvgpr_read_b32 v77, a45
    v_accvgpr_read_b32 v74, a38
    v_accvgpr_read_b32 v78, a46
    v_accvgpr_read_b32 v75, a39
    v_accvgpr_read_b32 v79, a47
    v_mul_f32 v72, v72, v21
    v_mul_f32 v73, v73, v21
    v_mul_f32 v74, v74, v21
    v_mul_f32 v75, v75, v21
    v_mul_f32 v76, v76, v21
    v_mul_f32 v77, v77, v21
    v_mul_f32 v78, v78, v21
    v_mul_f32 v79, v79, v21
    v_cvt_pk_bf16_f32 v72, v72, v73
    v_cvt_pk_bf16_f32 v73, v74, v75
    v_cvt_pk_bf16_f32 v74, v76, v77
    v_cvt_pk_bf16_f32 v75, v78, v79
    s_mov_b32 s48, 15360
    buffer_store_dwordx4 v[72:75], v0, s[40:43], s48 offen sc1
    v_accvgpr_read_b32 v80, a52
    v_accvgpr_read_b32 v84, a60
    v_accvgpr_read_b32 v81, a53
    v_accvgpr_read_b32 v85, a61
    v_accvgpr_read_b32 v82, a54
    v_accvgpr_read_b32 v86, a62
    v_accvgpr_read_b32 v83, a55
    v_accvgpr_read_b32 v87, a63
    v_mul_f32 v80, v80, v21
    v_mul_f32 v81, v81, v21
    v_mul_f32 v82, v82, v21
    v_mul_f32 v83, v83, v21
    v_mul_f32 v84, v84, v21
    v_mul_f32 v85, v85, v21
    v_mul_f32 v86, v86, v21
    v_mul_f32 v87, v87, v21
    v_cvt_pk_bf16_f32 v80, v80, v81
    v_cvt_pk_bf16_f32 v81, v82, v83
    v_cvt_pk_bf16_f32 v82, v84, v85
    v_cvt_pk_bf16_f32 v83, v86, v87
    s_mov_b32 s48, 12288
    buffer_store_dwordx4 v[80:83], v0, s[40:43], s48 offen sc1
    s_waitcnt lgkmcnt(0)
    s_barrier
    s_cmp_lg_u32 s6, 0
    s_cbranch_scc1 L_h0_1
    s_add_u32 m0, s57, 0
    s_add_u32 s48, s57, 65536
    buffer_load_dwordx4 v16, s[8:11], s48 offen offset:0 nt lds
    buffer_load_dwordx4 v17, s[8:11], s48 offen offset:1024 nt lds
    buffer_load_dwordx4 v16, s[8:11], s48 offen offset:2048 nt lds
    buffer_load_dwordx4 v17, s[8:11], s48 offen offset:3072 nt lds
    s_add_u32 m0, s57, 16384
    s_add_u32 s48, s57, 65536
    buffer_load_dwordx4 v16, s[12:15], s48 offen offset:0 nt lds
    buffer_load_dwordx4 v17, s[12:15], s48 offen offset:1024 nt lds
    buffer_load_dwordx4 v16, s[12:15], s48 offen offset:2048 nt lds
    buffer_load_dwordx4 v17, s[12:15], s48 offen offset:3072 nt lds
L_h0_1:
    ds_read_b32 v24, v12 offset:0
    ds_read_b32 v28, v12 offset:1024
    ds_read_b32 v25, v12 offset:256
    ds_read_b32 v29, v12 offset:1280
    ds_read_b32 v26, v12 offset:512
    ds_read_b32 v30, v12 offset:1536
    ds_read_b32 v27, v12 offset:768
    ds_read_b32 v31, v12 offset:1792
    s_waitcnt lgkmcnt(5)
    v_min_f32 v22, v24, v25
    s_waitcnt lgkmcnt(1)
    v_min3_f32 v22, v22, v26, v27
    v_sub_f32 v24, v22, v24
    v_sub_f32 v25, v22, v25
    v_sub_f32 v26, v22, v26
    v_sub_f32 v27, v22, v27
    v_exp_f32 v24, v24
    v_exp_f32 v25, v25
    v_exp_f32 v26, v26
    v_exp_f32 v27, v27
    s_nop 0
    v_mul_f32 v22, v24, v28
    v_fmac_f32 v22, v25, v29
    v_fmac_f32 v22, v26, v30
    s_waitcnt lgkmcnt(0)
    v_fmac_f32 v22, v27, v31
    v_rcp_f32 v22, v22
    s_nop 0
    v_mul_f32 v22, v22, v25
    v_add_u32 v12, 133120, v0
    v_accvgpr_read_b32 v44, a72
    v_accvgpr_read_b32 v45, a73
    v_accvgpr_read_b32 v46, a74
    v_accvgpr_read_b32 v47, a75
    v_mul_f32 v44, v44, v22
    v_mul_f32 v45, v45, v22
    v_mul_f32 v46, v46, v22
    v_mul_f32 v47, v47, v22
    ds_write_b128 v12, v[44:47] offset:16384
    v_accvgpr_read_b32 v48, a76
    v_accvgpr_read_b32 v49, a77
    v_accvgpr_read_b32 v50, a78
    v_accvgpr_read_b32 v51, a79
    v_mul_f32 v48, v48, v22
    v_mul_f32 v49, v49, v22
    v_mul_f32 v50, v50, v22
    v_mul_f32 v51, v51, v22
    ds_write_b128 v12, v[48:51] offset:17408
    v_accvgpr_read_b32 v36, a80
    v_accvgpr_read_b32 v37, a81
    v_accvgpr_read_b32 v38, a82
    v_accvgpr_read_b32 v39, a83
    v_mul_f32 v36, v36, v22
    v_mul_f32 v37, v37, v22
    v_mul_f32 v38, v38, v22
    v_mul_f32 v39, v39, v22
    ds_write_b128 v12, v[36:39] offset:20480
    v_accvgpr_read_b32 v40, a84
    v_accvgpr_read_b32 v41, a85
    v_accvgpr_read_b32 v42, a86
    v_accvgpr_read_b32 v43, a87
    v_mul_f32 v40, v40, v22
    v_mul_f32 v41, v41, v22
    v_mul_f32 v42, v42, v22
    v_mul_f32 v43, v43, v22
    ds_write_b128 v12, v[40:43] offset:21504
    v_accvgpr_read_b32 v44, a88
    v_accvgpr_read_b32 v45, a89
    v_accvgpr_read_b32 v46, a90
    v_accvgpr_read_b32 v47, a91
    v_mul_f32 v44, v44, v22
    v_mul_f32 v45, v45, v22
    v_mul_f32 v46, v46, v22
    v_mul_f32 v47, v47, v22
    ds_write_b128 v12, v[44:47] offset:0
    v_accvgpr_read_b32 v48, a92
    v_accvgpr_read_b32 v49, a93
    v_accvgpr_read_b32 v50, a94
    v_accvgpr_read_b32 v51, a95
    v_mul_f32 v48, v48, v22
    v_mul_f32 v49, v49, v22
    v_mul_f32 v50, v50, v22
    v_mul_f32 v51, v51, v22
    ds_write_b128 v12, v[48:51] offset:1024
    v_accvgpr_read_b32 v24, a64
    v_accvgpr_read_b32 v25, a65
    v_accvgpr_read_b32 v26, a66
    v_accvgpr_read_b32 v27, a67
    v_mul_f32 v24, v24, v22
    v_mul_f32 v25, v25, v22
    v_mul_f32 v26, v26, v22
    v_mul_f32 v27, v27, v22
    v_accvgpr_read_b32 v28, a68
    v_accvgpr_read_b32 v29, a69
    v_accvgpr_read_b32 v30, a70
    v_accvgpr_read_b32 v31, a71
    v_mul_f32 v28, v28, v22
    v_mul_f32 v29, v29, v22
    v_mul_f32 v30, v30, v22
    v_mul_f32 v31, v31, v22
    s_waitcnt lgkmcnt(0)
    s_barrier
    ds_read_b128 v[36:39], v12 offset:6144
    ds_read_b128 v[40:43], v12 offset:7168
    ds_read_b128 v[44:47], v12 offset:8192
    ds_read_b128 v[48:51], v12 offset:9216
    ds_read_b128 v[52:55], v12 offset:10240
    ds_read_b128 v[56:59], v12 offset:11264
    s_waitcnt lgkmcnt(3)
    v_add_f32 v36, v36, v44
    s_waitcnt lgkmcnt(1)
    v_add_f32 v24, v24, v52
    v_add_f32 v36, v36, v24
    v_add_f32 v37, v37, v45
    v_add_f32 v25, v25, v53
    v_add_f32 v37, v37, v25
    v_add_f32 v38, v38, v46
    v_add_f32 v26, v26, v54
    v_add_f32 v38, v38, v26
    v_add_f32 v39, v39, v47
    v_add_f32 v27, v27, v55
    v_add_f32 v39, v39, v27
    v_add_f32 v40, v40, v48
    s_waitcnt lgkmcnt(0)
    v_add_f32 v28, v28, v56
    v_add_f32 v40, v40, v28
    v_add_f32 v41, v41, v49
    v_add_f32 v29, v29, v57
    v_add_f32 v41, v41, v29
    v_add_f32 v42, v42, v50
    v_add_f32 v30, v30, v58
    v_add_f32 v42, v42, v30
    v_add_f32 v43, v43, v51
    v_add_f32 v31, v31, v59
    v_add_f32 v43, v43, v31
    v_cvt_pk_bf16_f32 v36, v36, v37
    v_cvt_pk_bf16_f32 v37, v38, v39
    v_cvt_pk_bf16_f32 v38, v40, v41
    v_cvt_pk_bf16_f32 v39, v42, v43
    s_mov_b32 s48, 33792
    buffer_store_dwordx4 v[36:39], v0, s[40:43], s48 offen sc1
    s_cmp_lg_u32 s6, 0
    s_cbranch_scc1 L_h1_1
    s_add_u32 m0, s57, 32768
    s_add_u32 s48, s57, 81920
    buffer_load_dwordx4 v16, s[8:11], s48 offen offset:0 nt lds
    buffer_load_dwordx4 v17, s[8:11], s48 offen offset:1024 nt lds
    buffer_load_dwordx4 v16, s[8:11], s48 offen offset:2048 nt lds
    buffer_load_dwordx4 v17, s[8:11], s48 offen offset:3072 nt lds
    s_add_u32 m0, s57, 49152
    s_add_u32 s48, s57, 81920
    buffer_load_dwordx4 v16, s[12:15], s48 offen offset:0 nt lds
    buffer_load_dwordx4 v17, s[12:15], s48 offen offset:1024 nt lds
    buffer_load_dwordx4 v16, s[12:15], s48 offen offset:2048 nt lds
    buffer_load_dwordx4 v17, s[12:15], s48 offen offset:3072 nt lds
L_h1_1:
    s_cmp_lg_u32 s6, 0
    s_cbranch_scc1 L_e3a_1
    s_waitcnt vmcnt(8)
    s_branch L_e3b_1
L_e3a_1:
    s_waitcnt vmcnt(0)
L_e3b_1:
    s_barrier
    s_branch L_fin
L_wave2:
    s_branch L_w2_first
L_w2_fake:
    ds_read_b128 v[72:75], v12 offset:0
    ds_read_b128 v[76:79], v13 offset:0
    ds_read_b128 v[80:83], v14 offset:0
    ds_read_b128 v[84:87], v15 offset:0
L_w2_loop:
    s_waitcnt lgkmcnt(3)
    v_mfma_f32_16x16x32_bf16 v[36:39], v[72:75], a[120:123], v[24:27]
    ds_read_b128 v[88:91], v12 offset:4096
    v_mfma_f32_16x16x32_bf16 v[44:47], v[72:75], a[136:139], v[28:31]
    s_waitcnt lgkmcnt(3)
    v_mfma_f32_16x16x32_bf16 v[36:39], v[76:79], a[124:127], v[36:39]
    ds_read_b128 v[92:95], v13 offset:4096
    v_mfma_f32_16x16x32_bf16 v[44:47], v[76:79], a[140:143], v[44:47]
    s_waitcnt lgkmcnt(3)
    v_mfma_f32_16x16x32_bf16 v[36:39], v[80:83], a[112:115], v[36:39]
    ds_read_b128 v[72:75], v14 offset:4096
    v_mfma_f32_16x16x32_bf16 v[44:47], v[80:83], a[128:131], v[44:47]
    s_waitcnt lgkmcnt(3)
    v_mfma_f32_16x16x32_bf16 v[36:39], v[84:87], a[116:119], v[36:39]
    ds_read_b128 v[76:79], v15 offset:4096
    v_mfma_f32_16x16x32_bf16 v[44:47], v[84:87], a[132:135], v[44:47]
    s_waitcnt lgkmcnt(3)
    v_mfma_f32_16x16x32_bf16 v[40:43], v[88:91], a[120:123], v[24:27]
    ds_read_b128 v[80:83], v12 offset:8192
    v_mfma_f32_16x16x32_bf16 v[48:51], v[88:91], a[136:139], v[28:31]
    s_waitcnt lgkmcnt(3)
    v_mfma_f32_16x16x32_bf16 v[40:43], v[92:95], a[124:127], v[40:43]
    ds_read_b128 v[84:87], v13 offset:8192
    v_exp_f32 v36, v36
    v_mfma_f32_16x16x32_bf16 v[48:51], v[92:95], a[140:143], v[48:51]
    v_exp_f32 v37, v37
    s_waitcnt lgkmcnt(3)
    v_mfma_f32_16x16x32_bf16 v[40:43], v[72:75], a[112:115], v[40:43]
    ds_read_b128 v[88:91], v14 offset:8192
    v_exp_f32 v38, v38
    v_mfma_f32_16x16x32_bf16 v[48:51], v[72:75], a[128:131], v[48:51]
    v_exp_f32 v39, v39
    v_cvt_pk_bf16_f32 v36, v36, v37
    s_waitcnt lgkmcnt(3)
    v_mfma_f32_16x16x32_bf16 v[40:43], v[76:79], a[116:119], v[40:43]
    ds_read_b128 v[92:95], v15 offset:8192
    v_cvt_pk_bf16_f32 v37, v38, v39
    v_or_b32 v20, v36, v37
    v_mfma_f32_16x16x32_bf16 v[48:51], v[76:79], a[132:135], v[48:51]
    v_exp_f32 v44, v44
    s_waitcnt lgkmcnt(3)
    v_mfma_f32_16x16x32_bf16 v[52:55], v[80:83], a[120:123], v[24:27]
    ds_read_b128 v[72:75], v12 offset:12288
    v_mfma_f32_16x16x32_bf16 v[60:63], v[80:83], a[136:139], v[28:31]
    v_exp_f32 v45, v45
    v_mfma_f32_16x16x32_bf16 v[68:71], v[80:83], a[144:147], v[32:35]
    v_exp_f32 v46, v46
    s_waitcnt lgkmcnt(3)
    v_mfma_f32_16x16x32_bf16 v[52:55], v[84:87], a[124:127], v[52:55]
    ds_read_b128 v[76:79], v13 offset:12288
    v_exp_f32 v47, v47
    v_cvt_pk_bf16_f32 v44, v44, v45
    v_mfma_f32_16x16x32_bf16 v[60:63], v[84:87], a[140:143], v[60:63]
    v_cvt_pk_bf16_f32 v45, v46, v47
    v_or3_b32 v20, v44, v45, v20
    v_mfma_f32_16x16x32_bf16 v[68:71], v[84:87], a[148:151], v[68:71]
    v_exp_f32 v40, v40
    s_waitcnt lgkmcnt(3)
    v_mfma_f32_16x16x32_bf16 v[52:55], v[88:91], a[112:115], v[52:55]
    ds_read_b128 v[80:83], v14 offset:12288
    v_exp_f32 v41, v41
    v_mfma_f32_16x16x32_bf16 v[60:63], v[88:91], a[128:131], v[60:63]
    v_exp_f32 v42, v42
    v_mfma_f32_16x16x32_bf16 v[68:71], v[88:91], a[152:155], v[68:71]
    v_exp_f32 v43, v43
    v_cvt_pk_bf16_f32 v38, v40, v41
    s_waitcnt lgkmcnt(3)
    v_mfma_f32_16x16x32_bf16 v[52:55], v[92:95], a[116:119], v[52:55]
    ds_read_b128 v[84:87], v15 offset:12288
    v_cvt_pk_bf16_f32 v39, v42, v43
    v_or3_b32 v20, v38, v39, v20
    v_mfma_f32_16x16x32_bf16 v[60:63], v[92:95], a[132:135], v[60:63]
    v_exp_f32 v48, v48
    v_mfma_f32_16x16x32_bf16 v[68:71], v[92:95], a[156:159], v[68:71]
    v_exp_f32 v49, v49
    s_waitcnt lgkmcnt(3)
    v_mfma_f32_16x16x32_bf16 v[56:59], v[72:75], a[120:123], v[24:27]
    ds_read_b64_tr_b16 v[88:89], v4 offset:0
    ds_read_b64_tr_b16 v[90:91], v4 offset:4096
    v_mfma_f32_16x16x32_bf16 v[64:67], v[72:75], a[136:139], v[28:31]
    v_exp_f32 v50, v50
    s_waitcnt lgkmcnt(4)
    v_mfma_f32_16x16x32_bf16 v[56:59], v[76:79], a[124:127], v[56:59]
    ds_read_b64_tr_b16 v[72:73], v5 offset:0
    ds_read_b64_tr_b16 v[74:75], v5 offset:4096
    v_mfma_f32_16x16x32_bf16 v[64:67], v[76:79], a[140:143], v[64:67]
    v_exp_f32 v51, v51
    s_waitcnt lgkmcnt(5)
    v_mfma_f32_16x16x32_bf16 v[56:59], v[80:83], a[112:115], v[56:59]
    ds_read_b64_tr_b16 v[76:77], v6 offset:0
    ds_read_b64_tr_b16 v[78:79], v6 offset:4096
    v_mfma_f32_16x16x32_bf16 v[64:67], v[80:83], a[128:131], v[64:67]
    v_cvt_pk_bf16_f32 v46, v48, v49
    v_cvt_pk_bf16_f32 v47, v50, v51
    s_waitcnt lgkmcnt(6)
    v_mfma_f32_16x16x32_bf16 v[56:59], v[84:87], a[116:119], v[56:59]
    ds_read_b64_tr_b16 v[80:81], v7 offset:0
    ds_read_b64_tr_b16 v[82:83], v7 offset:4096
    v_or3_b32 v20, v46, v47, v20
    v_mfma_f32_16x16x32_bf16 v[64:67], v[84:87], a[132:135], v[64:67]
    v_and_b32 v20, s52, v20
    v_cmp_ne_u32 vcc, 0, v20
    s_cbranch_vccnz L_w2_rareA
L_w2_Aafter:
    v_mfma_f32_16x16x32_bf16 a[96:99], a[108:111], v[36:39], a[96:99]
    v_mfma_f32_16x16x32_bf16 a[100:103], a[108:111], v[44:47], a[100:103]
    s_waitcnt lgkmcnt(6)
    v_mfma_f32_16x16x32_bf16 a[0:3], v[88:91], v[36:39], a[0:3]
    ds_read_b64_tr_b16 v[84:85], v8 offset:0
    ds_read_b64_tr_b16 v[86:87], v8 offset:4096
    v_exp_f32 v52, v52
    v_mfma_f32_16x16x32_bf16 a[4:7], v[88:91], v[44:47], a[4:7]
    v_exp_f32 v53, v53
    v_exp_f32 v54, v54
    s_waitcnt lgkmcnt(6)
    v_mfma_f32_16x16x32_bf16 a[8:11], v[72:75], v[36:39], a[8:11]
    ds_read_b64_tr_b16 v[88:89], v9 offset:0
    ds_read_b64_tr_b16 v[90:91], v9 offset:4096
    v_exp_f32 v55, v55
    v_mfma_f32_16x16x32_bf16 a[12:15], v[72:75], v[44:47], a[12:15]
    v_cvt_pk_bf16_f32 v52, v52, v53
    v_cvt_pk_bf16_f32 v53, v54, v55
    v_or_b32 v21, v52, v53
    s_waitcnt lgkmcnt(6)
    v_mfma_f32_16x16x32_bf16 a[16:19], v[76:79], v[36:39], a[16:19]
    ds_read_b64_tr_b16 v[72:73], v10 offset:0
    ds_read_b64_tr_b16 v[74:75], v10 offset:4096
    v_exp_f32 v60, v60
    v_mfma_f32_16x16x32_bf16 a[20:23], v[76:79], v[44:47], a[20:23]
    v_exp_f32 v61, v61
    v_exp_f32 v62, v62
    s_waitcnt lgkmcnt(6)
    v_mfma_f32_16x16x32_bf16 a[24:27], v[80:83], v[36:39], a[24:27]
    ds_read_b64_tr_b16 v[76:77], v11 offset:0
    ds_read_b64_tr_b16 v[78:79], v11 offset:4096
    s_add_u32 s48, s45, 32768
    s_cmp_eq_u32 s48, 131072
    s_cselect_b32 s48, 0, s48
    s_sub_u32 s58, s48, s45
    v_mfma_f32_16x16x32_bf16 a[28:31], v[80:83], v[44:47], a[28:31]
    v_exp_f32 v63, v63
    v_cvt_pk_bf16_f32 v60, v60, v61
    v_cvt_pk_bf16_f32 v61, v62, v63
    s_waitcnt lgkmcnt(6)
    v_mfma_f32_16x16x32_bf16 a[32:35], v[84:87], v[36:39], a[32:35]
    ds_read_b64_tr_b16 v[80:81], v4 offset:8192
    ds_read_b64_tr_b16 v[82:83], v4 offset:12288
    v_or3_b32 v21, v60, v61, v21
    v_mfma_f32_16x16x32_bf16 a[36:39], v[84:87], v[44:47], a[36:39]
    v_exp_f32 v68, v68
    v_exp_f32 v69, v69
    s_waitcnt lgkmcnt(6)
    v_mfma_f32_16x16x32_bf16 a[40:43], v[88:91], v[36:39], a[40:43]
    ds_read_b64_tr_b16 v[84:85], v5 offset:8192
    ds_read_b64_tr_b16 v[86:87], v5 offset:12288
    v_exp_f32 v70, v70
    v_mfma_f32_16x16x32_bf16 a[44:47], v[88:91], v[44:47], a[44:47]
    v_exp_f32 v71, v71
    v_cvt_pk_bf16_f32 v68, v68, v69
    v_cvt_pk_bf16_f32 v69, v70, v71
    s_waitcnt lgkmcnt(6)
    v_mfma_f32_16x16x32_bf16 a[48:51], v[72:75], v[36:39], a[48:51]
    ds_read_b64_tr_b16 v[88:89], v6 offset:8192
    ds_read_b64_tr_b16 v[90:91], v6 offset:12288
    v_or3_b32 v21, v68, v69, v21
    v_mfma_f32_16x16x32_bf16 a[52:55], v[72:75], v[44:47], a[52:55]
    v_exp_f32 v56, v56
    v_exp_f32 v57, v57
    s_waitcnt lgkmcnt(6)
    v_mfma_f32_16x16x32_bf16 a[56:59], v[76:79], v[36:39], a[56:59]
    ds_read_b64_tr_b16 v[72:73], v7 offset:8192
    ds_read_b64_tr_b16 v[74:75], v7 offset:12288
    v_exp_f32 v58, v58
    v_mfma_f32_16x16x32_bf16 a[60:63], v[76:79], v[44:47], a[60:63]
    v_exp_f32 v59, v59
    v_cvt_pk_bf16_f32 v54, v56, v57
    v_cvt_pk_bf16_f32 v55, v58, v59
    v_or3_b32 v21, v54, v55, v21
    v_exp_f32 v64, v64
    v_exp_f32 v65, v65
    v_exp_f32 v66, v66
    v_exp_f32 v67, v67
    v_cvt_pk_bf16_f32 v62, v64, v65
    v_cvt_pk_bf16_f32 v63, v66, v67
    v_or3_b32 v21, v62, v63, v21
    v_and_b32 v21, s52, v21
    v_cmp_ne_u32 vcc, 0, v21
    s_cbranch_vccnz L_w2_rareB
L_w2_Bafter:
    v_mfma_f32_16x16x32_bf16 a[96:99], a[108:111], v[52:55], a[96:99]
    v_mfma_f32_16x16x32_bf16 a[100:103], a[108:111], v[60:63], a[100:103]
    v_mfma_f32_16x16x16_bf16 a[104:107], a[108:109], v[68:69], a[104:107]
    s_waitcnt lgkmcnt(6)
    v_mfma_f32_16x16x32_bf16 a[0:3], v[80:83], v[52:55], a[0:3]
    ds_read_b64_tr_b16 v[76:77], v8 offset:8192
    ds_read_b64_tr_b16 v[78:79], v8 offset:12288
    v_mfma_f32_16x16x32_bf16 a[4:7], v[80:83], v[60:63], a[4:7]
    v_mfma_f32_16x16x16_bf16 a[64:67], v[80:81], v[68:69], a[64:67]
    s_waitcnt lgkmcnt(6)
    v_mfma_f32_16x16x32_bf16 a[8:11], v[84:87], v[52:55], a[8:11]
    ds_read_b64_tr_b16 v[80:81], v9 offset:8192
    ds_read_b64_tr_b16 v[82:83], v9 offset:12288
    v_mfma_f32_16x16x32_bf16 a[12:15], v[84:87], v[60:63], a[12:15]
    v_mfma_f32_16x16x16_bf16 a[68:71], v[84:85], v[68:69], a[68:71]
    s_waitcnt lgkmcnt(6)
    v_mfma_f32_16x16x32_bf16 a[16:19], v[88:91], v[52:55], a[16:19]
    ds_read_b64_tr_b16 v[84:85], v10 offset:8192
    ds_read_b64_tr_b16 v[86:87], v10 offset:12288
    v_mfma_f32_16x16x32_bf16 a[20:23], v[88:91], v[60:63], a[20:23]
    v_add_u32 v12, s58, v12
    v_add_u32 v13, s58, v13
    v_add_u32 v14, s58, v14
    v_add_u32 v15, s58, v15
    v_mfma_f32_16x16x16_bf16 a[72:75], v[88:89], v[68:69], a[72:75]
    s_waitcnt lgkmcnt(6)
    v_mfma_f32_16x16x32_bf16 a[24:27], v[72:75], v[52:55], a[24:27]
    ds_read_b64_tr_b16 v[88:89], v11 offset:8192
    ds_read_b64_tr_b16 v[90:91], v11 offset:12288
    v_mfma_f32_16x16x32_bf16 a[28:31], v[72:75], v[60:63], a[28:31]
    v_mfma_f32_16x16x16_bf16 a[76:79], v[72:73], v[68:69], a[76:79]
    s_cmp_eq_u32 s68, 0
    s_cbranch_scc1 L_w2_v0
    s_cmp_eq_u32 s68, 1
    s_cmp_eq_u32 s68, 1
    s_cbranch_scc1 L_w2_v8
    s_waitcnt vmcnt(16) lgkmcnt(0)
    s_mov_b32 s68, 1
    s_branch L_w2_v9
L_w2_v8:
    s_waitcnt vmcnt(8) lgkmcnt(0)
    s_mov_b32 s68, 0
    s_branch L_w2_v9
L_w2_v0:
    s_waitcnt vmcnt(0) lgkmcnt(0)
L_w2_v9:
    s_barrier
    v_mfma_f32_16x16x32_bf16 a[32:35], v[76:79], v[52:55], a[32:35]
    ds_read_b128 v[72:75], v12 offset:0
    v_mfma_f32_16x16x32_bf16 a[36:39], v[76:79], v[60:63], a[36:39]
    v_mfma_f32_16x16x16_bf16 a[80:83], v[76:77], v[68:69], a[80:83]
    v_add_u32 v4, s58, v4
    v_add_u32 v5, s58, v5
    v_add_u32 v6, s58, v6
    v_add_u32 v7, s58, v7
    v_mfma_f32_16x16x32_bf16 a[40:43], v[80:83], v[52:55], a[40:43]
    ds_read_b128 v[76:79], v13 offset:0
    v_mfma_f32_16x16x32_bf16 a[44:47], v[80:83], v[60:63], a[44:47]
    v_mfma_f32_16x16x16_bf16 a[84:87], v[80:81], v[68:69], a[84:87]
    v_add_u32 v8, s58, v8
    v_add_u32 v9, s58, v9
    v_add_u32 v10, s58, v10
    v_add_u32 v11, s58, v11
    v_mfma_f32_16x16x32_bf16 a[48:51], v[84:87], v[52:55], a[48:51]
    ds_read_b128 v[80:83], v14 offset:0
    v_mfma_f32_16x16x32_bf16 a[52:55], v[84:87], v[60:63], a[52:55]
    v_mfma_f32_16x16x16_bf16 a[88:91], v[84:85], v[68:69], a[88:91]
    v_mfma_f32_16x16x32_bf16 a[56:59], v[88:91], v[52:55], a[56:59]
    ds_read_b128 v[84:87], v15 offset:0
    v_mfma_f32_16x16x32_bf16 a[60:63], v[88:91], v[60:63], a[60:63]
    v_mfma_f32_16x16x16_bf16 a[92:95], v[88:89], v[68:69], a[92:95]
    s_add_u32 s45, s45, s58
    s_add_u32 s47, s47, 16384
    s_add_u32 s44, s44, 1
    s_cmp_lt_u32 s44, 8
    s_cbranch_scc1 L_w2_loop
    s_waitcnt lgkmcnt(0)
    s_branch L_w2_done
L_w2_first:
    ds_read_b128 v[72:75], v12 offset:0
    ds_read_b128 v[76:79], v13 offset:0
    ds_read_b128 v[80:83], v14 offset:0
    s_waitcnt lgkmcnt(2)
    v_mfma_f32_16x16x32_bf16 v[36:39], v[72:75], a[120:123], v[24:27]
    ds_read_b128 v[84:87], v15 offset:0
    ds_read_b128 v[88:91], v12 offset:4096
    v_mfma_f32_16x16x32_bf16 v[44:47], v[72:75], a[136:139], v[28:31]
    s_waitcnt lgkmcnt(3)
    v_mfma_f32_16x16x32_bf16 v[36:39], v[76:79], a[124:127], v[36:39]
    ds_read_b128 v[92:95], v13 offset:4096
    v_mfma_f32_16x16x32_bf16 v[44:47], v[76:79], a[140:143], v[44:47]
    s_waitcnt lgkmcnt(3)
    v_mfma_f32_16x16x32_bf16 v[36:39], v[80:83], a[112:115], v[36:39]
    ds_read_b128 v[72:75], v14 offset:4096
    v_mfma_f32_16x16x32_bf16 v[44:47], v[80:83], a[128:131], v[44:47]
    s_waitcnt lgkmcnt(3)
    v_mfma_f32_16x16x32_bf16 v[36:39], v[84:87], a[116:119], v[36:39]
    ds_read_b128 v[76:79], v15 offset:4096
    v_mfma_f32_16x16x32_bf16 v[44:47], v[84:87], a[132:135], v[44:47]
    s_waitcnt lgkmcnt(3)
    v_mfma_f32_16x16x32_bf16 v[40:43], v[88:91], a[120:123], v[24:27]
    ds_read_b128 v[80:83], v12 offset:8192
    v_mfma_f32_16x16x32_bf16 v[48:51], v[88:91], a[136:139], v[28:31]
    s_waitcnt lgkmcnt(3)
    v_mfma_f32_16x16x32_bf16 v[40:43], v[92:95], a[124:127], v[40:43]
    ds_read_b128 v[84:87], v13 offset:8192
    v_mfma_f32_16x16x32_bf16 v[48:51], v[92:95], a[140:143], v[48:51]
    s_waitcnt lgkmcnt(3)
    v_mfma_f32_16x16x32_bf16 v[40:43], v[72:75], a[112:115], v[40:43]
    ds_read_b128 v[88:91], v14 offset:8192
    v_mfma_f32_16x16x32_bf16 v[48:51], v[72:75], a[128:131], v[48:51]
    s_waitcnt lgkmcnt(3)
    v_mfma_f32_16x16x32_bf16 v[40:43], v[76:79], a[116:119], v[40:43]
    ds_read_b128 v[92:95], v15 offset:8192
    v_mfma_f32_16x16x32_bf16 v[48:51], v[76:79], a[132:135], v[48:51]
    s_waitcnt lgkmcnt(3)
    v_mfma_f32_16x16x32_bf16 v[52:55], v[80:83], a[120:123], v[24:27]
    ds_read_b128 v[72:75], v12 offset:12288
    v_mfma_f32_16x16x32_bf16 v[60:63], v[80:83], a[136:139], v[28:31]
    v_mfma_f32_16x16x32_bf16 v[68:71], v[80:83], a[144:147], v[32:35]
    s_waitcnt lgkmcnt(3)
    v_mfma_f32_16x16x32_bf16 v[52:55], v[84:87], a[124:127], v[52:55]
    ds_read_b128 v[76:79], v13 offset:12288
    v_mfma_f32_16x16x32_bf16 v[60:63], v[84:87], a[140:143], v[60:63]
    v_mfma_f32_16x16x32_bf16 v[68:71], v[84:87], a[148:151], v[68:71]
    s_waitcnt lgkmcnt(3)
    v_mfma_f32_16x16x32_bf16 v[52:55], v[88:91], a[112:115], v[52:55]
    ds_read_b128 v[80:83], v14 offset:12288
    v_mfma_f32_16x16x32_bf16 v[60:63], v[88:91], a[128:131], v[60:63]
    v_mfma_f32_16x16x32_bf16 v[68:71], v[88:91], a[152:155], v[68:71]
    s_waitcnt lgkmcnt(3)
    v_mfma_f32_16x16x32_bf16 v[52:55], v[92:95], a[116:119], v[52:55]
    ds_read_b128 v[84:87], v15 offset:12288
    v_mfma_f32_16x16x32_bf16 v[60:63], v[92:95], a[132:135], v[60:63]
    v_mfma_f32_16x16x32_bf16 v[68:71], v[92:95], a[156:159], v[68:71]
    s_waitcnt lgkmcnt(3)
    v_mfma_f32_16x16x32_bf16 v[56:59], v[72:75], a[120:123], v[24:27]
    ds_read_b64_tr_b16 v[88:89], v4 offset:0
    ds_read_b64_tr_b16 v[90:91], v4 offset:4096
    v_mfma_f32_16x16x32_bf16 v[64:67], v[72:75], a[136:139], v[28:31]
    s_waitcnt lgkmcnt(4)
    v_mfma_f32_16x16x32_bf16 v[56:59], v[76:79], a[124:127], v[56:59]
    ds_read_b64_tr_b16 v[72:73], v5 offset:0
    ds_read_b64_tr_b16 v[74:75], v5 offset:4096
    v_mfma_f32_16x16x32_bf16 v[64:67], v[76:79], a[140:143], v[64:67]
    s_waitcnt lgkmcnt(5)
    v_mfma_f32_16x16x32_bf16 v[56:59], v[80:83], a[112:115], v[56:59]
    ds_read_b64_tr_b16 v[76:77], v6 offset:0
    ds_read_b64_tr_b16 v[78:79], v6 offset:4096
    v_mfma_f32_16x16x32_bf16 v[64:67], v[80:83], a[128:131], v[64:67]
    s_waitcnt lgkmcnt(6)
    v_mfma_f32_16x16x32_bf16 v[56:59], v[84:87], a[116:119], v[56:59]
    ds_read_b64_tr_b16 v[80:81], v7 offset:0
    ds_read_b64_tr_b16 v[82:83], v7 offset:4096
    v_mfma_f32_16x16x32_bf16 v[64:67], v[84:87], a[132:135], v[64:67]
    s_nop 7
    s_mov_b32 s51, 0xff7fffff
    v_max3_f32 v20, v36, v37, v38
    v_max3_f32 v20, v20, v39, v40
    v_max3_f32 v20, v20, v41, v42
    v_max3_f32 v20, v20, v43, v52
    v_max3_f32 v20, v20, v53, v54
    v_max3_f32 v20, v20, v55, v56
    v_max3_f32 v20, v20, v57, v58
    v_max_f32 v20, v20, v59
    v_mov_b32 v23, v20
    s_nop 1
    v_permlane16_swap_b32 v20, v23
    v_max_f32 v20, v20, v23
    v_mov_b32 v23, v20
    s_nop 1
    v_permlane32_swap_b32 v20, v23
    v_max_f32 v20, v20, v23
    v_add_f32 v20, 0x40e00000, v20
    v_max_f32 v20, s51, v20
    v_sub_f32 v36, v36, v20
    v_sub_f32 v37, v37, v20
    v_sub_f32 v38, v38, v20
    v_sub_f32 v39, v39, v20
    v_sub_f32 v40, v40, v20
    v_sub_f32 v41, v41, v20
    v_sub_f32 v42, v42, v20
    v_sub_f32 v43, v43, v20
    v_sub_f32 v52, v52, v20
    v_sub_f32 v53, v53, v20
    v_sub_f32 v54, v54, v20
    v_sub_f32 v55, v55, v20
    v_sub_f32 v56, v56, v20
    v_sub_f32 v57, v57, v20
    v_sub_f32 v58, v58, v20
    v_sub_f32 v59, v59, v20
    v_sub_f32 v24, v24, v20
    v_sub_f32 v25, v25, v20
    v_sub_f32 v26, v26, v20
    v_sub_f32 v27, v27, v20
    v_max3_f32 v21, v44, v45, v46
    v_max3_f32 v21, v21, v47, v48
    v_max3_f32 v21, v21, v49, v50
    v_max3_f32 v21, v21, v51, v60
    v_max3_f32 v21, v21, v61, v62
    v_max3_f32 v21, v21, v63, v64
    v_max3_f32 v21, v21, v65, v66
    v_max_f32 v21, v21, v67
    v_mov_b32 v23, v21
    s_nop 1
    v_permlane16_swap_b32 v21, v23
    v_max_f32 v21, v21, v23
    v_mov_b32 v23, v21
    s_nop 1
    v_permlane32_swap_b32 v21, v23
    v_max_f32 v21, v21, v23
    v_add_f32 v21, 0x40e00000, v21
    v_max_f32 v21, s51, v21
    v_sub_f32 v44, v44, v21
    v_sub_f32 v45, v45, v21
    v_sub_f32 v46, v46, v21
    v_sub_f32 v47, v47, v21
    v_sub_f32 v48, v48, v21
    v_sub_f32 v49, v49, v21
    v_sub_f32 v50, v50, v21
    v_sub_f32 v51, v51, v21
    v_sub_f32 v60, v60, v21
    v_sub_f32 v61, v61, v21
    v_sub_f32 v62, v62, v21
    v_sub_f32 v63, v63, v21
    v_sub_f32 v64, v64, v21
    v_sub_f32 v65, v65, v21
    v_sub_f32 v66, v66, v21
    v_sub_f32 v67, v67, v21
    v_sub_f32 v28, v28, v21
    v_sub_f32 v29, v29, v21
    v_sub_f32 v30, v30, v21
    v_sub_f32 v31, v31, v21
    v_max3_f32 v22, v68, v69, v70
    v_max_f32 v22, v22, v71
    v_mov_b32 v23, v22
    s_nop 1
    v_permlane16_swap_b32 v22, v23
    v_max_f32 v22, v22, v23
    v_mov_b32 v23, v22
    s_nop 1
    v_permlane32_swap_b32 v22, v23
    v_max_f32 v22, v22, v23
    v_add_f32 v22, 0x40e00000, v22
    v_max_f32 v22, s51, v22
    v_sub_f32 v68, v68, v22
    v_sub_f32 v69, v69, v22
    v_sub_f32 v70, v70, v22
    v_sub_f32 v71, v71, v22
    v_sub_f32 v32, v32, v22
    v_sub_f32 v33, v33, v22
    v_sub_f32 v34, v34, v22
    v_sub_f32 v35, v35, v22
    v_exp_f32 v36, v36
    v_exp_f32 v37, v37
    v_exp_f32 v38, v38
    v_exp_f32 v39, v39
    v_cvt_pk_bf16_f32 v36, v36, v37
    v_cvt_pk_bf16_f32 v37, v38, v39
    v_exp_f32 v44, v44
    v_exp_f32 v45, v45
    v_exp_f32 v46, v46
    v_exp_f32 v47, v47
    v_cvt_pk_bf16_f32 v44, v44, v45
    v_cvt_pk_bf16_f32 v45, v46, v47
    v_exp_f32 v40, v40
    v_exp_f32 v41, v41
    v_exp_f32 v42, v42
    v_exp_f32 v43, v43
    v_cvt_pk_bf16_f32 v38, v40, v41
    v_cvt_pk_bf16_f32 v39, v42, v43
    v_exp_f32 v48, v48
    v_exp_f32 v49, v49
    v_exp_f32 v50, v50
    v_exp_f32 v51, v51
    v_cvt_pk_bf16_f32 v46, v48, v49
    v_cvt_pk_bf16_f32 v47, v50, v51
    s_waitcnt lgkmcnt(0)
    s_branch L_w2_Aafter
L_w2_rareA:
    s_waitcnt lgkmcnt(0)
    s_nop 7
    s_nop 7
    ds_read_b128 v[20:23], v12 offset:0
    s_waitcnt lgkmcnt(0)
    v_mfma_f32_16x16x32_bf16 v[36:39], v[20:23], a[120:123], v[24:27]
    v_mfma_f32_16x16x32_bf16 v[44:47], v[20:23], a[136:139], v[28:31]
    s_nop 1
    ds_read_b128 v[20:23], v13 offset:0
    s_waitcnt lgkmcnt(0)
    v_mfma_f32_16x16x32_bf16 v[36:39], v[20:23], a[124:127], v[36:39]
    v_mfma_f32_16x16x32_bf16 v[44:47], v[20:23], a[140:143], v[44:47]
    s_nop 1
    ds_read_b128 v[20:23], v14 offset:0
    s_waitcnt lgkmcnt(0)
    v_mfma_f32_16x16x32_bf16 v[36:39], v[20:23], a[112:115], v[36:39]
    v_mfma_f32_16x16x32_bf16 v[44:47], v[20:23], a[128:131], v[44:47]
    s_nop 1
    ds_read_b128 v[20:23], v15 offset:0
    s_waitcnt lgkmcnt(0)
    v_mfma_f32_16x16x32_bf16 v[36:39], v[20:23], a[116:119], v[36:39]
    v_mfma_f32_16x16x32_bf16 v[44:47], v[20:23], a[132:135], v[44:47]
    s_nop 1
    ds_read_b128 v[20:23], v12 offset:4096
    s_waitcnt lgkmcnt(0)
    v_mfma_f32_16x16x32_bf16 v[40:43], v[20:23], a[120:123], v[24:27]
    v_mfma_f32_16x16x32_bf16 v[48:51], v[20:23], a[136:139], v[28:31]
    s_nop 1
    ds_read_b128 v[20:23], v13 offset:4096
    s_waitcnt lgkmcnt(0)
    v_mfma_f32_16x16x32_bf16 v[40:43], v[20:23], a[124:127], v[40:43]
    v_mfma_f32_16x16x32_bf16 v[48:51], v[20:23], a[140:143], v[48:51]
    s_nop 1
    ds_read_b128 v[20:23], v14 offset:4096
    s_waitcnt lgkmcnt(0)
    v_mfma_f32_16x16x32_bf16 v[40:43], v[20:23], a[112:115], v[40:43]
    v_mfma_f32_16x16x32_bf16 v[48:51], v[20:23], a[128:131], v[48:51]
    s_nop 1
    ds_read_b128 v[20:23], v15 offset:4096
    s_waitcnt lgkmcnt(0)
    v_mfma_f32_16x16x32_bf16 v[40:43], v[20:23], a[116:119], v[40:43]
    v_mfma_f32_16x16x32_bf16 v[48:51], v[20:23], a[132:135], v[48:51]
    s_nop 1
    s_nop 7
    s_nop 3
    s_mov_b32 s51, 0
    v_max3_f32 v20, v36, v37, v38
    v_max3_f32 v20, v20, v39, v40
    v_max3_f32 v20, v20, v41, v42
    v_max3_f32 v20, v20, v43, v52
    v_max3_f32 v20, v20, v53, v54
    v_max3_f32 v20, v20, v55, v56
    v_max3_f32 v20, v20, v57, v58
    v_max_f32 v20, v20, v59
    v_mov_b32 v23, v20
    s_nop 1
    v_permlane16_swap_b32 v20, v23
    v_max_f32 v20, v20, v23
    v_mov_b32 v23, v20
    s_nop 1
    v_permlane32_swap_b32 v20, v23
    v_max_f32 v20, v20, v23
    v_add_f32 v20, 0x40e00000, v20
    v_max_f32 v20, s51, v20
    v_sub_f32 v36, v36, v20
    v_sub_f32 v37, v37, v20
    v_sub_f32 v38, v38, v20
    v_sub_f32 v39, v39, v20
    v_sub_f32 v40, v40, v20
    v_sub_f32 v41, v41, v20
    v_sub_f32 v42, v42, v20
    v_sub_f32 v43, v43, v20
    v_sub_f32 v52, v52, v20
    v_sub_f32 v53, v53, v20
    v_sub_f32 v54, v54, v20
    v_sub_f32 v55, v55, v20
    v_sub_f32 v56, v56, v20
    v_sub_f32 v57, v57, v20
    v_sub_f32 v58, v58, v20
    v_sub_f32 v59, v59, v20
    v_sub_f32 v24, v24, v20
    v_sub_f32 v25, v25, v20
    v_sub_f32 v26, v26, v20
    v_sub_f32 v27, v27, v20
    v_max3_f32 v21, v44, v45, v46
    v_max3_f32 v21, v21, v47, v48
    v_max3_f32 v21, v21, v49, v50
    v_max3_f32 v21, v21, v51, v60
    v_max3_f32 v21, v21, v61, v62
    v_max3_f32 v21, v21, v63, v64
    v_max3_f32 v21, v21, v65, v66
    v_max_f32 v21, v21, v67
    v_mov_b32 v23, v21
    s_nop 1
    v_permlane16_swap_b32 v21, v23
    v_max_f32 v21, v21, v23
    v_mov_b32 v23, v21
    s_nop 1
    v_permlane32_swap_b32 v21, v23
    v_max_f32 v21, v21, v23
    v_add_f32 v21, 0x40e00000, v21
    v_max_f32 v21, s51, v21
    v_sub_f32 v44, v44, v21
    v_sub_f32 v45, v45, v21
    v_sub_f32 v46, v46, v21
    v_sub_f32 v47, v47, v21
    v_sub_f32 v48, v48, v21
    v_sub_f32 v49, v49, v21
    v_sub_f32 v50, v50, v21
    v_sub_f32 v51, v51, v21
    v_sub_f32 v60, v60, v21
    v_sub_f32 v61, v61, v21
    v_sub_f32 v62, v62, v21
    v_sub_f32 v63, v63, v21
    v_sub_f32 v64, v64, v21
    v_sub_f32 v65, v65, v21
    v_sub_f32 v66, v66, v21
    v_sub_f32 v67, v67, v21
    v_sub_f32 v28, v28, v21
    v_sub_f32 v29, v29, v21
    v_sub_f32 v30, v30, v21
    v_sub_f32 v31, v31, v21
    v_max3_f32 v22, v68, v69, v70
    v_max_f32 v22, v22, v71
    v_mov_b32 v23, v22
    s_nop 1
    v_permlane16_swap_b32 v22, v23
    v_max_f32 v22, v22, v23
    v_mov_b32 v23, v22
    s_nop 1
    v_permlane32_swap_b32 v22, v23
    v_max_f32 v22, v22, v23
    v_add_f32 v22, 0x40e00000, v22
    v_max_f32 v22, s51, v22
    v_sub_f32 v68, v68, v22
    v_sub_f32 v69, v69, v22
    v_sub_f32 v70, v70, v22
    v_sub_f32 v71, v71, v22
    v_sub_f32 v32, v32, v22
    v_sub_f32 v33, v33, v22
    v_sub_f32 v34, v34, v22
    v_sub_f32 v35, v35, v22
    s_mov_b32 s53, 0
    s_branch L_w2_resc
L_w2_rareB:
    s_waitcnt lgkmcnt(0)
    s_nop 7
    s_nop 7
    ds_read_b128 v[20:23], v12 offset:8192
    s_waitcnt lgkmcnt(0)
    v_mfma_f32_16x16x32_bf16 v[52:55], v[20:23], a[120:123], v[24:27]
    v_mfma_f32_16x16x32_bf16 v[60:63], v[20:23], a[136:139], v[28:31]
    v_mfma_f32_16x16x32_bf16 v[68:71], v[20:23], a[144:147], v[32:35]
    s_nop 1
    ds_read_b128 v[20:23], v13 offset:8192
    s_waitcnt lgkmcnt(0)
    v_mfma_f32_16x16x32_bf16 v[52:55], v[20:23], a[124:127], v[52:55]
    v_mfma_f32_16x16x32_bf16 v[60:63], v[20:23], a[140:143], v[60:63]
    v_mfma_f32_16x16x32_bf16 v[68:71], v[20:23], a[148:151], v[68:71]
    s_nop 1
    ds_read_b128 v[20:23], v14 offset:8192
    s_waitcnt lgkmcnt(0)
    v_mfma_f32_16x16x32_bf16 v[52:55], v[20:23], a[112:115], v[52:55]
    v_mfma_f32_16x16x32_bf16 v[60:63], v[20:23], a[128:131], v[60:63]
    v_mfma_f32_16x16x32_bf16 v[68:71], v[20:23], a[152:155], v[68:71]
    s_nop 1
    ds_read_b128 v[20:23], v15 offset:8192
    s_waitcnt lgkmcnt(0)
    v_mfma_f32_16x16x32_bf16 v[52:55], v[20:23], a[116:119], v[52:55]
    v_mfma_f32_16x16x32_bf16 v[60:63], v[20:23], a[132:135], v[60:63]
    v_mfma_f32_16x16x32_bf16 v[68:71], v[20:23], a[156:159], v[68:71]
    s_nop 1
    ds_read_b128 v[20:23], v12 offset:12288
    s_waitcnt lgkmcnt(0)
    v_mfma_f32_16x16x32_bf16 v[56:59], v[20:23], a[120:123], v[24:27]
    v_mfma_f32_16x16x32_bf16 v[64:67], v[20:23], a[136:139], v[28:31]
    s_nop 1
    ds_read_b128 v[20:23], v13 offset:12288
    s_waitcnt lgkmcnt(0)
    v_mfma_f32_16x16x32_bf16 v[56:59], v[20:23], a[124:127], v[56:59]
    v_mfma_f32_16x16x32_bf16 v[64:67], v[20:23], a[140:143], v[64:67]
    s_nop 1
    ds_read_b128 v[20:23], v14 offset:12288
    s_waitcnt lgkmcnt(0)
    v_mfma_f32_16x16x32_bf16 v[56:59], v[20:23], a[112:115], v[56:59]
    v_mfma_f32_16x16x32_bf16 v[64:67], v[20:23], a[128:131], v[64:67]
    s_nop 1
    ds_read_b128 v[20:23], v15 offset:12288
    s_waitcnt lgkmcnt(0)
    v_mfma_f32_16x16x32_bf16 v[56:59], v[20:23], a[116:119], v[56:59]
    v_mfma_f32_16x16x32_bf16 v[64:67], v[20:23], a[132:135], v[64:67]
    s_nop 1
    s_nop 7
    s_nop 3
    s_mov_b32 s51, 0
    v_max3_f32 v20, v52, v53, v54
    v_max3_f32 v20, v20, v55, v56
    v_max3_f32 v20, v20, v57, v58
    v_max_f32 v20, v20, v59
    v_mov_b32 v23, v20
    s_nop 1
    v_permlane16_swap_b32 v20, v23
    v_max_f32 v20, v20, v23
    v_mov_b32 v23, v20
    s_nop 1
    v_permlane32_swap_b32 v20, v23
    v_max_f32 v20, v20, v23
    v_add_f32 v20, 0x40e00000, v20
    v_max_f32 v20, s51, v20
    v_sub_f32 v52, v52, v20
    v_sub_f32 v53, v53, v20
    v_sub_f32 v54, v54, v20
    v_sub_f32 v55, v55, v20
    v_sub_f32 v56, v56, v20
    v_sub_f32 v57, v57, v20
    v_sub_f32 v58, v58, v20
    v_sub_f32 v59, v59, v20
    v_sub_f32 v24, v24, v20
    v_sub_f32 v25, v25, v20
    v_sub_f32 v26, v26, v20
    v_sub_f32 v27, v27, v20
    v_max3_f32 v21, v60, v61, v62
    v_max3_f32 v21, v21, v63, v64
    v_max3_f32 v21, v21, v65, v66
    v_max_f32 v21, v21, v67
    v_mov_b32 v23, v21
    s_nop 1
    v_permlane16_swap_b32 v21, v23
    v_max_f32 v21, v21, v23
    v_mov_b32 v23, v21
    s_nop 1
    v_permlane32_swap_b32 v21, v23
    v_max_f32 v21, v21, v23
    v_add_f32 v21, 0x40e00000, v21
    v_max_f32 v21, s51, v21
    v_sub_f32 v60, v60, v21
    v_sub_f32 v61, v61, v21
    v_sub_f32 v62, v62, v21
    v_sub_f32 v63, v63, v21
    v_sub_f32 v64, v64, v21
    v_sub_f32 v65, v65, v21
    v_sub_f32 v66, v66, v21
    v_sub_f32 v67, v67, v21
    v_sub_f32 v28, v28, v21
    v_sub_f32 v29, v29, v21
    v_sub_f32 v30, v30, v21
    v_sub_f32 v31, v31, v21
    v_max3_f32 v22, v68, v69, v70
    v_max_f32 v22, v22, v71
    v_mov_b32 v23, v22
    s_nop 1
    v_permlane16_swap_b32 v22, v23
    v_max_f32 v22, v22, v23
    v_mov_b32 v23, v22
    s_nop 1
    v_permlane32_swap_b32 v22, v23
    v_max_f32 v22, v22, v23
    v_add_f32 v22, 0x40e00000, v22
    v_max_f32 v22, s51, v22
    v_sub_f32 v68, v68, v22
    v_sub_f32 v69, v69, v22
    v_sub_f32 v70, v70, v22
    v_sub_f32 v71, v71, v22
    v_sub_f32 v32, v32, v22
    v_sub_f32 v33, v33, v22
    v_sub_f32 v34, v34, v22
    v_sub_f32 v35, v35, v22
    s_mov_b32 s53, 1
L_w2_resc:
    v_exp_f32 v20, -v20
    v_exp_f32 v21, -v21
    v_exp_f32 v22, -v22
    v_accvgpr_read_b32 v23, a0
    v_mul_f32 v23, v23, v20
    v_accvgpr_write_b32 a0, v23
    v_accvgpr_read_b32 v23, a1
    v_mul_f32 v23, v23, v20
    v_accvgpr_write_b32 a1, v23
    v_accvgpr_read_b32 v23, a2
    v_mul_f32 v23, v23, v20
    v_accvgpr_write_b32 a2, v23
    v_accvgpr_read_b32 v23, a3
    v_mul_f32 v23, v23, v20
    v_accvgpr_write_b32 a3, v23
    v_accvgpr_read_b32 v23, a4
    v_mul_f32 v23, v23, v21
    v_accvgpr_write_b32 a4, v23
    v_accvgpr_read_b32 v23, a5
    v_mul_f32 v23, v23, v21
    v_accvgpr_write_b32 a5, v23
    v_accvgpr_read_b32 v23, a6
    v_mul_f32 v23, v23, v21
    v_accvgpr_write_b32 a6, v23
    v_accvgpr_read_b32 v23, a7
    v_mul_f32 v23, v23, v21
    v_accvgpr_write_b32 a7, v23
    v_accvgpr_read_b32 v23, a64
    v_mul_f32 v23, v23, v22
    v_accvgpr_write_b32 a64, v23
    v_accvgpr_read_b32 v23, a65
    v_mul_f32 v23, v23, v22
    v_accvgpr_write_b32 a65, v23
    v_accvgpr_read_b32 v23, a66
    v_mul_f32 v23, v23, v22
    v_accvgpr_write_b32 a66, v23
    v_accvgpr_read_b32 v23, a67
    v_mul_f32 v23, v23, v22
    v_accvgpr_write_b32 a67, v23
    v_accvgpr_read_b32 v23, a8
    v_mul_f32 v23, v23, v20
    v_accvgpr_write_b32 a8, v23
    v_accvgpr_read_b32 v23, a9
    v_mul_f32 v23, v23, v20
    v_accvgpr_write_b32 a9, v23
    v_accvgpr_read_b32 v23, a10
    v_mul_f32 v23, v23, v20
    v_accvgpr_write_b32 a10, v23
    v_accvgpr_read_b32 v23, a11
    v_mul_f32 v23, v23, v20
    v_accvgpr_write_b32 a11, v23
    v_accvgpr_read_b32 v23, a12
    v_mul_f32 v23, v23, v21
    v_accvgpr_write_b32 a12, v23
    v_accvgpr_read_b32 v23, a13
    v_mul_f32 v23, v23, v21
    v_accvgpr_write_b32 a13, v23
    v_accvgpr_read_b32 v23, a14
    v_mul_f32 v23, v23, v21
    v_accvgpr_write_b32 a14, v23
    v_accvgpr_read_b32 v23, a15
    v_mul_f32 v23, v23, v21
    v_accvgpr_write_b32 a15, v23
    v_accvgpr_read_b32 v23, a68
    v_mul_f32 v23, v23, v22
    v_accvgpr_write_b32 a68, v23
    v_accvgpr_read_b32 v23, a69
    v_mul_f32 v23, v23, v22
    v_accvgpr_write_b32 a69, v23
    v_accvgpr_read_b32 v23, a70
    v_mul_f32 v23, v23, v22
    v_accvgpr_write_b32 a70, v23
    v_accvgpr_read_b32 v23, a71
    v_mul_f32 v23, v23, v22
    v_accvgpr_write_b32 a71, v23
    v_accvgpr_read_b32 v23, a16
    v_mul_f32 v23, v23, v20
    v_accvgpr_write_b32 a16, v23
    v_accvgpr_read_b32 v23, a17
    v_mul_f32 v23, v23, v20
    v_accvgpr_write_b32 a17, v23
    v_accvgpr_read_b32 v23, a18
    v_mul_f32 v23, v23, v20
    v_accvgpr_write_b32 a18, v23
    v_accvgpr_read_b32 v23, a19
    v_mul_f32 v23, v23, v20
    v_accvgpr_write_b32 a19, v23
    v_accvgpr_read_b32 v23, a20
    v_mul_f32 v23, v23, v21
    v_accvgpr_write_b32 a20, v23
    v_accvgpr_read_b32 v23, a21
    v_mul_f32 v23, v23, v21
    v_accvgpr_write_b32 a21, v23
    v_accvgpr_read_b32 v23, a22
    v_mul_f32 v23, v23, v21
    v_accvgpr_write_b32 a22, v23
    v_accvgpr_read_b32 v23, a23
    v_mul_f32 v23, v23, v21
    v_accvgpr_write_b32 a23, v23
    v_accvgpr_read_b32 v23, a72
    v_mul_f32 v23, v23, v22
    v_accvgpr_write_b32 a72, v23
    v_accvgpr_read_b32 v23, a73
    v_mul_f32 v23, v23, v22
    v_accvgpr_write_b32 a73, v23
    v_accvgpr_read_b32 v23, a74
    v_mul_f32 v23, v23, v22
    v_accvgpr_write_b32 a74, v23
    v_accvgpr_read_b32 v23, a75
    v_mul_f32 v23, v23, v22
    v_accvgpr_write_b32 a75, v23
    v_accvgpr_read_b32 v23, a24
    v_mul_f32 v23, v23, v20
    v_accvgpr_write_b32 a24, v23
    v_accvgpr_read_b32 v23, a25
    v_mul_f32 v23, v23, v20
    v_accvgpr_write_b32 a25, v23
    v_accvgpr_read_b32 v23, a26
    v_mul_f32 v23, v23, v20
    v_accvgpr_write_b32 a26, v23
    v_accvgpr_read_b32 v23, a27
    v_mul_f32 v23, v23, v20
    v_accvgpr_write_b32 a27, v23
    v_accvgpr_read_b32 v23, a28
    v_mul_f32 v23, v23, v21
    v_accvgpr_write_b32 a28, v23
    v_accvgpr_read_b32 v23, a29
    v_mul_f32 v23, v23, v21
    v_accvgpr_write_b32 a29, v23
    v_accvgpr_read_b32 v23, a30
    v_mul_f32 v23, v23, v21
    v_accvgpr_write_b32 a30, v23
    v_accvgpr_read_b32 v23, a31
    v_mul_f32 v23, v23, v21
    v_accvgpr_write_b32 a31, v23
    v_accvgpr_read_b32 v23, a76
    v_mul_f32 v23, v23, v22
    v_accvgpr_write_b32 a76, v23
    v_accvgpr_read_b32 v23, a77
    v_mul_f32 v23, v23, v22
    v_accvgpr_write_b32 a77, v23
    v_accvgpr_read_b32 v23, a78
    v_mul_f32 v23, v23, v22
    v_accvgpr_write_b32 a78, v23
    v_accvgpr_read_b32 v23, a79
    v_mul_f32 v23, v23, v22
    v_accvgpr_write_b32 a79, v23
    v_accvgpr_read_b32 v23, a32
    v_mul_f32 v23, v23, v20
    v_accvgpr_write_b32 a32, v23
    v_accvgpr_read_b32 v23, a33
    v_mul_f32 v23, v23, v20
    v_accvgpr_write_b32 a33, v23
    v_accvgpr_read_b32 v23, a34
    v_mul_f32 v23, v23, v20
    v_accvgpr_write_b32 a34, v23
    v_accvgpr_read_b32 v23, a35
    v_mul_f32 v23, v23, v20
    v_accvgpr_write_b32 a35, v23
    v_accvgpr_read_b32 v23, a36
    v_mul_f32 v23, v23, v21
    v_accvgpr_write_b32 a36, v23
    v_accvgpr_read_b32 v23, a37
    v_mul_f32 v23, v23, v21
    v_accvgpr_write_b32 a37, v23
    v_accvgpr_read_b32 v23, a38
    v_mul_f32 v23, v23, v21
    v_accvgpr_write_b32 a38, v23
    v_accvgpr_read_b32 v23, a39
    v_mul_f32 v23, v23, v21
    v_accvgpr_write_b32 a39, v23
    v_accvgpr_read_b32 v23, a80
    v_mul_f32 v23, v23, v22
    v_accvgpr_write_b32 a80, v23
    v_accvgpr_read_b32 v23, a81
    v_mul_f32 v23, v23, v22
    v_accvgpr_write_b32 a81, v23
    v_accvgpr_read_b32 v23, a82
    v_mul_f32 v23, v23, v22
    v_accvgpr_write_b32 a82, v23
    v_accvgpr_read_b32 v23, a83
    v_mul_f32 v23, v23, v22
    v_accvgpr_write_b32 a83, v23
    v_accvgpr_read_b32 v23, a40
    v_mul_f32 v23, v23, v20
    v_accvgpr_write_b32 a40, v23
    v_accvgpr_read_b32 v23, a41
    v_mul_f32 v23, v23, v20
    v_accvgpr_write_b32 a41, v23
    v_accvgpr_read_b32 v23, a42
    v_mul_f32 v23, v23, v20
    v_accvgpr_write_b32 a42, v23
    v_accvgpr_read_b32 v23, a43
    v_mul_f32 v23, v23, v20
    v_accvgpr_write_b32 a43, v23
    v_accvgpr_read_b32 v23, a44
    v_mul_f32 v23, v23, v21
    v_accvgpr_write_b32 a44, v23
    v_accvgpr_read_b32 v23, a45
    v_mul_f32 v23, v23, v21
    v_accvgpr_write_b32 a45, v23
    v_accvgpr_read_b32 v23, a46
    v_mul_f32 v23, v23, v21
    v_accvgpr_write_b32 a46, v23
    v_accvgpr_read_b32 v23, a47
    v_mul_f32 v23, v23, v21
    v_accvgpr_write_b32 a47, v23
    v_accvgpr_read_b32 v23, a84
    v_mul_f32 v23, v23, v22
    v_accvgpr_write_b32 a84, v23
    v_accvgpr_read_b32 v23, a85
    v_mul_f32 v23, v23, v22
    v_accvgpr_write_b32 a85, v23
    v_accvgpr_read_b32 v23, a86
    v_mul_f32 v23, v23, v22
    v_accvgpr_write_b32 a86, v23
    v_accvgpr_read_b32 v23, a87
    v_mul_f32 v23, v23, v22
    v_accvgpr_write_b32 a87, v23
    v_accvgpr_read_b32 v23, a48
    v_mul_f32 v23, v23, v20
    v_accvgpr_write_b32 a48, v23
    v_accvgpr_read_b32 v23, a49
    v_mul_f32 v23, v23, v20
    v_accvgpr_write_b32 a49, v23
    v_accvgpr_read_b32 v23, a50
    v_mul_f32 v23, v23, v20
    v_accvgpr_write_b32 a50, v23
    v_accvgpr_read_b32 v23, a51
    v_mul_f32 v23, v23, v20
    v_accvgpr_write_b32 a51, v23
    v_accvgpr_read_b32 v23, a52
    v_mul_f32 v23, v23, v21
    v_accvgpr_write_b32 a52, v23
    v_accvgpr_read_b32 v23, a53
    v_mul_f32 v23, v23, v21
    v_accvgpr_write_b32 a53, v23
    v_accvgpr_read_b32 v23, a54
    v_mul_f32 v23, v23, v21
    v_accvgpr_write_b32 a54, v23
    v_accvgpr_read_b32 v23, a55
    v_mul_f32 v23, v23, v21
    v_accvgpr_write_b32 a55, v23
    v_accvgpr_read_b32 v23, a88
    v_mul_f32 v23, v23, v22
    v_accvgpr_write_b32 a88, v23
    v_accvgpr_read_b32 v23, a89
    v_mul_f32 v23, v23, v22
    v_accvgpr_write_b32 a89, v23
    v_accvgpr_read_b32 v23, a90
    v_mul_f32 v23, v23, v22
    v_accvgpr_write_b32 a90, v23
    v_accvgpr_read_b32 v23, a91
    v_mul_f32 v23, v23, v22
    v_accvgpr_write_b32 a91, v23
    v_accvgpr_read_b32 v23, a56
    v_mul_f32 v23, v23, v20
    v_accvgpr_write_b32 a56, v23
    v_accvgpr_read_b32 v23, a57
    v_mul_f32 v23, v23, v20
    v_accvgpr_write_b32 a57, v23
    v_accvgpr_read_b32 v23, a58
    v_mul_f32 v23, v23, v20
    v_accvgpr_write_b32 a58, v23
    v_accvgpr_read_b32 v23, a59
    v_mul_f32 v23, v23, v20
    v_accvgpr_write_b32 a59, v23
    v_accvgpr_read_b32 v23, a60
    v_mul_f32 v23, v23, v21
    v_accvgpr_write_b32 a60, v23
    v_accvgpr_read_b32 v23, a61
    v_mul_f32 v23, v23, v21
    v_accvgpr_write_b32 a61, v23
    v_accvgpr_read_b32 v23, a62
    v_mul_f32 v23, v23, v21
    v_accvgpr_write_b32 a62, v23
    v_accvgpr_read_b32 v23, a63
    v_mul_f32 v23, v23, v21
    v_accvgpr_write_b32 a63, v23
    v_accvgpr_read_b32 v23, a92
    v_mul_f32 v23, v23, v22
    v_accvgpr_write_b32 a92, v23
    v_accvgpr_read_b32 v23, a93
    v_mul_f32 v23, v23, v22
    v_accvgpr_write_b32 a93, v23
    v_accvgpr_read_b32 v23, a94
    v_mul_f32 v23, v23, v22
    v_accvgpr_write_b32 a94, v23
    v_accvgpr_read_b32 v23, a95
    v_mul_f32 v23, v23, v22
    v_accvgpr_write_b32 a95, v23
    v_accvgpr_read_b32 v23, a96
    v_mul_f32 v23, v23, v20
    v_accvgpr_write_b32 a96, v23
    v_accvgpr_read_b32 v23, a97
    v_mul_f32 v23, v23, v20
    v_accvgpr_write_b32 a97, v23
    v_accvgpr_read_b32 v23, a98
    v_mul_f32 v23, v23, v20
    v_accvgpr_write_b32 a98, v23
    v_accvgpr_read_b32 v23, a99
    v_mul_f32 v23, v23, v20
    v_accvgpr_write_b32 a99, v23
    v_accvgpr_read_b32 v23, a100
    v_mul_f32 v23, v23, v21
    v_accvgpr_write_b32 a100, v23
    v_accvgpr_read_b32 v23, a101
    v_mul_f32 v23, v23, v21
    v_accvgpr_write_b32 a101, v23
    v_accvgpr_read_b32 v23, a102
    v_mul_f32 v23, v23, v21
    v_accvgpr_write_b32 a102, v23
    v_accvgpr_read_b32 v23, a103
    v_mul_f32 v23, v23, v21
    v_accvgpr_write_b32 a103, v23
    v_accvgpr_read_b32 v23, a104
    v_mul_f32 v23, v23, v22
    v_accvgpr_write_b32 a104, v23
    v_accvgpr_read_b32 v23, a105
    v_mul_f32 v23, v23, v22
    v_accvgpr_write_b32 a105, v23
    v_accvgpr_read_b32 v23, a106
    v_mul_f32 v23, v23, v22
    v_accvgpr_write_b32 a106, v23
    v_accvgpr_read_b32 v23, a107
    v_mul_f32 v23, v23, v22
    v_accvgpr_write_b32 a107, v23
    s_cmp_eq_u32 s53, 1
    s_cbranch_scc1 L_w2_retB
    v_exp_f32 v36, v36
    v_exp_f32 v37, v37
    v_exp_f32 v38, v38
    v_exp_f32 v39, v39
    v_cvt_pk_bf16_f32 v36, v36, v37
    v_cvt_pk_bf16_f32 v37, v38, v39
    v_exp_f32 v44, v44
    v_exp_f32 v45, v45
    v_exp_f32 v46, v46
    v_exp_f32 v47, v47
    v_cvt_pk_bf16_f32 v44, v44, v45
    v_cvt_pk_bf16_f32 v45, v46, v47
    v_exp_f32 v40, v40
    v_exp_f32 v41, v41
    v_exp_f32 v42, v42
    v_exp_f32 v43, v43
    v_cvt_pk_bf16_f32 v38, v40, v41
    v_cvt_pk_bf16_f32 v39, v42, v43
    v_exp_f32 v48, v48
    v_exp_f32 v49, v49
    v_exp_f32 v50, v50
    v_exp_f32 v51, v51
    v_cvt_pk_bf16_f32 v46, v48, v49
    v_cvt_pk_bf16_f32 v47, v50, v51
    s_branch L_w2_Aafter
L_w2_retB:
    v_exp_f32 v52, v52
    v_exp_f32 v53, v53
    v_exp_f32 v54, v54
    v_exp_f32 v55, v55
    v_cvt_pk_bf16_f32 v52, v52, v53
    v_cvt_pk_bf16_f32 v53, v54, v55
    v_exp_f32 v60, v60
    v_exp_f32 v61, v61
    v_exp_f32 v62, v62
    v_exp_f32 v63, v63
    v_cvt_pk_bf16_f32 v60, v60, v61
    v_cvt_pk_bf16_f32 v61, v62, v63
    v_exp_f32 v68, v68
    v_exp_f32 v69, v69
    v_exp_f32 v70, v70
    v_exp_f32 v71, v71
    v_cvt_pk_bf16_f32 v68, v68, v69
    v_cvt_pk_bf16_f32 v69, v70, v71
    v_exp_f32 v56, v56
    v_exp_f32 v57, v57
    v_exp_f32 v58, v58
    v_exp_f32 v59, v59
    v_cvt_pk_bf16_f32 v54, v56, v57
    v_cvt_pk_bf16_f32 v55, v58, v59
    v_exp_f32 v64, v64
    v_exp_f32 v65, v65
    v_exp_f32 v66, v66
    v_exp_f32 v67, v67
    v_cvt_pk_bf16_f32 v62, v64, v65
    v_cvt_pk_bf16_f32 v63, v66, v67
    s_branch L_w2_Bafter
L_w2_done:
    s_add_u32 s8, s32, 524288
    s_addc_u32 s9, s33, 0
    s_mov_b32 s10, 131072
    s_mov_b32 s11, 0x20000
    s_add_u32 s12, s36, 524288
    s_addc_u32 s13, s37, 0
    s_mov_b32 s14, 131072
    s_mov_b32 s15, 0x20000
    s_nop 7
    v_lshlrev_b32 v0, 4, v1
    v_accvgpr_read_b32 v22, a104
    v_lshlrev_b32 v12, 2, v1
    v_add_u32 v12, 131072, v12
    ds_write_b32 v12, v32 offset:512
    ds_write_b32 v12, v22 offset:1536
    v_accvgpr_read_b32 v20, a96
    v_accvgpr_read_b32 v21, a100
    v_rcp_f32 v20, v20
    v_rcp_f32 v21, v21
    v_accvgpr_read_b32 v72, a0
    v_accvgpr_read_b32 v76, a8
    v_accvgpr_read_b32 v73, a1
    v_accvgpr_read_b32 v77, a9
    v_accvgpr_read_b32 v74, a2
    v_accvgpr_read_b32 v78, a10
    v_accvgpr_read_b32 v75, a3
    v_accvgpr_read_b32 v79, a11
    v_mul_f32 v72, v72, v20
    v_mul_f32 v73, v73, v20
    v_mul_f32 v74, v74, v20
    v_mul_f32 v75, v75, v20
    v_mul_f32 v76, v76, v20
    v_mul_f32 v77, v77, v20
    v_mul_f32 v78, v78, v20
    v_mul_f32 v79, v79, v20
    v_cvt_pk_bf16_f32 v72, v72, v73
    v_cvt_pk_bf16_f32 v73, v74, v75
    v_cvt_pk_bf16_f32 v74, v76, v77
    v_cvt_pk_bf16_f32 v75, v78, v79
    s_mov_b32 s48, 18432
    buffer_store_dwordx4 v[72:75], v0, s[40:43], s48 offen sc1
    v_accvgpr_read_b32 v80, a16
    v_accvgpr_read_b32 v84, a24
    v_accvgpr_read_b32 v81, a17
    v_accvgpr_read_b32 v85, a25
    v_accvgpr_read_b32 v82, a18
    v_accvgpr_read_b32 v86, a26
    v_accvgpr_read_b32 v83, a19
    v_accvgpr_read_b32 v87, a27
    v_mul_f32 v80, v80, v20
    v_mul_f32 v81, v81, v20
    v_mul_f32 v82, v82, v20
    v_mul_f32 v83, v83, v20
    v_mul_f32 v84, v84, v20
    v_mul_f32 v85, v85, v20
    v_mul_f32 v86, v86, v20
    v_mul_f32 v87, v87, v20
    v_cvt_pk_bf16_f32 v80, v80, v81
    v_cvt_pk_bf16_f32 v81, v82, v83
    v_cvt_pk_bf16_f32 v82, v84, v85
    v_cvt_pk_bf16_f32 v83, v86, v87
    s_mov_b32 s48, 19456
    buffer_store_dwordx4 v[80:83], v0, s[40:43], s48 offen sc1
    v_accvgpr_read_b32 v88, a32
    v_accvgpr_read_b32 v92, a40
    v_accvgpr_read_b32 v89, a33
    v_accvgpr_read_b32 v93, a41
    v_accvgpr_read_b32 v90, a34
    v_accvgpr_read_b32 v94, a42
    v_accvgpr_read_b32 v91, a35
    v_accvgpr_read_b32 v95, a43
    v_mul_f32 v88, v88, v20
    v_mul_f32 v89, v89, v20
    v_mul_f32 v90, v90, v20
    v_mul_f32 v91, v91, v20
    v_mul_f32 v92, v92, v20
    v_mul_f32 v93, v93, v20
    v_mul_f32 v94, v94, v20
    v_mul_f32 v95, v95, v20
    v_cvt_pk_bf16_f32 v88, v88, v89
    v_cvt_pk_bf16_f32 v89, v90, v91
    v_cvt_pk_bf16_f32 v90, v92, v93
    v_cvt_pk_bf16_f32 v91, v94, v95
    s_mov_b32 s48, 16384
    buffer_store_dwordx4 v[88:91], v0, s[40:43], s48 offen sc1
    v_accvgpr_read_b32 v72, a48
    v_accvgpr_read_b32 v76, a56
    v_accvgpr_read_b32 v73, a49
    v_accvgpr_read_b32 v77, a57
    v_accvgpr_read_b32 v74, a50
    v_accvgpr_read_b32 v78, a58
    v_accvgpr_read_b32 v75, a51
    v_accvgpr_read_b32 v79, a59
    v_mul_f32 v72, v72, v20
    v_mul_f32 v73, v73, v20
    v_mul_f32 v74, v74, v20
    v_mul_f32 v75, v75, v20
    v_mul_f32 v76, v76, v20
    v_mul_f32 v77, v77, v20
    v_mul_f32 v78, v78, v20
    v_mul_f32 v79, v79, v20
    v_cvt_pk_bf16_f32 v72, v72, v73
    v_cvt_pk_bf16_f32 v73, v74, v75
    v_cvt_pk_bf16_f32 v74, v76, v77
    v_cvt_pk_bf16_f32 v75, v78, v79
    s_mov_b32 s48, 17408
    buffer_store_dwordx4 v[72:75], v0, s[40:43], s48 offen sc1
    v_accvgpr_read_b32 v80, a4
    v_accvgpr_read_b32 v84, a12
    v_accvgpr_read_b32 v81, a5
    v_accvgpr_read_b32 v85, a13
    v_accvgpr_read_b32 v82, a6
    v_accvgpr_read_b32 v86, a14
    v_accvgpr_read_b32 v83, a7
    v_accvgpr_read_b32 v87, a15
    v_mul_f32 v80, v80, v21
    v_mul_f32 v81, v81, v21
    v_mul_f32 v82, v82, v21
    v_mul_f32 v83, v83, v21
    v_mul_f32 v84, v84, v21
    v_mul_f32 v85, v85, v21
    v_mul_f32 v86, v86, v21
    v_mul_f32 v87, v87, v21
    v_cvt_pk_bf16_f32 v80, v80, v81
    v_cvt_pk_bf16_f32 v81, v82, v83
    v_cvt_pk_bf16_f32 v82, v84, v85
    v_cvt_pk_bf16_f32 v83, v86, v87
    s_mov_b32 s48, 22528
    buffer_store_dwordx4 v[80:83], v0, s[40:43], s48 offen sc1
    v_accvgpr_read_b32 v88, a20
    v_accvgpr_read_b32 v92, a28
    v_accvgpr_read_b32 v89, a21
    v_accvgpr_read_b32 v93, a29
    v_accvgpr_read_b32 v90, a22
    v_accvgpr_read_b32 v94, a30
    v_accvgpr_read_b32 v91, a23
    v_accvgpr_read_b32 v95, a31
    v_mul_f32 v88, v88, v21
    v_mul_f32 v89, v89, v21
    v_mul_f32 v90, v90, v21
    v_mul_f32 v91, v91, v21
    v_mul_f32 v92, v92, v21
    v_mul_f32 v93, v93, v21
    v_mul_f32 v94, v94, v21
    v_mul_f32 v95, v95, v21
    v_cvt_pk_bf16_f32 v88, v88, v89
    v_cvt_pk_bf16_f32 v89, v90, v91
    v_cvt_pk_bf16_f32 v90, v92, v93
    v_cvt_pk_bf16_f32 v91, v94, v95
    s_mov_b32 s48, 23552
    buffer_store_dwordx4 v[88:91], v0, s[40:43], s48 offen sc1
    v_accvgpr_read_b32 v72, a36
    v_accvgpr_read_b32 v76, a44
    v_accvgpr_read_b32 v73, a37
    v_accvgpr_read_b32 v77, a45
    v_accvgpr_read_b32 v74, a38
    v_accvgpr_read_b32 v78, a46
    v_accvgpr_read_b32 v75, a39
    v_accvgpr_read_b32 v79, a47
    v_mul_f32 v72, v72, v21
    v_mul_f32 v73, v73, v21
    v_mul_f32 v74, v74, v21
    v_mul_f32 v75, v75, v21
    v_mul_f32 v76, v76, v21
    v_mul_f32 v77, v77, v21
    v_mul_f32 v78, v78, v21
    v_mul_f32 v79, v79, v21
    v_cvt_pk_bf16_f32 v72, v72, v73
    v_cvt_pk_bf16_f32 v73, v74, v75
    v_cvt_pk_bf16_f32 v74, v76, v77
    v_cvt_pk_bf16_f32 v75, v78, v79
    s_mov_b32 s48, 20480
    buffer_store_dwordx4 v[72:75], v0, s[40:43], s48 offen sc1
    v_accvgpr_read_b32 v80, a52
    v_accvgpr_read_b32 v84, a60
    v_accvgpr_read_b32 v81, a53
    v_accvgpr_read_b32 v85, a61
    v_accvgpr_read_b32 v82, a54
    v_accvgpr_read_b32 v86, a62
    v_accvgpr_read_b32 v83, a55
    v_accvgpr_read_b32 v87, a63
    v_mul_f32 v80, v80, v21
    v_mul_f32 v81, v81, v21
    v_mul_f32 v82, v82, v21
    v_mul_f32 v83, v83, v21
    v_mul_f32 v84, v84, v21
    v_mul_f32 v85, v85, v21
    v_mul_f32 v86, v86, v21
    v_mul_f32 v87, v87, v21
    v_cvt_pk_bf16_f32 v80, v80, v81
    v_cvt_pk_bf16_f32 v81, v82, v83
    v_cvt_pk_bf16_f32 v82, v84, v85
    v_cvt_pk_bf16_f32 v83, v86, v87
    s_mov_b32 s48, 21504
    buffer_store_dwordx4 v[80:83], v0, s[40:43], s48 offen sc1
    s_waitcnt lgkmcnt(0)
    s_barrier
    s_cmp_lg_u32 s6, 0
    s_cbranch_scc1 L_h0_2
    s_add_u32 m0, s57, 0
    s_add_u32 s48, s57, 65536
    buffer_load_dwordx4 v16, s[8:11], s48 offen offset:0 nt lds
    buffer_load_dwordx4 v17, s[8:11], s48 offen offset:1024 nt lds
    buffer_load_dwordx4 v16, s[8:11], s48 offen offset:2048 nt lds
    buffer_load_dwordx4 v17, s[8:11], s48 offen offset:3072 nt lds
    s_add_u32 m0, s57, 16384
    s_add_u32 s48, s57, 65536
    buffer_load_dwordx4 v16, s[12:15], s48 offen offset:0 nt lds
    buffer_load_dwordx4 v17, s[12:15], s48 offen offset:1024 nt lds
    buffer_load_dwordx4 v16, s[12:15], s48 offen offset:2048 nt lds
    buffer_load_dwordx4 v17, s[12:15], s48 offen offset:3072 nt lds
L_h0_2:
    ds_read_b32 v24, v12 offset:0
    ds_read_b32 v28, v12 offset:1024
    ds_read_b32 v25, v12 offset:256
    ds_read_b32 v29, v12 offset:1280
    ds_read_b32 v26, v12 offset:512
    ds_read_b32 v30, v12 offset:1536
    ds_read_b32 v27, v12 offset:768
    ds_read_b32 v31, v12 offset:1792
    s_waitcnt lgkmcnt(5)
    v_min_f32 v22, v24, v25
    s_waitcnt lgkmcnt(1)
    v_min3_f32 v22, v22, v26, v27
    v_sub_f32 v24, v22, v24
    v_sub_f32 v25, v22, v25
    v_sub_f32 v26, v22, v26
    v_sub_f32 v27, v22, v27
    v_exp_f32 v24, v24
    v_exp_f32 v25, v25
    v_exp_f32 v26, v26
    v_exp_f32 v27, v27
    s_nop 0
    v_mul_f32 v22, v24, v28
    v_fmac_f32 v22, v25, v29
    v_fmac_f32 v22, v26, v30
    s_waitcnt lgkmcnt(0)
    v_fmac_f32 v22, v27, v31
    v_rcp_f32 v22, v22
    s_nop 0
    v_mul_f32 v22, v22, v26
    v_add_u32 v12, 133120, v0
    v_accvgpr_read_b32 v44, a72
    v_accvgpr_read_b32 v45, a73
    v_accvgpr_read_b32 v46, a74
    v_accvgpr_read_b32 v47, a75
    v_mul_f32 v44, v44, v22
    v_mul_f32 v45, v45, v22
    v_mul_f32 v46, v46, v22
    v_mul_f32 v47, v47, v22
    ds_write_b128 v12, v[44:47] offset:22528
    v_accvgpr_read_b32 v48, a76
    v_accvgpr_read_b32 v49, a77
    v_accvgpr_read_b32 v50, a78
    v_accvgpr_read_b32 v51, a79
    v_mul_f32 v48, v48, v22
    v_mul_f32 v49, v49, v22
    v_mul_f32 v50, v50, v22
    v_mul_f32 v51, v51, v22
    ds_write_b128 v12, v[48:51] offset:23552
    v_accvgpr_read_b32 v36, a80
    v_accvgpr_read_b32 v37, a81
    v_accvgpr_read_b32 v38, a82
    v_accvgpr_read_b32 v39, a83
    v_mul_f32 v36, v36, v22
    v_mul_f32 v37, v37, v22
    v_mul_f32 v38, v38, v22
    v_mul_f32 v39, v39, v22
    ds_write_b128 v12, v[36:39] offset:2048
    v_accvgpr_read_b32 v40, a84
    v_accvgpr_read_b32 v41, a85
    v_accvgpr_read_b32 v42, a86
    v_accvgpr_read_b32 v43, a87
    v_mul_f32 v40, v40, v22
    v_mul_f32 v41, v41, v22
    v_mul_f32 v42, v42, v22
    v_mul_f32 v43, v43, v22
    ds_write_b128 v12, v[40:43] offset:3072
    v_accvgpr_read_b32 v44, a88
    v_accvgpr_read_b32 v45, a89
    v_accvgpr_read_b32 v46, a90
    v_accvgpr_read_b32 v47, a91
    v_mul_f32 v44, v44, v22
    v_mul_f32 v45, v45, v22
    v_mul_f32 v46, v46, v22
    v_mul_f32 v47, v47, v22
    ds_write_b128 v12, v[44:47] offset:6144
    v_accvgpr_read_b32 v48, a92
    v_accvgpr_read_b32 v49, a93
    v_accvgpr_read_b32 v50, a94
    v_accvgpr_read_b32 v51, a95
    v_mul_f32 v48, v48, v22
    v_mul_f32 v49, v49, v22
    v_mul_f32 v50, v50, v22
    v_mul_f32 v51, v51, v22
    ds_write_b128 v12, v[48:51] offset:7168
    v_accvgpr_read_b32 v24, a64
    v_accvgpr_read_b32 v25, a65
    v_accvgpr_read_b32 v26, a66
    v_accvgpr_read_b32 v27, a67
    v_mul_f32 v24, v24, v22
    v_mul_f32 v25, v25, v22
    v_mul_f32 v26, v26, v22
    v_mul_f32 v27, v27, v22
    v_accvgpr_read_b32 v28, a68
    v_accvgpr_read_b32 v29, a69
    v_accvgpr_read_b32 v30, a70
    v_accvgpr_read_b32 v31, a71
    v_mul_f32 v28, v28, v22
    v_mul_f32 v29, v29, v22
    v_mul_f32 v30, v30, v22
    v_mul_f32 v31, v31, v22
    s_waitcnt lgkmcnt(0)
    s_barrier
    ds_read_b128 v[36:39], v12 offset:12288
    ds_read_b128 v[40:43], v12 offset:13312
    ds_read_b128 v[44:47], v12 offset:14336
    ds_read_b128 v[48:51], v12 offset:15360
    ds_read_b128 v[52:55], v12 offset:16384
    ds_read_b128 v[56:59], v12 offset:17408
    s_waitcnt lgkmcnt(3)
    v_add_f32 v36, v36, v44
    s_waitcnt lgkmcnt(1)
    v_add_f32 v24, v24, v52
    v_add_f32 v36, v36, v24
    v_add_f32 v37, v37, v45
    v_add_f32 v25, v25, v53
    v_add_f32 v37, v37, v25
    v_add_f32 v38, v38, v46
    v_add_f32 v26, v26, v54
    v_add_f32 v38, v38, v26
    v_add_f32 v39, v39, v47
    v_add_f32 v27, v27, v55
    v_add_f32 v39, v39, v27
    v_add_f32 v40, v40, v48
    s_waitcnt lgkmcnt(0)
    v_add_f32 v28, v28, v56
    v_add_f32 v40, v40, v28
    v_add_f32 v41, v41, v49
    v_add_f32 v29, v29, v57
    v_add_f32 v41, v41, v29
    v_add_f32 v42, v42, v50
    v_add_f32 v30, v30, v58
    v_add_f32 v42, v42, v30
    v_add_f32 v43, v43, v51
    v_add_f32 v31, v31, v59
    v_add_f32 v43, v43, v31
    v_cvt_pk_bf16_f32 v36, v36, v37
    v_cvt_pk_bf16_f32 v37, v38, v39
    v_cvt_pk_bf16_f32 v38, v40, v41
    v_cvt_pk_bf16_f32 v39, v42, v43
    s_mov_b32 s48, 34816
    buffer_store_dwordx4 v[36:39], v0, s[40:43], s48 offen sc1
    s_cmp_lg_u32 s6, 0
    s_cbranch_scc1 L_h1_2
    s_add_u32 m0, s57, 32768
    s_add_u32 s48, s57, 81920
    buffer_load_dwordx4 v16, s[8:11], s48 offen offset:0 nt lds
    buffer_load_dwordx4 v17, s[8:11], s48 offen offset:1024 nt lds
    buffer_load_dwordx4 v16, s[8:11], s48 offen offset:2048 nt lds
    buffer_load_dwordx4 v17, s[8:11], s48 offen offset:3072 nt lds
    s_add_u32 m0, s57, 49152
    s_add_u32 s48, s57, 81920
    buffer_load_dwordx4 v16, s[12:15], s48 offen offset:0 nt lds
    buffer_load_dwordx4 v17, s[12:15], s48 offen offset:1024 nt lds
    buffer_load_dwordx4 v16, s[12:15], s48 offen offset:2048 nt lds
    buffer_load_dwordx4 v17, s[12:15], s48 offen offset:3072 nt lds
L_h1_2:
    s_cmp_lg_u32 s6, 0
    s_cbranch_scc1 L_e3a_2
    s_waitcnt vmcnt(8)
    s_branch L_e3b_2
L_e3a_2:
    s_waitcnt vmcnt(0)
L_e3b_2:
    s_barrier
    s_branch L_fin
L_wave3:
    s_branch L_w3_first
L_w3_fake:
    ds_read_b128 v[72:75], v12 offset:0
    ds_read_b128 v[76:79], v13 offset:0
    ds_read_b128 v[80:83], v14 offset:0
    ds_read_b128 v[84:87], v15 offset:0
L_w3_loop:
    s_waitcnt lgkmcnt(3)
    v_mfma_f32_16x16x32_bf16 v[36:39], v[72:75], a[116:119], v[24:27]
    ds_read_b128 v[88:91], v12 offset:4096
    v_mfma_f32_16x16x32_bf16 v[44:47], v[72:75], a[132:135], v[28:31]
    s_waitcnt lgkmcnt(3)
    v_mfma_f32_16x16x32_bf16 v[36:39], v[76:79], a[120:123], v[36:39]
    ds_read_b128 v[92:95], v13 offset:4096
    v_mfma_f32_16x16x32_bf16 v[44:47], v[76:79], a[136:139], v[44:47]
    s_waitcnt lgkmcnt(3)
    v_mfma_f32_16x16x32_bf16 v[36:39], v[80:83], a[124:127], v[36:39]
    ds_read_b128 v[72:75], v14 offset:4096
    v_mfma_f32_16x16x32_bf16 v[44:47], v[80:83], a[140:143], v[44:47]
    s_waitcnt lgkmcnt(3)
    v_mfma_f32_16x16x32_bf16 v[36:39], v[84:87], a[112:115], v[36:39]
    ds_read_b128 v[76:79], v15 offset:4096
    v_mfma_f32_16x16x32_bf16 v[44:47], v[84:87], a[128:131], v[44:47]
    s_waitcnt lgkmcnt(3)
    v_mfma_f32_16x16x32_bf16 v[40:43], v[88:91], a[116:119], v[24:27]
    ds_read_b128 v[80:83], v12 offset:8192
    v_mfma_f32_16x16x32_bf16 v[48:51], v[88:91], a[132:135], v[28:31]
    s_waitcnt lgkmcnt(3)
    v_mfma_f32_16x16x32_bf16 v[40:43], v[92:95], a[120:123], v[40:43]
    ds_read_b128 v[84:87], v13 offset:8192
    v_exp_f32 v36, v36
    v_mfma_f32_16x16x32_bf16 v[48:51], v[92:95], a[136:139], v[48:51]
    v_exp_f32 v37, v37
    s_waitcnt lgkmcnt(3)
    v_mfma_f32_16x16x32_bf16 v[40:43], v[72:75], a[124:127], v[40:43]
    ds_read_b128 v[88:91], v14 offset:8192
    v_exp_f32 v38, v38
    v_mfma_f32_16x16x32_bf16 v[48:51], v[72:75], a[140:143], v[48:51]
    v_exp_f32 v39, v39
    v_cvt_pk_bf16_f32 v36, v36, v37
    s_waitcnt lgkmcnt(3)
    v_mfma_f32_16x16x32_bf16 v[40:43], v[76:79], a[112:115], v[40:43]
    ds_read_b128 v[92:95], v15 offset:8192
    v_cvt_pk_bf16_f32 v37, v38, v39
    v_or_b32 v20, v36, v37
    v_mfma_f32_16x16x32_bf16 v[48:51], v[76:79], a[128:131], v[48:51]
    v_exp_f32 v44, v44
    s_waitcnt lgkmcnt(3)
    v_mfma_f32_16x16x32_bf16 v[52:55], v[80:83], a[116:119], v[24:27]
    ds_read_b128 v[72:75], v12 offset:12288
    v_mfma_f32_16x16x32_bf16 v[60:63], v[80:83], a[132:135], v[28:31]
    v_exp_f32 v45, v45
    s_waitcnt lgkmcnt(3)
    v_mfma_f32_16x16x32_bf16 v[52:55], v[84:87], a[120:123], v[52:55]
    ds_read_b128 v[76:79], v13 offset:12288
    v_exp_f32 v46, v46
    v_mfma_f32_16x16x32_bf16 v[60:63], v[84:87], a[136:139], v[60:63]
    v_exp_f32 v47, v47
    v_cvt_pk_bf16_f32 v44, v44, v45
    v_cvt_pk_bf16_f32 v45, v46, v47
    s_waitcnt lgkmcnt(3)
    v_mfma_f32_16x16x32_bf16 v[52:55], v[88:91], a[124:127], v[52:55]
    ds_read_b128 v[80:83], v14 offset:12288
    v_or3_b32 v20, v44, v45, v20
    v_mfma_f32_16x16x32_bf16 v[60:63], v[88:91], a[140:143], v[60:63]
    v_exp_f32 v40, v40
    s_waitcnt lgkmcnt(3)
    v_mfma_f32_16x16x32_bf16 v[52:55], v[92:95], a[112:115], v[52:55]
    ds_read_b128 v[84:87], v15 offset:12288
    v_exp_f32 v41, v41
    v_mfma_f32_16x16x32_bf16 v[60:63], v[92:95], a[128:131], v[60:63]
    v_exp_f32 v42, v42
    s_waitcnt lgkmcnt(3)
    v_mfma_f32_16x16x32_bf16 v[56:59], v[72:75], a[116:119], v[24:27]
    ds_read_b64_tr_b16 v[88:89], v4 offset:0
    ds_read_b64_tr_b16 v[90:91], v4 offset:4096
    v_mfma_f32_16x16x32_bf16 v[64:67], v[72:75], a[132:135], v[28:31]
    v_exp_f32 v43, v43
    v_cvt_pk_bf16_f32 v38, v40, v41
    v_mfma_f32_16x16x32_bf16 v[68:71], v[72:75], a[144:147], v[32:35]
    v_cvt_pk_bf16_f32 v39, v42, v43
    v_or3_b32 v20, v38, v39, v20
    s_waitcnt lgkmcnt(4)
    v_mfma_f32_16x16x32_bf16 v[56:59], v[76:79], a[120:123], v[56:59]
    ds_read_b64_tr_b16 v[72:73], v5 offset:0
    ds_read_b64_tr_b16 v[74:75], v5 offset:4096
    v_mfma_f32_16x16x32_bf16 v[64:67], v[76:79], a[136:139], v[64:67]
    v_exp_f32 v48, v48
    v_mfma_f32_16x16x32_bf16 v[68:71], v[76:79], a[148:151], v[68:71]
    v_exp_f32 v49, v49
    s_waitcnt lgkmcnt(5)
    v_mfma_f32_16x16x32_bf16 v[56:59], v[80:83], a[124:127], v[56:59]
    ds_read_b64_tr_b16 v[76:77], v6 offset:0
    ds_read_b64_tr_b16 v[78:79], v6 offset:4096
    v_mfma_f32_16x16x32_bf16 v[64:67], v[80:83], a[140:143], v[64:67]
    v_exp_f32 v50, v50
    v_mfma_f32_16x16x32_bf16 v[68:71], v[80:83], a[152:155], v[68:71]
    v_exp_f32 v51, v51
    s_waitcnt lgkmcnt(6)
    v_mfma_f32_16x16x32_bf16 v[56:59], v[84:87], a[112:115], v[56:59]
    ds_read_b64_tr_b16 v[80:81], v7 offset:0
    ds_read_b64_tr_b16 v[82:83], v7 offset:4096
    v_cvt_pk_bf16_f32 v46, v48, v49
    v_mfma_f32_16x16x32_bf16 v[64:67], v[84:87], a[128:131], v[64:67]
    v_cvt_pk_bf16_f32 v47, v50, v51
    v_or3_b32 v20, v46, v47, v20
    v_mfma_f32_16x16x32_bf16 v[68:71], v[84:87], a[156:159], v[68:71]
    v_and_b32 v20, s52, v20
    v_cmp_ne_u32 vcc, 0, v20
    s_cbranch_vccnz L_w3_rareA
L_w3_Aafter:
    v_mfma_f32_16x16x32_bf16 a[96:99], a[108:111], v[36:39], a[96:99]
    v_mfma_f32_16x16x32_bf16 a[100:103], a[108:111], v[44:47], a[100:103]
    s_waitcnt lgkmcnt(6)
    v_mfma_f32_16x16x32_bf16 a[0:3], v[88:91], v[36:39], a[0:3]
    ds_read_b64_tr_b16 v[84:85], v8 offset:0
    ds_read_b64_tr_b16 v[86:87], v8 offset:4096
    v_mfma_f32_16x16x32_bf16 a[4:7], v[88:91], v[44:47], a[4:7]
    v_exp_f32 v52, v52
    s_waitcnt lgkmcnt(6)
    v_mfma_f32_16x16x32_bf16 a[8:11], v[72:75], v[36:39], a[8:11]
    ds_read_b64_tr_b16 v[88:89], v9 offset:0
    ds_read_b64_tr_b16 v[90:91], v9 offset:4096
    v_exp_f32 v53, v53
    v_mfma_f32_16x16x32_bf16 a[12:15], v[72:75], v[44:47], a[12:15]
    v_exp_f32 v54, v54
    v_exp_f32 v55, v55
    s_waitcnt lgkmcnt(6)
    v_mfma_f32_16x16x32_bf16 a[16:19], v[76:79], v[36:39], a[16:19]
    ds_read_b64_tr_b16 v[72:73], v10 offset:0
    ds_read_b64_tr_b16 v[74:75], v10 offset:4096
    v_cvt_pk_bf16_f32 v52, v52, v53
    v_cvt_pk_bf16_f32 v53, v54, v55
    v_mfma_f32_16x16x32_bf16 a[20:23], v[76:79], v[44:47], a[20:23]
    v_or_b32 v21, v52, v53
    v_exp_f32 v60, v60
    s_waitcnt lgkmcnt(6)
    v_mfma_f32_16x16x32_bf16 a[24:27], v[80:83], v[36:39], a[24:27]
    ds_read_b64_tr_b16 v[76:77], v11 offset:0
    ds_read_b64_tr_b16 v[78:79], v11 offset:4096
    s_add_u32 s48, s45, 32768
    s_cmp_eq_u32 s48, 131072
    s_cselect_b32 s48, 0, s48
    s_sub_u32 s58, s48, s45
    v_mfma_f32_16x16x32_bf16 a[28:31], v[80:83], v[44:47], a[28:31]
    v_exp_f32 v61, v61
    v_exp_f32 v62, v62
    s_waitcnt lgkmcnt(6)
    v_mfma_f32_16x16x32_bf16 a[32:35], v[84:87], v[36:39], a[32:35]
    ds_read_b64_tr_b16 v[80:81], v4 offset:8192
    ds_read_b64_tr_b16 v[82:83], v4 offset:12288
    v_exp_f32 v63, v63
    v_mfma_f32_16x16x32_bf16 a[36:39], v[84:87], v[44:47], a[36:39]
    v_cvt_pk_bf16_f32 v60, v60, v61
    v_cvt_pk_bf16_f32 v61, v62, v63
    v_or3_b32 v21, v60, v61, v21
    s_waitcnt lgkmcnt(6)
    v_mfma_f32_16x16x32_bf16 a[40:43], v[88:91], v[36:39], a[40:43]
    ds_read_b64_tr_b16 v[84:85], v5 offset:8192
    ds_read_b64_tr_b16 v[86:87], v5 offset:12288
    v_exp_f32 v56, v56
    v_mfma_f32_16x16x32_bf16 a[44:47], v[88:91], v[44:47], a[44:47]
    v_exp_f32 v57, v57
    v_exp_f32 v58, v58
    s_waitcnt lgkmcnt(6)
    v_mfma_f32_16x16x32_bf16 a[48:51], v[72:75], v[36:39], a[48:51]
    ds_read_b64_tr_b16 v[88:89], v6 offset:8192
    ds_read_b64_tr_b16 v[90:91], v6 offset:12288
    v_exp_f32 v59, v59
    v_mfma_f32_16x16x32_bf16 a[52:55], v[72:75], v[44:47], a[52:55]
    v_cvt_pk_bf16_f32 v54, v56, v57
    v_cvt_pk_bf16_f32 v55, v58, v59
    v_or3_b32 v21, v54, v55, v21
    s_waitcnt lgkmcnt(6)
    v_mfma_f32_16x16x32_bf16 a[56:59], v[76:79], v[36:39], a[56:59]
    ds_read_b64_tr_b16 v[72:73], v7 offset:8192
    ds_read_b64_tr_b16 v[74:75], v7 offset:12288
    v_exp_f32 v64, v64
    v_mfma_f32_16x16x32_bf16 a[60:63], v[76:79], v[44:47], a[60:63]
    v_exp_f32 v65, v65
    v_exp_f32 v66, v66
    v_exp_f32 v67, v67
    v_cvt_pk_bf16_f32 v62, v64, v65
    v_cvt_pk_bf16_f32 v63, v66, v67
    v_or3_b32 v21, v62, v63, v21
    v_exp_f32 v68, v68
    v_exp_f32 v69, v69
    v_exp_f32 v70, v70
    v_exp_f32 v71, v71
    v_cvt_pk_bf16_f32 v68, v68, v69
    v_cvt_pk_bf16_f32 v69, v70, v71
    v_or3_b32 v21, v68, v69, v21
    v_and_b32 v21, s52, v21
    v_cmp_ne_u32 vcc, 0, v21
    s_cbranch_vccnz L_w3_rareB
L_w3_Bafter:
    v_mfma_f32_16x16x32_bf16 a[96:99], a[108:111], v[52:55], a[96:99]
    v_mfma_f32_16x16x32_bf16 a[100:103], a[108:111], v[60:63], a[100:103]
    v_mfma_f32_16x16x16_bf16 a[104:107], a[108:109], v[68:69], a[104:107]
    s_waitcnt lgkmcnt(6)
    v_mfma_f32_16x16x32_bf16 a[0:3], v[80:83], v[52:55], a[0:3]
    ds_read_b64_tr_b16 v[76:77], v8 offset:8192
    ds_read_b64_tr_b16 v[78:79], v8 offset:12288
    v_mfma_f32_16x16x32_bf16 a[4:7], v[80:83], v[60:63], a[4:7]
    v_mfma_f32_16x16x16_bf16 a[64:67], v[82:83], v[68:69], a[64:67]
    s_waitcnt lgkmcnt(6)
    v_mfma_f32_16x16x32_bf16 a[8:11], v[84:87], v[52:55], a[8:11]
    ds_read_b64_tr_b16 v[80:81], v9 offset:8192
    ds_read_b64_tr_b16 v[82:83], v9 offset:12288
    v_mfma_f32_16x16x32_bf16 a[12:15], v[84:87], v[60:63], a[12:15]
    v_mfma_f32_16x16x16_bf16 a[68:71], v[86:87], v[68:69], a[68:71]
    s_waitcnt lgkmcnt(6)
    v_mfma_f32_16x16x32_bf16 a[16:19], v[88:91], v[52:55], a[16:19]
    ds_read_b64_tr_b16 v[84:85], v10 offset:8192
    ds_read_b64_tr_b16 v[86:87], v10 offset:12288
    v_mfma_f32_16x16x32_bf16 a[20:23], v[88:91], v[60:63], a[20:23]
    v_add_u32 v12, s58, v12
    v_add_u32 v13, s58, v13
    v_add_u32 v14, s58, v14
    v_add_u32 v15, s58, v15
    v_mfma_f32_16x16x16_bf16 a[72:75], v[90:91], v[68:69], a[72:75]
    s_waitcnt lgkmcnt(6)
    v_mfma_f32_16x16x32_bf16 a[24:27], v[72:75], v[52:55], a[24:27]
    ds_read_b64_tr_b16 v[88:89], v11 offset:8192
    ds_read_b64_tr_b16 v[90:91], v11 offset:12288
    v_mfma_f32_16x16x32_bf16 a[28:31], v[72:75], v[60:63], a[28:31]
    v_mfma_f32_16x16x16_bf16 a[76:79], v[74:75], v[68:69], a[76:79]
    s_cmp_eq_u32 s68, 0
    s_cbranch_scc1 L_w3_v0
    s_cmp_eq_u32 s68, 1
    s_cmp_eq_u32 s68, 1
    s_cbranch_scc1 L_w3_v8
    s_waitcnt vmcnt(16) lgkmcnt(0)
    s_mov_b32 s68, 1
    s_branch L_w3_v9
L_w3_v8:
    s_waitcnt vmcnt(8) lgkmcnt(0)
    s_mov_b32 s68, 0
    s_branch L_w3_v9
L_w3_v0:
    s_waitcnt vmcnt(0) lgkmcnt(0)
L_w3_v9:
    s_barrier
    v_mfma_f32_16x16x32_bf16 a[32:35], v[76:79], v[52:55], a[32:35]
    ds_read_b128 v[72:75], v12 offset:0
    v_mfma_f32_16x16x32_bf16 a[36:39], v[76:79], v[60:63], a[36:39]
    v_mfma_f32_16x16x16_bf16 a[80:83], v[78:79], v[68:69], a[80:83]
    v_add_u32 v4, s58, v4
    v_add_u32 v5, s58, v5
    v_add_u32 v6, s58, v6
    v_add_u32 v7, s58, v7
    v_mfma_f32_16x16x32_bf16 a[40:43], v[80:83], v[52:55], a[40:43]
    ds_read_b128 v[76:79], v13 offset:0
    v_mfma_f32_16x16x32_bf16 a[44:47], v[80:83], v[60:63], a[44:47]
    v_mfma_f32_16x16x16_bf16 a[84:87], v[82:83], v[68:69], a[84:87]
    v_add_u32 v8, s58, v8
    v_add_u32 v9, s58, v9
    v_add_u32 v10, s58, v10
    v_add_u32 v11, s58, v11
    v_mfma_f32_16x16x32_bf16 a[48:51], v[84:87], v[52:55], a[48:51]
    ds_read_b128 v[80:83], v14 offset:0
    v_mfma_f32_16x16x32_bf16 a[52:55], v[84:87], v[60:63], a[52:55]
    v_mfma_f32_16x16x16_bf16 a[88:91], v[86:87], v[68:69], a[88:91]
    v_mfma_f32_16x16x32_bf16 a[56:59], v[88:91], v[52:55], a[56:59]
    ds_read_b128 v[84:87], v15 offset:0
    v_mfma_f32_16x16x32_bf16 a[60:63], v[88:91], v[60:63], a[60:63]
    v_mfma_f32_16x16x16_bf16 a[92:95], v[90:91], v[68:69], a[92:95]
    s_add_u32 s45, s45, s58
    s_add_u32 s47, s47, 16384
    s_add_u32 s44, s44, 1
    s_cmp_lt_u32 s44, 8
    s_cbranch_scc1 L_w3_loop
    s_waitcnt lgkmcnt(0)
    s_branch L_w3_done
L_w3_first:
    ds_read_b128 v[72:75], v12 offset:0
    ds_read_b128 v[76:79], v13 offset:0
    ds_read_b128 v[80:83], v14 offset:0
    s_waitcnt lgkmcnt(2)
    v_mfma_f32_16x16x32_bf16 v[36:39], v[72:75], a[116:119], v[24:27]
    ds_read_b128 v[84:87], v15 offset:0
    ds_read_b128 v[88:91], v12 offset:4096
    v_mfma_f32_16x16x32_bf16 v[44:47], v[72:75], a[132:135], v[28:31]
    s_waitcnt lgkmcnt(3)
    v_mfma_f32_16x16x32_bf16 v[36:39], v[76:79], a[120:123], v[36:39]
    ds_read_b128 v[92:95], v13 offset:4096
    v_mfma_f32_16x16x32_bf16 v[44:47], v[76:79], a[136:139], v[44:47]
    s_waitcnt lgkmcnt(3)
    v_mfma_f32_16x16x32_bf16 v[36:39], v[80:83], a[124:127], v[36:39]
    ds_read_b128 v[72:75], v14 offset:4096
    v_mfma_f32_16x16x32_bf16 v[44:47], v[80:83], a[140:143], v[44:47]
    s_waitcnt lgkmcnt(3)
    v_mfma_f32_16x16x32_bf16 v[36:39], v[84:87], a[112:115], v[36:39]
    ds_read_b128 v[76:79], v15 offset:4096
    v_mfma_f32_16x16x32_bf16 v[44:47], v[84:87], a[128:131], v[44:47]
    s_waitcnt lgkmcnt(3)
    v_mfma_f32_16x16x32_bf16 v[40:43], v[88:91], a[116:119], v[24:27]
    ds_read_b128 v[80:83], v12 offset:8192
    v_mfma_f32_16x16x32_bf16 v[48:51], v[88:91], a[132:135], v[28:31]
    s_waitcnt lgkmcnt(3)
    v_mfma_f32_16x16x32_bf16 v[40:43], v[92:95], a[120:123], v[40:43]
    ds_read_b128 v[84:87], v13 offset:8192
    v_mfma_f32_16x16x32_bf16 v[48:51], v[92:95], a[136:139], v[48:51]
    s_waitcnt lgkmcnt(3)
    v_mfma_f32_16x16x32_bf16 v[40:43], v[72:75], a[124:127], v[40:43]
    ds_read_b128 v[88:91], v14 offset:8192
    v_mfma_f32_16x16x32_bf16 v[48:51], v[72:75], a[140:143], v[48:51]
    s_waitcnt lgkmcnt(3)
    v_mfma_f32_16x16x32_bf16 v[40:43], v[76:79], a[112:115], v[40:43]
    ds_read_b128 v[92:95], v15 offset:8192
    v_mfma_f32_16x16x32_bf16 v[48:51], v[76:79], a[128:131], v[48:51]
    s_waitcnt lgkmcnt(3)
    v_mfma_f32_16x16x32_bf16 v[52:55], v[80:83], a[116:119], v[24:27]
    ds_read_b128 v[72:75], v12 offset:12288
    v_mfma_f32_16x16x32_bf16 v[60:63], v[80:83], a[132:135], v[28:31]
    s_waitcnt lgkmcnt(3)
    v_mfma_f32_16x16x32_bf16 v[52:55], v[84:87], a[120:123], v[52:55]
    ds_read_b128 v[76:79], v13 offset:12288
    v_mfma_f32_16x16x32_bf16 v[60:63], v[84:87], a[136:139], v[60:63]
    s_waitcnt lgkmcnt(3)
    v_mfma_f32_16x16x32_bf16 v[52:55], v[88:91], a[124:127], v[52:55]
    ds_read_b128 v[80:83], v14 offset:12288
    v_mfma_f32_16x16x32_bf16 v[60:63], v[88:91], a[140:143], v[60:63]
    s_waitcnt lgkmcnt(3)
    v_mfma_f32_16x16x32_bf16 v[52:55], v[92:95], a[112:115], v[52:55]
    ds_read_b128 v[84:87], v15 offset:12288
    v_mfma_f32_16x16x32_bf16 v[60:63], v[92:95], a[128:131], v[60:63]
    s_waitcnt lgkmcnt(3)
    v_mfma_f32_16x16x32_bf16 v[56:59], v[72:75], a[116:119], v[24:27]
    ds_read_b64_tr_b16 v[88:89], v4 offset:0
    ds_read_b64_tr_b16 v[90:91], v4 offset:4096
    v_mfma_f32_16x16x32_bf16 v[64:67], v[72:75], a[132:135], v[28:31]
    v_mfma_f32_16x16x32_bf16 v[68:71], v[72:75], a[144:147], v[32:35]
    s_waitcnt lgkmcnt(4)
    v_mfma_f32_16x16x32_bf16 v[56:59], v[76:79], a[120:123], v[56:59]
    ds_read_b64_tr_b16 v[72:73], v5 offset:0
    ds_read_b64_tr_b16 v[74:75], v5 offset:4096
    v_mfma_f32_16x16x32_bf16 v[64:67], v[76:79], a[136:139], v[64:67]
    v_mfma_f32_16x16x32_bf16 v[68:71], v[76:79], a[148:151], v[68:71]
    s_waitcnt lgkmcnt(5)
    v_mfma_f32_16x16x32_bf16 v[56:59], v[80:83], a[124:127], v[56:59]
    ds_read_b64_tr_b16 v[76:77], v6 offset:0
    ds_read_b64_tr_b16 v[78:79], v6 offset:4096
    v_mfma_f32_16x16x32_bf16 v[64:67], v[80:83], a[140:143], v[64:67]
    v_mfma_f32_16x16x32_bf16 v[68:71], v[80:83], a[152:155], v[68:71]
    s_waitcnt lgkmcnt(6)
    v_mfma_f32_16x16x32_bf16 v[56:59], v[84:87], a[112:115], v[56:59]
    ds_read_b64_tr_b16 v[80:81], v7 offset:0
    ds_read_b64_tr_b16 v[82:83], v7 offset:4096
    v_mfma_f32_16x16x32_bf16 v[64:67], v[84:87], a[128:131], v[64:67]
    v_mfma_f32_16x16x32_bf16 v[68:71], v[84:87], a[156:159], v[68:71]
    s_nop 7
    s_mov_b32 s51, 0xff7fffff
    v_max3_f32 v20, v36, v37, v38
    v_max3_f32 v20, v20, v39, v40
    v_max3_f32 v20, v20, v41, v42
    v_max3_f32 v20, v20, v43, v52
    v_max3_f32 v20, v20, v53, v54
    v_max3_f32 v20, v20, v55, v56
    v_max3_f32 v20, v20, v57, v58
    v_max_f32 v20, v20, v59
    v_mov_b32 v23, v20
    s_nop 1
    v_permlane16_swap_b32 v20, v23
    v_max_f32 v20, v20, v23
    v_mov_b32 v23, v20
    s_nop 1
    v_permlane32_swap_b32 v20, v23
    v_max_f32 v20, v20, v23
    v_add_f32 v20, 0x40e00000, v20
    v_max_f32 v20, s51, v20
    v_sub_f32 v36, v36, v20
    v_sub_f32 v37, v37, v20
    v_sub_f32 v38, v38, v20
    v_sub_f32 v39, v39, v20
    v_sub_f32 v40, v40, v20
    v_sub_f32 v41, v41, v20
    v_sub_f32 v42, v42, v20
    v_sub_f32 v43, v43, v20
    v_sub_f32 v52, v52, v20
    v_sub_f32 v53, v53, v20
    v_sub_f32 v54, v54, v20
    v_sub_f32 v55, v55, v20
    v_sub_f32 v56, v56, v20
    v_sub_f32 v57, v57, v20
    v_sub_f32 v58, v58, v20
    v_sub_f32 v59, v59, v20
    v_sub_f32 v24, v24, v20
    v_sub_f32 v25, v25, v20
    v_sub_f32 v26, v26, v20
    v_sub_f32 v27, v27, v20
    v_max3_f32 v21, v44, v45, v46
    v_max3_f32 v21, v21, v47, v48
    v_max3_f32 v21, v21, v49, v50
    v_max3_f32 v21, v21, v51, v60
    v_max3_f32 v21, v21, v61, v62
    v_max3_f32 v21, v21, v63, v64
    v_max3_f32 v21, v21, v65, v66
    v_max_f32 v21, v21, v67
    v_mov_b32 v23, v21
    s_nop 1
    v_permlane16_swap_b32 v21, v23
    v_max_f32 v21, v21, v23
    v_mov_b32 v23, v21
    s_nop 1
    v_permlane32_swap_b32 v21, v23
    v_max_f32 v21, v21, v23
    v_add_f32 v21, 0x40e00000, v21
    v_max_f32 v21, s51, v21
    v_sub_f32 v44, v44, v21
    v_sub_f32 v45, v45, v21
    v_sub_f32 v46, v46, v21
    v_sub_f32 v47, v47, v21
    v_sub_f32 v48, v48, v21
    v_sub_f32 v49, v49, v21
    v_sub_f32 v50, v50, v21
    v_sub_f32 v51, v51, v21
    v_sub_f32 v60, v60, v21
    v_sub_f32 v61, v61, v21
    v_sub_f32 v62, v62, v21
    v_sub_f32 v63, v63, v21
    v_sub_f32 v64, v64, v21
    v_sub_f32 v65, v65, v21
    v_sub_f32 v66, v66, v21
    v_sub_f32 v67, v67, v21
    v_sub_f32 v28, v28, v21
    v_sub_f32 v29, v29, v21
    v_sub_f32 v30, v30, v21
    v_sub_f32 v31, v31, v21
    v_max3_f32 v22, v68, v69, v70
    v_max_f32 v22, v22, v71
    v_mov_b32 v23, v22
    s_nop 1
    v_permlane16_swap_b32 v22, v23
    v_max_f32 v22, v22, v23
    v_mov_b32 v23, v22
    s_nop 1
    v_permlane32_swap_b32 v22, v23
    v_max_f32 v22, v22, v23
    v_add_f32 v22, 0x40e00000, v22
    v_max_f32 v22, s51, v22
    v_sub_f32 v68, v68, v22
    v_sub_f32 v69, v69, v22
    v_sub_f32 v70, v70, v22
    v_sub_f32 v71, v71, v22
    v_sub_f32 v32, v32, v22
    v_sub_f32 v33, v33, v22
    v_sub_f32 v34, v34, v22
    v_sub_f32 v35, v35, v22
    v_exp_f32 v36, v36
    v_exp_f32 v37, v37
    v_exp_f32 v38, v38
    v_exp_f32 v39, v39
    v_cvt_pk_bf16_f32 v36, v36, v37
    v_cvt_pk_bf16_f32 v37, v38, v39
    v_exp_f32 v44, v44
    v_exp_f32 v45, v45
    v_exp_f32 v46, v46
    v_exp_f32 v47, v47
    v_cvt_pk_bf16_f32 v44, v44, v45
    v_cvt_pk_bf16_f32 v45, v46, v47
    v_exp_f32 v40, v40
    v_exp_f32 v41, v41
    v_exp_f32 v42, v42
    v_exp_f32 v43, v43
    v_cvt_pk_bf16_f32 v38, v40, v41
    v_cvt_pk_bf16_f32 v39, v42, v43
    v_exp_f32 v48, v48
    v_exp_f32 v49, v49
    v_exp_f32 v50, v50
    v_exp_f32 v51, v51
    v_cvt_pk_bf16_f32 v46, v48, v49
    v_cvt_pk_bf16_f32 v47, v50, v51
    s_waitcnt lgkmcnt(0)
    s_branch L_w3_Aafter
L_w3_rareA:
    s_waitcnt lgkmcnt(0)
    s_nop 7
    s_nop 7
    ds_read_b128 v[20:23], v12 offset:0
    s_waitcnt lgkmcnt(0)
    v_mfma_f32_16x16x32_bf16 v[36:39], v[20:23], a[116:119], v[24:27]
    v_mfma_f32_16x16x32_bf16 v[44:47], v[20:23], a[132:135], v[28:31]
    s_nop 1
    ds_read_b128 v[20:23], v13 offset:0
    s_waitcnt lgkmcnt(0)
    v_mfma_f32_16x16x32_bf16 v[36:39], v[20:23], a[120:123], v[36:39]
    v_mfma_f32_16x16x32_bf16 v[44:47], v[20:23], a[136:139], v[44:47]
    s_nop 1
    ds_read_b128 v[20:23], v14 offset:0
    s_waitcnt lgkmcnt(0)
    v_mfma_f32_16x16x32_bf16 v[36:39], v[20:23], a[124:127], v[36:39]
    v_mfma_f32_16x16x32_bf16 v[44:47], v[20:23], a[140:143], v[44:47]
    s_nop 1
    ds_read_b128 v[20:23], v15 offset:0
    s_waitcnt lgkmcnt(0)
    v_mfma_f32_16x16x32_bf16 v[36:39], v[20:23], a[112:115], v[36:39]
    v_mfma_f32_16x16x32_bf16 v[44:47], v[20:23], a[128:131], v[44:47]
    s_nop 1
    ds_read_b128 v[20:23], v12 offset:4096
    s_waitcnt lgkmcnt(0)
    v_mfma_f32_16x16x32_bf16 v[40:43], v[20:23], a[116:119], v[24:27]
    v_mfma_f32_16x16x32_bf16 v[48:51], v[20:23], a[132:135], v[28:31]
    s_nop 1
    ds_read_b128 v[20:23], v13 offset:4096
    s_waitcnt lgkmcnt(0)
    v_mfma_f32_16x16x32_bf16 v[40:43], v[20:23], a[120:123], v[40:43]
    v_mfma_f32_16x16x32_bf16 v[48:51], v[20:23], a[136:139], v[48:51]
    s_nop 1
    ds_read_b128 v[20:23], v14 offset:4096
    s_waitcnt lgkmcnt(0)
    v_mfma_f32_16x16x32_bf16 v[40:43], v[20:23], a[124:127], v[40:43]
    v_mfma_f32_16x16x32_bf16 v[48:51], v[20:23], a[140:143], v[48:51]
    s_nop 1
    ds_read_b128 v[20:23], v15 offset:4096
    s_waitcnt lgkmcnt(0)
    v_mfma_f32_16x16x32_bf16 v[40:43], v[20:23], a[112:115], v[40:43]
    v_mfma_f32_16x16x32_bf16 v[48:51], v[20:23], a[128:131], v[48:51]
    s_nop 1
    s_nop 7
    s_nop 3
    s_mov_b32 s51, 0
    v_max3_f32 v20, v36, v37, v38
    v_max3_f32 v20, v20, v39, v40
    v_max3_f32 v20, v20, v41, v42
    v_max3_f32 v20, v20, v43, v52
    v_max3_f32 v20, v20, v53, v54
    v_max3_f32 v20, v20, v55, v56
    v_max3_f32 v20, v20, v57, v58
    v_max_f32 v20, v20, v59
    v_mov_b32 v23, v20
    s_nop 1
    v_permlane16_swap_b32 v20, v23
    v_max_f32 v20, v20, v23
    v_mov_b32 v23, v20
    s_nop 1
    v_permlane32_swap_b32 v20, v23
    v_max_f32 v20, v20, v23
    v_add_f32 v20, 0x40e00000, v20
    v_max_f32 v20, s51, v20
    v_sub_f32 v36, v36, v20
    v_sub_f32 v37, v37, v20
    v_sub_f32 v38, v38, v20
    v_sub_f32 v39, v39, v20
    v_sub_f32 v40, v40, v20
    v_sub_f32 v41, v41, v20
    v_sub_f32 v42, v42, v20
    v_sub_f32 v43, v43, v20
    v_sub_f32 v52, v52, v20
    v_sub_f32 v53, v53, v20
    v_sub_f32 v54, v54, v20
    v_sub_f32 v55, v55, v20
    v_sub_f32 v56, v56, v20
    v_sub_f32 v57, v57, v20
    v_sub_f32 v58, v58, v20
    v_sub_f32 v59, v59, v20
    v_sub_f32 v24, v24, v20
    v_sub_f32 v25, v25, v20
    v_sub_f32 v26, v26, v20
    v_sub_f32 v27, v27, v20
    v_max3_f32 v21, v44, v45, v46
    v_max3_f32 v21, v21, v47, v48
    v_max3_f32 v21, v21, v49, v50
    v_max3_f32 v21, v21, v51, v60
    v_max3_f32 v21, v21, v61, v62
    v_max3_f32 v21, v21, v63, v64
    v_max3_f32 v21, v21, v65, v66
    v_max_f32 v21, v21, v67
    v_mov_b32 v23, v21
    s_nop 1
    v_permlane16_swap_b32 v21, v23
    v_max_f32 v21, v21, v23
    v_mov_b32 v23, v21
    s_nop 1
    v_permlane32_swap_b32 v21, v23
    v_max_f32 v21, v21, v23
    v_add_f32 v21, 0x40e00000, v21
    v_max_f32 v21, s51, v21
    v_sub_f32 v44, v44, v21
    v_sub_f32 v45, v45, v21
    v_sub_f32 v46, v46, v21
    v_sub_f32 v47, v47, v21
    v_sub_f32 v48, v48, v21
    v_sub_f32 v49, v49, v21
    v_sub_f32 v50, v50, v21
    v_sub_f32 v51, v51, v21
    v_sub_f32 v60, v60, v21
    v_sub_f32 v61, v61, v21
    v_sub_f32 v62, v62, v21
    v_sub_f32 v63, v63, v21
    v_sub_f32 v64, v64, v21
    v_sub_f32 v65, v65, v21
    v_sub_f32 v66, v66, v21
    v_sub_f32 v67, v67, v21
    v_sub_f32 v28, v28, v21
    v_sub_f32 v29, v29, v21
    v_sub_f32 v30, v30, v21
    v_sub_f32 v31, v31, v21
    v_max3_f32 v22, v68, v69, v70
    v_max_f32 v22, v22, v71
    v_mov_b32 v23, v22
    s_nop 1
    v_permlane16_swap_b32 v22, v23
    v_max_f32 v22, v22, v23
    v_mov_b32 v23, v22
    s_nop 1
    v_permlane32_swap_b32 v22, v23
    v_max_f32 v22, v22, v23
    v_add_f32 v22, 0x40e00000, v22
    v_max_f32 v22, s51, v22
    v_sub_f32 v68, v68, v22
    v_sub_f32 v69, v69, v22
    v_sub_f32 v70, v70, v22
    v_sub_f32 v71, v71, v22
    v_sub_f32 v32, v32, v22
    v_sub_f32 v33, v33, v22
    v_sub_f32 v34, v34, v22
    v_sub_f32 v35, v35, v22
    s_mov_b32 s53, 0
    s_branch L_w3_resc
L_w3_rareB:
    s_waitcnt lgkmcnt(0)
    s_nop 7
    s_nop 7
    ds_read_b128 v[20:23], v12 offset:8192
    s_waitcnt lgkmcnt(0)
    v_mfma_f32_16x16x32_bf16 v[52:55], v[20:23], a[116:119], v[24:27]
    v_mfma_f32_16x16x32_bf16 v[60:63], v[20:23], a[132:135], v[28:31]
    s_nop 1
    ds_read_b128 v[20:23], v13 offset:8192
    s_waitcnt lgkmcnt(0)
    v_mfma_f32_16x16x32_bf16 v[52:55], v[20:23], a[120:123], v[52:55]
    v_mfma_f32_16x16x32_bf16 v[60:63], v[20:23], a[136:139], v[60:63]
    s_nop 1
    ds_read_b128 v[20:23], v14 offset:8192
    s_waitcnt lgkmcnt(0)
    v_mfma_f32_16x16x32_bf16 v[52:55], v[20:23], a[124:127], v[52:55]
    v_mfma_f32_16x16x32_bf16 v[60:63], v[20:23], a[140:143], v[60:63]
    s_nop 1
    ds_read_b128 v[20:23], v15 offset:8192
    s_waitcnt lgkmcnt(0)
    v_mfma_f32_16x16x32_bf16 v[52:55], v[20:23], a[112:115], v[52:55]
    v_mfma_f32_16x16x32_bf16 v[60:63], v[20:23], a[128:131], v[60:63]
    s_nop 1
    ds_read_b128 v[20:23], v12 offset:12288
    s_waitcnt lgkmcnt(0)
    v_mfma_f32_16x16x32_bf16 v[56:59], v[20:23], a[116:119], v[24:27]
    v_mfma_f32_16x16x32_bf16 v[64:67], v[20:23], a[132:135], v[28:31]
    v_mfma_f32_16x16x32_bf16 v[68:71], v[20:23], a[144:147], v[32:35]
    s_nop 1
    ds_read_b128 v[20:23], v13 offset:12288
    s_waitcnt lgkmcnt(0)
    v_mfma_f32_16x16x32_bf16 v[56:59], v[20:23], a[120:123], v[56:59]
    v_mfma_f32_16x16x32_bf16 v[64:67], v[20:23], a[136:139], v[64:67]
    v_mfma_f32_16x16x32_bf16 v[68:71], v[20:23], a[148:151], v[68:71]
    s_nop 1
    ds_read_b128 v[20:23], v14 offset:12288
    s_waitcnt lgkmcnt(0)
    v_mfma_f32_16x16x32_bf16 v[56:59], v[20:23], a[124:127], v[56:59]
    v_mfma_f32_16x16x32_bf16 v[64:67], v[20:23], a[140:143], v[64:67]
    v_mfma_f32_16x16x32_bf16 v[68:71], v[20:23], a[152:155], v[68:71]
    s_nop 1
    ds_read_b128 v[20:23], v15 offset:12288
    s_waitcnt lgkmcnt(0)
    v_mfma_f32_16x16x32_bf16 v[56:59], v[20:23], a[112:115], v[56:59]
    v_mfma_f32_16x16x32_bf16 v[64:67], v[20:23], a[128:131], v[64:67]
    v_mfma_f32_16x16x32_bf16 v[68:71], v[20:23], a[156:159], v[68:71]
    s_nop 1
    s_nop 7
    s_nop 3
    s_mov_b32 s51, 0
    v_max3_f32 v20, v52, v53, v54
    v_max3_f32 v20, v20, v55, v56
    v_max3_f32 v20, v20, v57, v58
    v_max_f32 v20, v20, v59
    v_mov_b32 v23, v20
    s_nop 1
    v_permlane16_swap_b32 v20, v23
    v_max_f32 v20, v20, v23
    v_mov_b32 v23, v20
    s_nop 1
    v_permlane32_swap_b32 v20, v23
    v_max_f32 v20, v20, v23
    v_add_f32 v20, 0x40e00000, v20
    v_max_f32 v20, s51, v20
    v_sub_f32 v52, v52, v20
    v_sub_f32 v53, v53, v20
    v_sub_f32 v54, v54, v20
    v_sub_f32 v55, v55, v20
    v_sub_f32 v56, v56, v20
    v_sub_f32 v57, v57, v20
    v_sub_f32 v58, v58, v20
    v_sub_f32 v59, v59, v20
    v_sub_f32 v24, v24, v20
    v_sub_f32 v25, v25, v20
    v_sub_f32 v26, v26, v20
    v_sub_f32 v27, v27, v20
    v_max3_f32 v21, v60, v61, v62
    v_max3_f32 v21, v21, v63, v64
    v_max3_f32 v21, v21, v65, v66
    v_max_f32 v21, v21, v67
    v_mov_b32 v23, v21
    s_nop 1
    v_permlane16_swap_b32 v21, v23
    v_max_f32 v21, v21, v23
    v_mov_b32 v23, v21
    s_nop 1
    v_permlane32_swap_b32 v21, v23
    v_max_f32 v21, v21, v23
    v_add_f32 v21, 0x40e00000, v21
    v_max_f32 v21, s51, v21
    v_sub_f32 v60, v60, v21
    v_sub_f32 v61, v61, v21
    v_sub_f32 v62, v62, v21
    v_sub_f32 v63, v63, v21
    v_sub_f32 v64, v64, v21
    v_sub_f32 v65, v65, v21
    v_sub_f32 v66, v66, v21
    v_sub_f32 v67, v67, v21
    v_sub_f32 v28, v28, v21
    v_sub_f32 v29, v29, v21
    v_sub_f32 v30, v30, v21
    v_sub_f32 v31, v31, v21
    v_max3_f32 v22, v68, v69, v70
    v_max_f32 v22, v22, v71
    v_mov_b32 v23, v22
    s_nop 1
    v_permlane16_swap_b32 v22, v23
    v_max_f32 v22, v22, v23
    v_mov_b32 v23, v22
    s_nop 1
    v_permlane32_swap_b32 v22, v23
    v_max_f32 v22, v22, v23
    v_add_f32 v22, 0x40e00000, v22
    v_max_f32 v22, s51, v22
    v_sub_f32 v68, v68, v22
    v_sub_f32 v69, v69, v22
    v_sub_f32 v70, v70, v22
    v_sub_f32 v71, v71, v22
    v_sub_f32 v32, v32, v22
    v_sub_f32 v33, v33, v22
    v_sub_f32 v34, v34, v22
    v_sub_f32 v35, v35, v22
    s_mov_b32 s53, 1
L_w3_resc:
    v_exp_f32 v20, -v20
    v_exp_f32 v21, -v21
    v_exp_f32 v22, -v22
    v_accvgpr_read_b32 v23, a0
    v_mul_f32 v23, v23, v20
    v_accvgpr_write_b32 a0, v23
    v_accvgpr_read_b32 v23, a1
    v_mul_f32 v23, v23, v20
    v_accvgpr_write_b32 a1, v23
    v_accvgpr_read_b32 v23, a2
    v_mul_f32 v23, v23, v20
    v_accvgpr_write_b32 a2, v23
    v_accvgpr_read_b32 v23, a3
    v_mul_f32 v23, v23, v20
    v_accvgpr_write_b32 a3, v23
    v_accvgpr_read_b32 v23, a4
    v_mul_f32 v23, v23, v21
    v_accvgpr_write_b32 a4, v23
    v_accvgpr_read_b32 v23, a5
    v_mul_f32 v23, v23, v21
    v_accvgpr_write_b32 a5, v23
    v_accvgpr_read_b32 v23, a6
    v_mul_f32 v23, v23, v21
    v_accvgpr_write_b32 a6, v23
    v_accvgpr_read_b32 v23, a7
    v_mul_f32 v23, v23, v21
    v_accvgpr_write_b32 a7, v23
    v_accvgpr_read_b32 v23, a64
    v_mul_f32 v23, v23, v22
    v_accvgpr_write_b32 a64, v23
    v_accvgpr_read_b32 v23, a65
    v_mul_f32 v23, v23, v22
    v_accvgpr_write_b32 a65, v23
    v_accvgpr_read_b32 v23, a66
    v_mul_f32 v23, v23, v22
    v_accvgpr_write_b32 a66, v23
    v_accvgpr_read_b32 v23, a67
    v_mul_f32 v23, v23, v22
    v_accvgpr_write_b32 a67, v23
    v_accvgpr_read_b32 v23, a8
    v_mul_f32 v23, v23, v20
    v_accvgpr_write_b32 a8, v23
    v_accvgpr_read_b32 v23, a9
    v_mul_f32 v23, v23, v20
    v_accvgpr_write_b32 a9, v23
    v_accvgpr_read_b32 v23, a10
    v_mul_f32 v23, v23, v20
    v_accvgpr_write_b32 a10, v23
    v_accvgpr_read_b32 v23, a11
    v_mul_f32 v23, v23, v20
    v_accvgpr_write_b32 a11, v23
    v_accvgpr_read_b32 v23, a12
    v_mul_f32 v23, v23, v21
    v_accvgpr_write_b32 a12, v23
    v_accvgpr_read_b32 v23, a13
    v_mul_f32 v23, v23, v21
    v_accvgpr_write_b32 a13, v23
    v_accvgpr_read_b32 v23, a14
    v_mul_f32 v23, v23, v21
    v_accvgpr_write_b32 a14, v23
    v_accvgpr_read_b32 v23, a15
    v_mul_f32 v23, v23, v21
    v_accvgpr_write_b32 a15, v23
    v_accvgpr_read_b32 v23, a68
    v_mul_f32 v23, v23, v22
    v_accvgpr_write_b32 a68, v23
    v_accvgpr_read_b32 v23, a69
    v_mul_f32 v23, v23, v22
    v_accvgpr_write_b32 a69, v23
    v_accvgpr_read_b32 v23, a70
    v_mul_f32 v23, v23, v22
    v_accvgpr_write_b32 a70, v23
    v_accvgpr_read_b32 v23, a71
    v_mul_f32 v23, v23, v22
    v_accvgpr_write_b32 a71, v23
    v_accvgpr_read_b32 v23, a16
    v_mul_f32 v23, v23, v20
    v_accvgpr_write_b32 a16, v23
    v_accvgpr_read_b32 v23, a17
    v_mul_f32 v23, v23, v20
    v_accvgpr_write_b32 a17, v23
    v_accvgpr_read_b32 v23, a18
    v_mul_f32 v23, v23, v20
    v_accvgpr_write_b32 a18, v23
    v_accvgpr_read_b32 v23, a19
    v_mul_f32 v23, v23, v20
    v_accvgpr_write_b32 a19, v23
    v_accvgpr_read_b32 v23, a20
    v_mul_f32 v23, v23, v21
    v_accvgpr_write_b32 a20, v23
    v_accvgpr_read_b32 v23, a21
    v_mul_f32 v23, v23, v21
    v_accvgpr_write_b32 a21, v23
    v_accvgpr_read_b32 v23, a22
    v_mul_f32 v23, v23, v21
    v_accvgpr_write_b32 a22, v23
    v_accvgpr_read_b32 v23, a23
    v_mul_f32 v23, v23, v21
    v_accvgpr_write_b32 a23, v23
    v_accvgpr_read_b32 v23, a72
    v_mul_f32 v23, v23, v22
    v_accvgpr_write_b32 a72, v23
    v_accvgpr_read_b32 v23, a73
    v_mul_f32 v23, v23, v22
    v_accvgpr_write_b32 a73, v23
    v_accvgpr_read_b32 v23, a74
    v_mul_f32 v23, v23, v22
    v_accvgpr_write_b32 a74, v23
    v_accvgpr_read_b32 v23, a75
    v_mul_f32 v23, v23, v22
    v_accvgpr_write_b32 a75, v23
    v_accvgpr_read_b32 v23, a24
    v_mul_f32 v23, v23, v20
    v_accvgpr_write_b32 a24, v23
    v_accvgpr_read_b32 v23, a25
    v_mul_f32 v23, v23, v20
    v_accvgpr_write_b32 a25, v23
    v_accvgpr_read_b32 v23, a26
    v_mul_f32 v23, v23, v20
    v_accvgpr_write_b32 a26, v23
    v_accvgpr_read_b32 v23, a27
    v_mul_f32 v23, v23, v20
    v_accvgpr_write_b32 a27, v23
    v_accvgpr_read_b32 v23, a28
    v_mul_f32 v23, v23, v21
    v_accvgpr_write_b32 a28, v23
    v_accvgpr_read_b32 v23, a29
    v_mul_f32 v23, v23, v21
    v_accvgpr_write_b32 a29, v23
    v_accvgpr_read_b32 v23, a30
    v_mul_f32 v23, v23, v21
    v_accvgpr_write_b32 a30, v23
    v_accvgpr_read_b32 v23, a31
    v_mul_f32 v23, v23, v21
    v_accvgpr_write_b32 a31, v23
    v_accvgpr_read_b32 v23, a76
    v_mul_f32 v23, v23, v22
    v_accvgpr_write_b32 a76, v23
    v_accvgpr_read_b32 v23, a77
    v_mul_f32 v23, v23, v22
    v_accvgpr_write_b32 a77, v23
    v_accvgpr_read_b32 v23, a78
    v_mul_f32 v23, v23, v22
    v_accvgpr_write_b32 a78, v23
    v_accvgpr_read_b32 v23, a79
    v_mul_f32 v23, v23, v22
    v_accvgpr_write_b32 a79, v23
    v_accvgpr_read_b32 v23, a32
    v_mul_f32 v23, v23, v20
    v_accvgpr_write_b32 a32, v23
    v_accvgpr_read_b32 v23, a33
    v_mul_f32 v23, v23, v20
    v_accvgpr_write_b32 a33, v23
    v_accvgpr_read_b32 v23, a34
    v_mul_f32 v23, v23, v20
    v_accvgpr_write_b32 a34, v23
    v_accvgpr_read_b32 v23, a35
    v_mul_f32 v23, v23, v20
    v_accvgpr_write_b32 a35, v23
    v_accvgpr_read_b32 v23, a36
    v_mul_f32 v23, v23, v21
    v_accvgpr_write_b32 a36, v23
    v_accvgpr_read_b32 v23, a37
    v_mul_f32 v23, v23, v21
    v_accvgpr_write_b32 a37, v23
    v_accvgpr_read_b32 v23, a38
    v_mul_f32 v23, v23, v21
    v_accvgpr_write_b32 a38, v23
    v_accvgpr_read_b32 v23, a39
    v_mul_f32 v23, v23, v21
    v_accvgpr_write_b32 a39, v23
    v_accvgpr_read_b32 v23, a80
    v_mul_f32 v23, v23, v22
    v_accvgpr_write_b32 a80, v23
    v_accvgpr_read_b32 v23, a81
    v_mul_f32 v23, v23, v22
    v_accvgpr_write_b32 a81, v23
    v_accvgpr_read_b32 v23, a82
    v_mul_f32 v23, v23, v22
    v_accvgpr_write_b32 a82, v23
    v_accvgpr_read_b32 v23, a83
    v_mul_f32 v23, v23, v22
    v_accvgpr_write_b32 a83, v23
    v_accvgpr_read_b32 v23, a40
    v_mul_f32 v23, v23, v20
    v_accvgpr_write_b32 a40, v23
    v_accvgpr_read_b32 v23, a41
    v_mul_f32 v23, v23, v20
    v_accvgpr_write_b32 a41, v23
    v_accvgpr_read_b32 v23, a42
    v_mul_f32 v23, v23, v20
    v_accvgpr_write_b32 a42, v23
    v_accvgpr_read_b32 v23, a43
    v_mul_f32 v23, v23, v20
    v_accvgpr_write_b32 a43, v23
    v_accvgpr_read_b32 v23, a44
    v_mul_f32 v23, v23, v21
    v_accvgpr_write_b32 a44, v23
    v_accvgpr_read_b32 v23, a45
    v_mul_f32 v23, v23, v21
    v_accvgpr_write_b32 a45, v23
    v_accvgpr_read_b32 v23, a46
    v_mul_f32 v23, v23, v21
    v_accvgpr_write_b32 a46, v23
    v_accvgpr_read_b32 v23, a47
    v_mul_f32 v23, v23, v21
    v_accvgpr_write_b32 a47, v23
    v_accvgpr_read_b32 v23, a84
    v_mul_f32 v23, v23, v22
    v_accvgpr_write_b32 a84, v23
    v_accvgpr_read_b32 v23, a85
    v_mul_f32 v23, v23, v22
    v_accvgpr_write_b32 a85, v23
    v_accvgpr_read_b32 v23, a86
    v_mul_f32 v23, v23, v22
    v_accvgpr_write_b32 a86, v23
    v_accvgpr_read_b32 v23, a87
    v_mul_f32 v23, v23, v22
    v_accvgpr_write_b32 a87, v23
    v_accvgpr_read_b32 v23, a48
    v_mul_f32 v23, v23, v20
    v_accvgpr_write_b32 a48, v23
    v_accvgpr_read_b32 v23, a49
    v_mul_f32 v23, v23, v20
    v_accvgpr_write_b32 a49, v23
    v_accvgpr_read_b32 v23, a50
    v_mul_f32 v23, v23, v20
    v_accvgpr_write_b32 a50, v23
    v_accvgpr_read_b32 v23, a51
    v_mul_f32 v23, v23, v20
    v_accvgpr_write_b32 a51, v23
    v_accvgpr_read_b32 v23, a52
    v_mul_f32 v23, v23, v21
    v_accvgpr_write_b32 a52, v23
    v_accvgpr_read_b32 v23, a53
    v_mul_f32 v23, v23, v21
    v_accvgpr_write_b32 a53, v23
    v_accvgpr_read_b32 v23, a54
    v_mul_f32 v23, v23, v21
    v_accvgpr_write_b32 a54, v23
    v_accvgpr_read_b32 v23, a55
    v_mul_f32 v23, v23, v21
    v_accvgpr_write_b32 a55, v23
    v_accvgpr_read_b32 v23, a88
    v_mul_f32 v23, v23, v22
    v_accvgpr_write_b32 a88, v23
    v_accvgpr_read_b32 v23, a89
    v_mul_f32 v23, v23, v22
    v_accvgpr_write_b32 a89, v23
    v_accvgpr_read_b32 v23, a90
    v_mul_f32 v23, v23, v22
    v_accvgpr_write_b32 a90, v23
    v_accvgpr_read_b32 v23, a91
    v_mul_f32 v23, v23, v22
    v_accvgpr_write_b32 a91, v23
    v_accvgpr_read_b32 v23, a56
    v_mul_f32 v23, v23, v20
    v_accvgpr_write_b32 a56, v23
    v_accvgpr_read_b32 v23, a57
    v_mul_f32 v23, v23, v20
    v_accvgpr_write_b32 a57, v23
    v_accvgpr_read_b32 v23, a58
    v_mul_f32 v23, v23, v20
    v_accvgpr_write_b32 a58, v23
    v_accvgpr_read_b32 v23, a59
    v_mul_f32 v23, v23, v20
    v_accvgpr_write_b32 a59, v23
    v_accvgpr_read_b32 v23, a60
    v_mul_f32 v23, v23, v21
    v_accvgpr_write_b32 a60, v23
    v_accvgpr_read_b32 v23, a61
    v_mul_f32 v23, v23, v21
    v_accvgpr_write_b32 a61, v23
    v_accvgpr_read_b32 v23, a62
    v_mul_f32 v23, v23, v21
    v_accvgpr_write_b32 a62, v23
    v_accvgpr_read_b32 v23, a63
    v_mul_f32 v23, v23, v21
    v_accvgpr_write_b32 a63, v23
    v_accvgpr_read_b32 v23, a92
    v_mul_f32 v23, v23, v22
    v_accvgpr_write_b32 a92, v23
    v_accvgpr_read_b32 v23, a93
    v_mul_f32 v23, v23, v22
    v_accvgpr_write_b32 a93, v23
    v_accvgpr_read_b32 v23, a94
    v_mul_f32 v23, v23, v22
    v_accvgpr_write_b32 a94, v23
    v_accvgpr_read_b32 v23, a95
    v_mul_f32 v23, v23, v22
    v_accvgpr_write_b32 a95, v23
    v_accvgpr_read_b32 v23, a96
    v_mul_f32 v23, v23, v20
    v_accvgpr_write_b32 a96, v23
    v_accvgpr_read_b32 v23, a97
    v_mul_f32 v23, v23, v20
    v_accvgpr_write_b32 a97, v23
    v_accvgpr_read_b32 v23, a98
    v_mul_f32 v23, v23, v20
    v_accvgpr_write_b32 a98, v23
    v_accvgpr_read_b32 v23, a99
    v_mul_f32 v23, v23, v20
    v_accvgpr_write_b32 a99, v23
    v_accvgpr_read_b32 v23, a100
    v_mul_f32 v23, v23, v21
    v_accvgpr_write_b32 a100, v23
    v_accvgpr_read_b32 v23, a101
    v_mul_f32 v23, v23, v21
    v_accvgpr_write_b32 a101, v23
    v_accvgpr_read_b32 v23, a102
    v_mul_f32 v23, v23, v21
    v_accvgpr_write_b32 a102, v23
    v_accvgpr_read_b32 v23, a103
    v_mul_f32 v23, v23, v21
    v_accvgpr_write_b32 a103, v23
    v_accvgpr_read_b32 v23, a104
    v_mul_f32 v23, v23, v22
    v_accvgpr_write_b32 a104, v23
    v_accvgpr_read_b32 v23, a105
    v_mul_f32 v23, v23, v22
    v_accvgpr_write_b32 a105, v23
    v_accvgpr_read_b32 v23, a106
    v_mul_f32 v23, v23, v22
    v_accvgpr_write_b32 a106, v23
    v_accvgpr_read_b32 v23, a107
    v_mul_f32 v23, v23, v22
    v_accvgpr_write_b32 a107, v23
    s_cmp_eq_u32 s53, 1
    s_cbranch_scc1 L_w3_retB
    v_exp_f32 v36, v36
    v_exp_f32 v37, v37
    v_exp_f32 v38, v38
    v_exp_f32 v39, v39
    v_cvt_pk_bf16_f32 v36, v36, v37
    v_cvt_pk_bf16_f32 v37, v38, v39
    v_exp_f32 v44, v44
    v_exp_f32 v45, v45
    v_exp_f32 v46, v46
    v_exp_f32 v47, v47
    v_cvt_pk_bf16_f32 v44, v44, v45
    v_cvt_pk_bf16_f32 v45, v46, v47
    v_exp_f32 v40, v40
    v_exp_f32 v41, v41
    v_exp_f32 v42, v42
    v_exp_f32 v43, v43
    v_cvt_pk_bf16_f32 v38, v40, v41
    v_cvt_pk_bf16_f32 v39, v42, v43
    v_exp_f32 v48, v48
    v_exp_f32 v49, v49
    v_exp_f32 v50, v50
    v_exp_f32 v51, v51
    v_cvt_pk_bf16_f32 v46, v48, v49
    v_cvt_pk_bf16_f32 v47, v50, v51
    s_branch L_w3_Aafter
L_w3_retB:
    v_exp_f32 v52, v52
    v_exp_f32 v53, v53
    v_exp_f32 v54, v54
    v_exp_f32 v55, v55
    v_cvt_pk_bf16_f32 v52, v52, v53
    v_cvt_pk_bf16_f32 v53, v54, v55
    v_exp_f32 v60, v60
    v_exp_f32 v61, v61
    v_exp_f32 v62, v62
    v_exp_f32 v63, v63
    v_cvt_pk_bf16_f32 v60, v60, v61
    v_cvt_pk_bf16_f32 v61, v62, v63
    v_exp_f32 v56, v56
    v_exp_f32 v57, v57
    v_exp_f32 v58, v58
    v_exp_f32 v59, v59
    v_cvt_pk_bf16_f32 v54, v56, v57
    v_cvt_pk_bf16_f32 v55, v58, v59
    v_exp_f32 v64, v64
    v_exp_f32 v65, v65
    v_exp_f32 v66, v66
    v_exp_f32 v67, v67
    v_cvt_pk_bf16_f32 v62, v64, v65
    v_cvt_pk_bf16_f32 v63, v66, v67
    v_exp_f32 v68, v68
    v_exp_f32 v69, v69
    v_exp_f32 v70, v70
    v_exp_f32 v71, v71
    v_cvt_pk_bf16_f32 v68, v68, v69
    v_cvt_pk_bf16_f32 v69, v70, v71
    s_branch L_w3_Bafter
L_w3_done:
    s_add_u32 s8, s32, 524288
    s_addc_u32 s9, s33, 0
    s_mov_b32 s10, 131072
    s_mov_b32 s11, 0x20000
    s_add_u32 s12, s36, 524288
    s_addc_u32 s13, s37, 0
    s_mov_b32 s14, 131072
    s_mov_b32 s15, 0x20000
    s_nop 7
    v_lshlrev_b32 v0, 4, v1
    v_accvgpr_read_b32 v22, a104
    v_lshlrev_b32 v12, 2, v1
    v_add_u32 v12, 131072, v12
    ds_write_b32 v12, v32 offset:768
    ds_write_b32 v12, v22 offset:1792
    v_accvgpr_read_b32 v20, a96
    v_accvgpr_read_b32 v21, a100
    v_rcp_f32 v20, v20
    v_rcp_f32 v21, v21
    v_accvgpr_read_b32 v72, a0
    v_accvgpr_read_b32 v76, a8
    v_accvgpr_read_b32 v73, a1
    v_accvgpr_read_b32 v77, a9
    v_accvgpr_read_b32 v74, a2
    v_accvgpr_read_b32 v78, a10
    v_accvgpr_read_b32 v75, a3
    v_accvgpr_read_b32 v79, a11
    v_mul_f32 v72, v72, v20
    v_mul_f32 v73, v73, v20
    v_mul_f32 v74, v74, v20
    v_mul_f32 v75, v75, v20
    v_mul_f32 v76, v76, v20
    v_mul_f32 v77, v77, v20
    v_mul_f32 v78, v78, v20
    v_mul_f32 v79, v79, v20
    v_cvt_pk_bf16_f32 v72, v72, v73
    v_cvt_pk_bf16_f32 v73, v74, v75
    v_cvt_pk_bf16_f32 v74, v76, v77
    v_cvt_pk_bf16_f32 v75, v78, v79
    s_mov_b32 s48, 27648
    buffer_store_dwordx4 v[72:75], v0, s[40:43], s48 offen sc1
    v_accvgpr_read_b32 v80, a16
    v_accvgpr_read_b32 v84, a24
    v_accvgpr_read_b32 v81, a17
    v_accvgpr_read_b32 v85, a25
    v_accvgpr_read_b32 v82, a18
    v_accvgpr_read_b32 v86, a26
    v_accvgpr_read_b32 v83, a19
    v_accvgpr_read_b32 v87, a27
    v_mul_f32 v80, v80, v20
    v_mul_f32 v81, v81, v20
    v_mul_f32 v82, v82, v20
    v_mul_f32 v83, v83, v20
    v_mul_f32 v84, v84, v20
    v_mul_f32 v85, v85, v20
    v_mul_f32 v86, v86, v20
    v_mul_f32 v87, v87, v20
    v_cvt_pk_bf16_f32 v80, v80, v81
    v_cvt_pk_bf16_f32 v81, v82, v83
    v_cvt_pk_bf16_f32 v82, v84, v85
    v_cvt_pk_bf16_f32 v83, v86, v87
    s_mov_b32 s48, 24576
    buffer_store_dwordx4 v[80:83], v0, s[40:43], s48 offen sc1
    v_accvgpr_read_b32 v88, a32
    v_accvgpr_read_b32 v92, a40
    v_accvgpr_read_b32 v89, a33
    v_accvgpr_read_b32 v93, a41
    v_accvgpr_read_b32 v90, a34
    v_accvgpr_read_b32 v94, a42
    v_accvgpr_read_b32 v91, a35
    v_accvgpr_read_b32 v95, a43
    v_mul_f32 v88, v88, v20
    v_mul_f32 v89, v89, v20
    v_mul_f32 v90, v90, v20
    v_mul_f32 v91, v91, v20
    v_mul_f32 v92, v92, v20
    v_mul_f32 v93, v93, v20
    v_mul_f32 v94, v94, v20
    v_mul_f32 v95, v95, v20
    v_cvt_pk_bf16_f32 v88, v88, v89
    v_cvt_pk_bf16_f32 v89, v90, v91
    v_cvt_pk_bf16_f32 v90, v92, v93
    v_cvt_pk_bf16_f32 v91, v94, v95
    s_mov_b32 s48, 25600
    buffer_store_dwordx4 v[88:91], v0, s[40:43], s48 offen sc1
    v_accvgpr_read_b32 v72, a48
    v_accvgpr_read_b32 v76, a56
    v_accvgpr_read_b32 v73, a49
    v_accvgpr_read_b32 v77, a57
    v_accvgpr_read_b32 v74, a50
    v_accvgpr_read_b32 v78, a58
    v_accvgpr_read_b32 v75, a51
    v_accvgpr_read_b32 v79, a59
    v_mul_f32 v72, v72, v20
    v_mul_f32 v73, v73, v20
    v_mul_f32 v74, v74, v20
    v_mul_f32 v75, v75, v20
    v_mul_f32 v76, v76, v20
    v_mul_f32 v77, v77, v20
    v_mul_f32 v78, v78, v20
    v_mul_f32 v79, v79, v20
    v_cvt_pk_bf16_f32 v72, v72, v73
    v_cvt_pk_bf16_f32 v73, v74, v75
    v_cvt_pk_bf16_f32 v74, v76, v77
    v_cvt_pk_bf16_f32 v75, v78, v79
    s_mov_b32 s48, 26624
    buffer_store_dwordx4 v[72:75], v0, s[40:43], s48 offen sc1
    v_accvgpr_read_b32 v80, a4
    v_accvgpr_read_b32 v84, a12
    v_accvgpr_read_b32 v81, a5
    v_accvgpr_read_b32 v85, a13
    v_accvgpr_read_b32 v82, a6
    v_accvgpr_read_b32 v86, a14
    v_accvgpr_read_b32 v83, a7
    v_accvgpr_read_b32 v87, a15
    v_mul_f32 v80, v80, v21
    v_mul_f32 v81, v81, v21
    v_mul_f32 v82, v82, v21
    v_mul_f32 v83, v83, v21
    v_mul_f32 v84, v84, v21
    v_mul_f32 v85, v85, v21
    v_mul_f32 v86, v86, v21
    v_mul_f32 v87, v87, v21
    v_cvt_pk_bf16_f32 v80, v80, v81
    v_cvt_pk_bf16_f32 v81, v82, v83
    v_cvt_pk_bf16_f32 v82, v84, v85
    v_cvt_pk_bf16_f32 v83, v86, v87
    s_mov_b32 s48, 31744
    buffer_store_dwordx4 v[80:83], v0, s[40:43], s48 offen sc1
    v_accvgpr_read_b32 v88, a20
    v_accvgpr_read_b32 v92, a28
    v_accvgpr_read_b32 v89, a21
    v_accvgpr_read_b32 v93, a29
    v_accvgpr_read_b32 v90, a22
    v_accvgpr_read_b32 v94, a30
    v_accvgpr_read_b32 v91, a23
    v_accvgpr_read_b32 v95, a31
    v_mul_f32 v88, v88, v21
    v_mul_f32 v89, v89, v21
    v_mul_f32 v90, v90, v21
    v_mul_f32 v91, v91, v21
    v_mul_f32 v92, v92, v21
    v_mul_f32 v93, v93, v21
    v_mul_f32 v94, v94, v21
    v_mul_f32 v95, v95, v21
    v_cvt_pk_bf16_f32 v88, v88, v89
    v_cvt_pk_bf16_f32 v89, v90, v91
    v_cvt_pk_bf16_f32 v90, v92, v93
    v_cvt_pk_bf16_f32 v91, v94, v95
    s_mov_b32 s48, 28672
    buffer_store_dwordx4 v[88:91], v0, s[40:43], s48 offen sc1
    v_accvgpr_read_b32 v72, a36
    v_accvgpr_read_b32 v76, a44
    v_accvgpr_read_b32 v73, a37
    v_accvgpr_read_b32 v77, a45
    v_accvgpr_read_b32 v74, a38
    v_accvgpr_read_b32 v78, a46
    v_accvgpr_read_b32 v75, a39
    v_accvgpr_read_b32 v79, a47
    v_mul_f32 v72, v72, v21
    v_mul_f32 v73, v73, v21
    v_mul_f32 v74, v74, v21
    v_mul_f32 v75, v75, v21
    v_mul_f32 v76, v76, v21
    v_mul_f32 v77, v77, v21
    v_mul_f32 v78, v78, v21
    v_mul_f32 v79, v79, v21
    v_cvt_pk_bf16_f32 v72, v72, v73
    v_cvt_pk_bf16_f32 v73, v74, v75
    v_cvt_pk_bf16_f32 v74, v76, v77
    v_cvt_pk_bf16_f32 v75, v78, v79
    s_mov_b32 s48, 29696
    buffer_store_dwordx4 v[72:75], v0, s[40:43], s48 offen sc1
    v_accvgpr_read_b32 v80, a52
    v_accvgpr_read_b32 v84, a60
    v_accvgpr_read_b32 v81, a53
    v_accvgpr_read_b32 v85, a61
    v_accvgpr_read_b32 v82, a54
    v_accvgpr_read_b32 v86, a62
    v_accvgpr_read_b32 v83, a55
    v_accvgpr_read_b32 v87, a63
    v_mul_f32 v80, v80, v21
    v_mul_f32 v81, v81, v21
    v_mul_f32 v82, v82, v21
    v_mul_f32 v83, v83, v21
    v_mul_f32 v84, v84, v21
    v_mul_f32 v85, v85, v21
    v_mul_f32 v86, v86, v21
    v_mul_f32 v87, v87, v21
    v_cvt_pk_bf16_f32 v80, v80, v81
    v_cvt_pk_bf16_f32 v81, v82, v83
    v_cvt_pk_bf16_f32 v82, v84, v85
    v_cvt_pk_bf16_f32 v83, v86, v87
    s_mov_b32 s48, 30720
    buffer_store_dwordx4 v[80:83], v0, s[40:43], s48 offen sc1
    s_waitcnt lgkmcnt(0)
    s_barrier
    s_cmp_lg_u32 s6, 0
    s_cbranch_scc1 L_h0_3
    s_add_u32 m0, s57, 0
    s_add_u32 s48, s57, 65536
    buffer_load_dwordx4 v16, s[8:11], s48 offen offset:0 nt lds
    buffer_load_dwordx4 v17, s[8:11], s48 offen offset:1024 nt lds
    buffer_load_dwordx4 v16, s[8:11], s48 offen offset:2048 nt lds
    buffer_load_dwordx4 v17, s[8:11], s48 offen offset:3072 nt lds
    s_add_u32 m0, s57, 16384
    s_add_u32 s48, s57, 65536
    buffer_load_dwordx4 v16, s[12:15], s48 offen offset:0 nt lds
    buffer_load_dwordx4 v17, s[12:15], s48 offen offset:1024 nt lds
    buffer_load_dwordx4 v16, s[12:15], s48 offen offset:2048 nt lds
    buffer_load_dwordx4 v17, s[12:15], s48 offen offset:3072 nt lds
L_h0_3:
    ds_read_b32 v24, v12 offset:0
    ds_read_b32 v28, v12 offset:1024
    ds_read_b32 v25, v12 offset:256
    ds_read_b32 v29, v12 offset:1280
    ds_read_b32 v26, v12 offset:512
    ds_read_b32 v30, v12 offset:1536
    ds_read_b32 v27, v12 offset:768
    ds_read_b32 v31, v12 offset:1792
    s_waitcnt lgkmcnt(5)
    v_min_f32 v22, v24, v25
    s_waitcnt lgkmcnt(1)
    v_min3_f32 v22, v22, v26, v27
    v_sub_f32 v24, v22, v24
    v_sub_f32 v25, v22, v25
    v_sub_f32 v26, v22, v26
    v_sub_f32 v27, v22, v27
    v_exp_f32 v24, v24
    v_exp_f32 v25, v25
    v_exp_f32 v26, v26
    v_exp_f32 v27, v27
    s_nop 0
    v_mul_f32 v22, v24, v28
    v_fmac_f32 v22, v25, v29
    v_fmac_f32 v22, v26, v30
    s_waitcnt lgkmcnt(0)
    v_fmac_f32 v22, v27, v31
    v_rcp_f32 v22, v22
    s_nop 0
    v_mul_f32 v22, v22, v27
    v_add_u32 v12, 133120, v0
    v_accvgpr_read_b32 v44, a72
    v_accvgpr_read_b32 v45, a73
    v_accvgpr_read_b32 v46, a74
    v_accvgpr_read_b32 v47, a75
    v_mul_f32 v44, v44, v22
    v_mul_f32 v45, v45, v22
    v_mul_f32 v46, v46, v22
    v_mul_f32 v47, v47, v22
    ds_write_b128 v12, v[44:47] offset:4096
    v_accvgpr_read_b32 v48, a76
    v_accvgpr_read_b32 v49, a77
    v_accvgpr_read_b32 v50, a78
    v_accvgpr_read_b32 v51, a79
    v_mul_f32 v48, v48, v22
    v_mul_f32 v49, v49, v22
    v_mul_f32 v50, v50, v22
    v_mul_f32 v51, v51, v22
    ds_write_b128 v12, v[48:51] offset:5120
    v_accvgpr_read_b32 v36, a80
    v_accvgpr_read_b32 v37, a81
    v_accvgpr_read_b32 v38, a82
    v_accvgpr_read_b32 v39, a83
    v_mul_f32 v36, v36, v22
    v_mul_f32 v37, v37, v22
    v_mul_f32 v38, v38, v22
    v_mul_f32 v39, v39, v22
    ds_write_b128 v12, v[36:39] offset:8192
    v_accvgpr_read_b32 v40, a84
    v_accvgpr_read_b32 v41, a85
    v_accvgpr_read_b32 v42, a86
    v_accvgpr_read_b32 v43, a87
    v_mul_f32 v40, v40, v22
    v_mul_f32 v41, v41, v22
    v_mul_f32 v42, v42, v22
    v_mul_f32 v43, v43, v22
    ds_write_b128 v12, v[40:43] offset:9216
    v_accvgpr_read_b32 v44, a88
    v_accvgpr_read_b32 v45, a89
    v_accvgpr_read_b32 v46, a90
    v_accvgpr_read_b32 v47, a91
    v_mul_f32 v44, v44, v22
    v_mul_f32 v45, v45, v22
    v_mul_f32 v46, v46, v22
    v_mul_f32 v47, v47, v22
    ds_write_b128 v12, v[44:47] offset:12288
    v_accvgpr_read_b32 v48, a92
    v_accvgpr_read_b32 v49, a93
    v_accvgpr_read_b32 v50, a94
    v_accvgpr_read_b32 v51, a95
    v_mul_f32 v48, v48, v22
    v_mul_f32 v49, v49, v22
    v_mul_f32 v50, v50, v22
    v_mul_f32 v51, v51, v22
    ds_write_b128 v12, v[48:51] offset:13312
    v_accvgpr_read_b32 v24, a64
    v_accvgpr_read_b32 v25, a65
    v_accvgpr_read_b32 v26, a66
    v_accvgpr_read_b32 v27, a67
    v_mul_f32 v24, v24, v22
    v_mul_f32 v25, v25, v22
    v_mul_f32 v26, v26, v22
    v_mul_f32 v27, v27, v22
    v_accvgpr_read_b32 v28, a68
    v_accvgpr_read_b32 v29, a69
    v_accvgpr_read_b32 v30, a70
    v_accvgpr_read_b32 v31, a71
    v_mul_f32 v28, v28, v22
    v_mul_f32 v29, v29, v22
    v_mul_f32 v30, v30, v22
    v_mul_f32 v31, v31, v22
    s_waitcnt lgkmcnt(0)
    s_barrier
    ds_read_b128 v[36:39], v12 offset:18432
    ds_read_b128 v[40:43], v12 offset:19456
    ds_read_b128 v[44:47], v12 offset:20480
    ds_read_b128 v[48:51], v12 offset:21504
    ds_read_b128 v[52:55], v12 offset:22528
    ds_read_b128 v[56:59], v12 offset:23552
    s_waitcnt lgkmcnt(3)
    v_add_f32 v36, v36, v44
    s_waitcnt lgkmcnt(1)
    v_add_f32 v24, v24, v52
    v_add_f32 v36, v36, v24
    v_add_f32 v37, v37, v45
    v_add_f32 v25, v25, v53
    v_add_f32 v37, v37, v25
    v_add_f32 v38, v38, v46
    v_add_f32 v26, v26, v54
    v_add_f32 v38, v38, v26
    v_add_f32 v39, v39, v47
    v_add_f32 v27, v27, v55
    v_add_f32 v39, v39, v27
    v_add_f32 v40, v40, v48
    s_waitcnt lgkmcnt(0)
    v_add_f32 v28, v28, v56
    v_add_f32 v40, v40, v28
    v_add_f32 v41, v41, v49
    v_add_f32 v29, v29, v57
    v_add_f32 v41, v41, v29
    v_add_f32 v42, v42, v50
    v_add_f32 v30, v30, v58
    v_add_f32 v42, v42, v30
    v_add_f32 v43, v43, v51
    v_add_f32 v31, v31, v59
    v_add_f32 v43, v43, v31
    v_cvt_pk_bf16_f32 v36, v36, v37
    v_cvt_pk_bf16_f32 v37, v38, v39
    v_cvt_pk_bf16_f32 v38, v40, v41
    v_cvt_pk_bf16_f32 v39, v42, v43
    s_mov_b32 s48, 35840
    buffer_store_dwordx4 v[36:39], v0, s[40:43], s48 offen sc1
    s_cmp_lg_u32 s6, 0
    s_cbranch_scc1 L_h1_3
    s_add_u32 m0, s57, 32768
    s_add_u32 s48, s57, 81920
    buffer_load_dwordx4 v16, s[8:11], s48 offen offset:0 nt lds
    buffer_load_dwordx4 v17, s[8:11], s48 offen offset:1024 nt lds
    buffer_load_dwordx4 v16, s[8:11], s48 offen offset:2048 nt lds
    buffer_load_dwordx4 v17, s[8:11], s48 offen offset:3072 nt lds
    s_add_u32 m0, s57, 49152
    s_add_u32 s48, s57, 81920
    buffer_load_dwordx4 v16, s[12:15], s48 offen offset:0 nt lds
    buffer_load_dwordx4 v17, s[12:15], s48 offen offset:1024 nt lds
    buffer_load_dwordx4 v16, s[12:15], s48 offen offset:2048 nt lds
    buffer_load_dwordx4 v17, s[12:15], s48 offen offset:3072 nt lds
L_h1_3:
    s_cmp_lg_u32 s6, 0
    s_cbranch_scc1 L_e3a_3
    s_waitcnt vmcnt(8)
    s_branch L_e3b_3
L_e3a_3:
    s_waitcnt vmcnt(0)
L_e3b_3:
    s_barrier
    s_branch L_fin
L_fin:
    s_add_u32 s48, s6, 1
    s_mov_b32 s39, s48
    s_cmp_lg_u32 s3, 0
    s_cbranch_scc1 L_pub1
    s_and_b32 s48, s2, 7
    s_lshl_b32 s48, s48, 5
    s_lshr_b32 s49, s2, 3
    s_add_u32 s48, s48, s49
    v_mov_b32 v2, s48
    v_mov_b32 v3, s39
    s_mov_b64 exec, 1
    global_store_byte v2, v3, s[22:23] sc1
    s_mov_b64 exec, -1
L_pub1:
    s_cmp_lg_u32 s6, 0
    s_cbranch_scc1 L_g1fin
    s_add_u32 m0, s57, 65536
    s_add_u32 s48, s57, 98304
    buffer_load_dwordx4 v16, s[8:11], s48 offen offset:0 nt lds
    buffer_load_dwordx4 v17, s[8:11], s48 offen offset:1024 nt lds
    buffer_load_dwordx4 v16, s[8:11], s48 offen offset:2048 nt lds
    buffer_load_dwordx4 v17, s[8:11], s48 offen offset:3072 nt lds
    s_add_u32 m0, s57, 81920
    s_add_u32 s48, s57, 98304
    buffer_load_dwordx4 v16, s[12:15], s48 offen offset:0 nt lds
    buffer_load_dwordx4 v17, s[12:15], s48 offen offset:1024 nt lds
    buffer_load_dwordx4 v16, s[12:15], s48 offen offset:2048 nt lds
    buffer_load_dwordx4 v17, s[12:15], s48 offen offset:3072 nt lds
    s_and_b32 s84, s2, 7
    s_lshr_b32 s60, s2, 3
    s_lshr_b32 s62, s84, 2
    s_add_u32 s61, s84, 0
    s_and_b32 s61, s61, 3
    s_load_dwordx2 s[16:17], s[0:1], 32
    s_load_dwordx2 s[18:19], s[0:1], 72
    s_mul_i32 s63, s60, 52
    s_lshr_b32 s63, s63, 8
    s_mul_i32 s64, s63, 5
    s_sub_u32 s64, s60, s64
    s_waitcnt lgkmcnt(0)
    s_cmp_eq_u32 s62, 0
    s_cselect_b32 s16, s16, s18
    s_cselect_b32 s17, s17, s19
    s_mul_i32 s84, s61, 1310720
    s_lshl_b32 s85, s64, 8
    s_add_u32 s84, s84, s85
    s_add_u32 s24, s16, s84
    s_addc_u32 s25, s17, 0
    s_sub_u32 s26, 5242880, s84
    s_mov_b32 s27, 0x20000
    s_mov_b32 s28, s4
    s_mov_b32 s29, s5
    s_mov_b32 s30, 18874368
    s_mov_b32 s31, 0x20000
    s_mul_i32 s84, s63, 12
    s_mul_i32 s85, s3, 3
    s_add_u32 s84, s84, s85
    s_add_u32 s85, s84, 0
    s_mul_i32 s86, s85, 57
    s_lshr_b32 s86, s86, 9
    s_mul_i32 s87, s86, 9
    s_sub_u32 s87, s85, s87
    s_lshl_b32 s88, s62, 3
    s_add_u32 s88, s88, s86
    s_lshl_b32 s88, s88, 5
    s_lshl_b32 s89, s61, 3
    s_add_u32 s88, s88, s89
    s_mul_i32 s88, s88, 36864
    s_lshl_b32 s87, s87, 12
    s_add_u32 s96, s88, s87
    s_add_u32 s85, s84, 1
    s_mul_i32 s86, s85, 57
    s_lshr_b32 s86, s86, 9
    s_mul_i32 s87, s86, 9
    s_sub_u32 s87, s85, s87
    s_lshl_b32 s88, s62, 3
    s_add_u32 s88, s88, s86
    s_lshl_b32 s88, s88, 5
    s_lshl_b32 s89, s61, 3
    s_add_u32 s88, s88, s89
    s_mul_i32 s88, s88, 36864
    s_lshl_b32 s87, s87, 12
    s_add_u32 s97, s88, s87
    s_add_u32 s85, s84, 2
    s_mul_i32 s86, s85, 57
    s_lshr_b32 s86, s86, 9
    s_mul_i32 s87, s86, 9
    s_sub_u32 s87, s85, s87
    s_lshl_b32 s88, s62, 3
    s_add_u32 s88, s88, s86
    s_lshl_b32 s88, s88, 5
    s_lshl_b32 s89, s61, 3
    s_add_u32 s88, s88, s89
    s_mul_i32 s88, s88, 36864
    s_lshl_b32 s87, s87, 12
    s_add_u32 s98, s88, s87
    s_mul_i32 s59, s7, 10240
    s_mul_i32 s99, s63, 3
    s_add_u32 s99, s99, s64
    s_and_b32 s99, s99, 7
    s_waitcnt vmcnt(16)
    s_barrier
    s_cmp_ge_u32 s60, 30
    s_cbranch_scc1 L_nopf1
    s_lshl_b32 s85, s64, 8
    s_sub_u32 s16, s24, s85
    s_subb_u32 s17, s25, 0
    s_mov_b32 s18, 1310720
    s_mov_b32 s19, 0x20000
    s_mul_i32 s84, s60, 44032
    s_mul_i32 s85, s3, 11008
    s_add_u32 s84, s84, s85
    v_lshlrev_b32 v2, 7, v1
    buffer_load_dword a158, v2, s[16:19], s84 offen
    s_add_u32 s84, s84, 8192
    v_cmp_gt_u32 vcc, 22, v1
    s_and_saveexec_b64 s[92:93], vcc
    buffer_load_dword a158, v2, s[16:19], s84 offen
    s_mov_b64 exec, s[92:93]
L_nopf1:
    s_add_u32 m0, s57, 98304
    s_add_u32 s48, s57, 114688
    buffer_load_dwordx4 v16, s[8:11], s48 offen offset:0 nt lds
    buffer_load_dwordx4 v17, s[8:11], s48 offen offset:1024 nt lds
    buffer_load_dwordx4 v16, s[8:11], s48 offen offset:2048 nt lds
    buffer_load_dwordx4 v17, s[8:11], s48 offen offset:3072 nt lds
    s_add_u32 m0, s57, 114688
    s_add_u32 s48, s57, 114688
    buffer_load_dwordx4 v16, s[12:15], s48 offen offset:0 nt lds
    buffer_load_dwordx4 v17, s[12:15], s48 offen offset:1024 nt lds
    buffer_load_dwordx4 v16, s[12:15], s48 offen offset:2048 nt lds
    buffer_load_dwordx4 v17, s[12:15], s48 offen offset:3072 nt lds
    s_waitcnt vmcnt(16)
    s_barrier
    s_waitcnt vmcnt(8)
    s_barrier
    s_cmp_ge_u32 s60, 30
    s_cbranch_scc1 L_nopf2
    s_mov_b32 s51, 1
    s_cmp_lg_u32 s3, 0
    s_cbranch_scc1 L_pg0_skip
    s_and_b32 s48, s2, 7
    s_lshl_b32 s48, s48, 5
    v_and_b32 v2, 31, v1
    v_add_u32 v2, s48, v2
    s_mov_b32 s69, 0
L_pg0_poll:
    global_load_ubyte v3, v2, s[22:23] sc1
    s_add_u32 s69, s69, 1
    s_waitcnt vmcnt(0)
    v_cmp_gt_u32 vcc, s51, v3
    s_cmp_ge_u32 s69, 131072
    s_cbranch_scc1 L_pg0_skip
    s_nop 2
    s_cbranch_vccz L_pg0_skip
    s_sleep 2
    s_branch L_pg0_poll
L_pg0_skip:
L_nopf2:
    s_waitcnt vmcnt(0)
    s_barrier
    s_cmp_ge_u32 s60, 30
    s_cbranch_scc1 L_noop0
    v_and_b32 v20, 15, v1
    v_lshrrev_b32 v21, 4, v1
    v_lshlrev_b32 v3, 1, v21
    v_xor_b32 v3, v20, v3
    v_lshlrev_b32 v3, 4, v3
    v_mul_u32_u24 v2, 1280, v21
    v_add_u32 v20, v2, v3
    v_xor_b32 v21, 128, v20
    v_lshlrev_b32 v0, 4, v1
    s_add_u32 s84, s45, 16384
    s_sub_u32 s58, 0, s84
    v_add_u32 v4, s58, v4
    v_add_u32 v5, s58, v5
    v_add_u32 v6, s58, v6
    v_add_u32 v7, s58, v7
    v_add_u32 v8, s58, v8
    v_add_u32 v9, s58, v9
    v_add_u32 v10, s58, v10
    v_add_u32 v11, s58, v11
    v_add_u32 v12, 0x10000, v4
    v_add_u32 v13, 0x10000, v5
    v_add_u32 v14, 0x10000, v6
    v_add_u32 v15, 0x10000, v7
    v_add_u32 v16, 0x10000, v8
    v_add_u32 v17, 0x10000, v9
    v_add_u32 v18, 0x10000, v10
    v_add_u32 v19, 0x10000, v11
    s_mov_b32 s51, s99
    s_lshr_b32 s52, s51, 1
    s_mul_i32 s52, s52, 36864
    s_and_b32 s48, s51, 1
    s_lshl_b32 s48, s48, 11
    s_add_u32 s52, s52, s48
    s_add_u32 s51, s51, 1
    s_and_b32 s51, s51, 7
    s_add_u32 s48, s96, s52
    buffer_load_dwordx4 a[96:99], v0, s[28:31], s48 offen offset:0 sc1
    s_add_u32 s48, s97, s52
    buffer_load_dwordx4 a[100:103], v0, s[28:31], s48 offen offset:0 sc1
    s_add_u32 s48, s96, s52
    buffer_load_dwordx4 a[108:111], v0, s[28:31], s48 offen offset:1024 sc1
    s_add_u32 s48, s97, s52
    buffer_load_dwordx4 a[112:115], v0, s[28:31], s48 offen offset:1024 sc1
    s_lshr_b32 s52, s51, 1
    s_mul_i32 s52, s52, 36864
    s_and_b32 s48, s51, 1
    s_lshl_b32 s48, s48, 11
    s_add_u32 s52, s52, s48
    s_add_u32 s51, s51, 1
    s_and_b32 s51, s51, 7
    s_add_u32 s48, s96, s52
    buffer_load_dwordx4 a[120:123], v0, s[28:31], s48 offen offset:0 sc1
    s_add_u32 s48, s97, s52
    buffer_load_dwordx4 a[124:127], v0, s[28:31], s48 offen offset:0 sc1
    s_add_u32 s48, s96, s52
    buffer_load_dwordx4 a[132:135], v0, s[28:31], s48 offen offset:1024 sc1
    s_add_u32 s48, s97, s52
    buffer_load_dwordx4 a[136:139], v0, s[28:31], s48 offen offset:1024 sc1
    s_lshr_b32 s52, s51, 1
    s_mul_i32 s52, s52, 36864
    s_and_b32 s48, s51, 1
    s_lshl_b32 s48, s48, 11
    s_add_u32 s52, s52, s48
    s_add_u32 s51, s51, 1
    s_and_b32 s51, s51, 7
    s_add_u32 s48, s96, s52
    buffer_load_dwordx4 v[24:27], v0, s[28:31], s48 offen offset:0 sc1
    s_add_u32 s48, s97, s52
    buffer_load_dwordx4 v[28:31], v0, s[28:31], s48 offen offset:0 sc1
    s_add_u32 s48, s96, s52
    buffer_load_dwordx4 v[36:39], v0, s[28:31], s48 offen offset:1024 sc1
    s_add_u32 s48, s97, s52
    buffer_load_dwordx4 v[40:43], v0, s[28:31], s48 offen offset:1024 sc1
    s_lshr_b32 s52, s51, 1
    s_mul_i32 s52, s52, 36864
    s_and_b32 s48, s51, 1
    s_lshl_b32 s48, s48, 11
    s_add_u32 s52, s52, s48
    s_add_u32 s51, s51, 1
    s_and_b32 s51, s51, 7
    s_add_u32 s48, s96, s52
    buffer_load_dwordx4 v[48:51], v0, s[28:31], s48 offen offset:0 sc1
    s_add_u32 s48, s97, s52
    buffer_load_dwordx4 v[52:55], v0, s[28:31], s48 offen offset:0 sc1
    s_add_u32 s48, s96, s52
    buffer_load_dwordx4 v[60:63], v0, s[28:31], s48 offen offset:1024 sc1
    s_add_u32 s48, s97, s52
    buffer_load_dwordx4 v[64:67], v0, s[28:31], s48 offen offset:1024 sc1
    s_barrier
    s_branch L_g0op
L_noop0:
    s_barrier
    s_branch L_noop
L_g1fin:
    s_cmp_ge_u32 s60, 30
    s_cbranch_scc1 L_noop
    v_and_b32 v20, 15, v1
    v_lshrrev_b32 v21, 4, v1
    v_lshlrev_b32 v3, 1, v21
    v_xor_b32 v3, v20, v3
    v_lshlrev_b32 v3, 4, v3
    v_mul_u32_u24 v2, 1280, v21
    v_add_u32 v20, v2, v3
    v_xor_b32 v21, 128, v20
    v_lshlrev_b32 v0, 4, v1
    s_add_u32 s84, s45, 16384
    s_sub_u32 s58, 0, s84
    v_add_u32 v4, s58, v4
    v_add_u32 v5, s58, v5
    v_add_u32 v6, s58, v6
    v_add_u32 v7, s58, v7
    v_add_u32 v8, s58, v8
    v_add_u32 v9, s58, v9
    v_add_u32 v10, s58, v10
    v_add_u32 v11, s58, v11
    v_add_u32 v12, 0x10000, v4
    v_add_u32 v13, 0x10000, v5
    v_add_u32 v14, 0x10000, v6
    v_add_u32 v15, 0x10000, v7
    v_add_u32 v16, 0x10000, v8
    v_add_u32 v17, 0x10000, v9
    v_add_u32 v18, 0x10000, v10
    v_add_u32 v19, 0x10000, v11
    s_branch L_g1op
L_g0op:
    s_sub_u32 s47, s99, 1
    s_add_u32 s47, s47, 1
    s_and_b32 s47, s47, 7
    s_mul_i32 s66, s47, 81920
    s_add_u32 s66, s66, 0
    s_mov_b32 s67, 0
    s_add_u32 s49, s67, s57
    s_mul_i32 s48, s3, 20480
    s_add_u32 s66, s66, s48
    s_add_u32 m0, s49, 0
    s_add_u32 s48, s66, 0
    buffer_load_dwordx4 v20, s[24:27], s48 offen lds
    s_add_u32 m0, s49, 1024
    s_add_u32 s48, s66, 5120
    buffer_load_dwordx4 v21, s[24:27], s48 offen lds
    s_add_u32 m0, s49, 2048
    s_add_u32 s48, s66, 10240
    buffer_load_dwordx4 v20, s[24:27], s48 offen lds
    s_add_u32 m0, s49, 3072
    s_add_u32 s48, s66, 15360
    buffer_load_dwordx4 v21, s[24:27], s48 offen lds
    s_add_u32 s47, s47, 1
    s_and_b32 s47, s47, 7
    s_mul_i32 s66, s47, 81920
    s_add_u32 s66, s66, 0
    s_mov_b32 s67, 16384
    s_add_u32 s49, s67, s57
    s_mul_i32 s48, s3, 20480
    s_add_u32 s66, s66, s48
    s_add_u32 m0, s49, 0
    s_add_u32 s48, s66, 0
    buffer_load_dwordx4 v20, s[24:27], s48 offen lds
    s_add_u32 m0, s49, 1024
    s_add_u32 s48, s66, 5120
    buffer_load_dwordx4 v21, s[24:27], s48 offen lds
    s_add_u32 m0, s49, 2048
    s_add_u32 s48, s66, 10240
    buffer_load_dwordx4 v20, s[24:27], s48 offen lds
    s_add_u32 m0, s49, 3072
    s_add_u32 s48, s66, 15360
    buffer_load_dwordx4 v21, s[24:27], s48 offen lds
    s_add_u32 s47, s47, 1
    s_and_b32 s47, s47, 7
    s_mul_i32 s66, s47, 81920
    s_add_u32 s66, s66, 0
    s_mov_b32 s67, 32768
    s_add_u32 s49, s67, s57
    s_mul_i32 s48, s3, 20480
    s_add_u32 s66, s66, s48
    s_add_u32 m0, s49, 0
    s_add_u32 s48, s66, 0
    buffer_load_dwordx4 v20, s[24:27], s48 offen lds
    s_add_u32 m0, s49, 1024
    s_add_u32 s48, s66, 5120
    buffer_load_dwordx4 v21, s[24:27], s48 offen lds
    s_add_u32 m0, s49, 2048
    s_add_u32 s48, s66, 10240
    buffer_load_dwordx4 v20, s[24:27], s48 offen lds
    s_add_u32 m0, s49, 3072
    s_add_u32 s48, s66, 15360
    buffer_load_dwordx4 v21, s[24:27], s48 offen lds
    s_barrier
    s_add_u32 s47, s47, 1
    s_and_b32 s47, s47, 7
    s_mul_i32 s66, s47, 81920
    s_add_u32 s66, s66, 0
    s_mov_b32 s67, 49152
    s_add_u32 s49, s67, s57
    s_mul_i32 s48, s3, 20480
    s_add_u32 s66, s66, s48
    s_add_u32 m0, s49, 0
    s_add_u32 s48, s66, 0
    buffer_load_dwordx4 v20, s[24:27], s48 offen lds
    s_add_u32 m0, s49, 1024
    s_add_u32 s48, s66, 5120
    buffer_load_dwordx4 v21, s[24:27], s48 offen lds
    s_add_u32 m0, s49, 2048
    s_add_u32 s48, s66, 10240
    buffer_load_dwordx4 v20, s[24:27], s48 offen lds
    s_add_u32 m0, s49, 3072
    s_add_u32 s48, s66, 15360
    buffer_load_dwordx4 v21, s[24:27], s48 offen lds
    s_add_u32 s47, s47, 1
    s_and_b32 s47, s47, 7
    s_mul_i32 s66, s47, 81920
    s_add_u32 s66, s66, 0
    s_mov_b32 s67, 65536
    s_add_u32 s49, s67, s57
    s_mul_i32 s48, s3, 20480
    s_add_u32 s66, s66, s48
    s_add_u32 m0, s49, 0
    s_add_u32 s48, s66, 0
    buffer_load_dwordx4 v20, s[24:27], s48 offen lds
    s_add_u32 m0, s49, 1024
    s_add_u32 s48, s66, 5120
    buffer_load_dwordx4 v21, s[24:27], s48 offen lds
    s_add_u32 m0, s49, 2048
    s_add_u32 s48, s66, 10240
    buffer_load_dwordx4 v20, s[24:27], s48 offen lds
    s_add_u32 m0, s49, 3072
    s_add_u32 s48, s66, 15360
    buffer_load_dwordx4 v21, s[24:27], s48 offen lds
    s_add_u32 s47, s47, 1
    s_and_b32 s47, s47, 7
    s_mul_i32 s66, s47, 81920
    s_add_u32 s66, s66, 0
    s_mov_b32 s67, 81920
    s_add_u32 s49, s67, s57
    s_mul_i32 s48, s3, 20480
    s_add_u32 s66, s66, s48
    s_add_u32 m0, s49, 0
    s_add_u32 s48, s66, 0
    buffer_load_dwordx4 v20, s[24:27], s48 offen lds
    s_add_u32 m0, s49, 1024
    s_add_u32 s48, s66, 5120
    buffer_load_dwordx4 v21, s[24:27], s48 offen lds
    s_add_u32 m0, s49, 2048
    s_add_u32 s48, s66, 10240
    buffer_load_dwordx4 v20, s[24:27], s48 offen lds
    s_add_u32 m0, s49, 3072
    s_add_u32 s48, s66, 15360
    buffer_load_dwordx4 v21, s[24:27], s48 offen lds
    s_barrier
    s_add_u32 s47, s47, 1
    s_and_b32 s47, s47, 7
    s_mul_i32 s66, s47, 81920
    s_add_u32 s66, s66, 0
    s_mov_b32 s67, 98304
    s_add_u32 s49, s67, s57
    s_mul_i32 s48, s3, 20480
    s_add_u32 s66, s66, s48
    s_add_u32 m0, s49, 0
    s_add_u32 s48, s66, 0
    buffer_load_dwordx4 v20, s[24:27], s48 offen lds
    s_add_u32 m0, s49, 1024
    s_add_u32 s48, s66, 5120
    buffer_load_dwordx4 v21, s[24:27], s48 offen lds
    s_add_u32 m0, s49, 2048
    s_add_u32 s48, s66, 10240
    buffer_load_dwordx4 v20, s[24:27], s48 offen lds
    s_add_u32 m0, s49, 3072
    s_add_u32 s48, s66, 15360
    buffer_load_dwordx4 v21, s[24:27], s48 offen lds
    s_add_u32 s47, s47, 1
    s_and_b32 s47, s47, 7
    s_mul_i32 s66, s47, 81920
    s_add_u32 s66, s66, 0
    s_mov_b32 s67, 114688
    s_add_u32 s49, s67, s57
    s_mul_i32 s48, s3, 20480
    s_add_u32 s66, s66, s48
    s_add_u32 m0, s49, 0
    s_add_u32 s48, s66, 0
    buffer_load_dwordx4 v20, s[24:27], s48 offen lds
    s_add_u32 m0, s49, 1024
    s_add_u32 s48, s66, 5120
    buffer_load_dwordx4 v21, s[24:27], s48 offen lds
    s_add_u32 m0, s49, 2048
    s_add_u32 s48, s66, 10240
    buffer_load_dwordx4 v20, s[24:27], s48 offen lds
    s_add_u32 m0, s49, 3072
    s_add_u32 s48, s66, 15360
    buffer_load_dwordx4 v21, s[24:27], s48 offen lds
    s_waitcnt vmcnt(0)
    s_barrier
    ds_read_b64_tr_b16 v[72:73], v4 offset:0
    ds_read_b64_tr_b16 v[74:75], v4 offset:4096
    ds_read_b64_tr_b16 v[76:77], v5 offset:0
    ds_read_b64_tr_b16 v[78:79], v5 offset:4096
    ds_read_b64_tr_b16 v[80:81], v6 offset:0
    ds_read_b64_tr_b16 v[82:83], v6 offset:4096
    s_waitcnt lgkmcnt(4)
    v_mfma_f32_16x16x32_bf16 a[0:3], v[72:75], a[96:99], 0
    ds_read_b64_tr_b16 v[84:85], v7 offset:0
    ds_read_b64_tr_b16 v[86:87], v7 offset:4096
    v_mfma_f32_16x16x32_bf16 a[32:35], v[72:75], a[100:103], 0
    ds_read_b64_tr_b16 v[88:89], v8 offset:0
    ds_read_b64_tr_b16 v[90:91], v8 offset:4096
    s_waitcnt lgkmcnt(6)
    v_mfma_f32_16x16x32_bf16 a[4:7], v[76:79], a[96:99], 0
    ds_read_b64_tr_b16 v[92:93], v9 offset:0
    ds_read_b64_tr_b16 v[94:95], v9 offset:4096
    v_mfma_f32_16x16x32_bf16 a[36:39], v[76:79], a[100:103], 0
    s_waitcnt lgkmcnt(6)
    v_mfma_f32_16x16x32_bf16 a[8:11], v[80:83], a[96:99], 0
    ds_read_b64_tr_b16 v[72:73], v10 offset:0
    ds_read_b64_tr_b16 v[74:75], v10 offset:4096
    v_mfma_f32_16x16x32_bf16 a[40:43], v[80:83], a[100:103], 0
    s_waitcnt lgkmcnt(6)
    v_mfma_f32_16x16x32_bf16 a[12:15], v[84:87], a[96:99], 0
    ds_read_b64_tr_b16 v[76:77], v11 offset:0
    ds_read_b64_tr_b16 v[78:79], v11 offset:4096
    v_mfma_f32_16x16x32_bf16 a[44:47], v[84:87], a[100:103], 0
    s_waitcnt lgkmcnt(6)
    v_mfma_f32_16x16x32_bf16 a[16:19], v[88:91], a[96:99], 0
    ds_read_b64_tr_b16 v[80:81], v4 offset:8192
    ds_read_b64_tr_b16 v[82:83], v4 offset:12288
    v_mfma_f32_16x16x32_bf16 a[48:51], v[88:91], a[100:103], 0
    s_waitcnt lgkmcnt(6)
    v_mfma_f32_16x16x32_bf16 a[20:23], v[92:95], a[96:99], 0
    ds_read_b64_tr_b16 v[84:85], v5 offset:8192
    ds_read_b64_tr_b16 v[86:87], v5 offset:12288
    v_mfma_f32_16x16x32_bf16 a[52:55], v[92:95], a[100:103], 0
    s_waitcnt lgkmcnt(6)
    v_mfma_f32_16x16x32_bf16 a[24:27], v[72:75], a[96:99], 0
    ds_read_b64_tr_b16 v[88:89], v6 offset:8192
    ds_read_b64_tr_b16 v[90:91], v6 offset:12288
    v_mfma_f32_16x16x32_bf16 a[56:59], v[72:75], a[100:103], 0
    s_waitcnt lgkmcnt(6)
    v_mfma_f32_16x16x32_bf16 a[28:31], v[76:79], a[96:99], 0
    ds_read_b64_tr_b16 v[92:93], v7 offset:8192
    ds_read_b64_tr_b16 v[94:95], v7 offset:12288
    v_mfma_f32_16x16x32_bf16 a[60:63], v[76:79], a[100:103], 0
    s_waitcnt lgkmcnt(6)
    v_mfma_f32_16x16x32_bf16 a[0:3], v[80:83], a[108:111], a[0:3]
    ds_read_b64_tr_b16 v[72:73], v8 offset:8192
    ds_read_b64_tr_b16 v[74:75], v8 offset:12288
    v_mfma_f32_16x16x32_bf16 a[32:35], v[80:83], a[112:115], a[32:35]
    s_waitcnt lgkmcnt(6)
    v_mfma_f32_16x16x32_bf16 a[4:7], v[84:87], a[108:111], a[4:7]
    ds_read_b64_tr_b16 v[76:77], v9 offset:8192
    ds_read_b64_tr_b16 v[78:79], v9 offset:12288
    v_mfma_f32_16x16x32_bf16 a[36:39], v[84:87], a[112:115], a[36:39]
    s_waitcnt lgkmcnt(6)
    v_mfma_f32_16x16x32_bf16 a[8:11], v[88:91], a[108:111], a[8:11]
    ds_read_b64_tr_b16 v[80:81], v10 offset:8192
    ds_read_b64_tr_b16 v[82:83], v10 offset:12288
    v_mfma_f32_16x16x32_bf16 a[40:43], v[88:91], a[112:115], a[40:43]
    s_waitcnt lgkmcnt(6)
    v_mfma_f32_16x16x32_bf16 a[12:15], v[92:95], a[108:111], a[12:15]
    ds_read_b64_tr_b16 v[84:85], v11 offset:8192
    ds_read_b64_tr_b16 v[86:87], v11 offset:12288
    v_mfma_f32_16x16x32_bf16 a[44:47], v[92:95], a[112:115], a[44:47]
    s_waitcnt lgkmcnt(6)
    v_mfma_f32_16x16x32_bf16 a[16:19], v[72:75], a[108:111], a[16:19]
    ds_read_b64_tr_b16 v[88:89], v4 offset:16384
    ds_read_b64_tr_b16 v[90:91], v4 offset:20480
    v_mfma_f32_16x16x32_bf16 a[48:51], v[72:75], a[112:115], a[48:51]
    s_waitcnt lgkmcnt(6)
    v_mfma_f32_16x16x32_bf16 a[20:23], v[76:79], a[108:111], a[20:23]
    ds_read_b64_tr_b16 v[92:93], v5 offset:16384
    ds_read_b64_tr_b16 v[94:95], v5 offset:20480
    v_mfma_f32_16x16x32_bf16 a[52:55], v[76:79], a[112:115], a[52:55]
    s_waitcnt lgkmcnt(6)
    v_mfma_f32_16x16x32_bf16 a[24:27], v[80:83], a[108:111], a[24:27]
    ds_read_b64_tr_b16 v[72:73], v6 offset:16384
    ds_read_b64_tr_b16 v[74:75], v6 offset:20480
    v_mfma_f32_16x16x32_bf16 a[56:59], v[80:83], a[112:115], a[56:59]
    s_waitcnt lgkmcnt(6)
    v_mfma_f32_16x16x32_bf16 a[28:31], v[84:87], a[108:111], a[28:31]
    ds_read_b64_tr_b16 v[76:77], v7 offset:16384
    ds_read_b64_tr_b16 v[78:79], v7 offset:20480
    v_mfma_f32_16x16x32_bf16 a[60:63], v[84:87], a[112:115], a[60:63]
    s_lshr_b32 s52, s51, 1
    s_mul_i32 s52, s52, 36864
    s_and_b32 s48, s51, 1
    s_lshl_b32 s48, s48, 11
    s_add_u32 s52, s52, s48
    s_add_u32 s51, s51, 1
    s_and_b32 s51, s51, 7
    s_add_u32 s48, s96, s52
    buffer_load_dwordx4 a[96:99], v0, s[28:31], s48 offen offset:0 sc1
    s_add_u32 s48, s97, s52
    buffer_load_dwordx4 a[100:103], v0, s[28:31], s48 offen offset:0 sc1
    s_add_u32 s48, s96, s52
    buffer_load_dwordx4 a[108:111], v0, s[28:31], s48 offen offset:1024 sc1
    s_add_u32 s48, s97, s52
    buffer_load_dwordx4 a[112:115], v0, s[28:31], s48 offen offset:1024 sc1
    s_waitcnt lgkmcnt(6)
    v_mfma_f32_16x16x32_bf16 a[0:3], v[88:91], a[120:123], a[0:3]
    ds_read_b64_tr_b16 v[80:81], v8 offset:16384
    ds_read_b64_tr_b16 v[82:83], v8 offset:20480
    v_mfma_f32_16x16x32_bf16 a[32:35], v[88:91], a[124:127], a[32:35]
    s_waitcnt lgkmcnt(6)
    v_mfma_f32_16x16x32_bf16 a[4:7], v[92:95], a[120:123], a[4:7]
    ds_read_b64_tr_b16 v[84:85], v9 offset:16384
    ds_read_b64_tr_b16 v[86:87], v9 offset:20480
    v_mfma_f32_16x16x32_bf16 a[36:39], v[92:95], a[124:127], a[36:39]
    s_waitcnt lgkmcnt(6)
    v_mfma_f32_16x16x32_bf16 a[8:11], v[72:75], a[120:123], a[8:11]
    ds_read_b64_tr_b16 v[88:89], v10 offset:16384
    ds_read_b64_tr_b16 v[90:91], v10 offset:20480
    v_mfma_f32_16x16x32_bf16 a[40:43], v[72:75], a[124:127], a[40:43]
    s_waitcnt lgkmcnt(6)
    v_mfma_f32_16x16x32_bf16 a[12:15], v[76:79], a[120:123], a[12:15]
    ds_read_b64_tr_b16 v[92:93], v11 offset:16384
    ds_read_b64_tr_b16 v[94:95], v11 offset:20480
    v_mfma_f32_16x16x32_bf16 a[44:47], v[76:79], a[124:127], a[44:47]
    s_waitcnt lgkmcnt(6)
    v_mfma_f32_16x16x32_bf16 a[16:19], v[80:83], a[120:123], a[16:19]
    ds_read_b64_tr_b16 v[72:73], v4 offset:24576
    ds_read_b64_tr_b16 v[74:75], v4 offset:28672
    v_mfma_f32_16x16x32_bf16 a[48:51], v[80:83], a[124:127], a[48:51]
    s_waitcnt lgkmcnt(6)
    v_mfma_f32_16x16x32_bf16 a[20:23], v[84:87], a[120:123], a[20:23]
    ds_read_b64_tr_b16 v[76:77], v5 offset:24576
    ds_read_b64_tr_b16 v[78:79], v5 offset:28672
    v_mfma_f32_16x16x32_bf16 a[52:55], v[84:87], a[124:127], a[52:55]
    s_waitcnt lgkmcnt(6)
    v_mfma_f32_16x16x32_bf16 a[24:27], v[88:91], a[120:123], a[24:27]
    ds_read_b64_tr_b16 v[80:81], v6 offset:24576
    ds_read_b64_tr_b16 v[82:83], v6 offset:28672
    v_mfma_f32_16x16x32_bf16 a[56:59], v[88:91], a[124:127], a[56:59]
    s_waitcnt lgkmcnt(6)
    v_mfma_f32_16x16x32_bf16 a[28:31], v[92:95], a[120:123], a[28:31]
    ds_read_b64_tr_b16 v[84:85], v7 offset:24576
    ds_read_b64_tr_b16 v[86:87], v7 offset:28672
    v_mfma_f32_16x16x32_bf16 a[60:63], v[92:95], a[124:127], a[60:63]
    s_waitcnt lgkmcnt(6)
    v_mfma_f32_16x16x32_bf16 a[0:3], v[72:75], a[132:135], a[0:3]
    ds_read_b64_tr_b16 v[88:89], v8 offset:24576
    ds_read_b64_tr_b16 v[90:91], v8 offset:28672
    v_mfma_f32_16x16x32_bf16 a[32:35], v[72:75], a[136:139], a[32:35]
    s_waitcnt lgkmcnt(6)
    v_mfma_f32_16x16x32_bf16 a[4:7], v[76:79], a[132:135], a[4:7]
    ds_read_b64_tr_b16 v[92:93], v9 offset:24576
    ds_read_b64_tr_b16 v[94:95], v9 offset:28672
    v_mfma_f32_16x16x32_bf16 a[36:39], v[76:79], a[136:139], a[36:39]
    s_waitcnt lgkmcnt(6)
    v_mfma_f32_16x16x32_bf16 a[8:11], v[80:83], a[132:135], a[8:11]
    ds_read_b64_tr_b16 v[72:73], v10 offset:24576
    ds_read_b64_tr_b16 v[74:75], v10 offset:28672
    v_mfma_f32_16x16x32_bf16 a[40:43], v[80:83], a[136:139], a[40:43]
    s_waitcnt lgkmcnt(6)
    v_mfma_f32_16x16x32_bf16 a[12:15], v[84:87], a[132:135], a[12:15]
    ds_read_b64_tr_b16 v[76:77], v11 offset:24576
    ds_read_b64_tr_b16 v[78:79], v11 offset:28672
    v_mfma_f32_16x16x32_bf16 a[44:47], v[84:87], a[136:139], a[44:47]
    s_waitcnt lgkmcnt(6)
    v_mfma_f32_16x16x32_bf16 a[16:19], v[88:91], a[132:135], a[16:19]
    ds_read_b64_tr_b16 v[80:81], v4 offset:32768
    ds_read_b64_tr_b16 v[82:83], v4 offset:36864
    v_mfma_f32_16x16x32_bf16 a[48:51], v[88:91], a[136:139], a[48:51]
    s_waitcnt lgkmcnt(6)
    v_mfma_f32_16x16x32_bf16 a[20:23], v[92:95], a[132:135], a[20:23]
    ds_read_b64_tr_b16 v[84:85], v5 offset:32768
    ds_read_b64_tr_b16 v[86:87], v5 offset:36864
    v_mfma_f32_16x16x32_bf16 a[52:55], v[92:95], a[136:139], a[52:55]
    s_waitcnt lgkmcnt(6)
    v_mfma_f32_16x16x32_bf16 a[24:27], v[72:75], a[132:135], a[24:27]
    ds_read_b64_tr_b16 v[88:89], v6 offset:32768
    ds_read_b64_tr_b16 v[90:91], v6 offset:36864
    v_mfma_f32_16x16x32_bf16 a[56:59], v[72:75], a[136:139], a[56:59]
    s_waitcnt lgkmcnt(6)
    v_mfma_f32_16x16x32_bf16 a[28:31], v[76:79], a[132:135], a[28:31]
    ds_read_b64_tr_b16 v[92:93], v7 offset:32768
    ds_read_b64_tr_b16 v[94:95], v7 offset:36864
    v_mfma_f32_16x16x32_bf16 a[60:63], v[76:79], a[136:139], a[60:63]
    s_lshr_b32 s52, s51, 1
    s_mul_i32 s52, s52, 36864
    s_and_b32 s48, s51, 1
    s_lshl_b32 s48, s48, 11
    s_add_u32 s52, s52, s48
    s_add_u32 s51, s51, 1
    s_and_b32 s51, s51, 7
    s_add_u32 s48, s96, s52
    buffer_load_dwordx4 a[120:123], v0, s[28:31], s48 offen offset:0 sc1
    s_add_u32 s48, s97, s52
    buffer_load_dwordx4 a[124:127], v0, s[28:31], s48 offen offset:0 sc1
    s_add_u32 s48, s96, s52
    buffer_load_dwordx4 a[132:135], v0, s[28:31], s48 offen offset:1024 sc1
    s_add_u32 s48, s97, s52
    buffer_load_dwordx4 a[136:139], v0, s[28:31], s48 offen offset:1024 sc1
    s_waitcnt lgkmcnt(6)
    v_mfma_f32_16x16x32_bf16 a[0:3], v[80:83], v[24:27], a[0:3]
    ds_read_b64_tr_b16 v[72:73], v8 offset:32768
    ds_read_b64_tr_b16 v[74:75], v8 offset:36864
    v_mfma_f32_16x16x32_bf16 a[32:35], v[80:83], v[28:31], a[32:35]
    s_waitcnt lgkmcnt(6)
    v_mfma_f32_16x16x32_bf16 a[4:7], v[84:87], v[24:27], a[4:7]
    ds_read_b64_tr_b16 v[76:77], v9 offset:32768
    ds_read_b64_tr_b16 v[78:79], v9 offset:36864
    v_mfma_f32_16x16x32_bf16 a[36:39], v[84:87], v[28:31], a[36:39]
    s_waitcnt lgkmcnt(6)
    v_mfma_f32_16x16x32_bf16 a[8:11], v[88:91], v[24:27], a[8:11]
    ds_read_b64_tr_b16 v[80:81], v10 offset:32768
    ds_read_b64_tr_b16 v[82:83], v10 offset:36864
    v_mfma_f32_16x16x32_bf16 a[40:43], v[88:91], v[28:31], a[40:43]
    s_waitcnt lgkmcnt(6)
    v_mfma_f32_16x16x32_bf16 a[12:15], v[92:95], v[24:27], a[12:15]
    ds_read_b64_tr_b16 v[84:85], v11 offset:32768
    ds_read_b64_tr_b16 v[86:87], v11 offset:36864
    v_mfma_f32_16x16x32_bf16 a[44:47], v[92:95], v[28:31], a[44:47]
    s_waitcnt lgkmcnt(6)
    v_mfma_f32_16x16x32_bf16 a[16:19], v[72:75], v[24:27], a[16:19]
    ds_read_b64_tr_b16 v[88:89], v4 offset:40960
    ds_read_b64_tr_b16 v[90:91], v4 offset:45056
    v_mfma_f32_16x16x32_bf16 a[48:51], v[72:75], v[28:31], a[48:51]
    s_waitcnt lgkmcnt(6)
    v_mfma_f32_16x16x32_bf16 a[20:23], v[76:79], v[24:27], a[20:23]
    ds_read_b64_tr_b16 v[92:93], v5 offset:40960
    ds_read_b64_tr_b16 v[94:95], v5 offset:45056
    v_mfma_f32_16x16x32_bf16 a[52:55], v[76:79], v[28:31], a[52:55]
    s_waitcnt lgkmcnt(6)
    v_mfma_f32_16x16x32_bf16 a[24:27], v[80:83], v[24:27], a[24:27]
    ds_read_b64_tr_b16 v[72:73], v6 offset:40960
    ds_read_b64_tr_b16 v[74:75], v6 offset:45056
    v_mfma_f32_16x16x32_bf16 a[56:59], v[80:83], v[28:31], a[56:59]
    s_waitcnt lgkmcnt(6)
    v_mfma_f32_16x16x32_bf16 a[28:31], v[84:87], v[24:27], a[28:31]
    ds_read_b64_tr_b16 v[76:77], v7 offset:40960
    ds_read_b64_tr_b16 v[78:79], v7 offset:45056
    v_mfma_f32_16x16x32_bf16 a[60:63], v[84:87], v[28:31], a[60:63]
    s_waitcnt lgkmcnt(6)
    v_mfma_f32_16x16x32_bf16 a[0:3], v[88:91], v[36:39], a[0:3]
    ds_read_b64_tr_b16 v[80:81], v8 offset:40960
    ds_read_b64_tr_b16 v[82:83], v8 offset:45056
    v_mfma_f32_16x16x32_bf16 a[32:35], v[88:91], v[40:43], a[32:35]
    s_waitcnt lgkmcnt(6)
    v_mfma_f32_16x16x32_bf16 a[4:7], v[92:95], v[36:39], a[4:7]
    ds_read_b64_tr_b16 v[84:85], v9 offset:40960
    ds_read_b64_tr_b16 v[86:87], v9 offset:45056
    v_mfma_f32_16x16x32_bf16 a[36:39], v[92:95], v[40:43], a[36:39]
    s_waitcnt lgkmcnt(6)
    v_mfma_f32_16x16x32_bf16 a[8:11], v[72:75], v[36:39], a[8:11]
    ds_read_b64_tr_b16 v[88:89], v10 offset:40960
    ds_read_b64_tr_b16 v[90:91], v10 offset:45056
    v_mfma_f32_16x16x32_bf16 a[40:43], v[72:75], v[40:43], a[40:43]
    s_waitcnt lgkmcnt(6)
    v_mfma_f32_16x16x32_bf16 a[12:15], v[76:79], v[36:39], a[12:15]
    ds_read_b64_tr_b16 v[92:93], v11 offset:40960
    ds_read_b64_tr_b16 v[94:95], v11 offset:45056
    v_mfma_f32_16x16x32_bf16 a[44:47], v[76:79], v[40:43], a[44:47]
    s_waitcnt lgkmcnt(6)
    v_mfma_f32_16x16x32_bf16 a[16:19], v[80:83], v[36:39], a[16:19]
    ds_read_b64_tr_b16 v[72:73], v4 offset:49152
    ds_read_b64_tr_b16 v[74:75], v4 offset:53248
    v_mfma_f32_16x16x32_bf16 a[48:51], v[80:83], v[40:43], a[48:51]
    s_waitcnt lgkmcnt(6)
    v_mfma_f32_16x16x32_bf16 a[20:23], v[84:87], v[36:39], a[20:23]
    ds_read_b64_tr_b16 v[76:77], v5 offset:49152
    ds_read_b64_tr_b16 v[78:79], v5 offset:53248
    v_mfma_f32_16x16x32_bf16 a[52:55], v[84:87], v[40:43], a[52:55]
    s_waitcnt lgkmcnt(6)
    v_mfma_f32_16x16x32_bf16 a[24:27], v[88:91], v[36:39], a[24:27]
    ds_read_b64_tr_b16 v[80:81], v6 offset:49152
    ds_read_b64_tr_b16 v[82:83], v6 offset:53248
    v_mfma_f32_16x16x32_bf16 a[56:59], v[88:91], v[40:43], a[56:59]
    s_waitcnt lgkmcnt(6)
    v_mfma_f32_16x16x32_bf16 a[28:31], v[92:95], v[36:39], a[28:31]
    ds_read_b64_tr_b16 v[84:85], v7 offset:49152
    ds_read_b64_tr_b16 v[86:87], v7 offset:53248
    v_mfma_f32_16x16x32_bf16 a[60:63], v[92:95], v[40:43], a[60:63]
    s_lshr_b32 s52, s51, 1
    s_mul_i32 s52, s52, 36864
    s_and_b32 s48, s51, 1
    s_lshl_b32 s48, s48, 11
    s_add_u32 s52, s52, s48
    s_add_u32 s51, s51, 1
    s_and_b32 s51, s51, 7
    s_add_u32 s48, s96, s52
    buffer_load_dwordx4 v[24:27], v0, s[28:31], s48 offen offset:0 sc1
    s_add_u32 s48, s97, s52
    buffer_load_dwordx4 v[28:31], v0, s[28:31], s48 offen offset:0 sc1
    s_add_u32 s48, s96, s52
    buffer_load_dwordx4 v[36:39], v0, s[28:31], s48 offen offset:1024 sc1
    s_add_u32 s48, s97, s52
    buffer_load_dwordx4 v[40:43], v0, s[28:31], s48 offen offset:1024 sc1
    s_waitcnt lgkmcnt(6)
    v_mfma_f32_16x16x32_bf16 a[0:3], v[72:75], v[48:51], a[0:3]
    ds_read_b64_tr_b16 v[88:89], v8 offset:49152
    ds_read_b64_tr_b16 v[90:91], v8 offset:53248
    v_mfma_f32_16x16x32_bf16 a[32:35], v[72:75], v[52:55], a[32:35]
    s_waitcnt lgkmcnt(6)
    v_mfma_f32_16x16x32_bf16 a[4:7], v[76:79], v[48:51], a[4:7]
    ds_read_b64_tr_b16 v[92:93], v9 offset:49152
    ds_read_b64_tr_b16 v[94:95], v9 offset:53248
    v_mfma_f32_16x16x32_bf16 a[36:39], v[76:79], v[52:55], a[36:39]
    s_waitcnt lgkmcnt(6)
    v_mfma_f32_16x16x32_bf16 a[8:11], v[80:83], v[48:51], a[8:11]
    ds_read_b64_tr_b16 v[72:73], v10 offset:49152
    ds_read_b64_tr_b16 v[74:75], v10 offset:53248
    v_mfma_f32_16x16x32_bf16 a[40:43], v[80:83], v[52:55], a[40:43]
    s_waitcnt lgkmcnt(6)
    v_mfma_f32_16x16x32_bf16 a[12:15], v[84:87], v[48:51], a[12:15]
    ds_read_b64_tr_b16 v[76:77], v11 offset:49152
    ds_read_b64_tr_b16 v[78:79], v11 offset:53248
    v_mfma_f32_16x16x32_bf16 a[44:47], v[84:87], v[52:55], a[44:47]
    s_waitcnt lgkmcnt(6)
    v_mfma_f32_16x16x32_bf16 a[16:19], v[88:91], v[48:51], a[16:19]
    ds_read_b64_tr_b16 v[80:81], v4 offset:57344
    ds_read_b64_tr_b16 v[82:83], v4 offset:61440
    v_mfma_f32_16x16x32_bf16 a[48:51], v[88:91], v[52:55], a[48:51]
    s_waitcnt lgkmcnt(6)
    v_mfma_f32_16x16x32_bf16 a[20:23], v[92:95], v[48:51], a[20:23]
    ds_read_b64_tr_b16 v[84:85], v5 offset:57344
    ds_read_b64_tr_b16 v[86:87], v5 offset:61440
    v_mfma_f32_16x16x32_bf16 a[52:55], v[92:95], v[52:55], a[52:55]
    s_waitcnt lgkmcnt(6)
    v_mfma_f32_16x16x32_bf16 a[24:27], v[72:75], v[48:51], a[24:27]
    ds_read_b64_tr_b16 v[88:89], v6 offset:57344
    ds_read_b64_tr_b16 v[90:91], v6 offset:61440
    v_mfma_f32_16x16x32_bf16 a[56:59], v[72:75], v[52:55], a[56:59]
    s_waitcnt lgkmcnt(6)
    v_mfma_f32_16x16x32_bf16 a[28:31], v[76:79], v[48:51], a[28:31]
    ds_read_b64_tr_b16 v[92:93], v7 offset:57344
    ds_read_b64_tr_b16 v[94:95], v7 offset:61440
    v_mfma_f32_16x16x32_bf16 a[60:63], v[76:79], v[52:55], a[60:63]
    s_waitcnt lgkmcnt(6)
    v_mfma_f32_16x16x32_bf16 a[0:3], v[80:83], v[60:63], a[0:3]
    ds_read_b64_tr_b16 v[72:73], v8 offset:57344
    ds_read_b64_tr_b16 v[74:75], v8 offset:61440
    v_mfma_f32_16x16x32_bf16 a[32:35], v[80:83], v[64:67], a[32:35]
    s_waitcnt lgkmcnt(6)
    v_mfma_f32_16x16x32_bf16 a[4:7], v[84:87], v[60:63], a[4:7]
    ds_read_b64_tr_b16 v[76:77], v9 offset:57344
    ds_read_b64_tr_b16 v[78:79], v9 offset:61440
    v_mfma_f32_16x16x32_bf16 a[36:39], v[84:87], v[64:67], a[36:39]
    s_waitcnt lgkmcnt(6)
    v_mfma_f32_16x16x32_bf16 a[8:11], v[88:91], v[60:63], a[8:11]
    ds_read_b64_tr_b16 v[80:81], v10 offset:57344
    ds_read_b64_tr_b16 v[82:83], v10 offset:61440
    v_mfma_f32_16x16x32_bf16 a[40:43], v[88:91], v[64:67], a[40:43]
    s_waitcnt lgkmcnt(6)
    v_mfma_f32_16x16x32_bf16 a[12:15], v[92:95], v[60:63], a[12:15]
    ds_read_b64_tr_b16 v[84:85], v11 offset:57344
    ds_read_b64_tr_b16 v[86:87], v11 offset:61440
    v_mfma_f32_16x16x32_bf16 a[44:47], v[92:95], v[64:67], a[44:47]
    s_waitcnt vmcnt(8)
    s_waitcnt lgkmcnt(0)
    s_barrier
    v_mfma_f32_16x16x32_bf16 a[16:19], v[72:75], v[60:63], a[16:19]
    ds_read_b64_tr_b16 v[88:89], v12 offset:0
    ds_read_b64_tr_b16 v[90:91], v12 offset:4096
    v_mfma_f32_16x16x32_bf16 a[48:51], v[72:75], v[64:67], a[48:51]
    v_mfma_f32_16x16x32_bf16 a[20:23], v[76:79], v[60:63], a[20:23]
    ds_read_b64_tr_b16 v[92:93], v13 offset:0
    ds_read_b64_tr_b16 v[94:95], v13 offset:4096
    v_mfma_f32_16x16x32_bf16 a[52:55], v[76:79], v[64:67], a[52:55]
    s_add_u32 s47, s47, 1
    s_and_b32 s47, s47, 7
    s_mul_i32 s66, s47, 81920
    s_add_u32 s66, s66, 655360
    s_mov_b32 s67, 0
    v_mfma_f32_16x16x32_bf16 a[24:27], v[80:83], v[60:63], a[24:27]
    ds_read_b64_tr_b16 v[72:73], v14 offset:0
    ds_read_b64_tr_b16 v[74:75], v14 offset:4096
    v_mfma_f32_16x16x32_bf16 a[56:59], v[80:83], v[64:67], a[56:59]
    s_add_u32 m0, s67, s20
    s_add_u32 s48, s66, s59
    s_add_u32 m0, m0, 0
    s_add_u32 s48, s48, 0
    buffer_load_dwordx4 v20, s[24:27], s48 offen lds
    v_mfma_f32_16x16x32_bf16 a[28:31], v[84:87], v[60:63], a[28:31]
    ds_read_b64_tr_b16 v[76:77], v15 offset:0
    ds_read_b64_tr_b16 v[78:79], v15 offset:4096
    v_mfma_f32_16x16x32_bf16 a[60:63], v[84:87], v[64:67], a[60:63]
    s_add_u32 m0, s67, s20
    s_add_u32 s48, s66, s59
    s_add_u32 m0, m0, 1024
    s_add_u32 s48, s48, 5120
    buffer_load_dwordx4 v21, s[24:27], s48 offen lds
    s_lshr_b32 s52, s51, 1
    s_mul_i32 s52, s52, 36864
    s_and_b32 s48, s51, 1
    s_lshl_b32 s48, s48, 11
    s_add_u32 s52, s52, s48
    s_add_u32 s51, s51, 1
    s_and_b32 s51, s51, 7
    s_add_u32 s48, s96, s52
    buffer_load_dwordx4 v[48:51], v0, s[28:31], s48 offen offset:0 sc1
    s_add_u32 s48, s97, s52
    buffer_load_dwordx4 v[52:55], v0, s[28:31], s48 offen offset:0 sc1
    s_add_u32 s48, s96, s52
    buffer_load_dwordx4 v[60:63], v0, s[28:31], s48 offen offset:1024 sc1
    s_add_u32 s48, s97, s52
    buffer_load_dwordx4 v[64:67], v0, s[28:31], s48 offen offset:1024 sc1
    s_waitcnt lgkmcnt(6)
    v_mfma_f32_16x16x32_bf16 a[0:3], v[88:91], a[96:99], a[0:3]
    ds_read_b64_tr_b16 v[80:81], v16 offset:0
    ds_read_b64_tr_b16 v[82:83], v16 offset:4096
    v_mfma_f32_16x16x32_bf16 a[32:35], v[88:91], a[100:103], a[32:35]
    s_add_u32 s47, s47, 1
    s_and_b32 s47, s47, 7
    s_mul_i32 s66, s47, 81920
    s_add_u32 s66, s66, 655360
    s_mov_b32 s67, 16384
    s_waitcnt lgkmcnt(6)
    v_mfma_f32_16x16x32_bf16 a[4:7], v[92:95], a[96:99], a[4:7]
    ds_read_b64_tr_b16 v[84:85], v17 offset:0
    ds_read_b64_tr_b16 v[86:87], v17 offset:4096
    v_mfma_f32_16x16x32_bf16 a[36:39], v[92:95], a[100:103], a[36:39]
    s_add_u32 m0, s67, s20
    s_add_u32 s48, s66, s59
    s_add_u32 m0, m0, 0
    s_add_u32 s48, s48, 0
    buffer_load_dwordx4 v20, s[24:27], s48 offen lds
    s_waitcnt lgkmcnt(6)
    v_mfma_f32_16x16x32_bf16 a[8:11], v[72:75], a[96:99], a[8:11]
    ds_read_b64_tr_b16 v[88:89], v18 offset:0
    ds_read_b64_tr_b16 v[90:91], v18 offset:4096
    v_mfma_f32_16x16x32_bf16 a[40:43], v[72:75], a[100:103], a[40:43]
    s_add_u32 m0, s67, s20
    s_add_u32 s48, s66, s59
    s_add_u32 m0, m0, 1024
    s_add_u32 s48, s48, 5120
    buffer_load_dwordx4 v21, s[24:27], s48 offen lds
    s_waitcnt lgkmcnt(6)
    v_mfma_f32_16x16x32_bf16 a[12:15], v[76:79], a[96:99], a[12:15]
    ds_read_b64_tr_b16 v[92:93], v19 offset:0
    ds_read_b64_tr_b16 v[94:95], v19 offset:4096
    v_mfma_f32_16x16x32_bf16 a[44:47], v[76:79], a[100:103], a[44:47]
    s_add_u32 s47, s47, 1
    s_and_b32 s47, s47, 7
    s_mul_i32 s66, s47, 81920
    s_add_u32 s66, s66, 655360
    s_mov_b32 s67, 32768
    s_waitcnt lgkmcnt(6)
    v_mfma_f32_16x16x32_bf16 a[16:19], v[80:83], a[96:99], a[16:19]
    ds_read_b64_tr_b16 v[72:73], v12 offset:8192
    ds_read_b64_tr_b16 v[74:75], v12 offset:12288
    v_mfma_f32_16x16x32_bf16 a[48:51], v[80:83], a[100:103], a[48:51]
    s_add_u32 m0, s67, s20
    s_add_u32 s48, s66, s59
    s_add_u32 m0, m0, 0
    s_add_u32 s48, s48, 0
    buffer_load_dwordx4 v20, s[24:27], s48 offen lds
    s_waitcnt lgkmcnt(6)
    v_mfma_f32_16x16x32_bf16 a[20:23], v[84:87], a[96:99], a[20:23]
    ds_read_b64_tr_b16 v[76:77], v13 offset:8192
    ds_read_b64_tr_b16 v[78:79], v13 offset:12288
    v_mfma_f32_16x16x32_bf16 a[52:55], v[84:87], a[100:103], a[52:55]
    s_add_u32 m0, s67, s20
    s_add_u32 s48, s66, s59
    s_add_u32 m0, m0, 1024
    s_add_u32 s48, s48, 5120
    buffer_load_dwordx4 v21, s[24:27], s48 offen lds
    s_waitcnt lgkmcnt(6)
    v_mfma_f32_16x16x32_bf16 a[24:27], v[88:91], a[96:99], a[24:27]
    ds_read_b64_tr_b16 v[80:81], v14 offset:8192
    ds_read_b64_tr_b16 v[82:83], v14 offset:12288
    v_mfma_f32_16x16x32_bf16 a[56:59], v[88:91], a[100:103], a[56:59]
    s_add_u32 s47, s47, 1
    s_and_b32 s47, s47, 7
    s_mul_i32 s66, s47, 81920
    s_add_u32 s66, s66, 655360
    s_mov_b32 s67, 49152
    s_waitcnt lgkmcnt(6)
    v_mfma_f32_16x16x32_bf16 a[28:31], v[92:95], a[96:99], a[28:31]
    ds_read_b64_tr_b16 v[84:85], v15 offset:8192
    ds_read_b64_tr_b16 v[86:87], v15 offset:12288
    v_mfma_f32_16x16x32_bf16 a[60:63], v[92:95], a[100:103], a[60:63]
    s_add_u32 m0, s67, s20
    s_add_u32 s48, s66, s59
    s_add_u32 m0, m0, 0
    s_add_u32 s48, s48, 0
    buffer_load_dwordx4 v20, s[24:27], s48 offen lds
    s_waitcnt lgkmcnt(6)
    v_mfma_f32_16x16x32_bf16 a[0:3], v[72:75], a[108:111], a[0:3]
    ds_read_b64_tr_b16 v[88:89], v16 offset:8192
    ds_read_b64_tr_b16 v[90:91], v16 offset:12288
    v_mfma_f32_16x16x32_bf16 a[32:35], v[72:75], a[112:115], a[32:35]
    s_add_u32 m0, s67, s20
    s_add_u32 s48, s66, s59
    s_add_u32 m0, m0, 1024
    s_add_u32 s48, s48, 5120
    buffer_load_dwordx4 v21, s[24:27], s48 offen lds
    s_waitcnt lgkmcnt(6)
    v_mfma_f32_16x16x32_bf16 a[4:7], v[76:79], a[108:111], a[4:7]
    ds_read_b64_tr_b16 v[92:93], v17 offset:8192
    ds_read_b64_tr_b16 v[94:95], v17 offset:12288
    v_mfma_f32_16x16x32_bf16 a[36:39], v[76:79], a[112:115], a[36:39]
    s_waitcnt lgkmcnt(6)
    v_mfma_f32_16x16x32_bf16 a[8:11], v[80:83], a[108:111], a[8:11]
    ds_read_b64_tr_b16 v[72:73], v18 offset:8192
    ds_read_b64_tr_b16 v[74:75], v18 offset:12288
    v_mfma_f32_16x16x32_bf16 a[40:43], v[80:83], a[112:115], a[40:43]
    s_waitcnt lgkmcnt(6)
    v_mfma_f32_16x16x32_bf16 a[12:15], v[84:87], a[108:111], a[12:15]
    ds_read_b64_tr_b16 v[76:77], v19 offset:8192
    ds_read_b64_tr_b16 v[78:79], v19 offset:12288
    v_mfma_f32_16x16x32_bf16 a[44:47], v[84:87], a[112:115], a[44:47]
    s_waitcnt vmcnt(16)
    s_mov_b32 s51, 2
    s_cmp_lg_u32 s7, 0
    s_cbranch_scc1 L_pg1a_skip
    s_and_b32 s48, s2, 7
    s_lshl_b32 s48, s48, 5
    v_and_b32 v2, 31, v1
    v_add_u32 v2, s48, v2
    s_mov_b32 s69, 0
L_pg1a_poll:
    global_load_ubyte v3, v2, s[22:23] sc1
    s_add_u32 s69, s69, 1
    s_waitcnt vmcnt(0)
    v_cmp_gt_u32 vcc, s51, v3
    s_cmp_ge_u32 s69, 131072
    s_cbranch_scc1 L_pg1a_skip
    s_nop 2
    s_cbranch_vccz L_pg1a_skip
    s_sleep 2
    s_branch L_pg1a_poll
L_pg1a_skip:
    s_waitcnt lgkmcnt(0)
    s_barrier
    s_mov_b32 s51, s99
    s_add_u32 s96, s96, 147456
    s_add_u32 s97, s97, 147456
    s_add_u32 s98, s98, 147456
    v_mfma_f32_16x16x32_bf16 a[16:19], v[88:91], a[108:111], a[16:19]
    ds_read_b64_tr_b16 v[80:81], v12 offset:16384
    ds_read_b64_tr_b16 v[82:83], v12 offset:20480
    v_mfma_f32_16x16x32_bf16 a[48:51], v[88:91], a[112:115], a[48:51]
    v_mfma_f32_16x16x32_bf16 a[20:23], v[92:95], a[108:111], a[20:23]
    ds_read_b64_tr_b16 v[84:85], v13 offset:16384
    ds_read_b64_tr_b16 v[86:87], v13 offset:20480
    v_mfma_f32_16x16x32_bf16 a[52:55], v[92:95], a[112:115], a[52:55]
    v_mfma_f32_16x16x32_bf16 a[24:27], v[72:75], a[108:111], a[24:27]
    ds_read_b64_tr_b16 v[88:89], v14 offset:16384
    ds_read_b64_tr_b16 v[90:91], v14 offset:20480
    v_mfma_f32_16x16x32_bf16 a[56:59], v[72:75], a[112:115], a[56:59]
    v_mfma_f32_16x16x32_bf16 a[28:31], v[76:79], a[108:111], a[28:31]
    ds_read_b64_tr_b16 v[92:93], v15 offset:16384
    ds_read_b64_tr_b16 v[94:95], v15 offset:20480
    v_mfma_f32_16x16x32_bf16 a[60:63], v[76:79], a[112:115], a[60:63]
    s_lshr_b32 s52, s51, 1
    s_mul_i32 s52, s52, 36864
    s_and_b32 s48, s51, 1
    s_lshl_b32 s48, s48, 11
    s_add_u32 s52, s52, s48
    s_add_u32 s51, s51, 1
    s_and_b32 s51, s51, 7
    s_add_u32 s48, s96, s52
    buffer_load_dwordx4 a[96:99], v0, s[28:31], s48 offen offset:0 sc1
    s_add_u32 s48, s97, s52
    buffer_load_dwordx4 a[100:103], v0, s[28:31], s48 offen offset:0 sc1
    s_add_u32 s48, s96, s52
    buffer_load_dwordx4 a[108:111], v0, s[28:31], s48 offen offset:1024 sc1
    s_add_u32 s48, s97, s52
    buffer_load_dwordx4 a[112:115], v0, s[28:31], s48 offen offset:1024 sc1
    s_waitcnt lgkmcnt(6)
    v_mfma_f32_16x16x32_bf16 a[0:3], v[80:83], a[120:123], a[0:3]
    ds_read_b64_tr_b16 v[72:73], v16 offset:16384
    ds_read_b64_tr_b16 v[74:75], v16 offset:20480
    v_mfma_f32_16x16x32_bf16 a[32:35], v[80:83], a[124:127], a[32:35]
    s_waitcnt lgkmcnt(6)
    v_mfma_f32_16x16x32_bf16 a[4:7], v[84:87], a[120:123], a[4:7]
    ds_read_b64_tr_b16 v[76:77], v17 offset:16384
    ds_read_b64_tr_b16 v[78:79], v17 offset:20480
    v_mfma_f32_16x16x32_bf16 a[36:39], v[84:87], a[124:127], a[36:39]
    s_waitcnt lgkmcnt(6)
    v_mfma_f32_16x16x32_bf16 a[8:11], v[88:91], a[120:123], a[8:11]
    ds_read_b64_tr_b16 v[80:81], v18 offset:16384
    ds_read_b64_tr_b16 v[82:83], v18 offset:20480
    v_mfma_f32_16x16x32_bf16 a[40:43], v[88:91], a[124:127], a[40:43]
    s_waitcnt lgkmcnt(6)
    v_mfma_f32_16x16x32_bf16 a[12:15], v[92:95], a[120:123], a[12:15]
    ds_read_b64_tr_b16 v[84:85], v19 offset:16384
    ds_read_b64_tr_b16 v[86:87], v19 offset:20480
    v_mfma_f32_16x16x32_bf16 a[44:47], v[92:95], a[124:127], a[44:47]
    s_waitcnt lgkmcnt(6)
    v_mfma_f32_16x16x32_bf16 a[16:19], v[72:75], a[120:123], a[16:19]
    ds_read_b64_tr_b16 v[88:89], v12 offset:24576
    ds_read_b64_tr_b16 v[90:91], v12 offset:28672
    v_mfma_f32_16x16x32_bf16 a[48:51], v[72:75], a[124:127], a[48:51]
    s_waitcnt lgkmcnt(6)
    v_mfma_f32_16x16x32_bf16 a[20:23], v[76:79], a[120:123], a[20:23]
    ds_read_b64_tr_b16 v[92:93], v13 offset:24576
    ds_read_b64_tr_b16 v[94:95], v13 offset:28672
    v_mfma_f32_16x16x32_bf16 a[52:55], v[76:79], a[124:127], a[52:55]
    s_waitcnt lgkmcnt(6)
    v_mfma_f32_16x16x32_bf16 a[24:27], v[80:83], a[120:123], a[24:27]
    ds_read_b64_tr_b16 v[72:73], v14 offset:24576
    ds_read_b64_tr_b16 v[74:75], v14 offset:28672
    v_mfma_f32_16x16x32_bf16 a[56:59], v[80:83], a[124:127], a[56:59]
    s_waitcnt lgkmcnt(6)
    v_mfma_f32_16x16x32_bf16 a[28:31], v[84:87], a[120:123], a[28:31]
    ds_read_b64_tr_b16 v[76:77], v15 offset:24576
    ds_read_b64_tr_b16 v[78:79], v15 offset:28672
    v_mfma_f32_16x16x32_bf16 a[60:63], v[84:87], a[124:127], a[60:63]
    s_waitcnt lgkmcnt(6)
    v_mfma_f32_16x16x32_bf16 a[0:3], v[88:91], a[132:135], a[0:3]
    ds_read_b64_tr_b16 v[80:81], v16 offset:24576
    ds_read_b64_tr_b16 v[82:83], v16 offset:28672
    v_mfma_f32_16x16x32_bf16 a[32:35], v[88:91], a[136:139], a[32:35]
    s_waitcnt lgkmcnt(6)
    v_mfma_f32_16x16x32_bf16 a[4:7], v[92:95], a[132:135], a[4:7]
    ds_read_b64_tr_b16 v[84:85], v17 offset:24576
    ds_read_b64_tr_b16 v[86:87], v17 offset:28672
    v_mfma_f32_16x16x32_bf16 a[36:39], v[92:95], a[136:139], a[36:39]
    s_waitcnt lgkmcnt(6)
    v_mfma_f32_16x16x32_bf16 a[8:11], v[72:75], a[132:135], a[8:11]
    ds_read_b64_tr_b16 v[88:89], v18 offset:24576
    ds_read_b64_tr_b16 v[90:91], v18 offset:28672
    v_mfma_f32_16x16x32_bf16 a[40:43], v[72:75], a[136:139], a[40:43]
    s_waitcnt lgkmcnt(6)
    v_mfma_f32_16x16x32_bf16 a[12:15], v[76:79], a[132:135], a[12:15]
    ds_read_b64_tr_b16 v[92:93], v19 offset:24576
    ds_read_b64_tr_b16 v[94:95], v19 offset:28672
    v_mfma_f32_16x16x32_bf16 a[44:47], v[76:79], a[136:139], a[44:47]
    s_waitcnt vmcnt(16)
    s_waitcnt lgkmcnt(6)
    v_mfma_f32_16x16x32_bf16 a[16:19], v[80:83], a[132:135], a[16:19]
    ds_read_b64_tr_b16 v[72:73], v12 offset:32768
    ds_read_b64_tr_b16 v[74:75], v12 offset:36864
    v_mfma_f32_16x16x32_bf16 a[48:51], v[80:83], a[136:139], a[48:51]
    s_waitcnt lgkmcnt(6)
    v_mfma_f32_16x16x32_bf16 a[20:23], v[84:87], a[132:135], a[20:23]
    ds_read_b64_tr_b16 v[76:77], v13 offset:32768
    ds_read_b64_tr_b16 v[78:79], v13 offset:36864
    v_mfma_f32_16x16x32_bf16 a[52:55], v[84:87], a[136:139], a[52:55]
    s_waitcnt lgkmcnt(6)
    v_mfma_f32_16x16x32_bf16 a[24:27], v[88:91], a[132:135], a[24:27]
    ds_read_b64_tr_b16 v[80:81], v14 offset:32768
    ds_read_b64_tr_b16 v[82:83], v14 offset:36864
    v_mfma_f32_16x16x32_bf16 a[56:59], v[88:91], a[136:139], a[56:59]
    s_waitcnt lgkmcnt(6)
    v_mfma_f32_16x16x32_bf16 a[28:31], v[92:95], a[132:135], a[28:31]
    ds_read_b64_tr_b16 v[84:85], v15 offset:32768
    ds_read_b64_tr_b16 v[86:87], v15 offset:36864
    v_mfma_f32_16x16x32_bf16 a[60:63], v[92:95], a[136:139], a[60:63]
    s_lshr_b32 s52, s51, 1
    s_mul_i32 s52, s52, 36864
    s_and_b32 s48, s51, 1
    s_lshl_b32 s48, s48, 11
    s_add_u32 s52, s52, s48
    s_add_u32 s51, s51, 1
    s_and_b32 s51, s51, 7
    s_add_u32 s48, s96, s52
    buffer_load_dwordx4 a[120:123], v0, s[28:31], s48 offen offset:0 sc1
    s_add_u32 s48, s97, s52
    buffer_load_dwordx4 a[124:127], v0, s[28:31], s48 offen offset:0 sc1
    s_add_u32 s48, s96, s52
    buffer_load_dwordx4 a[132:135], v0, s[28:31], s48 offen offset:1024 sc1
    s_add_u32 s48, s97, s52
    buffer_load_dwordx4 a[136:139], v0, s[28:31], s48 offen offset:1024 sc1
    s_waitcnt lgkmcnt(6)
    v_mfma_f32_16x16x32_bf16 a[0:3], v[72:75], v[24:27], a[0:3]
    ds_read_b64_tr_b16 v[88:89], v16 offset:32768
    ds_read_b64_tr_b16 v[90:91], v16 offset:36864
    v_mfma_f32_16x16x32_bf16 a[32:35], v[72:75], v[28:31], a[32:35]
    s_waitcnt lgkmcnt(6)
    v_mfma_f32_16x16x32_bf16 a[4:7], v[76:79], v[24:27], a[4:7]
    ds_read_b64_tr_b16 v[92:93], v17 offset:32768
    ds_read_b64_tr_b16 v[94:95], v17 offset:36864
    v_mfma_f32_16x16x32_bf16 a[36:39], v[76:79], v[28:31], a[36:39]
    s_waitcnt lgkmcnt(6)
    v_mfma_f32_16x16x32_bf16 a[8:11], v[80:83], v[24:27], a[8:11]
    ds_read_b64_tr_b16 v[72:73], v18 offset:32768
    ds_read_b64_tr_b16 v[74:75], v18 offset:36864
    v_mfma_f32_16x16x32_bf16 a[40:43], v[80:83], v[28:31], a[40:43]
    s_waitcnt lgkmcnt(6)
    v_mfma_f32_16x16x32_bf16 a[12:15], v[84:87], v[24:27], a[12:15]
    ds_read_b64_tr_b16 v[76:77], v19 offset:32768
    ds_read_b64_tr_b16 v[78:79], v19 offset:36864
    v_mfma_f32_16x16x32_bf16 a[44:47], v[84:87], v[28:31], a[44:47]
    s_waitcnt lgkmcnt(6)
    v_mfma_f32_16x16x32_bf16 a[16:19], v[88:91], v[24:27], a[16:19]
    ds_read_b64_tr_b16 v[80:81], v12 offset:40960
    ds_read_b64_tr_b16 v[82:83], v12 offset:45056
    v_mfma_f32_16x16x32_bf16 a[48:51], v[88:91], v[28:31], a[48:51]
    s_waitcnt lgkmcnt(6)
    v_mfma_f32_16x16x32_bf16 a[20:23], v[92:95], v[24:27], a[20:23]
    ds_read_b64_tr_b16 v[84:85], v13 offset:40960
    ds_read_b64_tr_b16 v[86:87], v13 offset:45056
    v_mfma_f32_16x16x32_bf16 a[52:55], v[92:95], v[28:31], a[52:55]
    s_waitcnt lgkmcnt(6)
    v_mfma_f32_16x16x32_bf16 a[24:27], v[72:75], v[24:27], a[24:27]
    ds_read_b64_tr_b16 v[88:89], v14 offset:40960
    ds_read_b64_tr_b16 v[90:91], v14 offset:45056
    v_mfma_f32_16x16x32_bf16 a[56:59], v[72:75], v[28:31], a[56:59]
    s_waitcnt lgkmcnt(6)
    v_mfma_f32_16x16x32_bf16 a[28:31], v[76:79], v[24:27], a[28:31]
    ds_read_b64_tr_b16 v[92:93], v15 offset:40960
    ds_read_b64_tr_b16 v[94:95], v15 offset:45056
    v_mfma_f32_16x16x32_bf16 a[60:63], v[76:79], v[28:31], a[60:63]
    s_waitcnt lgkmcnt(6)
    v_mfma_f32_16x16x32_bf16 a[0:3], v[80:83], v[36:39], a[0:3]
    ds_read_b64_tr_b16 v[72:73], v16 offset:40960
    ds_read_b64_tr_b16 v[74:75], v16 offset:45056
    v_mfma_f32_16x16x32_bf16 a[32:35], v[80:83], v[40:43], a[32:35]
    s_waitcnt lgkmcnt(6)
    v_mfma_f32_16x16x32_bf16 a[4:7], v[84:87], v[36:39], a[4:7]
    ds_read_b64_tr_b16 v[76:77], v17 offset:40960
    ds_read_b64_tr_b16 v[78:79], v17 offset:45056
    v_mfma_f32_16x16x32_bf16 a[36:39], v[84:87], v[40:43], a[36:39]
    s_waitcnt lgkmcnt(6)
    v_mfma_f32_16x16x32_bf16 a[8:11], v[88:91], v[36:39], a[8:11]
    ds_read_b64_tr_b16 v[80:81], v18 offset:40960
    ds_read_b64_tr_b16 v[82:83], v18 offset:45056
    v_mfma_f32_16x16x32_bf16 a[40:43], v[88:91], v[40:43], a[40:43]
    s_waitcnt lgkmcnt(6)
    v_mfma_f32_16x16x32_bf16 a[12:15], v[92:95], v[36:39], a[12:15]
    ds_read_b64_tr_b16 v[84:85], v19 offset:40960
    ds_read_b64_tr_b16 v[86:87], v19 offset:45056
    v_mfma_f32_16x16x32_bf16 a[44:47], v[92:95], v[40:43], a[44:47]
    s_waitcnt vmcnt(14)
    s_waitcnt lgkmcnt(6)
    v_mfma_f32_16x16x32_bf16 a[16:19], v[72:75], v[36:39], a[16:19]
    ds_read_b64_tr_b16 v[88:89], v12 offset:49152
    ds_read_b64_tr_b16 v[90:91], v12 offset:53248
    v_mfma_f32_16x16x32_bf16 a[48:51], v[72:75], v[40:43], a[48:51]
    s_waitcnt lgkmcnt(6)
    v_mfma_f32_16x16x32_bf16 a[20:23], v[76:79], v[36:39], a[20:23]
    ds_read_b64_tr_b16 v[92:93], v13 offset:49152
    ds_read_b64_tr_b16 v[94:95], v13 offset:53248
    v_mfma_f32_16x16x32_bf16 a[52:55], v[76:79], v[40:43], a[52:55]
    s_waitcnt lgkmcnt(6)
    v_mfma_f32_16x16x32_bf16 a[24:27], v[80:83], v[36:39], a[24:27]
    ds_read_b64_tr_b16 v[72:73], v14 offset:49152
    ds_read_b64_tr_b16 v[74:75], v14 offset:53248
    v_mfma_f32_16x16x32_bf16 a[56:59], v[80:83], v[40:43], a[56:59]
    s_waitcnt lgkmcnt(6)
    v_mfma_f32_16x16x32_bf16 a[28:31], v[84:87], v[36:39], a[28:31]
    ds_read_b64_tr_b16 v[76:77], v15 offset:49152
    ds_read_b64_tr_b16 v[78:79], v15 offset:53248
    v_mfma_f32_16x16x32_bf16 a[60:63], v[84:87], v[40:43], a[60:63]
    s_lshr_b32 s52, s51, 1
    s_mul_i32 s52, s52, 36864
    s_and_b32 s48, s51, 1
    s_lshl_b32 s48, s48, 11
    s_add_u32 s52, s52, s48
    s_add_u32 s51, s51, 1
    s_and_b32 s51, s51, 7
    s_add_u32 s48, s96, s52
    buffer_load_dwordx4 v[24:27], v0, s[28:31], s48 offen offset:0 sc1
    s_add_u32 s48, s97, s52
    buffer_load_dwordx4 v[28:31], v0, s[28:31], s48 offen offset:0 sc1
    s_add_u32 s48, s96, s52
    buffer_load_dwordx4 v[36:39], v0, s[28:31], s48 offen offset:1024 sc1
    s_add_u32 s48, s97, s52
    buffer_load_dwordx4 v[40:43], v0, s[28:31], s48 offen offset:1024 sc1
    s_waitcnt lgkmcnt(6)
    v_mfma_f32_16x16x32_bf16 a[0:3], v[88:91], v[48:51], a[0:3]
    ds_read_b64_tr_b16 v[80:81], v16 offset:49152
    ds_read_b64_tr_b16 v[82:83], v16 offset:53248
    v_mfma_f32_16x16x32_bf16 a[32:35], v[88:91], v[52:55], a[32:35]
    s_waitcnt lgkmcnt(6)
    v_mfma_f32_16x16x32_bf16 a[4:7], v[92:95], v[48:51], a[4:7]
    ds_read_b64_tr_b16 v[84:85], v17 offset:49152
    ds_read_b64_tr_b16 v[86:87], v17 offset:53248
    v_mfma_f32_16x16x32_bf16 a[36:39], v[92:95], v[52:55], a[36:39]
    s_waitcnt lgkmcnt(6)
    v_mfma_f32_16x16x32_bf16 a[8:11], v[72:75], v[48:51], a[8:11]
    ds_read_b64_tr_b16 v[88:89], v18 offset:49152
    ds_read_b64_tr_b16 v[90:91], v18 offset:53248
    v_mfma_f32_16x16x32_bf16 a[40:43], v[72:75], v[52:55], a[40:43]
    s_waitcnt lgkmcnt(6)
    v_mfma_f32_16x16x32_bf16 a[12:15], v[76:79], v[48:51], a[12:15]
    ds_read_b64_tr_b16 v[92:93], v19 offset:49152
    ds_read_b64_tr_b16 v[94:95], v19 offset:53248
    v_mfma_f32_16x16x32_bf16 a[44:47], v[76:79], v[52:55], a[44:47]
    s_waitcnt lgkmcnt(6)
    v_mfma_f32_16x16x32_bf16 a[16:19], v[80:83], v[48:51], a[16:19]
    ds_read_b64_tr_b16 v[72:73], v12 offset:57344
    ds_read_b64_tr_b16 v[74:75], v12 offset:61440
    v_mfma_f32_16x16x32_bf16 a[48:51], v[80:83], v[52:55], a[48:51]
    s_waitcnt lgkmcnt(6)
    v_mfma_f32_16x16x32_bf16 a[20:23], v[84:87], v[48:51], a[20:23]
    ds_read_b64_tr_b16 v[76:77], v13 offset:57344
    ds_read_b64_tr_b16 v[78:79], v13 offset:61440
    v_mfma_f32_16x16x32_bf16 a[52:55], v[84:87], v[52:55], a[52:55]
    s_waitcnt lgkmcnt(6)
    v_mfma_f32_16x16x32_bf16 a[24:27], v[88:91], v[48:51], a[24:27]
    ds_read_b64_tr_b16 v[80:81], v14 offset:57344
    ds_read_b64_tr_b16 v[82:83], v14 offset:61440
    v_mfma_f32_16x16x32_bf16 a[56:59], v[88:91], v[52:55], a[56:59]
    s_waitcnt lgkmcnt(6)
    v_mfma_f32_16x16x32_bf16 a[28:31], v[92:95], v[48:51], a[28:31]
    ds_read_b64_tr_b16 v[84:85], v15 offset:57344
    ds_read_b64_tr_b16 v[86:87], v15 offset:61440
    v_mfma_f32_16x16x32_bf16 a[60:63], v[92:95], v[52:55], a[60:63]
    s_waitcnt lgkmcnt(6)
    v_mfma_f32_16x16x32_bf16 a[0:3], v[72:75], v[60:63], a[0:3]
    ds_read_b64_tr_b16 v[88:89], v16 offset:57344
    ds_read_b64_tr_b16 v[90:91], v16 offset:61440
    v_mfma_f32_16x16x32_bf16 a[32:35], v[72:75], v[64:67], a[32:35]
    s_waitcnt lgkmcnt(6)
    v_mfma_f32_16x16x32_bf16 a[4:7], v[76:79], v[60:63], a[4:7]
    ds_read_b64_tr_b16 v[92:93], v17 offset:57344
    ds_read_b64_tr_b16 v[94:95], v17 offset:61440
    v_mfma_f32_16x16x32_bf16 a[36:39], v[76:79], v[64:67], a[36:39]
    s_waitcnt lgkmcnt(6)
    v_mfma_f32_16x16x32_bf16 a[8:11], v[80:83], v[60:63], a[8:11]
    ds_read_b64_tr_b16 v[72:73], v18 offset:57344
    ds_read_b64_tr_b16 v[74:75], v18 offset:61440
    v_mfma_f32_16x16x32_bf16 a[40:43], v[80:83], v[64:67], a[40:43]
    s_waitcnt lgkmcnt(6)
    v_mfma_f32_16x16x32_bf16 a[12:15], v[84:87], v[60:63], a[12:15]
    ds_read_b64_tr_b16 v[76:77], v19 offset:57344
    ds_read_b64_tr_b16 v[78:79], v19 offset:61440
    v_mfma_f32_16x16x32_bf16 a[44:47], v[84:87], v[64:67], a[44:47]
    s_waitcnt vmcnt(8)
    s_waitcnt lgkmcnt(0)
    s_barrier
    v_mfma_f32_16x16x32_bf16 a[16:19], v[88:91], v[60:63], a[16:19]
    ds_read_b64_tr_b16 v[80:81], v4 offset:0
    ds_read_b64_tr_b16 v[82:83], v4 offset:4096
    v_mfma_f32_16x16x32_bf16 a[48:51], v[88:91], v[64:67], a[48:51]
    v_mfma_f32_16x16x32_bf16 a[20:23], v[92:95], v[60:63], a[20:23]
    ds_read_b64_tr_b16 v[84:85], v5 offset:0
    ds_read_b64_tr_b16 v[86:87], v5 offset:4096
    v_mfma_f32_16x16x32_bf16 a[52:55], v[92:95], v[64:67], a[52:55]
    s_add_u32 s47, s47, 1
    s_and_b32 s47, s47, 7
    s_mul_i32 s66, s47, 81920
    s_add_u32 s66, s66, 655360
    s_mov_b32 s67, 65536
    v_mfma_f32_16x16x32_bf16 a[24:27], v[72:75], v[60:63], a[24:27]
    ds_read_b64_tr_b16 v[88:89], v6 offset:0
    ds_read_b64_tr_b16 v[90:91], v6 offset:4096
    v_mfma_f32_16x16x32_bf16 a[56:59], v[72:75], v[64:67], a[56:59]
    s_add_u32 m0, s67, s20
    s_add_u32 s48, s66, s59
    s_add_u32 m0, m0, 0
    s_add_u32 s48, s48, 0
    buffer_load_dwordx4 v20, s[24:27], s48 offen lds
    v_mfma_f32_16x16x32_bf16 a[28:31], v[76:79], v[60:63], a[28:31]
    ds_read_b64_tr_b16 v[92:93], v7 offset:0
    ds_read_b64_tr_b16 v[94:95], v7 offset:4096
    v_mfma_f32_16x16x32_bf16 a[60:63], v[76:79], v[64:67], a[60:63]
    s_add_u32 m0, s67, s20
    s_add_u32 s48, s66, s59
    s_add_u32 m0, m0, 1024
    s_add_u32 s48, s48, 5120
    buffer_load_dwordx4 v21, s[24:27], s48 offen lds
    s_lshr_b32 s52, s51, 1
    s_mul_i32 s52, s52, 36864
    s_and_b32 s48, s51, 1
    s_lshl_b32 s48, s48, 11
    s_add_u32 s52, s52, s48
    s_add_u32 s51, s51, 1
    s_and_b32 s51, s51, 7
    s_add_u32 s48, s96, s52
    buffer_load_dwordx4 v[48:51], v0, s[28:31], s48 offen offset:0 sc1
    s_add_u32 s48, s97, s52
    buffer_load_dwordx4 v[52:55], v0, s[28:31], s48 offen offset:0 sc1
    s_add_u32 s48, s96, s52
    buffer_load_dwordx4 v[60:63], v0, s[28:31], s48 offen offset:1024 sc1
    s_add_u32 s48, s97, s52
    buffer_load_dwordx4 v[64:67], v0, s[28:31], s48 offen offset:1024 sc1
    s_waitcnt lgkmcnt(6)
    v_mfma_f32_16x16x32_bf16 a[0:3], v[80:83], a[96:99], a[0:3]
    ds_read_b64_tr_b16 v[72:73], v8 offset:0
    ds_read_b64_tr_b16 v[74:75], v8 offset:4096
    v_mfma_f32_16x16x32_bf16 a[32:35], v[80:83], a[100:103], a[32:35]
    s_add_u32 s47, s47, 1
    s_and_b32 s47, s47, 7
    s_mul_i32 s66, s47, 81920
    s_add_u32 s66, s66, 655360
    s_mov_b32 s67, 81920
    s_waitcnt lgkmcnt(6)
    v_mfma_f32_16x16x32_bf16 a[4:7], v[84:87], a[96:99], a[4:7]
    ds_read_b64_tr_b16 v[76:77], v9 offset:0
    ds_read_b64_tr_b16 v[78:79], v9 offset:4096
    v_mfma_f32_16x16x32_bf16 a[36:39], v[84:87], a[100:103], a[36:39]
    s_add_u32 m0, s67, s20
    s_add_u32 s48, s66, s59
    s_add_u32 m0, m0, 0
    s_add_u32 s48, s48, 0
    buffer_load_dwordx4 v20, s[24:27], s48 offen lds
    s_waitcnt lgkmcnt(6)
    v_mfma_f32_16x16x32_bf16 a[8:11], v[88:91], a[96:99], a[8:11]
    ds_read_b64_tr_b16 v[80:81], v10 offset:0
    ds_read_b64_tr_b16 v[82:83], v10 offset:4096
    v_mfma_f32_16x16x32_bf16 a[40:43], v[88:91], a[100:103], a[40:43]
    s_add_u32 m0, s67, s20
    s_add_u32 s48, s66, s59
    s_add_u32 m0, m0, 1024
    s_add_u32 s48, s48, 5120
    buffer_load_dwordx4 v21, s[24:27], s48 offen lds
    s_waitcnt lgkmcnt(6)
    v_mfma_f32_16x16x32_bf16 a[12:15], v[92:95], a[96:99], a[12:15]
    ds_read_b64_tr_b16 v[84:85], v11 offset:0
    ds_read_b64_tr_b16 v[86:87], v11 offset:4096
    v_mfma_f32_16x16x32_bf16 a[44:47], v[92:95], a[100:103], a[44:47]
    s_add_u32 s47, s47, 1
    s_and_b32 s47, s47, 7
    s_mul_i32 s66, s47, 81920
    s_add_u32 s66, s66, 655360
    s_mov_b32 s67, 98304
    s_waitcnt lgkmcnt(6)
    v_mfma_f32_16x16x32_bf16 a[16:19], v[72:75], a[96:99], a[16:19]
    ds_read_b64_tr_b16 v[88:89], v4 offset:8192
    ds_read_b64_tr_b16 v[90:91], v4 offset:12288
    v_mfma_f32_16x16x32_bf16 a[48:51], v[72:75], a[100:103], a[48:51]
    s_add_u32 m0, s67, s20
    s_add_u32 s48, s66, s59
    s_add_u32 m0, m0, 0
    s_add_u32 s48, s48, 0
    buffer_load_dwordx4 v20, s[24:27], s48 offen lds
    s_waitcnt lgkmcnt(6)
    v_mfma_f32_16x16x32_bf16 a[20:23], v[76:79], a[96:99], a[20:23]
    ds_read_b64_tr_b16 v[92:93], v5 offset:8192
    ds_read_b64_tr_b16 v[94:95], v5 offset:12288
    v_mfma_f32_16x16x32_bf16 a[52:55], v[76:79], a[100:103], a[52:55]
    s_add_u32 m0, s67, s20
    s_add_u32 s48, s66, s59
    s_add_u32 m0, m0, 1024
    s_add_u32 s48, s48, 5120
    buffer_load_dwordx4 v21, s[24:27], s48 offen lds
    s_waitcnt lgkmcnt(6)
    v_mfma_f32_16x16x32_bf16 a[24:27], v[80:83], a[96:99], a[24:27]
    ds_read_b64_tr_b16 v[72:73], v6 offset:8192
    ds_read_b64_tr_b16 v[74:75], v6 offset:12288
    v_mfma_f32_16x16x32_bf16 a[56:59], v[80:83], a[100:103], a[56:59]
    s_add_u32 s47, s47, 1
    s_and_b32 s47, s47, 7
    s_mul_i32 s66, s47, 81920
    s_add_u32 s66, s66, 655360
    s_mov_b32 s67, 114688
    s_waitcnt lgkmcnt(6)
    v_mfma_f32_16x16x32_bf16 a[28:31], v[84:87], a[96:99], a[28:31]
    ds_read_b64_tr_b16 v[76:77], v7 offset:8192
    ds_read_b64_tr_b16 v[78:79], v7 offset:12288
    v_mfma_f32_16x16x32_bf16 a[60:63], v[84:87], a[100:103], a[60:63]
    s_add_u32 m0, s67, s20
    s_add_u32 s48, s66, s59
    s_add_u32 m0, m0, 0
    s_add_u32 s48, s48, 0
    buffer_load_dwordx4 v20, s[24:27], s48 offen lds
    s_waitcnt lgkmcnt(6)
    v_mfma_f32_16x16x32_bf16 a[0:3], v[88:91], a[108:111], a[0:3]
    ds_read_b64_tr_b16 v[80:81], v8 offset:8192
    ds_read_b64_tr_b16 v[82:83], v8 offset:12288
    v_mfma_f32_16x16x32_bf16 a[32:35], v[88:91], a[112:115], a[32:35]
    s_add_u32 m0, s67, s20
    s_add_u32 s48, s66, s59
    s_add_u32 m0, m0, 1024
    s_add_u32 s48, s48, 5120
    buffer_load_dwordx4 v21, s[24:27], s48 offen lds
    s_waitcnt lgkmcnt(6)
    v_mfma_f32_16x16x32_bf16 a[4:7], v[92:95], a[108:111], a[4:7]
    ds_read_b64_tr_b16 v[84:85], v9 offset:8192
    ds_read_b64_tr_b16 v[86:87], v9 offset:12288
    v_mfma_f32_16x16x32_bf16 a[36:39], v[92:95], a[112:115], a[36:39]
    s_waitcnt lgkmcnt(6)
    v_mfma_f32_16x16x32_bf16 a[8:11], v[72:75], a[108:111], a[8:11]
    ds_read_b64_tr_b16 v[88:89], v10 offset:8192
    ds_read_b64_tr_b16 v[90:91], v10 offset:12288
    v_mfma_f32_16x16x32_bf16 a[40:43], v[72:75], a[112:115], a[40:43]
    s_waitcnt lgkmcnt(6)
    v_mfma_f32_16x16x32_bf16 a[12:15], v[76:79], a[108:111], a[12:15]
    ds_read_b64_tr_b16 v[92:93], v11 offset:8192
    ds_read_b64_tr_b16 v[94:95], v11 offset:12288
    v_mfma_f32_16x16x32_bf16 a[44:47], v[76:79], a[112:115], a[44:47]
    s_waitcnt vmcnt(16)
    s_waitcnt lgkmcnt(6)
    v_mfma_f32_16x16x32_bf16 a[16:19], v[80:83], a[108:111], a[16:19]
    ds_read_b64_tr_b16 v[72:73], v4 offset:16384
    ds_read_b64_tr_b16 v[74:75], v4 offset:20480
    v_mfma_f32_16x16x32_bf16 a[48:51], v[80:83], a[112:115], a[48:51]
    s_waitcnt lgkmcnt(6)
    v_mfma_f32_16x16x32_bf16 a[20:23], v[84:87], a[108:111], a[20:23]
    ds_read_b64_tr_b16 v[76:77], v5 offset:16384
    ds_read_b64_tr_b16 v[78:79], v5 offset:20480
    v_mfma_f32_16x16x32_bf16 a[52:55], v[84:87], a[112:115], a[52:55]
    s_waitcnt lgkmcnt(6)
    v_mfma_f32_16x16x32_bf16 a[24:27], v[88:91], a[108:111], a[24:27]
    ds_read_b64_tr_b16 v[80:81], v6 offset:16384
    ds_read_b64_tr_b16 v[82:83], v6 offset:20480
    v_mfma_f32_16x16x32_bf16 a[56:59], v[88:91], a[112:115], a[56:59]
    s_waitcnt lgkmcnt(6)
    v_mfma_f32_16x16x32_bf16 a[28:31], v[92:95], a[108:111], a[28:31]
    ds_read_b64_tr_b16 v[84:85], v7 offset:16384
    ds_read_b64_tr_b16 v[86:87], v7 offset:20480
    v_mfma_f32_16x16x32_bf16 a[60:63], v[92:95], a[112:115], a[60:63]
    s_lshr_b32 s52, s51, 1
    s_mul_i32 s52, s52, 36864
    s_and_b32 s48, s51, 1
    s_lshl_b32 s48, s48, 11
    s_add_u32 s52, s52, s48
    s_add_u32 s51, s51, 1
    s_and_b32 s51, s51, 7
    s_add_u32 s48, s96, s52
    buffer_load_dwordx4 a[96:99], v0, s[28:31], s48 offen offset:0 sc1
    s_add_u32 s48, s97, s52
    buffer_load_dwordx4 a[100:103], v0, s[28:31], s48 offen offset:0 sc1
    s_add_u32 s48, s96, s52
    buffer_load_dwordx4 a[108:111], v0, s[28:31], s48 offen offset:1024 sc1
    s_add_u32 s48, s97, s52
    buffer_load_dwordx4 a[112:115], v0, s[28:31], s48 offen offset:1024 sc1
    s_waitcnt lgkmcnt(6)
    v_mfma_f32_16x16x32_bf16 a[0:3], v[72:75], a[120:123], a[0:3]
    ds_read_b64_tr_b16 v[88:89], v8 offset:16384
    ds_read_b64_tr_b16 v[90:91], v8 offset:20480
    v_mfma_f32_16x16x32_bf16 a[32:35], v[72:75], a[124:127], a[32:35]
    s_waitcnt lgkmcnt(6)
    v_mfma_f32_16x16x32_bf16 a[4:7], v[76:79], a[120:123], a[4:7]
    ds_read_b64_tr_b16 v[92:93], v9 offset:16384
    ds_read_b64_tr_b16 v[94:95], v9 offset:20480
    v_mfma_f32_16x16x32_bf16 a[36:39], v[76:79], a[124:127], a[36:39]
    s_waitcnt lgkmcnt(6)
    v_mfma_f32_16x16x32_bf16 a[8:11], v[80:83], a[120:123], a[8:11]
    ds_read_b64_tr_b16 v[72:73], v10 offset:16384
    ds_read_b64_tr_b16 v[74:75], v10 offset:20480
    v_mfma_f32_16x16x32_bf16 a[40:43], v[80:83], a[124:127], a[40:43]
    s_waitcnt lgkmcnt(6)
    v_mfma_f32_16x16x32_bf16 a[12:15], v[84:87], a[120:123], a[12:15]
    ds_read_b64_tr_b16 v[76:77], v11 offset:16384
    ds_read_b64_tr_b16 v[78:79], v11 offset:20480
    v_mfma_f32_16x16x32_bf16 a[44:47], v[84:87], a[124:127], a[44:47]
    s_waitcnt lgkmcnt(6)
    v_mfma_f32_16x16x32_bf16 a[16:19], v[88:91], a[120:123], a[16:19]
    ds_read_b64_tr_b16 v[80:81], v4 offset:24576
    ds_read_b64_tr_b16 v[82:83], v4 offset:28672
    v_mfma_f32_16x16x32_bf16 a[48:51], v[88:91], a[124:127], a[48:51]
    s_waitcnt lgkmcnt(6)
    v_mfma_f32_16x16x32_bf16 a[20:23], v[92:95], a[120:123], a[20:23]
    ds_read_b64_tr_b16 v[84:85], v5 offset:24576
    ds_read_b64_tr_b16 v[86:87], v5 offset:28672
    v_mfma_f32_16x16x32_bf16 a[52:55], v[92:95], a[124:127], a[52:55]
    s_waitcnt lgkmcnt(6)
    v_mfma_f32_16x16x32_bf16 a[24:27], v[72:75], a[120:123], a[24:27]
    ds_read_b64_tr_b16 v[88:89], v6 offset:24576
    ds_read_b64_tr_b16 v[90:91], v6 offset:28672
    v_mfma_f32_16x16x32_bf16 a[56:59], v[72:75], a[124:127], a[56:59]
    s_waitcnt lgkmcnt(6)
    v_mfma_f32_16x16x32_bf16 a[28:31], v[76:79], a[120:123], a[28:31]
    ds_read_b64_tr_b16 v[92:93], v7 offset:24576
    ds_read_b64_tr_b16 v[94:95], v7 offset:28672
    v_mfma_f32_16x16x32_bf16 a[60:63], v[76:79], a[124:127], a[60:63]
    s_waitcnt lgkmcnt(6)
    v_mfma_f32_16x16x32_bf16 a[0:3], v[80:83], a[132:135], a[0:3]
    ds_read_b64_tr_b16 v[72:73], v8 offset:24576
    ds_read_b64_tr_b16 v[74:75], v8 offset:28672
    v_mfma_f32_16x16x32_bf16 a[32:35], v[80:83], a[136:139], a[32:35]
    s_waitcnt lgkmcnt(6)
    v_mfma_f32_16x16x32_bf16 a[4:7], v[84:87], a[132:135], a[4:7]
    ds_read_b64_tr_b16 v[76:77], v9 offset:24576
    ds_read_b64_tr_b16 v[78:79], v9 offset:28672
    v_mfma_f32_16x16x32_bf16 a[36:39], v[84:87], a[136:139], a[36:39]
    s_waitcnt lgkmcnt(6)
    v_mfma_f32_16x16x32_bf16 a[8:11], v[88:91], a[132:135], a[8:11]
    ds_read_b64_tr_b16 v[80:81], v10 offset:24576
    ds_read_b64_tr_b16 v[82:83], v10 offset:28672
    v_mfma_f32_16x16x32_bf16 a[40:43], v[88:91], a[136:139], a[40:43]
    s_waitcnt lgkmcnt(6)
    v_mfma_f32_16x16x32_bf16 a[12:15], v[92:95], a[132:135], a[12:15]
    ds_read_b64_tr_b16 v[84:85], v11 offset:24576
    ds_read_b64_tr_b16 v[86:87], v11 offset:28672
    v_mfma_f32_16x16x32_bf16 a[44:47], v[92:95], a[136:139], a[44:47]
    s_waitcnt vmcnt(16)
    s_waitcnt lgkmcnt(6)
    v_mfma_f32_16x16x32_bf16 a[16:19], v[72:75], a[132:135], a[16:19]
    ds_read_b64_tr_b16 v[88:89], v4 offset:32768
    ds_read_b64_tr_b16 v[90:91], v4 offset:36864
    v_mfma_f32_16x16x32_bf16 a[48:51], v[72:75], a[136:139], a[48:51]
    s_waitcnt lgkmcnt(6)
    v_mfma_f32_16x16x32_bf16 a[20:23], v[76:79], a[132:135], a[20:23]
    ds_read_b64_tr_b16 v[92:93], v5 offset:32768
    ds_read_b64_tr_b16 v[94:95], v5 offset:36864
    v_mfma_f32_16x16x32_bf16 a[52:55], v[76:79], a[136:139], a[52:55]
    s_waitcnt lgkmcnt(6)
    v_mfma_f32_16x16x32_bf16 a[24:27], v[80:83], a[132:135], a[24:27]
    ds_read_b64_tr_b16 v[72:73], v6 offset:32768
    ds_read_b64_tr_b16 v[74:75], v6 offset:36864
    v_mfma_f32_16x16x32_bf16 a[56:59], v[80:83], a[136:139], a[56:59]
    s_waitcnt lgkmcnt(6)
    v_mfma_f32_16x16x32_bf16 a[28:31], v[84:87], a[132:135], a[28:31]
    ds_read_b64_tr_b16 v[76:77], v7 offset:32768
    ds_read_b64_tr_b16 v[78:79], v7 offset:36864
    v_mfma_f32_16x16x32_bf16 a[60:63], v[84:87], a[136:139], a[60:63]
    s_lshr_b32 s52, s51, 1
    s_mul_i32 s52, s52, 36864
    s_and_b32 s48, s51, 1
    s_lshl_b32 s48, s48, 11
    s_add_u32 s52, s52, s48
    s_add_u32 s51, s51, 1
    s_and_b32 s51, s51, 7
    s_add_u32 s48, s96, s52
    buffer_load_dwordx4 a[120:123], v0, s[28:31], s48 offen offset:0 sc1
    s_add_u32 s48, s97, s52
    buffer_load_dwordx4 a[124:127], v0, s[28:31], s48 offen offset:0 sc1
    s_add_u32 s48, s96, s52
    buffer_load_dwordx4 a[132:135], v0, s[28:31], s48 offen offset:1024 sc1
    s_add_u32 s48, s97, s52
    buffer_load_dwordx4 a[136:139], v0, s[28:31], s48 offen offset:1024 sc1
    s_waitcnt lgkmcnt(6)
    v_mfma_f32_16x16x32_bf16 a[0:3], v[88:91], v[24:27], a[0:3]
    ds_read_b64_tr_b16 v[80:81], v8 offset:32768
    ds_read_b64_tr_b16 v[82:83], v8 offset:36864
    v_mfma_f32_16x16x32_bf16 a[32:35], v[88:91], v[28:31], a[32:35]
    s_waitcnt lgkmcnt(6)
    v_mfma_f32_16x16x32_bf16 a[4:7], v[92:95], v[24:27], a[4:7]
    ds_read_b64_tr_b16 v[84:85], v9 offset:32768
    ds_read_b64_tr_b16 v[86:87], v9 offset:36864
    v_mfma_f32_16x16x32_bf16 a[36:39], v[92:95], v[28:31], a[36:39]
    s_waitcnt lgkmcnt(6)
    v_mfma_f32_16x16x32_bf16 a[8:11], v[72:75], v[24:27], a[8:11]
    ds_read_b64_tr_b16 v[88:89], v10 offset:32768
    ds_read_b64_tr_b16 v[90:91], v10 offset:36864
    v_mfma_f32_16x16x32_bf16 a[40:43], v[72:75], v[28:31], a[40:43]
    s_waitcnt lgkmcnt(6)
    v_mfma_f32_16x16x32_bf16 a[12:15], v[76:79], v[24:27], a[12:15]
    ds_read_b64_tr_b16 v[92:93], v11 offset:32768
    ds_read_b64_tr_b16 v[94:95], v11 offset:36864
    v_mfma_f32_16x16x32_bf16 a[44:47], v[76:79], v[28:31], a[44:47]
    s_waitcnt lgkmcnt(6)
    v_mfma_f32_16x16x32_bf16 a[16:19], v[80:83], v[24:27], a[16:19]
    ds_read_b64_tr_b16 v[72:73], v4 offset:40960
    ds_read_b64_tr_b16 v[74:75], v4 offset:45056
    v_mfma_f32_16x16x32_bf16 a[48:51], v[80:83], v[28:31], a[48:51]
    s_waitcnt lgkmcnt(6)
    v_mfma_f32_16x16x32_bf16 a[20:23], v[84:87], v[24:27], a[20:23]
    ds_read_b64_tr_b16 v[76:77], v5 offset:40960
    ds_read_b64_tr_b16 v[78:79], v5 offset:45056
    v_mfma_f32_16x16x32_bf16 a[52:55], v[84:87], v[28:31], a[52:55]
    s_waitcnt lgkmcnt(6)
    v_mfma_f32_16x16x32_bf16 a[24:27], v[88:91], v[24:27], a[24:27]
    ds_read_b64_tr_b16 v[80:81], v6 offset:40960
    ds_read_b64_tr_b16 v[82:83], v6 offset:45056
    v_mfma_f32_16x16x32_bf16 a[56:59], v[88:91], v[28:31], a[56:59]
    s_waitcnt lgkmcnt(6)
    v_mfma_f32_16x16x32_bf16 a[28:31], v[92:95], v[24:27], a[28:31]
    ds_read_b64_tr_b16 v[84:85], v7 offset:40960
    ds_read_b64_tr_b16 v[86:87], v7 offset:45056
    v_mfma_f32_16x16x32_bf16 a[60:63], v[92:95], v[28:31], a[60:63]
    s_waitcnt lgkmcnt(6)
    v_mfma_f32_16x16x32_bf16 a[0:3], v[72:75], v[36:39], a[0:3]
    ds_read_b64_tr_b16 v[88:89], v8 offset:40960
    ds_read_b64_tr_b16 v[90:91], v8 offset:45056
    v_mfma_f32_16x16x32_bf16 a[32:35], v[72:75], v[40:43], a[32:35]
    s_waitcnt lgkmcnt(6)
    v_mfma_f32_16x16x32_bf16 a[4:7], v[76:79], v[36:39], a[4:7]
    ds_read_b64_tr_b16 v[92:93], v9 offset:40960
    ds_read_b64_tr_b16 v[94:95], v9 offset:45056
    v_mfma_f32_16x16x32_bf16 a[36:39], v[76:79], v[40:43], a[36:39]
    s_waitcnt lgkmcnt(6)
    v_mfma_f32_16x16x32_bf16 a[8:11], v[80:83], v[36:39], a[8:11]
    ds_read_b64_tr_b16 v[72:73], v10 offset:40960
    ds_read_b64_tr_b16 v[74:75], v10 offset:45056
    v_mfma_f32_16x16x32_bf16 a[40:43], v[80:83], v[40:43], a[40:43]
    s_waitcnt lgkmcnt(6)
    v_mfma_f32_16x16x32_bf16 a[12:15], v[84:87], v[36:39], a[12:15]
    ds_read_b64_tr_b16 v[76:77], v11 offset:40960
    ds_read_b64_tr_b16 v[78:79], v11 offset:45056
    v_mfma_f32_16x16x32_bf16 a[44:47], v[84:87], v[40:43], a[44:47]
    s_waitcnt vmcnt(14)
    s_waitcnt lgkmcnt(6)
    v_mfma_f32_16x16x32_bf16 a[16:19], v[88:91], v[36:39], a[16:19]
    ds_read_b64_tr_b16 v[80:81], v4 offset:49152
    ds_read_b64_tr_b16 v[82:83], v4 offset:53248
    v_mfma_f32_16x16x32_bf16 a[48:51], v[88:91], v[40:43], a[48:51]
    s_waitcnt lgkmcnt(6)
    v_mfma_f32_16x16x32_bf16 a[20:23], v[92:95], v[36:39], a[20:23]
    ds_read_b64_tr_b16 v[84:85], v5 offset:49152
    ds_read_b64_tr_b16 v[86:87], v5 offset:53248
    v_mfma_f32_16x16x32_bf16 a[52:55], v[92:95], v[40:43], a[52:55]
    s_waitcnt lgkmcnt(6)
    v_mfma_f32_16x16x32_bf16 a[24:27], v[72:75], v[36:39], a[24:27]
    ds_read_b64_tr_b16 v[88:89], v6 offset:49152
    ds_read_b64_tr_b16 v[90:91], v6 offset:53248
    v_mfma_f32_16x16x32_bf16 a[56:59], v[72:75], v[40:43], a[56:59]
    s_waitcnt lgkmcnt(6)
    v_mfma_f32_16x16x32_bf16 a[28:31], v[76:79], v[36:39], a[28:31]
    ds_read_b64_tr_b16 v[92:93], v7 offset:49152
    ds_read_b64_tr_b16 v[94:95], v7 offset:53248
    v_mfma_f32_16x16x32_bf16 a[60:63], v[76:79], v[40:43], a[60:63]
    s_lshr_b32 s52, s51, 1
    s_mul_i32 s52, s52, 36864
    s_and_b32 s48, s51, 1
    s_lshl_b32 s48, s48, 11
    s_add_u32 s52, s52, s48
    s_add_u32 s51, s51, 1
    s_and_b32 s51, s51, 7
    s_add_u32 s48, s96, s52
    buffer_load_dwordx4 v[24:27], v0, s[28:31], s48 offen offset:0 sc1
    s_add_u32 s48, s97, s52
    buffer_load_dwordx4 v[28:31], v0, s[28:31], s48 offen offset:0 sc1
    s_add_u32 s48, s96, s52
    buffer_load_dwordx4 v[36:39], v0, s[28:31], s48 offen offset:1024 sc1
    s_add_u32 s48, s97, s52
    buffer_load_dwordx4 v[40:43], v0, s[28:31], s48 offen offset:1024 sc1
    s_waitcnt lgkmcnt(6)
    v_mfma_f32_16x16x32_bf16 a[0:3], v[80:83], v[48:51], a[0:3]
    ds_read_b64_tr_b16 v[72:73], v8 offset:49152
    ds_read_b64_tr_b16 v[74:75], v8 offset:53248
    v_mfma_f32_16x16x32_bf16 a[32:35], v[80:83], v[52:55], a[32:35]
    s_waitcnt lgkmcnt(6)
    v_mfma_f32_16x16x32_bf16 a[4:7], v[84:87], v[48:51], a[4:7]
    ds_read_b64_tr_b16 v[76:77], v9 offset:49152
    ds_read_b64_tr_b16 v[78:79], v9 offset:53248
    v_mfma_f32_16x16x32_bf16 a[36:39], v[84:87], v[52:55], a[36:39]
    s_waitcnt lgkmcnt(6)
    v_mfma_f32_16x16x32_bf16 a[8:11], v[88:91], v[48:51], a[8:11]
    ds_read_b64_tr_b16 v[80:81], v10 offset:49152
    ds_read_b64_tr_b16 v[82:83], v10 offset:53248
    v_mfma_f32_16x16x32_bf16 a[40:43], v[88:91], v[52:55], a[40:43]
    s_waitcnt lgkmcnt(6)
    v_mfma_f32_16x16x32_bf16 a[12:15], v[92:95], v[48:51], a[12:15]
    ds_read_b64_tr_b16 v[84:85], v11 offset:49152
    ds_read_b64_tr_b16 v[86:87], v11 offset:53248
    v_mfma_f32_16x16x32_bf16 a[44:47], v[92:95], v[52:55], a[44:47]
    s_waitcnt lgkmcnt(6)
    v_mfma_f32_16x16x32_bf16 a[16:19], v[72:75], v[48:51], a[16:19]
    ds_read_b64_tr_b16 v[88:89], v4 offset:57344
    ds_read_b64_tr_b16 v[90:91], v4 offset:61440
    v_mfma_f32_16x16x32_bf16 a[48:51], v[72:75], v[52:55], a[48:51]
    s_waitcnt lgkmcnt(6)
    v_mfma_f32_16x16x32_bf16 a[20:23], v[76:79], v[48:51], a[20:23]
    ds_read_b64_tr_b16 v[92:93], v5 offset:57344
    ds_read_b64_tr_b16 v[94:95], v5 offset:61440
    v_mfma_f32_16x16x32_bf16 a[52:55], v[76:79], v[52:55], a[52:55]
    s_waitcnt lgkmcnt(6)
    v_mfma_f32_16x16x32_bf16 a[24:27], v[80:83], v[48:51], a[24:27]
    ds_read_b64_tr_b16 v[72:73], v6 offset:57344
    ds_read_b64_tr_b16 v[74:75], v6 offset:61440
    v_mfma_f32_16x16x32_bf16 a[56:59], v[80:83], v[52:55], a[56:59]
    s_waitcnt lgkmcnt(6)
    v_mfma_f32_16x16x32_bf16 a[28:31], v[84:87], v[48:51], a[28:31]
    ds_read_b64_tr_b16 v[76:77], v7 offset:57344
    ds_read_b64_tr_b16 v[78:79], v7 offset:61440
    v_mfma_f32_16x16x32_bf16 a[60:63], v[84:87], v[52:55], a[60:63]
    s_waitcnt lgkmcnt(6)
    v_mfma_f32_16x16x32_bf16 a[0:3], v[88:91], v[60:63], a[0:3]
    ds_read_b64_tr_b16 v[80:81], v8 offset:57344
    ds_read_b64_tr_b16 v[82:83], v8 offset:61440
    v_mfma_f32_16x16x32_bf16 a[32:35], v[88:91], v[64:67], a[32:35]
    s_waitcnt lgkmcnt(6)
    v_mfma_f32_16x16x32_bf16 a[4:7], v[92:95], v[60:63], a[4:7]
    ds_read_b64_tr_b16 v[84:85], v9 offset:57344
    ds_read_b64_tr_b16 v[86:87], v9 offset:61440
    v_mfma_f32_16x16x32_bf16 a[36:39], v[92:95], v[64:67], a[36:39]
    s_waitcnt lgkmcnt(6)
    v_mfma_f32_16x16x32_bf16 a[8:11], v[72:75], v[60:63], a[8:11]
    ds_read_b64_tr_b16 v[88:89], v10 offset:57344
    ds_read_b64_tr_b16 v[90:91], v10 offset:61440
    v_mfma_f32_16x16x32_bf16 a[40:43], v[72:75], v[64:67], a[40:43]
    s_waitcnt lgkmcnt(6)
    v_mfma_f32_16x16x32_bf16 a[12:15], v[76:79], v[60:63], a[12:15]
    ds_read_b64_tr_b16 v[92:93], v11 offset:57344
    ds_read_b64_tr_b16 v[94:95], v11 offset:61440
    v_mfma_f32_16x16x32_bf16 a[44:47], v[76:79], v[64:67], a[44:47]
    s_waitcnt vmcnt(8)
    s_waitcnt lgkmcnt(0)
    s_barrier
    v_mfma_f32_16x16x32_bf16 a[16:19], v[80:83], v[60:63], a[16:19]
    ds_read_b64_tr_b16 v[72:73], v12 offset:0
    ds_read_b64_tr_b16 v[74:75], v12 offset:4096
    v_mfma_f32_16x16x32_bf16 a[48:51], v[80:83], v[64:67], a[48:51]
    v_mfma_f32_16x16x32_bf16 a[20:23], v[84:87], v[60:63], a[20:23]
    ds_read_b64_tr_b16 v[76:77], v13 offset:0
    ds_read_b64_tr_b16 v[78:79], v13 offset:4096
    v_mfma_f32_16x16x32_bf16 a[52:55], v[84:87], v[64:67], a[52:55]
    v_mfma_f32_16x16x32_bf16 a[24:27], v[88:91], v[60:63], a[24:27]
    ds_read_b64_tr_b16 v[80:81], v14 offset:0
    ds_read_b64_tr_b16 v[82:83], v14 offset:4096
    v_mfma_f32_16x16x32_bf16 a[56:59], v[88:91], v[64:67], a[56:59]
    v_mfma_f32_16x16x32_bf16 a[28:31], v[92:95], v[60:63], a[28:31]
    ds_read_b64_tr_b16 v[84:85], v15 offset:0
    ds_read_b64_tr_b16 v[86:87], v15 offset:4096
    v_mfma_f32_16x16x32_bf16 a[60:63], v[92:95], v[64:67], a[60:63]
    s_lshr_b32 s52, s51, 1
    s_mul_i32 s52, s52, 36864
    s_and_b32 s48, s51, 1
    s_lshl_b32 s48, s48, 11
    s_add_u32 s52, s52, s48
    s_add_u32 s51, s51, 1
    s_and_b32 s51, s51, 7
    s_add_u32 s48, s96, s52
    buffer_load_dwordx4 v[48:51], v0, s[28:31], s48 offen offset:0 sc1
    s_add_u32 s48, s97, s52
    buffer_load_dwordx4 v[52:55], v0, s[28:31], s48 offen offset:0 sc1
    s_add_u32 s48, s96, s52
    buffer_load_dwordx4 v[60:63], v0, s[28:31], s48 offen offset:1024 sc1
    s_add_u32 s48, s97, s52
    buffer_load_dwordx4 v[64:67], v0, s[28:31], s48 offen offset:1024 sc1
    s_waitcnt lgkmcnt(6)
    v_mfma_f32_16x16x32_bf16 a[0:3], v[72:75], a[96:99], a[0:3]
    ds_read_b64_tr_b16 v[88:89], v16 offset:0
    ds_read_b64_tr_b16 v[90:91], v16 offset:4096
    v_mfma_f32_16x16x32_bf16 a[32:35], v[72:75], a[100:103], a[32:35]
    s_waitcnt lgkmcnt(6)
    v_mfma_f32_16x16x32_bf16 a[4:7], v[76:79], a[96:99], a[4:7]
    ds_read_b64_tr_b16 v[92:93], v17 offset:0
    ds_read_b64_tr_b16 v[94:95], v17 offset:4096
    v_mfma_f32_16x16x32_bf16 a[36:39], v[76:79], a[100:103], a[36:39]
    s_waitcnt lgkmcnt(6)
    v_mfma_f32_16x16x32_bf16 a[8:11], v[80:83], a[96:99], a[8:11]
    ds_read_b64_tr_b16 v[72:73], v18 offset:0
    ds_read_b64_tr_b16 v[74:75], v18 offset:4096
    v_mfma_f32_16x16x32_bf16 a[40:43], v[80:83], a[100:103], a[40:43]
    s_waitcnt lgkmcnt(6)
    v_mfma_f32_16x16x32_bf16 a[12:15], v[84:87], a[96:99], a[12:15]
    ds_read_b64_tr_b16 v[76:77], v19 offset:0
    ds_read_b64_tr_b16 v[78:79], v19 offset:4096
    v_mfma_f32_16x16x32_bf16 a[44:47], v[84:87], a[100:103], a[44:47]
    s_waitcnt lgkmcnt(6)
    v_mfma_f32_16x16x32_bf16 a[16:19], v[88:91], a[96:99], a[16:19]
    ds_read_b64_tr_b16 v[80:81], v12 offset:8192
    ds_read_b64_tr_b16 v[82:83], v12 offset:12288
    v_mfma_f32_16x16x32_bf16 a[48:51], v[88:91], a[100:103], a[48:51]
    s_waitcnt lgkmcnt(6)
    v_mfma_f32_16x16x32_bf16 a[20:23], v[92:95], a[96:99], a[20:23]
    ds_read_b64_tr_b16 v[84:85], v13 offset:8192
    ds_read_b64_tr_b16 v[86:87], v13 offset:12288
    v_mfma_f32_16x16x32_bf16 a[52:55], v[92:95], a[100:103], a[52:55]
    s_waitcnt lgkmcnt(6)
    v_mfma_f32_16x16x32_bf16 a[24:27], v[72:75], a[96:99], a[24:27]
    ds_read_b64_tr_b16 v[88:89], v14 offset:8192
    ds_read_b64_tr_b16 v[90:91], v14 offset:12288
    v_mfma_f32_16x16x32_bf16 a[56:59], v[72:75], a[100:103], a[56:59]
    s_waitcnt lgkmcnt(6)
    v_mfma_f32_16x16x32_bf16 a[28:31], v[76:79], a[96:99], a[28:31]
    ds_read_b64_tr_b16 v[92:93], v15 offset:8192
    ds_read_b64_tr_b16 v[94:95], v15 offset:12288
    v_mfma_f32_16x16x32_bf16 a[60:63], v[76:79], a[100:103], a[60:63]
    s_waitcnt lgkmcnt(6)
    v_mfma_f32_16x16x32_bf16 a[0:3], v[80:83], a[108:111], a[0:3]
    ds_read_b64_tr_b16 v[72:73], v16 offset:8192
    ds_read_b64_tr_b16 v[74:75], v16 offset:12288
    v_mfma_f32_16x16x32_bf16 a[32:35], v[80:83], a[112:115], a[32:35]
    s_waitcnt lgkmcnt(6)
    v_mfma_f32_16x16x32_bf16 a[4:7], v[84:87], a[108:111], a[4:7]
    ds_read_b64_tr_b16 v[76:77], v17 offset:8192
    ds_read_b64_tr_b16 v[78:79], v17 offset:12288
    v_mfma_f32_16x16x32_bf16 a[36:39], v[84:87], a[112:115], a[36:39]
    s_waitcnt lgkmcnt(6)
    v_mfma_f32_16x16x32_bf16 a[8:11], v[88:91], a[108:111], a[8:11]
    ds_read_b64_tr_b16 v[80:81], v18 offset:8192
    ds_read_b64_tr_b16 v[82:83], v18 offset:12288
    v_mfma_f32_16x16x32_bf16 a[40:43], v[88:91], a[112:115], a[40:43]
    s_waitcnt lgkmcnt(6)
    v_mfma_f32_16x16x32_bf16 a[12:15], v[92:95], a[108:111], a[12:15]
    ds_read_b64_tr_b16 v[84:85], v19 offset:8192
    ds_read_b64_tr_b16 v[86:87], v19 offset:12288
    v_mfma_f32_16x16x32_bf16 a[44:47], v[92:95], a[112:115], a[44:47]
    s_waitcnt vmcnt(8)
    s_waitcnt lgkmcnt(6)
    v_mfma_f32_16x16x32_bf16 a[16:19], v[72:75], a[108:111], a[16:19]
    ds_read_b64_tr_b16 v[88:89], v12 offset:16384
    ds_read_b64_tr_b16 v[90:91], v12 offset:20480
    v_mfma_f32_16x16x32_bf16 a[48:51], v[72:75], a[112:115], a[48:51]
    s_waitcnt lgkmcnt(6)
    v_mfma_f32_16x16x32_bf16 a[20:23], v[76:79], a[108:111], a[20:23]
    ds_read_b64_tr_b16 v[92:93], v13 offset:16384
    ds_read_b64_tr_b16 v[94:95], v13 offset:20480
    v_mfma_f32_16x16x32_bf16 a[52:55], v[76:79], a[112:115], a[52:55]
    s_waitcnt lgkmcnt(6)
    v_mfma_f32_16x16x32_bf16 a[24:27], v[80:83], a[108:111], a[24:27]
    ds_read_b64_tr_b16 v[72:73], v14 offset:16384
    ds_read_b64_tr_b16 v[74:75], v14 offset:20480
    v_mfma_f32_16x16x32_bf16 a[56:59], v[80:83], a[112:115], a[56:59]
    s_waitcnt lgkmcnt(6)
    v_mfma_f32_16x16x32_bf16 a[28:31], v[84:87], a[108:111], a[28:31]
    ds_read_b64_tr_b16 v[76:77], v15 offset:16384
    ds_read_b64_tr_b16 v[78:79], v15 offset:20480
    v_mfma_f32_16x16x32_bf16 a[60:63], v[84:87], a[112:115], a[60:63]
    s_waitcnt lgkmcnt(6)
    v_mfma_f32_16x16x32_bf16 a[0:3], v[88:91], a[120:123], a[0:3]
    ds_read_b64_tr_b16 v[80:81], v16 offset:16384
    ds_read_b64_tr_b16 v[82:83], v16 offset:20480
    v_mfma_f32_16x16x32_bf16 a[32:35], v[88:91], a[124:127], a[32:35]
    s_waitcnt lgkmcnt(6)
    v_mfma_f32_16x16x32_bf16 a[4:7], v[92:95], a[120:123], a[4:7]
    ds_read_b64_tr_b16 v[84:85], v17 offset:16384
    ds_read_b64_tr_b16 v[86:87], v17 offset:20480
    v_mfma_f32_16x16x32_bf16 a[36:39], v[92:95], a[124:127], a[36:39]
    s_waitcnt lgkmcnt(6)
    v_mfma_f32_16x16x32_bf16 a[8:11], v[72:75], a[120:123], a[8:11]
    ds_read_b64_tr_b16 v[88:89], v18 offset:16384
    ds_read_b64_tr_b16 v[90:91], v18 offset:20480
    v_mfma_f32_16x16x32_bf16 a[40:43], v[72:75], a[124:127], a[40:43]
    s_waitcnt lgkmcnt(6)
    v_mfma_f32_16x16x32_bf16 a[12:15], v[76:79], a[120:123], a[12:15]
    ds_read_b64_tr_b16 v[92:93], v19 offset:16384
    ds_read_b64_tr_b16 v[94:95], v19 offset:20480
    v_mfma_f32_16x16x32_bf16 a[44:47], v[76:79], a[124:127], a[44:47]
    s_waitcnt lgkmcnt(6)
    v_mfma_f32_16x16x32_bf16 a[16:19], v[80:83], a[120:123], a[16:19]
    ds_read_b64_tr_b16 v[72:73], v12 offset:24576
    ds_read_b64_tr_b16 v[74:75], v12 offset:28672
    v_mfma_f32_16x16x32_bf16 a[48:51], v[80:83], a[124:127], a[48:51]
    s_waitcnt lgkmcnt(6)
    v_mfma_f32_16x16x32_bf16 a[20:23], v[84:87], a[120:123], a[20:23]
    ds_read_b64_tr_b16 v[76:77], v13 offset:24576
    ds_read_b64_tr_b16 v[78:79], v13 offset:28672
    v_mfma_f32_16x16x32_bf16 a[52:55], v[84:87], a[124:127], a[52:55]
    s_waitcnt lgkmcnt(6)
    v_mfma_f32_16x16x32_bf16 a[24:27], v[88:91], a[120:123], a[24:27]
    ds_read_b64_tr_b16 v[80:81], v14 offset:24576
    ds_read_b64_tr_b16 v[82:83], v14 offset:28672
    v_mfma_f32_16x16x32_bf16 a[56:59], v[88:91], a[124:127], a[56:59]
    s_waitcnt lgkmcnt(6)
    v_mfma_f32_16x16x32_bf16 a[28:31], v[92:95], a[120:123], a[28:31]
    ds_read_b64_tr_b16 v[84:85], v15 offset:24576
    ds_read_b64_tr_b16 v[86:87], v15 offset:28672
    v_mfma_f32_16x16x32_bf16 a[60:63], v[92:95], a[124:127], a[60:63]
    s_waitcnt lgkmcnt(6)
    v_mfma_f32_16x16x32_bf16 a[0:3], v[72:75], a[132:135], a[0:3]
    ds_read_b64_tr_b16 v[88:89], v16 offset:24576
    ds_read_b64_tr_b16 v[90:91], v16 offset:28672
    v_mfma_f32_16x16x32_bf16 a[32:35], v[72:75], a[136:139], a[32:35]
    s_waitcnt lgkmcnt(6)
    v_mfma_f32_16x16x32_bf16 a[4:7], v[76:79], a[132:135], a[4:7]
    ds_read_b64_tr_b16 v[92:93], v17 offset:24576
    ds_read_b64_tr_b16 v[94:95], v17 offset:28672
    v_mfma_f32_16x16x32_bf16 a[36:39], v[76:79], a[136:139], a[36:39]
    s_waitcnt lgkmcnt(6)
    v_mfma_f32_16x16x32_bf16 a[8:11], v[80:83], a[132:135], a[8:11]
    ds_read_b64_tr_b16 v[72:73], v18 offset:24576
    ds_read_b64_tr_b16 v[74:75], v18 offset:28672
    v_mfma_f32_16x16x32_bf16 a[40:43], v[80:83], a[136:139], a[40:43]
    s_waitcnt lgkmcnt(6)
    v_mfma_f32_16x16x32_bf16 a[12:15], v[84:87], a[132:135], a[12:15]
    ds_read_b64_tr_b16 v[76:77], v19 offset:24576
    ds_read_b64_tr_b16 v[78:79], v19 offset:28672
    v_mfma_f32_16x16x32_bf16 a[44:47], v[84:87], a[136:139], a[44:47]
    s_waitcnt vmcnt(4)
    s_waitcnt lgkmcnt(6)
    v_mfma_f32_16x16x32_bf16 a[16:19], v[88:91], a[132:135], a[16:19]
    ds_read_b64_tr_b16 v[80:81], v12 offset:32768
    ds_read_b64_tr_b16 v[82:83], v12 offset:36864
    v_mfma_f32_16x16x32_bf16 a[48:51], v[88:91], a[136:139], a[48:51]
    s_waitcnt lgkmcnt(6)
    v_mfma_f32_16x16x32_bf16 a[20:23], v[92:95], a[132:135], a[20:23]
    ds_read_b64_tr_b16 v[84:85], v13 offset:32768
    ds_read_b64_tr_b16 v[86:87], v13 offset:36864
    v_mfma_f32_16x16x32_bf16 a[52:55], v[92:95], a[136:139], a[52:55]
    s_waitcnt lgkmcnt(6)
    v_mfma_f32_16x16x32_bf16 a[24:27], v[72:75], a[132:135], a[24:27]
    ds_read_b64_tr_b16 v[88:89], v14 offset:32768
    ds_read_b64_tr_b16 v[90:91], v14 offset:36864
    v_mfma_f32_16x16x32_bf16 a[56:59], v[72:75], a[136:139], a[56:59]
    s_waitcnt lgkmcnt(6)
    v_mfma_f32_16x16x32_bf16 a[28:31], v[76:79], a[132:135], a[28:31]
    ds_read_b64_tr_b16 v[92:93], v15 offset:32768
    ds_read_b64_tr_b16 v[94:95], v15 offset:36864
    v_mfma_f32_16x16x32_bf16 a[60:63], v[76:79], a[136:139], a[60:63]
    s_waitcnt lgkmcnt(6)
    v_mfma_f32_16x16x32_bf16 a[0:3], v[80:83], v[24:27], a[0:3]
    ds_read_b64_tr_b16 v[72:73], v16 offset:32768
    ds_read_b64_tr_b16 v[74:75], v16 offset:36864
    v_mfma_f32_16x16x32_bf16 a[32:35], v[80:83], v[28:31], a[32:35]
    s_waitcnt lgkmcnt(6)
    v_mfma_f32_16x16x32_bf16 a[4:7], v[84:87], v[24:27], a[4:7]
    ds_read_b64_tr_b16 v[76:77], v17 offset:32768
    ds_read_b64_tr_b16 v[78:79], v17 offset:36864
    v_mfma_f32_16x16x32_bf16 a[36:39], v[84:87], v[28:31], a[36:39]
    s_waitcnt lgkmcnt(6)
    v_mfma_f32_16x16x32_bf16 a[8:11], v[88:91], v[24:27], a[8:11]
    ds_read_b64_tr_b16 v[80:81], v18 offset:32768
    ds_read_b64_tr_b16 v[82:83], v18 offset:36864
    v_mfma_f32_16x16x32_bf16 a[40:43], v[88:91], v[28:31], a[40:43]
    s_waitcnt lgkmcnt(6)
    v_mfma_f32_16x16x32_bf16 a[12:15], v[92:95], v[24:27], a[12:15]
    ds_read_b64_tr_b16 v[84:85], v19 offset:32768
    ds_read_b64_tr_b16 v[86:87], v19 offset:36864
    v_mfma_f32_16x16x32_bf16 a[44:47], v[92:95], v[28:31], a[44:47]
    s_waitcnt lgkmcnt(6)
    v_mfma_f32_16x16x32_bf16 a[16:19], v[72:75], v[24:27], a[16:19]
    ds_read_b64_tr_b16 v[88:89], v12 offset:40960
    ds_read_b64_tr_b16 v[90:91], v12 offset:45056
    v_mfma_f32_16x16x32_bf16 a[48:51], v[72:75], v[28:31], a[48:51]
    s_waitcnt lgkmcnt(6)
    v_mfma_f32_16x16x32_bf16 a[20:23], v[76:79], v[24:27], a[20:23]
    ds_read_b64_tr_b16 v[92:93], v13 offset:40960
    ds_read_b64_tr_b16 v[94:95], v13 offset:45056
    v_mfma_f32_16x16x32_bf16 a[52:55], v[76:79], v[28:31], a[52:55]
    s_waitcnt lgkmcnt(6)
    v_mfma_f32_16x16x32_bf16 a[24:27], v[80:83], v[24:27], a[24:27]
    ds_read_b64_tr_b16 v[72:73], v14 offset:40960
    ds_read_b64_tr_b16 v[74:75], v14 offset:45056
    v_mfma_f32_16x16x32_bf16 a[56:59], v[80:83], v[28:31], a[56:59]
    s_waitcnt lgkmcnt(6)
    v_mfma_f32_16x16x32_bf16 a[28:31], v[84:87], v[24:27], a[28:31]
    ds_read_b64_tr_b16 v[76:77], v15 offset:40960
    ds_read_b64_tr_b16 v[78:79], v15 offset:45056
    v_mfma_f32_16x16x32_bf16 a[60:63], v[84:87], v[28:31], a[60:63]
    s_waitcnt lgkmcnt(6)
    v_mfma_f32_16x16x32_bf16 a[0:3], v[88:91], v[36:39], a[0:3]
    ds_read_b64_tr_b16 v[80:81], v16 offset:40960
    ds_read_b64_tr_b16 v[82:83], v16 offset:45056
    v_mfma_f32_16x16x32_bf16 a[32:35], v[88:91], v[40:43], a[32:35]
    s_waitcnt lgkmcnt(6)
    v_mfma_f32_16x16x32_bf16 a[4:7], v[92:95], v[36:39], a[4:7]
    ds_read_b64_tr_b16 v[84:85], v17 offset:40960
    ds_read_b64_tr_b16 v[86:87], v17 offset:45056
    v_mfma_f32_16x16x32_bf16 a[36:39], v[92:95], v[40:43], a[36:39]
    s_waitcnt lgkmcnt(6)
    v_mfma_f32_16x16x32_bf16 a[8:11], v[72:75], v[36:39], a[8:11]
    ds_read_b64_tr_b16 v[88:89], v18 offset:40960
    ds_read_b64_tr_b16 v[90:91], v18 offset:45056
    v_mfma_f32_16x16x32_bf16 a[40:43], v[72:75], v[40:43], a[40:43]
    s_waitcnt lgkmcnt(6)
    v_mfma_f32_16x16x32_bf16 a[12:15], v[76:79], v[36:39], a[12:15]
    ds_read_b64_tr_b16 v[92:93], v19 offset:40960
    ds_read_b64_tr_b16 v[94:95], v19 offset:45056
    v_mfma_f32_16x16x32_bf16 a[44:47], v[76:79], v[40:43], a[44:47]
    s_waitcnt vmcnt(0)
    s_waitcnt lgkmcnt(6)
    v_mfma_f32_16x16x32_bf16 a[16:19], v[80:83], v[36:39], a[16:19]
    ds_read_b64_tr_b16 v[72:73], v12 offset:49152
    ds_read_b64_tr_b16 v[74:75], v12 offset:53248
    v_mfma_f32_16x16x32_bf16 a[48:51], v[80:83], v[40:43], a[48:51]
    s_waitcnt lgkmcnt(6)
    v_mfma_f32_16x16x32_bf16 a[20:23], v[84:87], v[36:39], a[20:23]
    ds_read_b64_tr_b16 v[76:77], v13 offset:49152
    ds_read_b64_tr_b16 v[78:79], v13 offset:53248
    v_mfma_f32_16x16x32_bf16 a[52:55], v[84:87], v[40:43], a[52:55]
    s_waitcnt lgkmcnt(6)
    v_mfma_f32_16x16x32_bf16 a[24:27], v[88:91], v[36:39], a[24:27]
    ds_read_b64_tr_b16 v[80:81], v14 offset:49152
    ds_read_b64_tr_b16 v[82:83], v14 offset:53248
    v_mfma_f32_16x16x32_bf16 a[56:59], v[88:91], v[40:43], a[56:59]
    s_waitcnt lgkmcnt(6)
    v_mfma_f32_16x16x32_bf16 a[28:31], v[92:95], v[36:39], a[28:31]
    ds_read_b64_tr_b16 v[84:85], v15 offset:49152
    ds_read_b64_tr_b16 v[86:87], v15 offset:53248
    v_mfma_f32_16x16x32_bf16 a[60:63], v[92:95], v[40:43], a[60:63]
    s_waitcnt lgkmcnt(6)
    v_mfma_f32_16x16x32_bf16 a[0:3], v[72:75], v[48:51], a[0:3]
    ds_read_b64_tr_b16 v[88:89], v16 offset:49152
    ds_read_b64_tr_b16 v[90:91], v16 offset:53248
    v_mfma_f32_16x16x32_bf16 a[32:35], v[72:75], v[52:55], a[32:35]
    s_waitcnt lgkmcnt(6)
    v_mfma_f32_16x16x32_bf16 a[4:7], v[76:79], v[48:51], a[4:7]
    ds_read_b64_tr_b16 v[92:93], v17 offset:49152
    ds_read_b64_tr_b16 v[94:95], v17 offset:53248
    v_mfma_f32_16x16x32_bf16 a[36:39], v[76:79], v[52:55], a[36:39]
    s_waitcnt lgkmcnt(6)
    v_mfma_f32_16x16x32_bf16 a[8:11], v[80:83], v[48:51], a[8:11]
    ds_read_b64_tr_b16 v[72:73], v18 offset:49152
    ds_read_b64_tr_b16 v[74:75], v18 offset:53248
    v_mfma_f32_16x16x32_bf16 a[40:43], v[80:83], v[52:55], a[40:43]
    s_waitcnt lgkmcnt(6)
    v_mfma_f32_16x16x32_bf16 a[12:15], v[84:87], v[48:51], a[12:15]
    ds_read_b64_tr_b16 v[76:77], v19 offset:49152
    ds_read_b64_tr_b16 v[78:79], v19 offset:53248
    v_mfma_f32_16x16x32_bf16 a[44:47], v[84:87], v[52:55], a[44:47]
    s_waitcnt lgkmcnt(6)
    v_mfma_f32_16x16x32_bf16 a[16:19], v[88:91], v[48:51], a[16:19]
    ds_read_b64_tr_b16 v[80:81], v12 offset:57344
    ds_read_b64_tr_b16 v[82:83], v12 offset:61440
    v_mfma_f32_16x16x32_bf16 a[48:51], v[88:91], v[52:55], a[48:51]
    s_waitcnt lgkmcnt(6)
    v_mfma_f32_16x16x32_bf16 a[20:23], v[92:95], v[48:51], a[20:23]
    ds_read_b64_tr_b16 v[84:85], v13 offset:57344
    ds_read_b64_tr_b16 v[86:87], v13 offset:61440
    v_mfma_f32_16x16x32_bf16 a[52:55], v[92:95], v[52:55], a[52:55]
    s_waitcnt lgkmcnt(6)
    v_mfma_f32_16x16x32_bf16 a[24:27], v[72:75], v[48:51], a[24:27]
    ds_read_b64_tr_b16 v[88:89], v14 offset:57344
    ds_read_b64_tr_b16 v[90:91], v14 offset:61440
    v_mfma_f32_16x16x32_bf16 a[56:59], v[72:75], v[52:55], a[56:59]
    s_waitcnt lgkmcnt(6)
    v_mfma_f32_16x16x32_bf16 a[28:31], v[76:79], v[48:51], a[28:31]
    ds_read_b64_tr_b16 v[92:93], v15 offset:57344
    ds_read_b64_tr_b16 v[94:95], v15 offset:61440
    v_mfma_f32_16x16x32_bf16 a[60:63], v[76:79], v[52:55], a[60:63]
    s_waitcnt lgkmcnt(6)
    v_mfma_f32_16x16x32_bf16 a[0:3], v[80:83], v[60:63], a[0:3]
    ds_read_b64_tr_b16 v[72:73], v16 offset:57344
    ds_read_b64_tr_b16 v[74:75], v16 offset:61440
    v_mfma_f32_16x16x32_bf16 a[32:35], v[80:83], v[64:67], a[32:35]
    s_waitcnt lgkmcnt(6)
    v_mfma_f32_16x16x32_bf16 a[4:7], v[84:87], v[60:63], a[4:7]
    ds_read_b64_tr_b16 v[76:77], v17 offset:57344
    ds_read_b64_tr_b16 v[78:79], v17 offset:61440
    v_mfma_f32_16x16x32_bf16 a[36:39], v[84:87], v[64:67], a[36:39]
    s_waitcnt lgkmcnt(6)
    v_mfma_f32_16x16x32_bf16 a[8:11], v[88:91], v[60:63], a[8:11]
    ds_read_b64_tr_b16 v[80:81], v18 offset:57344
    ds_read_b64_tr_b16 v[82:83], v18 offset:61440
    v_mfma_f32_16x16x32_bf16 a[40:43], v[88:91], v[64:67], a[40:43]
    s_waitcnt lgkmcnt(6)
    v_mfma_f32_16x16x32_bf16 a[12:15], v[92:95], v[60:63], a[12:15]
    ds_read_b64_tr_b16 v[84:85], v19 offset:57344
    ds_read_b64_tr_b16 v[86:87], v19 offset:61440
    v_mfma_f32_16x16x32_bf16 a[44:47], v[92:95], v[64:67], a[44:47]
    s_waitcnt lgkmcnt(6)
    v_mfma_f32_16x16x32_bf16 a[16:19], v[72:75], v[60:63], a[16:19]
    v_mfma_f32_16x16x32_bf16 a[48:51], v[72:75], v[64:67], a[48:51]
    s_waitcnt lgkmcnt(4)
    v_mfma_f32_16x16x32_bf16 a[20:23], v[76:79], v[60:63], a[20:23]
    v_mfma_f32_16x16x32_bf16 a[52:55], v[76:79], v[64:67], a[52:55]
    s_waitcnt lgkmcnt(2)
    v_mfma_f32_16x16x32_bf16 a[24:27], v[80:83], v[60:63], a[24:27]
    v_mfma_f32_16x16x32_bf16 a[56:59], v[80:83], v[64:67], a[56:59]
    s_waitcnt lgkmcnt(0)
    v_mfma_f32_16x16x32_bf16 a[28:31], v[84:87], v[60:63], a[28:31]
    v_mfma_f32_16x16x32_bf16 a[60:63], v[84:87], v[64:67], a[60:63]
    s_cmp_eq_u32 s3, 1
    s_cbranch_scc1 L_xw1a
    s_cmp_eq_u32 s3, 2
    s_cbranch_scc1 L_xw2a
    s_cmp_eq_u32 s3, 3
    s_cbranch_scc1 L_xw3a
L_xw0a:
    s_lshl_b32 s84, s62, 2
    s_mul_i32 s84, s84, 30
    s_add_u32 s84, s84, s60
    s_lshl_b32 s84, s84, 2
    s_add_u32 s84, s84, s3
    s_mul_i32 s84, s84, 12288
    s_add_u32 s84, s84, 18874368
    s_add_u32 s32, s4, s84
    s_addc_u32 s33, s5, 0
    s_mov_b32 s34, 4435968
    s_mov_b32 s35, 0x20000
    s_mul_i32 s85, s61, 1474560
    s_load_dwordx2 s[8:9], s[0:1], 80
    s_nop 7
    s_cmp_lg_u32 s61, 0
    s_cbranch_scc1 L_x0_0a
    v_accvgpr_read_b32 v24, a8
    v_accvgpr_read_b32 v25, a9
    v_accvgpr_read_b32 v26, a10
    v_accvgpr_read_b32 v27, a11
    v_accvgpr_read_b32 v28, a12
    v_accvgpr_read_b32 v29, a13
    v_accvgpr_read_b32 v30, a14
    v_accvgpr_read_b32 v31, a15
    v_cvt_pk_bf16_f32 v24, v24, v25
    v_cvt_pk_bf16_f32 v25, v26, v27
    v_cvt_pk_bf16_f32 v26, v28, v29
    v_cvt_pk_bf16_f32 v27, v30, v31
    s_add_u32 s48, s85, 3072
    buffer_store_dwordx4 v[24:27], v0, s[32:35], s48 offen sc1
    v_accvgpr_read_b32 v32, a40
    v_accvgpr_read_b32 v33, a41
    v_accvgpr_read_b32 v34, a42
    v_accvgpr_read_b32 v35, a43
    v_accvgpr_read_b32 v36, a44
    v_accvgpr_read_b32 v37, a45
    v_accvgpr_read_b32 v38, a46
    v_accvgpr_read_b32 v39, a47
    v_cvt_pk_bf16_f32 v32, v32, v33
    v_cvt_pk_bf16_f32 v33, v34, v35
    v_cvt_pk_bf16_f32 v34, v36, v37
    v_cvt_pk_bf16_f32 v35, v38, v39
    s_add_u32 s48, s85, 4096
    buffer_store_dwordx4 v[32:35], v0, s[32:35], s48 offen sc1
    v_accvgpr_read_b32 v40, a16
    v_accvgpr_read_b32 v41, a17
    v_accvgpr_read_b32 v42, a18
    v_accvgpr_read_b32 v43, a19
    v_accvgpr_read_b32 v44, a20
    v_accvgpr_read_b32 v45, a21
    v_accvgpr_read_b32 v46, a22
    v_accvgpr_read_b32 v47, a23
    v_cvt_pk_bf16_f32 v40, v40, v41
    v_cvt_pk_bf16_f32 v41, v42, v43
    v_cvt_pk_bf16_f32 v42, v44, v45
    v_cvt_pk_bf16_f32 v43, v46, v47
    s_add_u32 s48, s85, 6144
    buffer_store_dwordx4 v[40:43], v0, s[32:35], s48 offen sc1
    v_accvgpr_read_b32 v48, a48
    v_accvgpr_read_b32 v49, a49
    v_accvgpr_read_b32 v50, a50
    v_accvgpr_read_b32 v51, a51
    v_accvgpr_read_b32 v52, a52
    v_accvgpr_read_b32 v53, a53
    v_accvgpr_read_b32 v54, a54
    v_accvgpr_read_b32 v55, a55
    v_cvt_pk_bf16_f32 v48, v48, v49
    v_cvt_pk_bf16_f32 v49, v50, v51
    v_cvt_pk_bf16_f32 v50, v52, v53
    v_cvt_pk_bf16_f32 v51, v54, v55
    s_add_u32 s48, s85, 7168
    buffer_store_dwordx4 v[48:51], v0, s[32:35], s48 offen sc1
    v_accvgpr_read_b32 v56, a24
    v_accvgpr_read_b32 v57, a25
    v_accvgpr_read_b32 v58, a26
    v_accvgpr_read_b32 v59, a27
    v_accvgpr_read_b32 v60, a28
    v_accvgpr_read_b32 v61, a29
    v_accvgpr_read_b32 v62, a30
    v_accvgpr_read_b32 v63, a31
    v_cvt_pk_bf16_f32 v56, v56, v57
    v_cvt_pk_bf16_f32 v57, v58, v59
    v_cvt_pk_bf16_f32 v58, v60, v61
    v_cvt_pk_bf16_f32 v59, v62, v63
    s_add_u32 s48, s85, 9216
    buffer_store_dwordx4 v[56:59], v0, s[32:35], s48 offen sc1
    v_accvgpr_read_b32 v64, a56
    v_accvgpr_read_b32 v65, a57
    v_accvgpr_read_b32 v66, a58
    v_accvgpr_read_b32 v67, a59
    v_accvgpr_read_b32 v68, a60
    v_accvgpr_read_b32 v69, a61
    v_accvgpr_read_b32 v70, a62
    v_accvgpr_read_b32 v71, a63
    v_cvt_pk_bf16_f32 v64, v64, v65
    v_cvt_pk_bf16_f32 v65, v66, v67
    v_cvt_pk_bf16_f32 v66, v68, v69
    v_cvt_pk_bf16_f32 v67, v70, v71
    s_add_u32 s48, s85, 10240
    buffer_store_dwordx4 v[64:67], v0, s[32:35], s48 offen sc1
    s_mul_i32 s86, s63, 12
    s_add_u32 s86, s86, 0
    s_mul_i32 s86, s86, 40960
    s_mul_i32 s87, s62, 1280
    s_add_u32 s86, s86, s87
    s_lshl_b32 s87, s64, 8
    s_add_u32 s86, s86, s87
    s_add_u32 s86, s86, 0
    s_waitcnt vmcnt(0) lgkmcnt(0)
    s_barrier
    s_cmp_lg_u32 s7, 0
    s_cbranch_scc1 L_pub2
    s_and_b32 s48, s2, 7
    s_lshl_b32 s48, s48, 5
    s_lshr_b32 s49, s2, 3
    s_add_u32 s48, s48, s49
    v_mov_b32 v2, s48
    v_mov_b32 v3, 3
    s_mov_b64 exec, 1
    global_store_byte v2, v3, s[22:23] sc1
    s_mov_b64 exec, -1
L_pub2:
    s_mov_b32 s12, s8
    s_mov_b32 s13, s9
    s_mov_b32 s14, 2949120
    s_mov_b32 s15, 0x20000
    s_cmp_lg_u32 s7, 0
    s_cbranch_scc1 L_xp0_0a_skip
    s_lshl_b32 s48, s62, 7
    s_add_u32 s48, s48, s60
    v_and_b32 v2, 3, v1
    v_lshlrev_b32 v2, 5, v2
    v_add_u32 v2, s48, v2
    s_mov_b32 s69, 0
L_xp0_0a_poll:
    global_load_ubyte v3, v2, s[22:23] sc1
    s_add_u32 s69, s69, 1
    s_waitcnt vmcnt(0)
    v_cmp_gt_u32 vcc, 3, v3
    s_cmp_ge_u32 s69, 131072
    s_cbranch_scc1 L_xp0_0a_skip
    s_nop 2
    s_cbranch_vccz L_xp0_0a_skip
    s_sleep 1
    s_branch L_xp0_0a_poll
L_xp0_0a_skip:
    s_barrier
    s_mov_b32 s48, 1474560
    buffer_load_dwordx4 v[24:27], v0, s[32:35], s48 offen sc1
    s_mov_b32 s48, 1475584
    buffer_load_dwordx4 v[28:31], v0, s[32:35], s48 offen sc1
    s_mov_b32 s48, 2949120
    buffer_load_dwordx4 v[36:39], v0, s[32:35], s48 offen sc1
    s_mov_b32 s48, 2950144
    buffer_load_dwordx4 v[40:43], v0, s[32:35], s48 offen sc1
    s_mov_b32 s48, 4423680
    buffer_load_dwordx4 v[48:51], v0, s[32:35], s48 offen sc1
    s_mov_b32 s48, 4424704
    buffer_load_dwordx4 v[52:55], v0, s[32:35], s48 offen sc1
    v_and_b32 v2, 15, v1
    v_mul_u32_u24 v2, 2560, v2
    v_lshrrev_b32 v3, 4, v1
    v_lshl_add_u32 v2, v3, 3, v2
    v_accvgpr_read_b32 v64, a0
    v_accvgpr_read_b32 v65, a1
    v_accvgpr_read_b32 v66, a2
    v_accvgpr_read_b32 v67, a3
    s_waitcnt vmcnt(5)
    v_lshlrev_b32 v22, 16, v24
    v_and_b32 v23, 0xffff0000, v24
    v_add_f32 v64, v64, v22
    v_add_f32 v65, v65, v23
    v_lshlrev_b32 v22, 16, v25
    v_and_b32 v23, 0xffff0000, v25
    v_add_f32 v66, v66, v22
    v_add_f32 v67, v67, v23
    s_waitcnt vmcnt(3)
    v_lshlrev_b32 v22, 16, v36
    v_and_b32 v23, 0xffff0000, v36
    v_add_f32 v64, v64, v22
    v_add_f32 v65, v65, v23
    v_lshlrev_b32 v22, 16, v37
    v_and_b32 v23, 0xffff0000, v37
    v_add_f32 v66, v66, v22
    v_add_f32 v67, v67, v23
    s_waitcnt vmcnt(1)
    v_lshlrev_b32 v22, 16, v48
    v_and_b32 v23, 0xffff0000, v48
    v_add_f32 v64, v64, v22
    v_add_f32 v65, v65, v23
    v_lshlrev_b32 v22, 16, v49
    v_and_b32 v23, 0xffff0000, v49
    v_add_f32 v66, v66, v22
    v_add_f32 v67, v67, v23
    v_cvt_pk_bf16_f32 v64, v64, v65
    v_cvt_pk_bf16_f32 v65, v66, v67
    s_add_u32 s48, s86, 0
    buffer_store_dwordx2 v[64:65], v2, s[12:15], s48 offen offset:0
    v_accvgpr_read_b32 v68, a4
    v_accvgpr_read_b32 v69, a5
    v_accvgpr_read_b32 v70, a6
    v_accvgpr_read_b32 v71, a7
    v_lshlrev_b32 v22, 16, v26
    v_and_b32 v23, 0xffff0000, v26
    v_add_f32 v68, v68, v22
    v_add_f32 v69, v69, v23
    v_lshlrev_b32 v22, 16, v27
    v_and_b32 v23, 0xffff0000, v27
    v_add_f32 v70, v70, v22
    v_add_f32 v71, v71, v23
    v_lshlrev_b32 v22, 16, v38
    v_and_b32 v23, 0xffff0000, v38
    v_add_f32 v68, v68, v22
    v_add_f32 v69, v69, v23
    v_lshlrev_b32 v22, 16, v39
    v_and_b32 v23, 0xffff0000, v39
    v_add_f32 v70, v70, v22
    v_add_f32 v71, v71, v23
    v_lshlrev_b32 v22, 16, v50
    v_and_b32 v23, 0xffff0000, v50
    v_add_f32 v68, v68, v22
    v_add_f32 v69, v69, v23
    v_lshlrev_b32 v22, 16, v51
    v_and_b32 v23, 0xffff0000, v51
    v_add_f32 v70, v70, v22
    v_add_f32 v71, v71, v23
    v_cvt_pk_bf16_f32 v68, v68, v69
    v_cvt_pk_bf16_f32 v69, v70, v71
    s_add_u32 s48, s86, 0
    buffer_store_dwordx2 v[68:69], v2, s[12:15], s48 offen offset:32
    v_accvgpr_read_b32 v72, a32
    v_accvgpr_read_b32 v73, a33
    v_accvgpr_read_b32 v74, a34
    v_accvgpr_read_b32 v75, a35
    v_lshlrev_b32 v22, 16, v28
    v_and_b32 v23, 0xffff0000, v28
    v_add_f32 v72, v72, v22
    v_add_f32 v73, v73, v23
    v_lshlrev_b32 v22, 16, v29
    v_and_b32 v23, 0xffff0000, v29
    v_add_f32 v74, v74, v22
    v_add_f32 v75, v75, v23
    v_lshlrev_b32 v22, 16, v40
    v_and_b32 v23, 0xffff0000, v40
    v_add_f32 v72, v72, v22
    v_add_f32 v73, v73, v23
    v_lshlrev_b32 v22, 16, v41
    v_and_b32 v23, 0xffff0000, v41
    v_add_f32 v74, v74, v22
    v_add_f32 v75, v75, v23
    s_waitcnt vmcnt(2)
    v_lshlrev_b32 v22, 16, v52
    v_and_b32 v23, 0xffff0000, v52
    v_add_f32 v72, v72, v22
    v_add_f32 v73, v73, v23
    v_lshlrev_b32 v22, 16, v53
    v_and_b32 v23, 0xffff0000, v53
    v_add_f32 v74, v74, v22
    v_add_f32 v75, v75, v23
    v_cvt_pk_bf16_f32 v72, v72, v73
    v_cvt_pk_bf16_f32 v73, v74, v75
    s_add_u32 s48, s86, 40960
    buffer_store_dwordx2 v[72:73], v2, s[12:15], s48 offen offset:0
    v_accvgpr_read_b32 v76, a36
    v_accvgpr_read_b32 v77, a37
    v_accvgpr_read_b32 v78, a38
    v_accvgpr_read_b32 v79, a39
    v_lshlrev_b32 v22, 16, v30
    v_and_b32 v23, 0xffff0000, v30
    v_add_f32 v76, v76, v22
    v_add_f32 v77, v77, v23
    v_lshlrev_b32 v22, 16, v31
    v_and_b32 v23, 0xffff0000, v31
    v_add_f32 v78, v78, v22
    v_add_f32 v79, v79, v23
    v_lshlrev_b32 v22, 16, v42
    v_and_b32 v23, 0xffff0000, v42
    v_add_f32 v76, v76, v22
    v_add_f32 v77, v77, v23
    v_lshlrev_b32 v22, 16, v43
    v_and_b32 v23, 0xffff0000, v43
    v_add_f32 v78, v78, v22
    v_add_f32 v79, v79, v23
    v_lshlrev_b32 v22, 16, v54
    v_and_b32 v23, 0xffff0000, v54
    v_add_f32 v76, v76, v22
    v_add_f32 v77, v77, v23
    v_lshlrev_b32 v22, 16, v55
    v_and_b32 v23, 0xffff0000, v55
    v_add_f32 v78, v78, v22
    v_add_f32 v79, v79, v23
    v_cvt_pk_bf16_f32 v76, v76, v77
    v_cvt_pk_bf16_f32 v77, v78, v79
    s_add_u32 s48, s86, 40960
    buffer_store_dwordx2 v[76:77], v2, s[12:15], s48 offen offset:32
    s_branch L_end2
L_x0_0a:
    s_cmp_lg_u32 s61, 1
    s_cbranch_scc1 L_x0_1a
    v_accvgpr_read_b32 v24, a0
    v_accvgpr_read_b32 v25, a1
    v_accvgpr_read_b32 v26, a2
    v_accvgpr_read_b32 v27, a3
    v_accvgpr_read_b32 v28, a4
    v_accvgpr_read_b32 v29, a5
    v_accvgpr_read_b32 v30, a6
    v_accvgpr_read_b32 v31, a7
    v_cvt_pk_bf16_f32 v24, v24, v25
    v_cvt_pk_bf16_f32 v25, v26, v27
    v_cvt_pk_bf16_f32 v26, v28, v29
    v_cvt_pk_bf16_f32 v27, v30, v31
    s_add_u32 s48, s85, 0
    buffer_store_dwordx4 v[24:27], v0, s[32:35], s48 offen sc1
    v_accvgpr_read_b32 v32, a32
    v_accvgpr_read_b32 v33, a33
    v_accvgpr_read_b32 v34, a34
    v_accvgpr_read_b32 v35, a35
    v_accvgpr_read_b32 v36, a36
    v_accvgpr_read_b32 v37, a37
    v_accvgpr_read_b32 v38, a38
    v_accvgpr_read_b32 v39, a39
    v_cvt_pk_bf16_f32 v32, v32, v33
    v_cvt_pk_bf16_f32 v33, v34, v35
    v_cvt_pk_bf16_f32 v34, v36, v37
    v_cvt_pk_bf16_f32 v35, v38, v39
    s_add_u32 s48, s85, 1024
    buffer_store_dwordx4 v[32:35], v0, s[32:35], s48 offen sc1
    v_accvgpr_read_b32 v40, a16
    v_accvgpr_read_b32 v41, a17
    v_accvgpr_read_b32 v42, a18
    v_accvgpr_read_b32 v43, a19
    v_accvgpr_read_b32 v44, a20
    v_accvgpr_read_b32 v45, a21
    v_accvgpr_read_b32 v46, a22
    v_accvgpr_read_b32 v47, a23
    v_cvt_pk_bf16_f32 v40, v40, v41
    v_cvt_pk_bf16_f32 v41, v42, v43
    v_cvt_pk_bf16_f32 v42, v44, v45
    v_cvt_pk_bf16_f32 v43, v46, v47
    s_add_u32 s48, s85, 6144
    buffer_store_dwordx4 v[40:43], v0, s[32:35], s48 offen sc1
    v_accvgpr_read_b32 v48, a48
    v_accvgpr_read_b32 v49, a49
    v_accvgpr_read_b32 v50, a50
    v_accvgpr_read_b32 v51, a51
    v_accvgpr_read_b32 v52, a52
    v_accvgpr_read_b32 v53, a53
    v_accvgpr_read_b32 v54, a54
    v_accvgpr_read_b32 v55, a55
    v_cvt_pk_bf16_f32 v48, v48, v49
    v_cvt_pk_bf16_f32 v49, v50, v51
    v_cvt_pk_bf16_f32 v50, v52, v53
    v_cvt_pk_bf16_f32 v51, v54, v55
    s_add_u32 s48, s85, 7168
    buffer_store_dwordx4 v[48:51], v0, s[32:35], s48 offen sc1
    v_accvgpr_read_b32 v56, a24
    v_accvgpr_read_b32 v57, a25
    v_accvgpr_read_b32 v58, a26
    v_accvgpr_read_b32 v59, a27
    v_accvgpr_read_b32 v60, a28
    v_accvgpr_read_b32 v61, a29
    v_accvgpr_read_b32 v62, a30
    v_accvgpr_read_b32 v63, a31
    v_cvt_pk_bf16_f32 v56, v56, v57
    v_cvt_pk_bf16_f32 v57, v58, v59
    v_cvt_pk_bf16_f32 v58, v60, v61
    v_cvt_pk_bf16_f32 v59, v62, v63
    s_add_u32 s48, s85, 9216
    buffer_store_dwordx4 v[56:59], v0, s[32:35], s48 offen sc1
    v_accvgpr_read_b32 v64, a56
    v_accvgpr_read_b32 v65, a57
    v_accvgpr_read_b32 v66, a58
    v_accvgpr_read_b32 v67, a59
    v_accvgpr_read_b32 v68, a60
    v_accvgpr_read_b32 v69, a61
    v_accvgpr_read_b32 v70, a62
    v_accvgpr_read_b32 v71, a63
    v_cvt_pk_bf16_f32 v64, v64, v65
    v_cvt_pk_bf16_f32 v65, v66, v67
    v_cvt_pk_bf16_f32 v66, v68, v69
    v_cvt_pk_bf16_f32 v67, v70, v71
    s_add_u32 s48, s85, 10240
    buffer_store_dwordx4 v[64:67], v0, s[32:35], s48 offen sc1
    s_mul_i32 s86, s63, 12
    s_add_u32 s86, s86, 0
    s_mul_i32 s86, s86, 40960
    s_mul_i32 s87, s62, 1280
    s_add_u32 s86, s86, s87
    s_lshl_b32 s87, s64, 8
    s_add_u32 s86, s86, s87
    s_add_u32 s86, s86, 64
    s_waitcnt vmcnt(0) lgkmcnt(0)
    s_barrier
    s_cmp_lg_u32 s7, 0
    s_cbranch_scc1 L_pub3
    s_and_b32 s48, s2, 7
    s_lshl_b32 s48, s48, 5
    s_lshr_b32 s49, s2, 3
    s_add_u32 s48, s48, s49
    v_mov_b32 v2, s48
    v_mov_b32 v3, 3
    s_mov_b64 exec, 1
    global_store_byte v2, v3, s[22:23] sc1
    s_mov_b64 exec, -1
L_pub3:
    s_mov_b32 s12, s8
    s_mov_b32 s13, s9
    s_mov_b32 s14, 2949120
    s_mov_b32 s15, 0x20000
    s_cmp_lg_u32 s7, 0
    s_cbranch_scc1 L_xp0_1a_skip
    s_lshl_b32 s48, s62, 7
    s_add_u32 s48, s48, s60
    v_and_b32 v2, 3, v1
    v_lshlrev_b32 v2, 5, v2
    v_add_u32 v2, s48, v2
    s_mov_b32 s69, 0
L_xp0_1a_poll:
    global_load_ubyte v3, v2, s[22:23] sc1
    s_add_u32 s69, s69, 1
    s_waitcnt vmcnt(0)
    v_cmp_gt_u32 vcc, 3, v3
    s_cmp_ge_u32 s69, 131072
    s_cbranch_scc1 L_xp0_1a_skip
    s_nop 2
    s_cbranch_vccz L_xp0_1a_skip
    s_sleep 1
    s_branch L_xp0_1a_poll
L_xp0_1a_skip:
    s_barrier
    s_mov_b32 s48, 3072
    buffer_load_dwordx4 v[24:27], v0, s[32:35], s48 offen sc1
    s_mov_b32 s48, 4096
    buffer_load_dwordx4 v[28:31], v0, s[32:35], s48 offen sc1
    s_mov_b32 s48, 2952192
    buffer_load_dwordx4 v[36:39], v0, s[32:35], s48 offen sc1
    s_mov_b32 s48, 2953216
    buffer_load_dwordx4 v[40:43], v0, s[32:35], s48 offen sc1
    s_mov_b32 s48, 4426752
    buffer_load_dwordx4 v[48:51], v0, s[32:35], s48 offen sc1
    s_mov_b32 s48, 4427776
    buffer_load_dwordx4 v[52:55], v0, s[32:35], s48 offen sc1
    v_and_b32 v2, 15, v1
    v_mul_u32_u24 v2, 2560, v2
    v_lshrrev_b32 v3, 4, v1
    v_lshl_add_u32 v2, v3, 3, v2
    v_accvgpr_read_b32 v64, a8
    v_accvgpr_read_b32 v65, a9
    v_accvgpr_read_b32 v66, a10
    v_accvgpr_read_b32 v67, a11
    s_waitcnt vmcnt(5)
    v_lshlrev_b32 v22, 16, v24
    v_and_b32 v23, 0xffff0000, v24
    v_add_f32 v64, v64, v22
    v_add_f32 v65, v65, v23
    v_lshlrev_b32 v22, 16, v25
    v_and_b32 v23, 0xffff0000, v25
    v_add_f32 v66, v66, v22
    v_add_f32 v67, v67, v23
    s_waitcnt vmcnt(3)
    v_lshlrev_b32 v22, 16, v36
    v_and_b32 v23, 0xffff0000, v36
    v_add_f32 v64, v64, v22
    v_add_f32 v65, v65, v23
    v_lshlrev_b32 v22, 16, v37
    v_and_b32 v23, 0xffff0000, v37
    v_add_f32 v66, v66, v22
    v_add_f32 v67, v67, v23
    s_waitcnt vmcnt(1)
    v_lshlrev_b32 v22, 16, v48
    v_and_b32 v23, 0xffff0000, v48
    v_add_f32 v64, v64, v22
    v_add_f32 v65, v65, v23
    v_lshlrev_b32 v22, 16, v49
    v_and_b32 v23, 0xffff0000, v49
    v_add_f32 v66, v66, v22
    v_add_f32 v67, v67, v23
    v_cvt_pk_bf16_f32 v64, v64, v65
    v_cvt_pk_bf16_f32 v65, v66, v67
    s_add_u32 s48, s86, 0
    buffer_store_dwordx2 v[64:65], v2, s[12:15], s48 offen offset:0
    v_accvgpr_read_b32 v68, a12
    v_accvgpr_read_b32 v69, a13
    v_accvgpr_read_b32 v70, a14
    v_accvgpr_read_b32 v71, a15
    v_lshlrev_b32 v22, 16, v26
    v_and_b32 v23, 0xffff0000, v26
    v_add_f32 v68, v68, v22
    v_add_f32 v69, v69, v23
    v_lshlrev_b32 v22, 16, v27
    v_and_b32 v23, 0xffff0000, v27
    v_add_f32 v70, v70, v22
    v_add_f32 v71, v71, v23
    v_lshlrev_b32 v22, 16, v38
    v_and_b32 v23, 0xffff0000, v38
    v_add_f32 v68, v68, v22
    v_add_f32 v69, v69, v23
    v_lshlrev_b32 v22, 16, v39
    v_and_b32 v23, 0xffff0000, v39
    v_add_f32 v70, v70, v22
    v_add_f32 v71, v71, v23
    v_lshlrev_b32 v22, 16, v50
    v_and_b32 v23, 0xffff0000, v50
    v_add_f32 v68, v68, v22
    v_add_f32 v69, v69, v23
    v_lshlrev_b32 v22, 16, v51
    v_and_b32 v23, 0xffff0000, v51
    v_add_f32 v70, v70, v22
    v_add_f32 v71, v71, v23
    v_cvt_pk_bf16_f32 v68, v68, v69
    v_cvt_pk_bf16_f32 v69, v70, v71
    s_add_u32 s48, s86, 0
    buffer_store_dwordx2 v[68:69], v2, s[12:15], s48 offen offset:32
    v_accvgpr_read_b32 v72, a40
    v_accvgpr_read_b32 v73, a41
    v_accvgpr_read_b32 v74, a42
    v_accvgpr_read_b32 v75, a43
    v_lshlrev_b32 v22, 16, v28
    v_and_b32 v23, 0xffff0000, v28
    v_add_f32 v72, v72, v22
    v_add_f32 v73, v73, v23
    v_lshlrev_b32 v22, 16, v29
    v_and_b32 v23, 0xffff0000, v29
    v_add_f32 v74, v74, v22
    v_add_f32 v75, v75, v23
    v_lshlrev_b32 v22, 16, v40
    v_and_b32 v23, 0xffff0000, v40
    v_add_f32 v72, v72, v22
    v_add_f32 v73, v73, v23
    v_lshlrev_b32 v22, 16, v41
    v_and_b32 v23, 0xffff0000, v41
    v_add_f32 v74, v74, v22
    v_add_f32 v75, v75, v23
    s_waitcnt vmcnt(2)
    v_lshlrev_b32 v22, 16, v52
    v_and_b32 v23, 0xffff0000, v52
    v_add_f32 v72, v72, v22
    v_add_f32 v73, v73, v23
    v_lshlrev_b32 v22, 16, v53
    v_and_b32 v23, 0xffff0000, v53
    v_add_f32 v74, v74, v22
    v_add_f32 v75, v75, v23
    v_cvt_pk_bf16_f32 v72, v72, v73
    v_cvt_pk_bf16_f32 v73, v74, v75
    s_add_u32 s48, s86, 40960
    buffer_store_dwordx2 v[72:73], v2, s[12:15], s48 offen offset:0
    v_accvgpr_read_b32 v76, a44
    v_accvgpr_read_b32 v77, a45
    v_accvgpr_read_b32 v78, a46
    v_accvgpr_read_b32 v79, a47
    v_lshlrev_b32 v22, 16, v30
    v_and_b32 v23, 0xffff0000, v30
    v_add_f32 v76, v76, v22
    v_add_f32 v77, v77, v23
    v_lshlrev_b32 v22, 16, v31
    v_and_b32 v23, 0xffff0000, v31
    v_add_f32 v78, v78, v22
    v_add_f32 v79, v79, v23
    v_lshlrev_b32 v22, 16, v42
    v_and_b32 v23, 0xffff0000, v42
    v_add_f32 v76, v76, v22
    v_add_f32 v77, v77, v23
    v_lshlrev_b32 v22, 16, v43
    v_and_b32 v23, 0xffff0000, v43
    v_add_f32 v78, v78, v22
    v_add_f32 v79, v79, v23
    v_lshlrev_b32 v22, 16, v54
    v_and_b32 v23, 0xffff0000, v54
    v_add_f32 v76, v76, v22
    v_add_f32 v77, v77, v23
    v_lshlrev_b32 v22, 16, v55
    v_and_b32 v23, 0xffff0000, v55
    v_add_f32 v78, v78, v22
    v_add_f32 v79, v79, v23
    v_cvt_pk_bf16_f32 v76, v76, v77
    v_cvt_pk_bf16_f32 v77, v78, v79
    s_add_u32 s48, s86, 40960
    buffer_store_dwordx2 v[76:77], v2, s[12:15], s48 offen offset:32
    s_branch L_end2
L_x0_1a:
    s_cmp_lg_u32 s61, 2
    s_cbranch_scc1 L_x0_2a
    v_accvgpr_read_b32 v24, a0
    v_accvgpr_read_b32 v25, a1
    v_accvgpr_read_b32 v26, a2
    v_accvgpr_read_b32 v27, a3
    v_accvgpr_read_b32 v28, a4
    v_accvgpr_read_b32 v29, a5
    v_accvgpr_read_b32 v30, a6
    v_accvgpr_read_b32 v31, a7
    v_cvt_pk_bf16_f32 v24, v24, v25
    v_cvt_pk_bf16_f32 v25, v26, v27
    v_cvt_pk_bf16_f32 v26, v28, v29
    v_cvt_pk_bf16_f32 v27, v30, v31
    s_add_u32 s48, s85, 0
    buffer_store_dwordx4 v[24:27], v0, s[32:35], s48 offen sc1
    v_accvgpr_read_b32 v32, a32
    v_accvgpr_read_b32 v33, a33
    v_accvgpr_read_b32 v34, a34
    v_accvgpr_read_b32 v35, a35
    v_accvgpr_read_b32 v36, a36
    v_accvgpr_read_b32 v37, a37
    v_accvgpr_read_b32 v38, a38
    v_accvgpr_read_b32 v39, a39
    v_cvt_pk_bf16_f32 v32, v32, v33
    v_cvt_pk_bf16_f32 v33, v34, v35
    v_cvt_pk_bf16_f32 v34, v36, v37
    v_cvt_pk_bf16_f32 v35, v38, v39
    s_add_u32 s48, s85, 1024
    buffer_store_dwordx4 v[32:35], v0, s[32:35], s48 offen sc1
    v_accvgpr_read_b32 v40, a8
    v_accvgpr_read_b32 v41, a9
    v_accvgpr_read_b32 v42, a10
    v_accvgpr_read_b32 v43, a11
    v_accvgpr_read_b32 v44, a12
    v_accvgpr_read_b32 v45, a13
    v_accvgpr_read_b32 v46, a14
    v_accvgpr_read_b32 v47, a15
    v_cvt_pk_bf16_f32 v40, v40, v41
    v_cvt_pk_bf16_f32 v41, v42, v43
    v_cvt_pk_bf16_f32 v42, v44, v45
    v_cvt_pk_bf16_f32 v43, v46, v47
    s_add_u32 s48, s85, 3072
    buffer_store_dwordx4 v[40:43], v0, s[32:35], s48 offen sc1
    v_accvgpr_read_b32 v48, a40
    v_accvgpr_read_b32 v49, a41
    v_accvgpr_read_b32 v50, a42
    v_accvgpr_read_b32 v51, a43
    v_accvgpr_read_b32 v52, a44
    v_accvgpr_read_b32 v53, a45
    v_accvgpr_read_b32 v54, a46
    v_accvgpr_read_b32 v55, a47
    v_cvt_pk_bf16_f32 v48, v48, v49
    v_cvt_pk_bf16_f32 v49, v50, v51
    v_cvt_pk_bf16_f32 v50, v52, v53
    v_cvt_pk_bf16_f32 v51, v54, v55
    s_add_u32 s48, s85, 4096
    buffer_store_dwordx4 v[48:51], v0, s[32:35], s48 offen sc1
    v_accvgpr_read_b32 v56, a24
    v_accvgpr_read_b32 v57, a25
    v_accvgpr_read_b32 v58, a26
    v_accvgpr_read_b32 v59, a27
    v_accvgpr_read_b32 v60, a28
    v_accvgpr_read_b32 v61, a29
    v_accvgpr_read_b32 v62, a30
    v_accvgpr_read_b32 v63, a31
    v_cvt_pk_bf16_f32 v56, v56, v57
    v_cvt_pk_bf16_f32 v57, v58, v59
    v_cvt_pk_bf16_f32 v58, v60, v61
    v_cvt_pk_bf16_f32 v59, v62, v63
    s_add_u32 s48, s85, 9216
    buffer_store_dwordx4 v[56:59], v0, s[32:35], s48 offen sc1
    v_accvgpr_read_b32 v64, a56
    v_accvgpr_read_b32 v65, a57
    v_accvgpr_read_b32 v66, a58
    v_accvgpr_read_b32 v67, a59
    v_accvgpr_read_b32 v68, a60
    v_accvgpr_read_b32 v69, a61
    v_accvgpr_read_b32 v70, a62
    v_accvgpr_read_b32 v71, a63
    v_cvt_pk_bf16_f32 v64, v64, v65
    v_cvt_pk_bf16_f32 v65, v66, v67
    v_cvt_pk_bf16_f32 v66, v68, v69
    v_cvt_pk_bf16_f32 v67, v70, v71
    s_add_u32 s48, s85, 10240
    buffer_store_dwordx4 v[64:67], v0, s[32:35], s48 offen sc1
    s_mul_i32 s86, s63, 12
    s_add_u32 s86, s86, 0
    s_mul_i32 s86, s86, 40960
    s_mul_i32 s87, s62, 1280
    s_add_u32 s86, s86, s87
    s_lshl_b32 s87, s64, 8
    s_add_u32 s86, s86, s87
    s_add_u32 s86, s86, 128
    s_waitcnt vmcnt(0) lgkmcnt(0)
    s_barrier
    s_cmp_lg_u32 s7, 0
    s_cbranch_scc1 L_pub4
    s_and_b32 s48, s2, 7
    s_lshl_b32 s48, s48, 5
    s_lshr_b32 s49, s2, 3
    s_add_u32 s48, s48, s49
    v_mov_b32 v2, s48
    v_mov_b32 v3, 3
    s_mov_b64 exec, 1
    global_store_byte v2, v3, s[22:23] sc1
    s_mov_b64 exec, -1
L_pub4:
    s_mov_b32 s12, s8
    s_mov_b32 s13, s9
    s_mov_b32 s14, 2949120
    s_mov_b32 s15, 0x20000
    s_cmp_lg_u32 s7, 0
    s_cbranch_scc1 L_xp0_2a_skip
    s_lshl_b32 s48, s62, 7
    s_add_u32 s48, s48, s60
    v_and_b32 v2, 3, v1
    v_lshlrev_b32 v2, 5, v2
    v_add_u32 v2, s48, v2
    s_mov_b32 s69, 0
L_xp0_2a_poll:
    global_load_ubyte v3, v2, s[22:23] sc1
    s_add_u32 s69, s69, 1
    s_waitcnt vmcnt(0)
    v_cmp_gt_u32 vcc, 3, v3
    s_cmp_ge_u32 s69, 131072
    s_cbranch_scc1 L_xp0_2a_skip
    s_nop 2
    s_cbranch_vccz L_xp0_2a_skip
    s_sleep 1
    s_branch L_xp0_2a_poll
L_xp0_2a_skip:
    s_barrier
    s_mov_b32 s48, 6144
    buffer_load_dwordx4 v[24:27], v0, s[32:35], s48 offen sc1
    s_mov_b32 s48, 7168
    buffer_load_dwordx4 v[28:31], v0, s[32:35], s48 offen sc1
    s_mov_b32 s48, 1480704
    buffer_load_dwordx4 v[36:39], v0, s[32:35], s48 offen sc1
    s_mov_b32 s48, 1481728
    buffer_load_dwordx4 v[40:43], v0, s[32:35], s48 offen sc1
    s_mov_b32 s48, 4429824
    buffer_load_dwordx4 v[48:51], v0, s[32:35], s48 offen sc1
    s_mov_b32 s48, 4430848
    buffer_load_dwordx4 v[52:55], v0, s[32:35], s48 offen sc1
    v_and_b32 v2, 15, v1
    v_mul_u32_u24 v2, 2560, v2
    v_lshrrev_b32 v3, 4, v1
    v_lshl_add_u32 v2, v3, 3, v2
    v_accvgpr_read_b32 v64, a16
    v_accvgpr_read_b32 v65, a17
    v_accvgpr_read_b32 v66, a18
    v_accvgpr_read_b32 v67, a19
    s_waitcnt vmcnt(5)
    v_lshlrev_b32 v22, 16, v24
    v_and_b32 v23, 0xffff0000, v24
    v_add_f32 v64, v64, v22
    v_add_f32 v65, v65, v23
    v_lshlrev_b32 v22, 16, v25
    v_and_b32 v23, 0xffff0000, v25
    v_add_f32 v66, v66, v22
    v_add_f32 v67, v67, v23
    s_waitcnt vmcnt(3)
    v_lshlrev_b32 v22, 16, v36
    v_and_b32 v23, 0xffff0000, v36
    v_add_f32 v64, v64, v22
    v_add_f32 v65, v65, v23
    v_lshlrev_b32 v22, 16, v37
    v_and_b32 v23, 0xffff0000, v37
    v_add_f32 v66, v66, v22
    v_add_f32 v67, v67, v23
    s_waitcnt vmcnt(1)
    v_lshlrev_b32 v22, 16, v48
    v_and_b32 v23, 0xffff0000, v48
    v_add_f32 v64, v64, v22
    v_add_f32 v65, v65, v23
    v_lshlrev_b32 v22, 16, v49
    v_and_b32 v23, 0xffff0000, v49
    v_add_f32 v66, v66, v22
    v_add_f32 v67, v67, v23
    v_cvt_pk_bf16_f32 v64, v64, v65
    v_cvt_pk_bf16_f32 v65, v66, v67
    s_add_u32 s48, s86, 0
    buffer_store_dwordx2 v[64:65], v2, s[12:15], s48 offen offset:0
    v_accvgpr_read_b32 v68, a20
    v_accvgpr_read_b32 v69, a21
    v_accvgpr_read_b32 v70, a22
    v_accvgpr_read_b32 v71, a23
    v_lshlrev_b32 v22, 16, v26
    v_and_b32 v23, 0xffff0000, v26
    v_add_f32 v68, v68, v22
    v_add_f32 v69, v69, v23
    v_lshlrev_b32 v22, 16, v27
    v_and_b32 v23, 0xffff0000, v27
    v_add_f32 v70, v70, v22
    v_add_f32 v71, v71, v23
    v_lshlrev_b32 v22, 16, v38
    v_and_b32 v23, 0xffff0000, v38
    v_add_f32 v68, v68, v22
    v_add_f32 v69, v69, v23
    v_lshlrev_b32 v22, 16, v39
    v_and_b32 v23, 0xffff0000, v39
    v_add_f32 v70, v70, v22
    v_add_f32 v71, v71, v23
    v_lshlrev_b32 v22, 16, v50
    v_and_b32 v23, 0xffff0000, v50
    v_add_f32 v68, v68, v22
    v_add_f32 v69, v69, v23
    v_lshlrev_b32 v22, 16, v51
    v_and_b32 v23, 0xffff0000, v51
    v_add_f32 v70, v70, v22
    v_add_f32 v71, v71, v23
    v_cvt_pk_bf16_f32 v68, v68, v69
    v_cvt_pk_bf16_f32 v69, v70, v71
    s_add_u32 s48, s86, 0
    buffer_store_dwordx2 v[68:69], v2, s[12:15], s48 offen offset:32
    v_accvgpr_read_b32 v72, a48
    v_accvgpr_read_b32 v73, a49
    v_accvgpr_read_b32 v74, a50
    v_accvgpr_read_b32 v75, a51
    v_lshlrev_b32 v22, 16, v28
    v_and_b32 v23, 0xffff0000, v28
    v_add_f32 v72, v72, v22
    v_add_f32 v73, v73, v23
    v_lshlrev_b32 v22, 16, v29
    v_and_b32 v23, 0xffff0000, v29
    v_add_f32 v74, v74, v22
    v_add_f32 v75, v75, v23
    v_lshlrev_b32 v22, 16, v40
    v_and_b32 v23, 0xffff0000, v40
    v_add_f32 v72, v72, v22
    v_add_f32 v73, v73, v23
    v_lshlrev_b32 v22, 16, v41
    v_and_b32 v23, 0xffff0000, v41
    v_add_f32 v74, v74, v22
    v_add_f32 v75, v75, v23
    s_waitcnt vmcnt(2)
    v_lshlrev_b32 v22, 16, v52
    v_and_b32 v23, 0xffff0000, v52
    v_add_f32 v72, v72, v22
    v_add_f32 v73, v73, v23
    v_lshlrev_b32 v22, 16, v53
    v_and_b32 v23, 0xffff0000, v53
    v_add_f32 v74, v74, v22
    v_add_f32 v75, v75, v23
    v_cvt_pk_bf16_f32 v72, v72, v73
    v_cvt_pk_bf16_f32 v73, v74, v75
    s_add_u32 s48, s86, 40960
    buffer_store_dwordx2 v[72:73], v2, s[12:15], s48 offen offset:0
    v_accvgpr_read_b32 v76, a52
    v_accvgpr_read_b32 v77, a53
    v_accvgpr_read_b32 v78, a54
    v_accvgpr_read_b32 v79, a55
    v_lshlrev_b32 v22, 16, v30
    v_and_b32 v23, 0xffff0000, v30
    v_add_f32 v76, v76, v22
    v_add_f32 v77, v77, v23
    v_lshlrev_b32 v22, 16, v31
    v_and_b32 v23, 0xffff0000, v31
    v_add_f32 v78, v78, v22
    v_add_f32 v79, v79, v23
    v_lshlrev_b32 v22, 16, v42
    v_and_b32 v23, 0xffff0000, v42
    v_add_f32 v76, v76, v22
    v_add_f32 v77, v77, v23
    v_lshlrev_b32 v22, 16, v43
    v_and_b32 v23, 0xffff0000, v43
    v_add_f32 v78, v78, v22
    v_add_f32 v79, v79, v23
    v_lshlrev_b32 v22, 16, v54
    v_and_b32 v23, 0xffff0000, v54
    v_add_f32 v76, v76, v22
    v_add_f32 v77, v77, v23
    v_lshlrev_b32 v22, 16, v55
    v_and_b32 v23, 0xffff0000, v55
    v_add_f32 v78, v78, v22
    v_add_f32 v79, v79, v23
    v_cvt_pk_bf16_f32 v76, v76, v77
    v_cvt_pk_bf16_f32 v77, v78, v79
    s_add_u32 s48, s86, 40960
    buffer_store_dwordx2 v[76:77], v2, s[12:15], s48 offen offset:32
    s_branch L_end2
L_x0_2a:
    s_cmp_lg_u32 s61, 3
    s_cbranch_scc1 L_x0_3a
    v_accvgpr_read_b32 v24, a0
    v_accvgpr_read_b32 v25, a1
    v_accvgpr_read_b32 v26, a2
    v_accvgpr_read_b32 v27, a3
    v_accvgpr_read_b32 v28, a4
    v_accvgpr_read_b32 v29, a5
    v_accvgpr_read_b32 v30, a6
    v_accvgpr_read_b32 v31, a7
    v_cvt_pk_bf16_f32 v24, v24, v25
    v_cvt_pk_bf16_f32 v25, v26, v27
    v_cvt_pk_bf16_f32 v26, v28, v29
    v_cvt_pk_bf16_f32 v27, v30, v31
    s_add_u32 s48, s85, 0
    buffer_store_dwordx4 v[24:27], v0, s[32:35], s48 offen sc1
    v_accvgpr_read_b32 v32, a32
    v_accvgpr_read_b32 v33, a33
    v_accvgpr_read_b32 v34, a34
    v_accvgpr_read_b32 v35, a35
    v_accvgpr_read_b32 v36, a36
    v_accvgpr_read_b32 v37, a37
    v_accvgpr_read_b32 v38, a38
    v_accvgpr_read_b32 v39, a39
    v_cvt_pk_bf16_f32 v32, v32, v33
    v_cvt_pk_bf16_f32 v33, v34, v35
    v_cvt_pk_bf16_f32 v34, v36, v37
    v_cvt_pk_bf16_f32 v35, v38, v39
    s_add_u32 s48, s85, 1024
    buffer_store_dwordx4 v[32:35], v0, s[32:35], s48 offen sc1
    v_accvgpr_read_b32 v40, a8
    v_accvgpr_read_b32 v41, a9
    v_accvgpr_read_b32 v42, a10
    v_accvgpr_read_b32 v43, a11
    v_accvgpr_read_b32 v44, a12
    v_accvgpr_read_b32 v45, a13
    v_accvgpr_read_b32 v46, a14
    v_accvgpr_read_b32 v47, a15
    v_cvt_pk_bf16_f32 v40, v40, v41
    v_cvt_pk_bf16_f32 v41, v42, v43
    v_cvt_pk_bf16_f32 v42, v44, v45
    v_cvt_pk_bf16_f32 v43, v46, v47
    s_add_u32 s48, s85, 3072
    buffer_store_dwordx4 v[40:43], v0, s[32:35], s48 offen sc1
    v_accvgpr_read_b32 v48, a40
    v_accvgpr_read_b32 v49, a41
    v_accvgpr_read_b32 v50, a42
    v_accvgpr_read_b32 v51, a43
    v_accvgpr_read_b32 v52, a44
    v_accvgpr_read_b32 v53, a45
    v_accvgpr_read_b32 v54, a46
    v_accvgpr_read_b32 v55, a47
    v_cvt_pk_bf16_f32 v48, v48, v49
    v_cvt_pk_bf16_f32 v49, v50, v51
    v_cvt_pk_bf16_f32 v50, v52, v53
    v_cvt_pk_bf16_f32 v51, v54, v55
    s_add_u32 s48, s85, 4096
    buffer_store_dwordx4 v[48:51], v0, s[32:35], s48 offen sc1
    v_accvgpr_read_b32 v56, a16
    v_accvgpr_read_b32 v57, a17
    v_accvgpr_read_b32 v58, a18
    v_accvgpr_read_b32 v59, a19
    v_accvgpr_read_b32 v60, a20
    v_accvgpr_read_b32 v61, a21
    v_accvgpr_read_b32 v62, a22
    v_accvgpr_read_b32 v63, a23
    v_cvt_pk_bf16_f32 v56, v56, v57
    v_cvt_pk_bf16_f32 v57, v58, v59
    v_cvt_pk_bf16_f32 v58, v60, v61
    v_cvt_pk_bf16_f32 v59, v62, v63
    s_add_u32 s48, s85, 6144
    buffer_store_dwordx4 v[56:59], v0, s[32:35], s48 offen sc1
    v_accvgpr_read_b32 v64, a48
    v_accvgpr_read_b32 v65, a49
    v_accvgpr_read_b32 v66, a50
    v_accvgpr_read_b32 v67, a51
    v_accvgpr_read_b32 v68, a52
    v_accvgpr_read_b32 v69, a53
    v_accvgpr_read_b32 v70, a54
    v_accvgpr_read_b32 v71, a55
    v_cvt_pk_bf16_f32 v64, v64, v65
    v_cvt_pk_bf16_f32 v65, v66, v67
    v_cvt_pk_bf16_f32 v66, v68, v69
    v_cvt_pk_bf16_f32 v67, v70, v71
    s_add_u32 s48, s85, 7168
    buffer_store_dwordx4 v[64:67], v0, s[32:35], s48 offen sc1
    s_mul_i32 s86, s63, 12
    s_add_u32 s86, s86, 0
    s_mul_i32 s86, s86, 40960
    s_mul_i32 s87, s62, 1280
    s_add_u32 s86, s86, s87
    s_lshl_b32 s87, s64, 8
    s_add_u32 s86, s86, s87
    s_add_u32 s86, s86, 192
    s_waitcnt vmcnt(0) lgkmcnt(0)
    s_barrier
    s_cmp_lg_u32 s7, 0
    s_cbranch_scc1 L_pub5
    s_and_b32 s48, s2, 7
    s_lshl_b32 s48, s48, 5
    s_lshr_b32 s49, s2, 3
    s_add_u32 s48, s48, s49
    v_mov_b32 v2, s48
    v_mov_b32 v3, 3
    s_mov_b64 exec, 1
    global_store_byte v2, v3, s[22:23] sc1
    s_mov_b64 exec, -1
L_pub5:
    s_mov_b32 s12, s8
    s_mov_b32 s13, s9
    s_mov_b32 s14, 2949120
    s_mov_b32 s15, 0x20000
    s_cmp_lg_u32 s7, 0
    s_cbranch_scc1 L_xp0_3a_skip
    s_lshl_b32 s48, s62, 7
    s_add_u32 s48, s48, s60
    v_and_b32 v2, 3, v1
    v_lshlrev_b32 v2, 5, v2
    v_add_u32 v2, s48, v2
    s_mov_b32 s69, 0
L_xp0_3a_poll:
    global_load_ubyte v3, v2, s[22:23] sc1
    s_add_u32 s69, s69, 1
    s_waitcnt vmcnt(0)
    v_cmp_gt_u32 vcc, 3, v3
    s_cmp_ge_u32 s69, 131072
    s_cbranch_scc1 L_xp0_3a_skip
    s_nop 2
    s_cbranch_vccz L_xp0_3a_skip
    s_sleep 1
    s_branch L_xp0_3a_poll
L_xp0_3a_skip:
    s_barrier
    s_mov_b32 s48, 9216
    buffer_load_dwordx4 v[24:27], v0, s[32:35], s48 offen sc1
    s_mov_b32 s48, 10240
    buffer_load_dwordx4 v[28:31], v0, s[32:35], s48 offen sc1
    s_mov_b32 s48, 1483776
    buffer_load_dwordx4 v[36:39], v0, s[32:35], s48 offen sc1
    s_mov_b32 s48, 1484800
    buffer_load_dwordx4 v[40:43], v0, s[32:35], s48 offen sc1
    s_mov_b32 s48, 2958336
    buffer_load_dwordx4 v[48:51], v0, s[32:35], s48 offen sc1
    s_mov_b32 s48, 2959360
    buffer_load_dwordx4 v[52:55], v0, s[32:35], s48 offen sc1
    v_and_b32 v2, 15, v1
    v_mul_u32_u24 v2, 2560, v2
    v_lshrrev_b32 v3, 4, v1
    v_lshl_add_u32 v2, v3, 3, v2
    v_accvgpr_read_b32 v64, a24
    v_accvgpr_read_b32 v65, a25
    v_accvgpr_read_b32 v66, a26
    v_accvgpr_read_b32 v67, a27
    s_waitcnt vmcnt(5)
    v_lshlrev_b32 v22, 16, v24
    v_and_b32 v23, 0xffff0000, v24
    v_add_f32 v64, v64, v22
    v_add_f32 v65, v65, v23
    v_lshlrev_b32 v22, 16, v25
    v_and_b32 v23, 0xffff0000, v25
    v_add_f32 v66, v66, v22
    v_add_f32 v67, v67, v23
    s_waitcnt vmcnt(3)
    v_lshlrev_b32 v22, 16, v36
    v_and_b32 v23, 0xffff0000, v36
    v_add_f32 v64, v64, v22
    v_add_f32 v65, v65, v23
    v_lshlrev_b32 v22, 16, v37
    v_and_b32 v23, 0xffff0000, v37
    v_add_f32 v66, v66, v22
    v_add_f32 v67, v67, v23
    s_waitcnt vmcnt(1)
    v_lshlrev_b32 v22, 16, v48
    v_and_b32 v23, 0xffff0000, v48
    v_add_f32 v64, v64, v22
    v_add_f32 v65, v65, v23
    v_lshlrev_b32 v22, 16, v49
    v_and_b32 v23, 0xffff0000, v49
    v_add_f32 v66, v66, v22
    v_add_f32 v67, v67, v23
    v_cvt_pk_bf16_f32 v64, v64, v65
    v_cvt_pk_bf16_f32 v65, v66, v67
    s_add_u32 s48, s86, 0
    buffer_store_dwordx2 v[64:65], v2, s[12:15], s48 offen offset:0
    v_accvgpr_read_b32 v68, a28
    v_accvgpr_read_b32 v69, a29
    v_accvgpr_read_b32 v70, a30
    v_accvgpr_read_b32 v71, a31
    v_lshlrev_b32 v22, 16, v26
    v_and_b32 v23, 0xffff0000, v26
    v_add_f32 v68, v68, v22
    v_add_f32 v69, v69, v23
    v_lshlrev_b32 v22, 16, v27
    v_and_b32 v23, 0xffff0000, v27
    v_add_f32 v70, v70, v22
    v_add_f32 v71, v71, v23
    v_lshlrev_b32 v22, 16, v38
    v_and_b32 v23, 0xffff0000, v38
    v_add_f32 v68, v68, v22
    v_add_f32 v69, v69, v23
    v_lshlrev_b32 v22, 16, v39
    v_and_b32 v23, 0xffff0000, v39
    v_add_f32 v70, v70, v22
    v_add_f32 v71, v71, v23
    v_lshlrev_b32 v22, 16, v50
    v_and_b32 v23, 0xffff0000, v50
    v_add_f32 v68, v68, v22
    v_add_f32 v69, v69, v23
    v_lshlrev_b32 v22, 16, v51
    v_and_b32 v23, 0xffff0000, v51
    v_add_f32 v70, v70, v22
    v_add_f32 v71, v71, v23
    v_cvt_pk_bf16_f32 v68, v68, v69
    v_cvt_pk_bf16_f32 v69, v70, v71
    s_add_u32 s48, s86, 0
    buffer_store_dwordx2 v[68:69], v2, s[12:15], s48 offen offset:32
    v_accvgpr_read_b32 v72, a56
    v_accvgpr_read_b32 v73, a57
    v_accvgpr_read_b32 v74, a58
    v_accvgpr_read_b32 v75, a59
    v_lshlrev_b32 v22, 16, v28
    v_and_b32 v23, 0xffff0000, v28
    v_add_f32 v72, v72, v22
    v_add_f32 v73, v73, v23
    v_lshlrev_b32 v22, 16, v29
    v_and_b32 v23, 0xffff0000, v29
    v_add_f32 v74, v74, v22
    v_add_f32 v75, v75, v23
    v_lshlrev_b32 v22, 16, v40
    v_and_b32 v23, 0xffff0000, v40
    v_add_f32 v72, v72, v22
    v_add_f32 v73, v73, v23
    v_lshlrev_b32 v22, 16, v41
    v_and_b32 v23, 0xffff0000, v41
    v_add_f32 v74, v74, v22
    v_add_f32 v75, v75, v23
    s_waitcnt vmcnt(2)
    v_lshlrev_b32 v22, 16, v52
    v_and_b32 v23, 0xffff0000, v52
    v_add_f32 v72, v72, v22
    v_add_f32 v73, v73, v23
    v_lshlrev_b32 v22, 16, v53
    v_and_b32 v23, 0xffff0000, v53
    v_add_f32 v74, v74, v22
    v_add_f32 v75, v75, v23
    v_cvt_pk_bf16_f32 v72, v72, v73
    v_cvt_pk_bf16_f32 v73, v74, v75
    s_add_u32 s48, s86, 40960
    buffer_store_dwordx2 v[72:73], v2, s[12:15], s48 offen offset:0
    v_accvgpr_read_b32 v76, a60
    v_accvgpr_read_b32 v77, a61
    v_accvgpr_read_b32 v78, a62
    v_accvgpr_read_b32 v79, a63
    v_lshlrev_b32 v22, 16, v30
    v_and_b32 v23, 0xffff0000, v30
    v_add_f32 v76, v76, v22
    v_add_f32 v77, v77, v23
    v_lshlrev_b32 v22, 16, v31
    v_and_b32 v23, 0xffff0000, v31
    v_add_f32 v78, v78, v22
    v_add_f32 v79, v79, v23
    v_lshlrev_b32 v22, 16, v42
    v_and_b32 v23, 0xffff0000, v42
    v_add_f32 v76, v76, v22
    v_add_f32 v77, v77, v23
    v_lshlrev_b32 v22, 16, v43
    v_and_b32 v23, 0xffff0000, v43
    v_add_f32 v78, v78, v22
    v_add_f32 v79, v79, v23
    v_lshlrev_b32 v22, 16, v54
    v_and_b32 v23, 0xffff0000, v54
    v_add_f32 v76, v76, v22
    v_add_f32 v77, v77, v23
    v_lshlrev_b32 v22, 16, v55
    v_and_b32 v23, 0xffff0000, v55
    v_add_f32 v78, v78, v22
    v_add_f32 v79, v79, v23
    v_cvt_pk_bf16_f32 v76, v76, v77
    v_cvt_pk_bf16_f32 v77, v78, v79
    s_add_u32 s48, s86, 40960
    buffer_store_dwordx2 v[76:77], v2, s[12:15], s48 offen offset:32
    s_branch L_end2
L_x0_3a:
L_xw1a:
    s_lshl_b32 s84, s62, 2
    s_mul_i32 s84, s84, 30
    s_add_u32 s84, s84, s60
    s_lshl_b32 s84, s84, 2
    s_add_u32 s84, s84, s3
    s_mul_i32 s84, s84, 12288
    s_add_u32 s84, s84, 18874368
    s_add_u32 s32, s4, s84
    s_addc_u32 s33, s5, 0
    s_mov_b32 s34, 4435968
    s_mov_b32 s35, 0x20000
    s_mul_i32 s85, s61, 1474560
    s_load_dwordx2 s[8:9], s[0:1], 80
    s_nop 7
    s_cmp_lg_u32 s61, 0
    s_cbranch_scc1 L_x1_0a
    v_accvgpr_read_b32 v24, a0
    v_accvgpr_read_b32 v25, a1
    v_accvgpr_read_b32 v26, a2
    v_accvgpr_read_b32 v27, a3
    v_accvgpr_read_b32 v28, a4
    v_accvgpr_read_b32 v29, a5
    v_accvgpr_read_b32 v30, a6
    v_accvgpr_read_b32 v31, a7
    v_cvt_pk_bf16_f32 v24, v24, v25
    v_cvt_pk_bf16_f32 v25, v26, v27
    v_cvt_pk_bf16_f32 v26, v28, v29
    v_cvt_pk_bf16_f32 v27, v30, v31
    s_add_u32 s48, s85, 3072
    buffer_store_dwordx4 v[24:27], v0, s[32:35], s48 offen sc1
    v_accvgpr_read_b32 v32, a32
    v_accvgpr_read_b32 v33, a33
    v_accvgpr_read_b32 v34, a34
    v_accvgpr_read_b32 v35, a35
    v_accvgpr_read_b32 v36, a36
    v_accvgpr_read_b32 v37, a37
    v_accvgpr_read_b32 v38, a38
    v_accvgpr_read_b32 v39, a39
    v_cvt_pk_bf16_f32 v32, v32, v33
    v_cvt_pk_bf16_f32 v33, v34, v35
    v_cvt_pk_bf16_f32 v34, v36, v37
    v_cvt_pk_bf16_f32 v35, v38, v39
    s_add_u32 s48, s85, 4096
    buffer_store_dwordx4 v[32:35], v0, s[32:35], s48 offen sc1
    v_accvgpr_read_b32 v40, a8
    v_accvgpr_read_b32 v41, a9
    v_accvgpr_read_b32 v42, a10
    v_accvgpr_read_b32 v43, a11
    v_accvgpr_read_b32 v44, a12
    v_accvgpr_read_b32 v45, a13
    v_accvgpr_read_b32 v46, a14
    v_accvgpr_read_b32 v47, a15
    v_cvt_pk_bf16_f32 v40, v40, v41
    v_cvt_pk_bf16_f32 v41, v42, v43
    v_cvt_pk_bf16_f32 v42, v44, v45
    v_cvt_pk_bf16_f32 v43, v46, v47
    s_add_u32 s48, s85, 6144
    buffer_store_dwordx4 v[40:43], v0, s[32:35], s48 offen sc1
    v_accvgpr_read_b32 v48, a40
    v_accvgpr_read_b32 v49, a41
    v_accvgpr_read_b32 v50, a42
    v_accvgpr_read_b32 v51, a43
    v_accvgpr_read_b32 v52, a44
    v_accvgpr_read_b32 v53, a45
    v_accvgpr_read_b32 v54, a46
    v_accvgpr_read_b32 v55, a47
    v_cvt_pk_bf16_f32 v48, v48, v49
    v_cvt_pk_bf16_f32 v49, v50, v51
    v_cvt_pk_bf16_f32 v50, v52, v53
    v_cvt_pk_bf16_f32 v51, v54, v55
    s_add_u32 s48, s85, 7168
    buffer_store_dwordx4 v[48:51], v0, s[32:35], s48 offen sc1
    v_accvgpr_read_b32 v56, a16
    v_accvgpr_read_b32 v57, a17
    v_accvgpr_read_b32 v58, a18
    v_accvgpr_read_b32 v59, a19
    v_accvgpr_read_b32 v60, a20
    v_accvgpr_read_b32 v61, a21
    v_accvgpr_read_b32 v62, a22
    v_accvgpr_read_b32 v63, a23
    v_cvt_pk_bf16_f32 v56, v56, v57
    v_cvt_pk_bf16_f32 v57, v58, v59
    v_cvt_pk_bf16_f32 v58, v60, v61
    v_cvt_pk_bf16_f32 v59, v62, v63
    s_add_u32 s48, s85, 9216
    buffer_store_dwordx4 v[56:59], v0, s[32:35], s48 offen sc1
    v_accvgpr_read_b32 v64, a48
    v_accvgpr_read_b32 v65, a49
    v_accvgpr_read_b32 v66, a50
    v_accvgpr_read_b32 v67, a51
    v_accvgpr_read_b32 v68, a52
    v_accvgpr_read_b32 v69, a53
    v_accvgpr_read_b32 v70, a54
    v_accvgpr_read_b32 v71, a55
    v_cvt_pk_bf16_f32 v64, v64, v65
    v_cvt_pk_bf16_f32 v65, v66, v67
    v_cvt_pk_bf16_f32 v66, v68, v69
    v_cvt_pk_bf16_f32 v67, v70, v71
    s_add_u32 s48, s85, 10240
    buffer_store_dwordx4 v[64:67], v0, s[32:35], s48 offen sc1
    s_mul_i32 s86, s63, 12
    s_add_u32 s86, s86, 3
    s_mul_i32 s86, s86, 40960
    s_mul_i32 s87, s62, 1280
    s_add_u32 s86, s86, s87
    s_lshl_b32 s87, s64, 8
    s_add_u32 s86, s86, s87
    s_add_u32 s86, s86, 0
    s_waitcnt vmcnt(0) lgkmcnt(0)
    s_barrier
    s_cmp_lg_u32 s7, 0
    s_cbranch_scc1 L_pub6
    s_and_b32 s48, s2, 7
    s_lshl_b32 s48, s48, 5
    s_lshr_b32 s49, s2, 3
    s_add_u32 s48, s48, s49
    v_mov_b32 v2, s48
    v_mov_b32 v3, 3
    s_mov_b64 exec, 1
    global_store_byte v2, v3, s[22:23] sc1
    s_mov_b64 exec, -1
L_pub6:
    s_mov_b32 s12, s8
    s_mov_b32 s13, s9
    s_mov_b32 s14, 2949120
    s_mov_b32 s15, 0x20000
    s_cmp_lg_u32 s7, 0
    s_cbranch_scc1 L_xp1_0a_skip
    s_lshl_b32 s48, s62, 7
    s_add_u32 s48, s48, s60
    v_and_b32 v2, 3, v1
    v_lshlrev_b32 v2, 5, v2
    v_add_u32 v2, s48, v2
    s_mov_b32 s69, 0
L_xp1_0a_poll:
    global_load_ubyte v3, v2, s[22:23] sc1
    s_add_u32 s69, s69, 1
    s_waitcnt vmcnt(0)
    v_cmp_gt_u32 vcc, 3, v3
    s_cmp_ge_u32 s69, 131072
    s_cbranch_scc1 L_xp1_0a_skip
    s_nop 2
    s_cbranch_vccz L_xp1_0a_skip
    s_sleep 1
    s_branch L_xp1_0a_poll
L_xp1_0a_skip:
    s_barrier
    s_mov_b32 s48, 1474560
    buffer_load_dwordx4 v[24:27], v0, s[32:35], s48 offen sc1
    s_mov_b32 s48, 1475584
    buffer_load_dwordx4 v[28:31], v0, s[32:35], s48 offen sc1
    s_mov_b32 s48, 2949120
    buffer_load_dwordx4 v[36:39], v0, s[32:35], s48 offen sc1
    s_mov_b32 s48, 2950144
    buffer_load_dwordx4 v[40:43], v0, s[32:35], s48 offen sc1
    s_mov_b32 s48, 4423680
    buffer_load_dwordx4 v[48:51], v0, s[32:35], s48 offen sc1
    s_mov_b32 s48, 4424704
    buffer_load_dwordx4 v[52:55], v0, s[32:35], s48 offen sc1
    v_and_b32 v2, 15, v1
    v_mul_u32_u24 v2, 2560, v2
    v_lshrrev_b32 v3, 4, v1
    v_lshl_add_u32 v2, v3, 3, v2
    v_accvgpr_read_b32 v64, a24
    v_accvgpr_read_b32 v65, a25
    v_accvgpr_read_b32 v66, a26
    v_accvgpr_read_b32 v67, a27
    s_waitcnt vmcnt(5)
    v_lshlrev_b32 v22, 16, v24
    v_and_b32 v23, 0xffff0000, v24
    v_add_f32 v64, v64, v22
    v_add_f32 v65, v65, v23
    v_lshlrev_b32 v22, 16, v25
    v_and_b32 v23, 0xffff0000, v25
    v_add_f32 v66, v66, v22
    v_add_f32 v67, v67, v23
    s_waitcnt vmcnt(3)
    v_lshlrev_b32 v22, 16, v36
    v_and_b32 v23, 0xffff0000, v36
    v_add_f32 v64, v64, v22
    v_add_f32 v65, v65, v23
    v_lshlrev_b32 v22, 16, v37
    v_and_b32 v23, 0xffff0000, v37
    v_add_f32 v66, v66, v22
    v_add_f32 v67, v67, v23
    s_waitcnt vmcnt(1)
    v_lshlrev_b32 v22, 16, v48
    v_and_b32 v23, 0xffff0000, v48
    v_add_f32 v64, v64, v22
    v_add_f32 v65, v65, v23
    v_lshlrev_b32 v22, 16, v49
    v_and_b32 v23, 0xffff0000, v49
    v_add_f32 v66, v66, v22
    v_add_f32 v67, v67, v23
    v_cvt_pk_bf16_f32 v64, v64, v65
    v_cvt_pk_bf16_f32 v65, v66, v67
    s_add_u32 s48, s86, 0
    buffer_store_dwordx2 v[64:65], v2, s[12:15], s48 offen offset:0
    v_accvgpr_read_b32 v68, a28
    v_accvgpr_read_b32 v69, a29
    v_accvgpr_read_b32 v70, a30
    v_accvgpr_read_b32 v71, a31
    v_lshlrev_b32 v22, 16, v26
    v_and_b32 v23, 0xffff0000, v26
    v_add_f32 v68, v68, v22
    v_add_f32 v69, v69, v23
    v_lshlrev_b32 v22, 16, v27
    v_and_b32 v23, 0xffff0000, v27
    v_add_f32 v70, v70, v22
    v_add_f32 v71, v71, v23
    v_lshlrev_b32 v22, 16, v38
    v_and_b32 v23, 0xffff0000, v38
    v_add_f32 v68, v68, v22
    v_add_f32 v69, v69, v23
    v_lshlrev_b32 v22, 16, v39
    v_and_b32 v23, 0xffff0000, v39
    v_add_f32 v70, v70, v22
    v_add_f32 v71, v71, v23
    v_lshlrev_b32 v22, 16, v50
    v_and_b32 v23, 0xffff0000, v50
    v_add_f32 v68, v68, v22
    v_add_f32 v69, v69, v23
    v_lshlrev_b32 v22, 16, v51
    v_and_b32 v23, 0xffff0000, v51
    v_add_f32 v70, v70, v22
    v_add_f32 v71, v71, v23
    v_cvt_pk_bf16_f32 v68, v68, v69
    v_cvt_pk_bf16_f32 v69, v70, v71
    s_add_u32 s48, s86, 0
    buffer_store_dwordx2 v[68:69], v2, s[12:15], s48 offen offset:32
    v_accvgpr_read_b32 v72, a56
    v_accvgpr_read_b32 v73, a57
    v_accvgpr_read_b32 v74, a58
    v_accvgpr_read_b32 v75, a59
    v_lshlrev_b32 v22, 16, v28
    v_and_b32 v23, 0xffff0000, v28
    v_add_f32 v72, v72, v22
    v_add_f32 v73, v73, v23
    v_lshlrev_b32 v22, 16, v29
    v_and_b32 v23, 0xffff0000, v29
    v_add_f32 v74, v74, v22
    v_add_f32 v75, v75, v23
    v_lshlrev_b32 v22, 16, v40
    v_and_b32 v23, 0xffff0000, v40
    v_add_f32 v72, v72, v22
    v_add_f32 v73, v73, v23
    v_lshlrev_b32 v22, 16, v41
    v_and_b32 v23, 0xffff0000, v41
    v_add_f32 v74, v74, v22
    v_add_f32 v75, v75, v23
    s_waitcnt vmcnt(2)
    v_lshlrev_b32 v22, 16, v52
    v_and_b32 v23, 0xffff0000, v52
    v_add_f32 v72, v72, v22
    v_add_f32 v73, v73, v23
    v_lshlrev_b32 v22, 16, v53
    v_and_b32 v23, 0xffff0000, v53
    v_add_f32 v74, v74, v22
    v_add_f32 v75, v75, v23
    v_cvt_pk_bf16_f32 v72, v72, v73
    v_cvt_pk_bf16_f32 v73, v74, v75
    s_add_u32 s48, s86, 40960
    buffer_store_dwordx2 v[72:73], v2, s[12:15], s48 offen offset:0
    v_accvgpr_read_b32 v76, a60
    v_accvgpr_read_b32 v77, a61
    v_accvgpr_read_b32 v78, a62
    v_accvgpr_read_b32 v79, a63
    v_lshlrev_b32 v22, 16, v30
    v_and_b32 v23, 0xffff0000, v30
    v_add_f32 v76, v76, v22
    v_add_f32 v77, v77, v23
    v_lshlrev_b32 v22, 16, v31
    v_and_b32 v23, 0xffff0000, v31
    v_add_f32 v78, v78, v22
    v_add_f32 v79, v79, v23
    v_lshlrev_b32 v22, 16, v42
    v_and_b32 v23, 0xffff0000, v42
    v_add_f32 v76, v76, v22
    v_add_f32 v77, v77, v23
    v_lshlrev_b32 v22, 16, v43
    v_and_b32 v23, 0xffff0000, v43
    v_add_f32 v78, v78, v22
    v_add_f32 v79, v79, v23
    v_lshlrev_b32 v22, 16, v54
    v_and_b32 v23, 0xffff0000, v54
    v_add_f32 v76, v76, v22
    v_add_f32 v77, v77, v23
    v_lshlrev_b32 v22, 16, v55
    v_and_b32 v23, 0xffff0000, v55
    v_add_f32 v78, v78, v22
    v_add_f32 v79, v79, v23
    v_cvt_pk_bf16_f32 v76, v76, v77
    v_cvt_pk_bf16_f32 v77, v78, v79
    s_add_u32 s48, s86, 40960
    buffer_store_dwordx2 v[76:77], v2, s[12:15], s48 offen offset:32
    s_branch L_end2
L_x1_0a:
    s_cmp_lg_u32 s61, 1
    s_cbranch_scc1 L_x1_1a
    v_accvgpr_read_b32 v24, a24
    v_accvgpr_read_b32 v25, a25
    v_accvgpr_read_b32 v26, a26
    v_accvgpr_read_b32 v27, a27
    v_accvgpr_read_b32 v28, a28
    v_accvgpr_read_b32 v29, a29
    v_accvgpr_read_b32 v30, a30
    v_accvgpr_read_b32 v31, a31
    v_cvt_pk_bf16_f32 v24, v24, v25
    v_cvt_pk_bf16_f32 v25, v26, v27
    v_cvt_pk_bf16_f32 v26, v28, v29
    v_cvt_pk_bf16_f32 v27, v30, v31
    s_add_u32 s48, s85, 0
    buffer_store_dwordx4 v[24:27], v0, s[32:35], s48 offen sc1
    v_accvgpr_read_b32 v32, a56
    v_accvgpr_read_b32 v33, a57
    v_accvgpr_read_b32 v34, a58
    v_accvgpr_read_b32 v35, a59
    v_accvgpr_read_b32 v36, a60
    v_accvgpr_read_b32 v37, a61
    v_accvgpr_read_b32 v38, a62
    v_accvgpr_read_b32 v39, a63
    v_cvt_pk_bf16_f32 v32, v32, v33
    v_cvt_pk_bf16_f32 v33, v34, v35
    v_cvt_pk_bf16_f32 v34, v36, v37
    v_cvt_pk_bf16_f32 v35, v38, v39
    s_add_u32 s48, s85, 1024
    buffer_store_dwordx4 v[32:35], v0, s[32:35], s48 offen sc1
    v_accvgpr_read_b32 v40, a8
    v_accvgpr_read_b32 v41, a9
    v_accvgpr_read_b32 v42, a10
    v_accvgpr_read_b32 v43, a11
    v_accvgpr_read_b32 v44, a12
    v_accvgpr_read_b32 v45, a13
    v_accvgpr_read_b32 v46, a14
    v_accvgpr_read_b32 v47, a15
    v_cvt_pk_bf16_f32 v40, v40, v41
    v_cvt_pk_bf16_f32 v41, v42, v43
    v_cvt_pk_bf16_f32 v42, v44, v45
    v_cvt_pk_bf16_f32 v43, v46, v47
    s_add_u32 s48, s85, 6144
    buffer_store_dwordx4 v[40:43], v0, s[32:35], s48 offen sc1
    v_accvgpr_read_b32 v48, a40
    v_accvgpr_read_b32 v49, a41
    v_accvgpr_read_b32 v50, a42
    v_accvgpr_read_b32 v51, a43
    v_accvgpr_read_b32 v52, a44
    v_accvgpr_read_b32 v53, a45
    v_accvgpr_read_b32 v54, a46
    v_accvgpr_read_b32 v55, a47
    v_cvt_pk_bf16_f32 v48, v48, v49
    v_cvt_pk_bf16_f32 v49, v50, v51
    v_cvt_pk_bf16_f32 v50, v52, v53
    v_cvt_pk_bf16_f32 v51, v54, v55
    s_add_u32 s48, s85, 7168
    buffer_store_dwordx4 v[48:51], v0, s[32:35], s48 offen sc1
    v_accvgpr_read_b32 v56, a16
    v_accvgpr_read_b32 v57, a17
    v_accvgpr_read_b32 v58, a18
    v_accvgpr_read_b32 v59, a19
    v_accvgpr_read_b32 v60, a20
    v_accvgpr_read_b32 v61, a21
    v_accvgpr_read_b32 v62, a22
    v_accvgpr_read_b32 v63, a23
    v_cvt_pk_bf16_f32 v56, v56, v57
    v_cvt_pk_bf16_f32 v57, v58, v59
    v_cvt_pk_bf16_f32 v58, v60, v61
    v_cvt_pk_bf16_f32 v59, v62, v63
    s_add_u32 s48, s85, 9216
    buffer_store_dwordx4 v[56:59], v0, s[32:35], s48 offen sc1
    v_accvgpr_read_b32 v64, a48
    v_accvgpr_read_b32 v65, a49
    v_accvgpr_read_b32 v66, a50
    v_accvgpr_read_b32 v67, a51
    v_accvgpr_read_b32 v68, a52
    v_accvgpr_read_b32 v69, a53
    v_accvgpr_read_b32 v70, a54
    v_accvgpr_read_b32 v71, a55
    v_cvt_pk_bf16_f32 v64, v64, v65
    v_cvt_pk_bf16_f32 v65, v66, v67
    v_cvt_pk_bf16_f32 v66, v68, v69
    v_cvt_pk_bf16_f32 v67, v70, v71
    s_add_u32 s48, s85, 10240
    buffer_store_dwordx4 v[64:67], v0, s[32:35], s48 offen sc1
    s_mul_i32 s86, s63, 12
    s_add_u32 s86, s86, 3
    s_mul_i32 s86, s86, 40960
    s_mul_i32 s87, s62, 1280
    s_add_u32 s86, s86, s87
    s_lshl_b32 s87, s64, 8
    s_add_u32 s86, s86, s87
    s_add_u32 s86, s86, 64
    s_waitcnt vmcnt(0) lgkmcnt(0)
    s_barrier
    s_cmp_lg_u32 s7, 0
    s_cbranch_scc1 L_pub7
    s_and_b32 s48, s2, 7
    s_lshl_b32 s48, s48, 5
    s_lshr_b32 s49, s2, 3
    s_add_u32 s48, s48, s49
    v_mov_b32 v2, s48
    v_mov_b32 v3, 3
    s_mov_b64 exec, 1
    global_store_byte v2, v3, s[22:23] sc1
    s_mov_b64 exec, -1
L_pub7:
    s_mov_b32 s12, s8
    s_mov_b32 s13, s9
    s_mov_b32 s14, 2949120
    s_mov_b32 s15, 0x20000
    s_cmp_lg_u32 s7, 0
    s_cbranch_scc1 L_xp1_1a_skip
    s_lshl_b32 s48, s62, 7
    s_add_u32 s48, s48, s60
    v_and_b32 v2, 3, v1
    v_lshlrev_b32 v2, 5, v2
    v_add_u32 v2, s48, v2
    s_mov_b32 s69, 0
L_xp1_1a_poll:
    global_load_ubyte v3, v2, s[22:23] sc1
    s_add_u32 s69, s69, 1
    s_waitcnt vmcnt(0)
    v_cmp_gt_u32 vcc, 3, v3
    s_cmp_ge_u32 s69, 131072
    s_cbranch_scc1 L_xp1_1a_skip
    s_nop 2
    s_cbranch_vccz L_xp1_1a_skip
    s_sleep 1
    s_branch L_xp1_1a_poll
L_xp1_1a_skip:
    s_barrier
    s_mov_b32 s48, 3072
    buffer_load_dwordx4 v[24:27], v0, s[32:35], s48 offen sc1
    s_mov_b32 s48, 4096
    buffer_load_dwordx4 v[28:31], v0, s[32:35], s48 offen sc1
    s_mov_b32 s48, 2952192
    buffer_load_dwordx4 v[36:39], v0, s[32:35], s48 offen sc1
    s_mov_b32 s48, 2953216
    buffer_load_dwordx4 v[40:43], v0, s[32:35], s48 offen sc1
    s_mov_b32 s48, 4426752
    buffer_load_dwordx4 v[48:51], v0, s[32:35], s48 offen sc1
    s_mov_b32 s48, 4427776
    buffer_load_dwordx4 v[52:55], v0, s[32:35], s48 offen sc1
    v_and_b32 v2, 15, v1
    v_mul_u32_u24 v2, 2560, v2
    v_lshrrev_b32 v3, 4, v1
    v_lshl_add_u32 v2, v3, 3, v2
    v_accvgpr_read_b32 v64, a0
    v_accvgpr_read_b32 v65, a1
    v_accvgpr_read_b32 v66, a2
    v_accvgpr_read_b32 v67, a3
    s_waitcnt vmcnt(5)
    v_lshlrev_b32 v22, 16, v24
    v_and_b32 v23, 0xffff0000, v24
    v_add_f32 v64, v64, v22
    v_add_f32 v65, v65, v23
    v_lshlrev_b32 v22, 16, v25
    v_and_b32 v23, 0xffff0000, v25
    v_add_f32 v66, v66, v22
    v_add_f32 v67, v67, v23
    s_waitcnt vmcnt(3)
    v_lshlrev_b32 v22, 16, v36
    v_and_b32 v23, 0xffff0000, v36
    v_add_f32 v64, v64, v22
    v_add_f32 v65, v65, v23
    v_lshlrev_b32 v22, 16, v37
    v_and_b32 v23, 0xffff0000, v37
    v_add_f32 v66, v66, v22
    v_add_f32 v67, v67, v23
    s_waitcnt vmcnt(1)
    v_lshlrev_b32 v22, 16, v48
    v_and_b32 v23, 0xffff0000, v48
    v_add_f32 v64, v64, v22
    v_add_f32 v65, v65, v23
    v_lshlrev_b32 v22, 16, v49
    v_and_b32 v23, 0xffff0000, v49
    v_add_f32 v66, v66, v22
    v_add_f32 v67, v67, v23
    v_cvt_pk_bf16_f32 v64, v64, v65
    v_cvt_pk_bf16_f32 v65, v66, v67
    s_add_u32 s48, s86, 0
    buffer_store_dwordx2 v[64:65], v2, s[12:15], s48 offen offset:0
    v_accvgpr_read_b32 v68, a4
    v_accvgpr_read_b32 v69, a5
    v_accvgpr_read_b32 v70, a6
    v_accvgpr_read_b32 v71, a7
    v_lshlrev_b32 v22, 16, v26
    v_and_b32 v23, 0xffff0000, v26
    v_add_f32 v68, v68, v22
    v_add_f32 v69, v69, v23
    v_lshlrev_b32 v22, 16, v27
    v_and_b32 v23, 0xffff0000, v27
    v_add_f32 v70, v70, v22
    v_add_f32 v71, v71, v23
    v_lshlrev_b32 v22, 16, v38
    v_and_b32 v23, 0xffff0000, v38
    v_add_f32 v68, v68, v22
    v_add_f32 v69, v69, v23
    v_lshlrev_b32 v22, 16, v39
    v_and_b32 v23, 0xffff0000, v39
    v_add_f32 v70, v70, v22
    v_add_f32 v71, v71, v23
    v_lshlrev_b32 v22, 16, v50
    v_and_b32 v23, 0xffff0000, v50
    v_add_f32 v68, v68, v22
    v_add_f32 v69, v69, v23
    v_lshlrev_b32 v22, 16, v51
    v_and_b32 v23, 0xffff0000, v51
    v_add_f32 v70, v70, v22
    v_add_f32 v71, v71, v23
    v_cvt_pk_bf16_f32 v68, v68, v69
    v_cvt_pk_bf16_f32 v69, v70, v71
    s_add_u32 s48, s86, 0
    buffer_store_dwordx2 v[68:69], v2, s[12:15], s48 offen offset:32
    v_accvgpr_read_b32 v72, a32
    v_accvgpr_read_b32 v73, a33
    v_accvgpr_read_b32 v74, a34
    v_accvgpr_read_b32 v75, a35
    v_lshlrev_b32 v22, 16, v28
    v_and_b32 v23, 0xffff0000, v28
    v_add_f32 v72, v72, v22
    v_add_f32 v73, v73, v23
    v_lshlrev_b32 v22, 16, v29
    v_and_b32 v23, 0xffff0000, v29
    v_add_f32 v74, v74, v22
    v_add_f32 v75, v75, v23
    v_lshlrev_b32 v22, 16, v40
    v_and_b32 v23, 0xffff0000, v40
    v_add_f32 v72, v72, v22
    v_add_f32 v73, v73, v23
    v_lshlrev_b32 v22, 16, v41
    v_and_b32 v23, 0xffff0000, v41
    v_add_f32 v74, v74, v22
    v_add_f32 v75, v75, v23
    s_waitcnt vmcnt(2)
    v_lshlrev_b32 v22, 16, v52
    v_and_b32 v23, 0xffff0000, v52
    v_add_f32 v72, v72, v22
    v_add_f32 v73, v73, v23
    v_lshlrev_b32 v22, 16, v53
    v_and_b32 v23, 0xffff0000, v53
    v_add_f32 v74, v74, v22
    v_add_f32 v75, v75, v23
    v_cvt_pk_bf16_f32 v72, v72, v73
    v_cvt_pk_bf16_f32 v73, v74, v75
    s_add_u32 s48, s86, 40960
    buffer_store_dwordx2 v[72:73], v2, s[12:15], s48 offen offset:0
    v_accvgpr_read_b32 v76, a36
    v_accvgpr_read_b32 v77, a37
    v_accvgpr_read_b32 v78, a38
    v_accvgpr_read_b32 v79, a39
    v_lshlrev_b32 v22, 16, v30
    v_and_b32 v23, 0xffff0000, v30
    v_add_f32 v76, v76, v22
    v_add_f32 v77, v77, v23
    v_lshlrev_b32 v22, 16, v31
    v_and_b32 v23, 0xffff0000, v31
    v_add_f32 v78, v78, v22
    v_add_f32 v79, v79, v23
    v_lshlrev_b32 v22, 16, v42
    v_and_b32 v23, 0xffff0000, v42
    v_add_f32 v76, v76, v22
    v_add_f32 v77, v77, v23
    v_lshlrev_b32 v22, 16, v43
    v_and_b32 v23, 0xffff0000, v43
    v_add_f32 v78, v78, v22
    v_add_f32 v79, v79, v23
    v_lshlrev_b32 v22, 16, v54
    v_and_b32 v23, 0xffff0000, v54
    v_add_f32 v76, v76, v22
    v_add_f32 v77, v77, v23
    v_lshlrev_b32 v22, 16, v55
    v_and_b32 v23, 0xffff0000, v55
    v_add_f32 v78, v78, v22
    v_add_f32 v79, v79, v23
    v_cvt_pk_bf16_f32 v76, v76, v77
    v_cvt_pk_bf16_f32 v77, v78, v79
    s_add_u32 s48, s86, 40960
    buffer_store_dwordx2 v[76:77], v2, s[12:15], s48 offen offset:32
    s_branch L_end2
L_x1_1a:
    s_cmp_lg_u32 s61, 2
    s_cbranch_scc1 L_x1_2a
    v_accvgpr_read_b32 v24, a24
    v_accvgpr_read_b32 v25, a25
    v_accvgpr_read_b32 v26, a26
    v_accvgpr_read_b32 v27, a27
    v_accvgpr_read_b32 v28, a28
    v_accvgpr_read_b32 v29, a29
    v_accvgpr_read_b32 v30, a30
    v_accvgpr_read_b32 v31, a31
    v_cvt_pk_bf16_f32 v24, v24, v25
    v_cvt_pk_bf16_f32 v25, v26, v27
    v_cvt_pk_bf16_f32 v26, v28, v29
    v_cvt_pk_bf16_f32 v27, v30, v31
    s_add_u32 s48, s85, 0
    buffer_store_dwordx4 v[24:27], v0, s[32:35], s48 offen sc1
    v_accvgpr_read_b32 v32, a56
    v_accvgpr_read_b32 v33, a57
    v_accvgpr_read_b32 v34, a58
    v_accvgpr_read_b32 v35, a59
    v_accvgpr_read_b32 v36, a60
    v_accvgpr_read_b32 v37, a61
    v_accvgpr_read_b32 v38, a62
    v_accvgpr_read_b32 v39, a63
    v_cvt_pk_bf16_f32 v32, v32, v33
    v_cvt_pk_bf16_f32 v33, v34, v35
    v_cvt_pk_bf16_f32 v34, v36, v37
    v_cvt_pk_bf16_f32 v35, v38, v39
    s_add_u32 s48, s85, 1024
    buffer_store_dwordx4 v[32:35], v0, s[32:35], s48 offen sc1
    v_accvgpr_read_b32 v40, a0
    v_accvgpr_read_b32 v41, a1
    v_accvgpr_read_b32 v42, a2
    v_accvgpr_read_b32 v43, a3
    v_accvgpr_read_b32 v44, a4
    v_accvgpr_read_b32 v45, a5
    v_accvgpr_read_b32 v46, a6
    v_accvgpr_read_b32 v47, a7
    v_cvt_pk_bf16_f32 v40, v40, v41
    v_cvt_pk_bf16_f32 v41, v42, v43
    v_cvt_pk_bf16_f32 v42, v44, v45
    v_cvt_pk_bf16_f32 v43, v46, v47
    s_add_u32 s48, s85, 3072
    buffer_store_dwordx4 v[40:43], v0, s[32:35], s48 offen sc1
    v_accvgpr_read_b32 v48, a32
    v_accvgpr_read_b32 v49, a33
    v_accvgpr_read_b32 v50, a34
    v_accvgpr_read_b32 v51, a35
    v_accvgpr_read_b32 v52, a36
    v_accvgpr_read_b32 v53, a37
    v_accvgpr_read_b32 v54, a38
    v_accvgpr_read_b32 v55, a39
    v_cvt_pk_bf16_f32 v48, v48, v49
    v_cvt_pk_bf16_f32 v49, v50, v51
    v_cvt_pk_bf16_f32 v50, v52, v53
    v_cvt_pk_bf16_f32 v51, v54, v55
    s_add_u32 s48, s85, 4096
    buffer_store_dwordx4 v[48:51], v0, s[32:35], s48 offen sc1
    v_accvgpr_read_b32 v56, a16
    v_accvgpr_read_b32 v57, a17
    v_accvgpr_read_b32 v58, a18
    v_accvgpr_read_b32 v59, a19
    v_accvgpr_read_b32 v60, a20
    v_accvgpr_read_b32 v61, a21
    v_accvgpr_read_b32 v62, a22
    v_accvgpr_read_b32 v63, a23
    v_cvt_pk_bf16_f32 v56, v56, v57
    v_cvt_pk_bf16_f32 v57, v58, v59
    v_cvt_pk_bf16_f32 v58, v60, v61
    v_cvt_pk_bf16_f32 v59, v62, v63
    s_add_u32 s48, s85, 9216
    buffer_store_dwordx4 v[56:59], v0, s[32:35], s48 offen sc1
    v_accvgpr_read_b32 v64, a48
    v_accvgpr_read_b32 v65, a49
    v_accvgpr_read_b32 v66, a50
    v_accvgpr_read_b32 v67, a51
    v_accvgpr_read_b32 v68, a52
    v_accvgpr_read_b32 v69, a53
    v_accvgpr_read_b32 v70, a54
    v_accvgpr_read_b32 v71, a55
    v_cvt_pk_bf16_f32 v64, v64, v65
    v_cvt_pk_bf16_f32 v65, v66, v67
    v_cvt_pk_bf16_f32 v66, v68, v69
    v_cvt_pk_bf16_f32 v67, v70, v71
    s_add_u32 s48, s85, 10240
    buffer_store_dwordx4 v[64:67], v0, s[32:35], s48 offen sc1
    s_mul_i32 s86, s63, 12
    s_add_u32 s86, s86, 3
    s_mul_i32 s86, s86, 40960
    s_mul_i32 s87, s62, 1280
    s_add_u32 s86, s86, s87
    s_lshl_b32 s87, s64, 8
    s_add_u32 s86, s86, s87
    s_add_u32 s86, s86, 128
    s_waitcnt vmcnt(0) lgkmcnt(0)
    s_barrier
    s_cmp_lg_u32 s7, 0
    s_cbranch_scc1 L_pub8
    s_and_b32 s48, s2, 7
    s_lshl_b32 s48, s48, 5
    s_lshr_b32 s49, s2, 3
    s_add_u32 s48, s48, s49
    v_mov_b32 v2, s48
    v_mov_b32 v3, 3
    s_mov_b64 exec, 1
    global_store_byte v2, v3, s[22:23] sc1
    s_mov_b64 exec, -1
L_pub8:
    s_mov_b32 s12, s8
    s_mov_b32 s13, s9
    s_mov_b32 s14, 2949120
    s_mov_b32 s15, 0x20000
    s_cmp_lg_u32 s7, 0
    s_cbranch_scc1 L_xp1_2a_skip
    s_lshl_b32 s48, s62, 7
    s_add_u32 s48, s48, s60
    v_and_b32 v2, 3, v1
    v_lshlrev_b32 v2, 5, v2
    v_add_u32 v2, s48, v2
    s_mov_b32 s69, 0
L_xp1_2a_poll:
    global_load_ubyte v3, v2, s[22:23] sc1
    s_add_u32 s69, s69, 1
    s_waitcnt vmcnt(0)
    v_cmp_gt_u32 vcc, 3, v3
    s_cmp_ge_u32 s69, 131072
    s_cbranch_scc1 L_xp1_2a_skip
    s_nop 2
    s_cbranch_vccz L_xp1_2a_skip
    s_sleep 1
    s_branch L_xp1_2a_poll
L_xp1_2a_skip:
    s_barrier
    s_mov_b32 s48, 6144
    buffer_load_dwordx4 v[24:27], v0, s[32:35], s48 offen sc1
    s_mov_b32 s48, 7168
    buffer_load_dwordx4 v[28:31], v0, s[32:35], s48 offen sc1
    s_mov_b32 s48, 1480704
    buffer_load_dwordx4 v[36:39], v0, s[32:35], s48 offen sc1
    s_mov_b32 s48, 1481728
    buffer_load_dwordx4 v[40:43], v0, s[32:35], s48 offen sc1
    s_mov_b32 s48, 4429824
    buffer_load_dwordx4 v[48:51], v0, s[32:35], s48 offen sc1
    s_mov_b32 s48, 4430848
    buffer_load_dwordx4 v[52:55], v0, s[32:35], s48 offen sc1
    v_and_b32 v2, 15, v1
    v_mul_u32_u24 v2, 2560, v2
    v_lshrrev_b32 v3, 4, v1
    v_lshl_add_u32 v2, v3, 3, v2
    v_accvgpr_read_b32 v64, a8
    v_accvgpr_read_b32 v65, a9
    v_accvgpr_read_b32 v66, a10
    v_accvgpr_read_b32 v67, a11
    s_waitcnt vmcnt(5)
    v_lshlrev_b32 v22, 16, v24
    v_and_b32 v23, 0xffff0000, v24
    v_add_f32 v64, v64, v22
    v_add_f32 v65, v65, v23
    v_lshlrev_b32 v22, 16, v25
    v_and_b32 v23, 0xffff0000, v25
    v_add_f32 v66, v66, v22
    v_add_f32 v67, v67, v23
    s_waitcnt vmcnt(3)
    v_lshlrev_b32 v22, 16, v36
    v_and_b32 v23, 0xffff0000, v36
    v_add_f32 v64, v64, v22
    v_add_f32 v65, v65, v23
    v_lshlrev_b32 v22, 16, v37
    v_and_b32 v23, 0xffff0000, v37
    v_add_f32 v66, v66, v22
    v_add_f32 v67, v67, v23
    s_waitcnt vmcnt(1)
    v_lshlrev_b32 v22, 16, v48
    v_and_b32 v23, 0xffff0000, v48
    v_add_f32 v64, v64, v22
    v_add_f32 v65, v65, v23
    v_lshlrev_b32 v22, 16, v49
    v_and_b32 v23, 0xffff0000, v49
    v_add_f32 v66, v66, v22
    v_add_f32 v67, v67, v23
    v_cvt_pk_bf16_f32 v64, v64, v65
    v_cvt_pk_bf16_f32 v65, v66, v67
    s_add_u32 s48, s86, 0
    buffer_store_dwordx2 v[64:65], v2, s[12:15], s48 offen offset:0
    v_accvgpr_read_b32 v68, a12
    v_accvgpr_read_b32 v69, a13
    v_accvgpr_read_b32 v70, a14
    v_accvgpr_read_b32 v71, a15
    v_lshlrev_b32 v22, 16, v26
    v_and_b32 v23, 0xffff0000, v26
    v_add_f32 v68, v68, v22
    v_add_f32 v69, v69, v23
    v_lshlrev_b32 v22, 16, v27
    v_and_b32 v23, 0xffff0000, v27
    v_add_f32 v70, v70, v22
    v_add_f32 v71, v71, v23
    v_lshlrev_b32 v22, 16, v38
    v_and_b32 v23, 0xffff0000, v38
    v_add_f32 v68, v68, v22
    v_add_f32 v69, v69, v23
    v_lshlrev_b32 v22, 16, v39
    v_and_b32 v23, 0xffff0000, v39
    v_add_f32 v70, v70, v22
    v_add_f32 v71, v71, v23
    v_lshlrev_b32 v22, 16, v50
    v_and_b32 v23, 0xffff0000, v50
    v_add_f32 v68, v68, v22
    v_add_f32 v69, v69, v23
    v_lshlrev_b32 v22, 16, v51
    v_and_b32 v23, 0xffff0000, v51
    v_add_f32 v70, v70, v22
    v_add_f32 v71, v71, v23
    v_cvt_pk_bf16_f32 v68, v68, v69
    v_cvt_pk_bf16_f32 v69, v70, v71
    s_add_u32 s48, s86, 0
    buffer_store_dwordx2 v[68:69], v2, s[12:15], s48 offen offset:32
    v_accvgpr_read_b32 v72, a40
    v_accvgpr_read_b32 v73, a41
    v_accvgpr_read_b32 v74, a42
    v_accvgpr_read_b32 v75, a43
    v_lshlrev_b32 v22, 16, v28
    v_and_b32 v23, 0xffff0000, v28
    v_add_f32 v72, v72, v22
    v_add_f32 v73, v73, v23
    v_lshlrev_b32 v22, 16, v29
    v_and_b32 v23, 0xffff0000, v29
    v_add_f32 v74, v74, v22
    v_add_f32 v75, v75, v23
    v_lshlrev_b32 v22, 16, v40
    v_and_b32 v23, 0xffff0000, v40
    v_add_f32 v72, v72, v22
    v_add_f32 v73, v73, v23
    v_lshlrev_b32 v22, 16, v41
    v_and_b32 v23, 0xffff0000, v41
    v_add_f32 v74, v74, v22
    v_add_f32 v75, v75, v23
    s_waitcnt vmcnt(2)
    v_lshlrev_b32 v22, 16, v52
    v_and_b32 v23, 0xffff0000, v52
    v_add_f32 v72, v72, v22
    v_add_f32 v73, v73, v23
    v_lshlrev_b32 v22, 16, v53
    v_and_b32 v23, 0xffff0000, v53
    v_add_f32 v74, v74, v22
    v_add_f32 v75, v75, v23
    v_cvt_pk_bf16_f32 v72, v72, v73
    v_cvt_pk_bf16_f32 v73, v74, v75
    s_add_u32 s48, s86, 40960
    buffer_store_dwordx2 v[72:73], v2, s[12:15], s48 offen offset:0
    v_accvgpr_read_b32 v76, a44
    v_accvgpr_read_b32 v77, a45
    v_accvgpr_read_b32 v78, a46
    v_accvgpr_read_b32 v79, a47
    v_lshlrev_b32 v22, 16, v30
    v_and_b32 v23, 0xffff0000, v30
    v_add_f32 v76, v76, v22
    v_add_f32 v77, v77, v23
    v_lshlrev_b32 v22, 16, v31
    v_and_b32 v23, 0xffff0000, v31
    v_add_f32 v78, v78, v22
    v_add_f32 v79, v79, v23
    v_lshlrev_b32 v22, 16, v42
    v_and_b32 v23, 0xffff0000, v42
    v_add_f32 v76, v76, v22
    v_add_f32 v77, v77, v23
    v_lshlrev_b32 v22, 16, v43
    v_and_b32 v23, 0xffff0000, v43
    v_add_f32 v78, v78, v22
    v_add_f32 v79, v79, v23
    v_lshlrev_b32 v22, 16, v54
    v_and_b32 v23, 0xffff0000, v54
    v_add_f32 v76, v76, v22
    v_add_f32 v77, v77, v23
    v_lshlrev_b32 v22, 16, v55
    v_and_b32 v23, 0xffff0000, v55
    v_add_f32 v78, v78, v22
    v_add_f32 v79, v79, v23
    v_cvt_pk_bf16_f32 v76, v76, v77
    v_cvt_pk_bf16_f32 v77, v78, v79
    s_add_u32 s48, s86, 40960
    buffer_store_dwordx2 v[76:77], v2, s[12:15], s48 offen offset:32
    s_branch L_end2
L_x1_2a:
    s_cmp_lg_u32 s61, 3
    s_cbranch_scc1 L_x1_3a
    v_accvgpr_read_b32 v24, a24
    v_accvgpr_read_b32 v25, a25
    v_accvgpr_read_b32 v26, a26
    v_accvgpr_read_b32 v27, a27
    v_accvgpr_read_b32 v28, a28
    v_accvgpr_read_b32 v29, a29
    v_accvgpr_read_b32 v30, a30
    v_accvgpr_read_b32 v31, a31
    v_cvt_pk_bf16_f32 v24, v24, v25
    v_cvt_pk_bf16_f32 v25, v26, v27
    v_cvt_pk_bf16_f32 v26, v28, v29
    v_cvt_pk_bf16_f32 v27, v30, v31
    s_add_u32 s48, s85, 0
    buffer_store_dwordx4 v[24:27], v0, s[32:35], s48 offen sc1
    v_accvgpr_read_b32 v32, a56
    v_accvgpr_read_b32 v33, a57
    v_accvgpr_read_b32 v34, a58
    v_accvgpr_read_b32 v35, a59
    v_accvgpr_read_b32 v36, a60
    v_accvgpr_read_b32 v37, a61
    v_accvgpr_read_b32 v38, a62
    v_accvgpr_read_b32 v39, a63
    v_cvt_pk_bf16_f32 v32, v32, v33
    v_cvt_pk_bf16_f32 v33, v34, v35
    v_cvt_pk_bf16_f32 v34, v36, v37
    v_cvt_pk_bf16_f32 v35, v38, v39
    s_add_u32 s48, s85, 1024
    buffer_store_dwordx4 v[32:35], v0, s[32:35], s48 offen sc1
    v_accvgpr_read_b32 v40, a0
    v_accvgpr_read_b32 v41, a1
    v_accvgpr_read_b32 v42, a2
    v_accvgpr_read_b32 v43, a3
    v_accvgpr_read_b32 v44, a4
    v_accvgpr_read_b32 v45, a5
    v_accvgpr_read_b32 v46, a6
    v_accvgpr_read_b32 v47, a7
    v_cvt_pk_bf16_f32 v40, v40, v41
    v_cvt_pk_bf16_f32 v41, v42, v43
    v_cvt_pk_bf16_f32 v42, v44, v45
    v_cvt_pk_bf16_f32 v43, v46, v47
    s_add_u32 s48, s85, 3072
    buffer_store_dwordx4 v[40:43], v0, s[32:35], s48 offen sc1
    v_accvgpr_read_b32 v48, a32
    v_accvgpr_read_b32 v49, a33
    v_accvgpr_read_b32 v50, a34
    v_accvgpr_read_b32 v51, a35
    v_accvgpr_read_b32 v52, a36
    v_accvgpr_read_b32 v53, a37
    v_accvgpr_read_b32 v54, a38
    v_accvgpr_read_b32 v55, a39
    v_cvt_pk_bf16_f32 v48, v48, v49
    v_cvt_pk_bf16_f32 v49, v50, v51
    v_cvt_pk_bf16_f32 v50, v52, v53
    v_cvt_pk_bf16_f32 v51, v54, v55
    s_add_u32 s48, s85, 4096
    buffer_store_dwordx4 v[48:51], v0, s[32:35], s48 offen sc1
    v_accvgpr_read_b32 v56, a8
    v_accvgpr_read_b32 v57, a9
    v_accvgpr_read_b32 v58, a10
    v_accvgpr_read_b32 v59, a11
    v_accvgpr_read_b32 v60, a12
    v_accvgpr_read_b32 v61, a13
    v_accvgpr_read_b32 v62, a14
    v_accvgpr_read_b32 v63, a15
    v_cvt_pk_bf16_f32 v56, v56, v57
    v_cvt_pk_bf16_f32 v57, v58, v59
    v_cvt_pk_bf16_f32 v58, v60, v61
    v_cvt_pk_bf16_f32 v59, v62, v63
    s_add_u32 s48, s85, 6144
    buffer_store_dwordx4 v[56:59], v0, s[32:35], s48 offen sc1
    v_accvgpr_read_b32 v64, a40
    v_accvgpr_read_b32 v65, a41
    v_accvgpr_read_b32 v66, a42
    v_accvgpr_read_b32 v67, a43
    v_accvgpr_read_b32 v68, a44
    v_accvgpr_read_b32 v69, a45
    v_accvgpr_read_b32 v70, a46
    v_accvgpr_read_b32 v71, a47
    v_cvt_pk_bf16_f32 v64, v64, v65
    v_cvt_pk_bf16_f32 v65, v66, v67
    v_cvt_pk_bf16_f32 v66, v68, v69
    v_cvt_pk_bf16_f32 v67, v70, v71
    s_add_u32 s48, s85, 7168
    buffer_store_dwordx4 v[64:67], v0, s[32:35], s48 offen sc1
    s_mul_i32 s86, s63, 12
    s_add_u32 s86, s86, 3
    s_mul_i32 s86, s86, 40960
    s_mul_i32 s87, s62, 1280
    s_add_u32 s86, s86, s87
    s_lshl_b32 s87, s64, 8
    s_add_u32 s86, s86, s87
    s_add_u32 s86, s86, 192
    s_waitcnt vmcnt(0) lgkmcnt(0)
    s_barrier
    s_cmp_lg_u32 s7, 0
    s_cbranch_scc1 L_pub9
    s_and_b32 s48, s2, 7
    s_lshl_b32 s48, s48, 5
    s_lshr_b32 s49, s2, 3
    s_add_u32 s48, s48, s49
    v_mov_b32 v2, s48
    v_mov_b32 v3, 3
    s_mov_b64 exec, 1
    global_store_byte v2, v3, s[22:23] sc1
    s_mov_b64 exec, -1
L_pub9:
    s_mov_b32 s12, s8
    s_mov_b32 s13, s9
    s_mov_b32 s14, 2949120
    s_mov_b32 s15, 0x20000
    s_cmp_lg_u32 s7, 0
    s_cbranch_scc1 L_xp1_3a_skip
    s_lshl_b32 s48, s62, 7
    s_add_u32 s48, s48, s60
    v_and_b32 v2, 3, v1
    v_lshlrev_b32 v2, 5, v2
    v_add_u32 v2, s48, v2
    s_mov_b32 s69, 0
L_xp1_3a_poll:
    global_load_ubyte v3, v2, s[22:23] sc1
    s_add_u32 s69, s69, 1
    s_waitcnt vmcnt(0)
    v_cmp_gt_u32 vcc, 3, v3
    s_cmp_ge_u32 s69, 131072
    s_cbranch_scc1 L_xp1_3a_skip
    s_nop 2
    s_cbranch_vccz L_xp1_3a_skip
    s_sleep 1
    s_branch L_xp1_3a_poll
L_xp1_3a_skip:
    s_barrier
    s_mov_b32 s48, 9216
    buffer_load_dwordx4 v[24:27], v0, s[32:35], s48 offen sc1
    s_mov_b32 s48, 10240
    buffer_load_dwordx4 v[28:31], v0, s[32:35], s48 offen sc1
    s_mov_b32 s48, 1483776
    buffer_load_dwordx4 v[36:39], v0, s[32:35], s48 offen sc1
    s_mov_b32 s48, 1484800
    buffer_load_dwordx4 v[40:43], v0, s[32:35], s48 offen sc1
    s_mov_b32 s48, 2958336
    buffer_load_dwordx4 v[48:51], v0, s[32:35], s48 offen sc1
    s_mov_b32 s48, 2959360
    buffer_load_dwordx4 v[52:55], v0, s[32:35], s48 offen sc1
    v_and_b32 v2, 15, v1
    v_mul_u32_u24 v2, 2560, v2
    v_lshrrev_b32 v3, 4, v1
    v_lshl_add_u32 v2, v3, 3, v2
    v_accvgpr_read_b32 v64, a16
    v_accvgpr_read_b32 v65, a17
    v_accvgpr_read_b32 v66, a18
    v_accvgpr_read_b32 v67, a19
    s_waitcnt vmcnt(5)
    v_lshlrev_b32 v22, 16, v24
    v_and_b32 v23, 0xffff0000, v24
    v_add_f32 v64, v64, v22
    v_add_f32 v65, v65, v23
    v_lshlrev_b32 v22, 16, v25
    v_and_b32 v23, 0xffff0000, v25
    v_add_f32 v66, v66, v22
    v_add_f32 v67, v67, v23
    s_waitcnt vmcnt(3)
    v_lshlrev_b32 v22, 16, v36
    v_and_b32 v23, 0xffff0000, v36
    v_add_f32 v64, v64, v22
    v_add_f32 v65, v65, v23
    v_lshlrev_b32 v22, 16, v37
    v_and_b32 v23, 0xffff0000, v37
    v_add_f32 v66, v66, v22
    v_add_f32 v67, v67, v23
    s_waitcnt vmcnt(1)
    v_lshlrev_b32 v22, 16, v48
    v_and_b32 v23, 0xffff0000, v48
    v_add_f32 v64, v64, v22
    v_add_f32 v65, v65, v23
    v_lshlrev_b32 v22, 16, v49
    v_and_b32 v23, 0xffff0000, v49
    v_add_f32 v66, v66, v22
    v_add_f32 v67, v67, v23
    v_cvt_pk_bf16_f32 v64, v64, v65
    v_cvt_pk_bf16_f32 v65, v66, v67
    s_add_u32 s48, s86, 0
    buffer_store_dwordx2 v[64:65], v2, s[12:15], s48 offen offset:0
    v_accvgpr_read_b32 v68, a20
    v_accvgpr_read_b32 v69, a21
    v_accvgpr_read_b32 v70, a22
    v_accvgpr_read_b32 v71, a23
    v_lshlrev_b32 v22, 16, v26
    v_and_b32 v23, 0xffff0000, v26
    v_add_f32 v68, v68, v22
    v_add_f32 v69, v69, v23
    v_lshlrev_b32 v22, 16, v27
    v_and_b32 v23, 0xffff0000, v27
    v_add_f32 v70, v70, v22
    v_add_f32 v71, v71, v23
    v_lshlrev_b32 v22, 16, v38
    v_and_b32 v23, 0xffff0000, v38
    v_add_f32 v68, v68, v22
    v_add_f32 v69, v69, v23
    v_lshlrev_b32 v22, 16, v39
    v_and_b32 v23, 0xffff0000, v39
    v_add_f32 v70, v70, v22
    v_add_f32 v71, v71, v23
    v_lshlrev_b32 v22, 16, v50
    v_and_b32 v23, 0xffff0000, v50
    v_add_f32 v68, v68, v22
    v_add_f32 v69, v69, v23
    v_lshlrev_b32 v22, 16, v51
    v_and_b32 v23, 0xffff0000, v51
    v_add_f32 v70, v70, v22
    v_add_f32 v71, v71, v23
    v_cvt_pk_bf16_f32 v68, v68, v69
    v_cvt_pk_bf16_f32 v69, v70, v71
    s_add_u32 s48, s86, 0
    buffer_store_dwordx2 v[68:69], v2, s[12:15], s48 offen offset:32
    v_accvgpr_read_b32 v72, a48
    v_accvgpr_read_b32 v73, a49
    v_accvgpr_read_b32 v74, a50
    v_accvgpr_read_b32 v75, a51
    v_lshlrev_b32 v22, 16, v28
    v_and_b32 v23, 0xffff0000, v28
    v_add_f32 v72, v72, v22
    v_add_f32 v73, v73, v23
    v_lshlrev_b32 v22, 16, v29
    v_and_b32 v23, 0xffff0000, v29
    v_add_f32 v74, v74, v22
    v_add_f32 v75, v75, v23
    v_lshlrev_b32 v22, 16, v40
    v_and_b32 v23, 0xffff0000, v40
    v_add_f32 v72, v72, v22
    v_add_f32 v73, v73, v23
    v_lshlrev_b32 v22, 16, v41
    v_and_b32 v23, 0xffff0000, v41
    v_add_f32 v74, v74, v22
    v_add_f32 v75, v75, v23
    s_waitcnt vmcnt(2)
    v_lshlrev_b32 v22, 16, v52
    v_and_b32 v23, 0xffff0000, v52
    v_add_f32 v72, v72, v22
    v_add_f32 v73, v73, v23
    v_lshlrev_b32 v22, 16, v53
    v_and_b32 v23, 0xffff0000, v53
    v_add_f32 v74, v74, v22
    v_add_f32 v75, v75, v23
    v_cvt_pk_bf16_f32 v72, v72, v73
    v_cvt_pk_bf16_f32 v73, v74, v75
    s_add_u32 s48, s86, 40960
    buffer_store_dwordx2 v[72:73], v2, s[12:15], s48 offen offset:0
    v_accvgpr_read_b32 v76, a52
    v_accvgpr_read_b32 v77, a53
    v_accvgpr_read_b32 v78, a54
    v_accvgpr_read_b32 v79, a55
    v_lshlrev_b32 v22, 16, v30
    v_and_b32 v23, 0xffff0000, v30
    v_add_f32 v76, v76, v22
    v_add_f32 v77, v77, v23
    v_lshlrev_b32 v22, 16, v31
    v_and_b32 v23, 0xffff0000, v31
    v_add_f32 v78, v78, v22
    v_add_f32 v79, v79, v23
    v_lshlrev_b32 v22, 16, v42
    v_and_b32 v23, 0xffff0000, v42
    v_add_f32 v76, v76, v22
    v_add_f32 v77, v77, v23
    v_lshlrev_b32 v22, 16, v43
    v_and_b32 v23, 0xffff0000, v43
    v_add_f32 v78, v78, v22
    v_add_f32 v79, v79, v23
    v_lshlrev_b32 v22, 16, v54
    v_and_b32 v23, 0xffff0000, v54
    v_add_f32 v76, v76, v22
    v_add_f32 v77, v77, v23
    v_lshlrev_b32 v22, 16, v55
    v_and_b32 v23, 0xffff0000, v55
    v_add_f32 v78, v78, v22
    v_add_f32 v79, v79, v23
    v_cvt_pk_bf16_f32 v76, v76, v77
    v_cvt_pk_bf16_f32 v77, v78, v79
    s_add_u32 s48, s86, 40960
    buffer_store_dwordx2 v[76:77], v2, s[12:15], s48 offen offset:32
    s_branch L_end2
L_x1_3a:
L_xw2a:
    s_lshl_b32 s84, s62, 2
    s_mul_i32 s84, s84, 30
    s_add_u32 s84, s84, s60
    s_lshl_b32 s84, s84, 2
    s_add_u32 s84, s84, s3
    s_mul_i32 s84, s84, 12288
    s_add_u32 s84, s84, 18874368
    s_add_u32 s32, s4, s84
    s_addc_u32 s33, s5, 0
    s_mov_b32 s34, 4435968
    s_mov_b32 s35, 0x20000
    s_mul_i32 s85, s61, 1474560
    s_load_dwordx2 s[8:9], s[0:1], 80
    s_nop 7
    s_cmp_lg_u32 s61, 0
    s_cbranch_scc1 L_x2_0a
    v_accvgpr_read_b32 v24, a24
    v_accvgpr_read_b32 v25, a25
    v_accvgpr_read_b32 v26, a26
    v_accvgpr_read_b32 v27, a27
    v_accvgpr_read_b32 v28, a28
    v_accvgpr_read_b32 v29, a29
    v_accvgpr_read_b32 v30, a30
    v_accvgpr_read_b32 v31, a31
    v_cvt_pk_bf16_f32 v24, v24, v25
    v_cvt_pk_bf16_f32 v25, v26, v27
    v_cvt_pk_bf16_f32 v26, v28, v29
    v_cvt_pk_bf16_f32 v27, v30, v31
    s_add_u32 s48, s85, 3072
    buffer_store_dwordx4 v[24:27], v0, s[32:35], s48 offen sc1
    v_accvgpr_read_b32 v32, a56
    v_accvgpr_read_b32 v33, a57
    v_accvgpr_read_b32 v34, a58
    v_accvgpr_read_b32 v35, a59
    v_accvgpr_read_b32 v36, a60
    v_accvgpr_read_b32 v37, a61
    v_accvgpr_read_b32 v38, a62
    v_accvgpr_read_b32 v39, a63
    v_cvt_pk_bf16_f32 v32, v32, v33
    v_cvt_pk_bf16_f32 v33, v34, v35
    v_cvt_pk_bf16_f32 v34, v36, v37
    v_cvt_pk_bf16_f32 v35, v38, v39
    s_add_u32 s48, s85, 4096
    buffer_store_dwordx4 v[32:35], v0, s[32:35], s48 offen sc1
    v_accvgpr_read_b32 v40, a0
    v_accvgpr_read_b32 v41, a1
    v_accvgpr_read_b32 v42, a2
    v_accvgpr_read_b32 v43, a3
    v_accvgpr_read_b32 v44, a4
    v_accvgpr_read_b32 v45, a5
    v_accvgpr_read_b32 v46, a6
    v_accvgpr_read_b32 v47, a7
    v_cvt_pk_bf16_f32 v40, v40, v41
    v_cvt_pk_bf16_f32 v41, v42, v43
    v_cvt_pk_bf16_f32 v42, v44, v45
    v_cvt_pk_bf16_f32 v43, v46, v47
    s_add_u32 s48, s85, 6144
    buffer_store_dwordx4 v[40:43], v0, s[32:35], s48 offen sc1
    v_accvgpr_read_b32 v48, a32
    v_accvgpr_read_b32 v49, a33
    v_accvgpr_read_b32 v50, a34
    v_accvgpr_read_b32 v51, a35
    v_accvgpr_read_b32 v52, a36
    v_accvgpr_read_b32 v53, a37
    v_accvgpr_read_b32 v54, a38
    v_accvgpr_read_b32 v55, a39
    v_cvt_pk_bf16_f32 v48, v48, v49
    v_cvt_pk_bf16_f32 v49, v50, v51
    v_cvt_pk_bf16_f32 v50, v52, v53
    v_cvt_pk_bf16_f32 v51, v54, v55
    s_add_u32 s48, s85, 7168
    buffer_store_dwordx4 v[48:51], v0, s[32:35], s48 offen sc1
    v_accvgpr_read_b32 v56, a8
    v_accvgpr_read_b32 v57, a9
    v_accvgpr_read_b32 v58, a10
    v_accvgpr_read_b32 v59, a11
    v_accvgpr_read_b32 v60, a12
    v_accvgpr_read_b32 v61, a13
    v_accvgpr_read_b32 v62, a14
    v_accvgpr_read_b32 v63, a15
    v_cvt_pk_bf16_f32 v56, v56, v57
    v_cvt_pk_bf16_f32 v57, v58, v59
    v_cvt_pk_bf16_f32 v58, v60, v61
    v_cvt_pk_bf16_f32 v59, v62, v63
    s_add_u32 s48, s85, 9216
    buffer_store_dwordx4 v[56:59], v0, s[32:35], s48 offen sc1
    v_accvgpr_read_b32 v64, a40
    v_accvgpr_read_b32 v65, a41
    v_accvgpr_read_b32 v66, a42
    v_accvgpr_read_b32 v67, a43
    v_accvgpr_read_b32 v68, a44
    v_accvgpr_read_b32 v69, a45
    v_accvgpr_read_b32 v70, a46
    v_accvgpr_read_b32 v71, a47
    v_cvt_pk_bf16_f32 v64, v64, v65
    v_cvt_pk_bf16_f32 v65, v66, v67
    v_cvt_pk_bf16_f32 v66, v68, v69
    v_cvt_pk_bf16_f32 v67, v70, v71
    s_add_u32 s48, s85, 10240
    buffer_store_dwordx4 v[64:67], v0, s[32:35], s48 offen sc1
    s_mul_i32 s86, s63, 12
    s_add_u32 s86, s86, 6
    s_mul_i32 s86, s86, 40960
    s_mul_i32 s87, s62, 1280
    s_add_u32 s86, s86, s87
    s_lshl_b32 s87, s64, 8
    s_add_u32 s86, s86, s87
    s_add_u32 s86, s86, 0
    s_waitcnt vmcnt(0) lgkmcnt(0)
    s_barrier
    s_cmp_lg_u32 s7, 0
    s_cbranch_scc1 L_pub10
    s_and_b32 s48, s2, 7
    s_lshl_b32 s48, s48, 5
    s_lshr_b32 s49, s2, 3
    s_add_u32 s48, s48, s49
    v_mov_b32 v2, s48
    v_mov_b32 v3, 3
    s_mov_b64 exec, 1
    global_store_byte v2, v3, s[22:23] sc1
    s_mov_b64 exec, -1
L_pub10:
    s_mov_b32 s12, s8
    s_mov_b32 s13, s9
    s_mov_b32 s14, 2949120
    s_mov_b32 s15, 0x20000
    s_cmp_lg_u32 s7, 0
    s_cbranch_scc1 L_xp2_0a_skip
    s_lshl_b32 s48, s62, 7
    s_add_u32 s48, s48, s60
    v_and_b32 v2, 3, v1
    v_lshlrev_b32 v2, 5, v2
    v_add_u32 v2, s48, v2
    s_mov_b32 s69, 0
L_xp2_0a_poll:
    global_load_ubyte v3, v2, s[22:23] sc1
    s_add_u32 s69, s69, 1
    s_waitcnt vmcnt(0)
    v_cmp_gt_u32 vcc, 3, v3
    s_cmp_ge_u32 s69, 131072
    s_cbranch_scc1 L_xp2_0a_skip
    s_nop 2
    s_cbranch_vccz L_xp2_0a_skip
    s_sleep 1
    s_branch L_xp2_0a_poll
L_xp2_0a_skip:
    s_barrier
    s_mov_b32 s48, 1474560
    buffer_load_dwordx4 v[24:27], v0, s[32:35], s48 offen sc1
    s_mov_b32 s48, 1475584
    buffer_load_dwordx4 v[28:31], v0, s[32:35], s48 offen sc1
    s_mov_b32 s48, 2949120
    buffer_load_dwordx4 v[36:39], v0, s[32:35], s48 offen sc1
    s_mov_b32 s48, 2950144
    buffer_load_dwordx4 v[40:43], v0, s[32:35], s48 offen sc1
    s_mov_b32 s48, 4423680
    buffer_load_dwordx4 v[48:51], v0, s[32:35], s48 offen sc1
    s_mov_b32 s48, 4424704
    buffer_load_dwordx4 v[52:55], v0, s[32:35], s48 offen sc1
    v_and_b32 v2, 15, v1
    v_mul_u32_u24 v2, 2560, v2
    v_lshrrev_b32 v3, 4, v1
    v_lshl_add_u32 v2, v3, 3, v2
    v_accvgpr_read_b32 v64, a16
    v_accvgpr_read_b32 v65, a17
    v_accvgpr_read_b32 v66, a18
    v_accvgpr_read_b32 v67, a19
    s_waitcnt vmcnt(5)
    v_lshlrev_b32 v22, 16, v24
    v_and_b32 v23, 0xffff0000, v24
    v_add_f32 v64, v64, v22
    v_add_f32 v65, v65, v23
    v_lshlrev_b32 v22, 16, v25
    v_and_b32 v23, 0xffff0000, v25
    v_add_f32 v66, v66, v22
    v_add_f32 v67, v67, v23
    s_waitcnt vmcnt(3)
    v_lshlrev_b32 v22, 16, v36
    v_and_b32 v23, 0xffff0000, v36
    v_add_f32 v64, v64, v22
    v_add_f32 v65, v65, v23
    v_lshlrev_b32 v22, 16, v37
    v_and_b32 v23, 0xffff0000, v37
    v_add_f32 v66, v66, v22
    v_add_f32 v67, v67, v23
    s_waitcnt vmcnt(1)
    v_lshlrev_b32 v22, 16, v48
    v_and_b32 v23, 0xffff0000, v48
    v_add_f32 v64, v64, v22
    v_add_f32 v65, v65, v23
    v_lshlrev_b32 v22, 16, v49
    v_and_b32 v23, 0xffff0000, v49
    v_add_f32 v66, v66, v22
    v_add_f32 v67, v67, v23
    v_cvt_pk_bf16_f32 v64, v64, v65
    v_cvt_pk_bf16_f32 v65, v66, v67
    s_add_u32 s48, s86, 0
    buffer_store_dwordx2 v[64:65], v2, s[12:15], s48 offen offset:0
    v_accvgpr_read_b32 v68, a20
    v_accvgpr_read_b32 v69, a21
    v_accvgpr_read_b32 v70, a22
    v_accvgpr_read_b32 v71, a23
    v_lshlrev_b32 v22, 16, v26
    v_and_b32 v23, 0xffff0000, v26
    v_add_f32 v68, v68, v22
    v_add_f32 v69, v69, v23
    v_lshlrev_b32 v22, 16, v27
    v_and_b32 v23, 0xffff0000, v27
    v_add_f32 v70, v70, v22
    v_add_f32 v71, v71, v23
    v_lshlrev_b32 v22, 16, v38
    v_and_b32 v23, 0xffff0000, v38
    v_add_f32 v68, v68, v22
    v_add_f32 v69, v69, v23
    v_lshlrev_b32 v22, 16, v39
    v_and_b32 v23, 0xffff0000, v39
    v_add_f32 v70, v70, v22
    v_add_f32 v71, v71, v23
    v_lshlrev_b32 v22, 16, v50
    v_and_b32 v23, 0xffff0000, v50
    v_add_f32 v68, v68, v22
    v_add_f32 v69, v69, v23
    v_lshlrev_b32 v22, 16, v51
    v_and_b32 v23, 0xffff0000, v51
    v_add_f32 v70, v70, v22
    v_add_f32 v71, v71, v23
    v_cvt_pk_bf16_f32 v68, v68, v69
    v_cvt_pk_bf16_f32 v69, v70, v71
    s_add_u32 s48, s86, 0
    buffer_store_dwordx2 v[68:69], v2, s[12:15], s48 offen offset:32
    v_accvgpr_read_b32 v72, a48
    v_accvgpr_read_b32 v73, a49
    v_accvgpr_read_b32 v74, a50
    v_accvgpr_read_b32 v75, a51
    v_lshlrev_b32 v22, 16, v28
    v_and_b32 v23, 0xffff0000, v28
    v_add_f32 v72, v72, v22
    v_add_f32 v73, v73, v23
    v_lshlrev_b32 v22, 16, v29
    v_and_b32 v23, 0xffff0000, v29
    v_add_f32 v74, v74, v22
    v_add_f32 v75, v75, v23
    v_lshlrev_b32 v22, 16, v40
    v_and_b32 v23, 0xffff0000, v40
    v_add_f32 v72, v72, v22
    v_add_f32 v73, v73, v23
    v_lshlrev_b32 v22, 16, v41
    v_and_b32 v23, 0xffff0000, v41
    v_add_f32 v74, v74, v22
    v_add_f32 v75, v75, v23
    s_waitcnt vmcnt(2)
    v_lshlrev_b32 v22, 16, v52
    v_and_b32 v23, 0xffff0000, v52
    v_add_f32 v72, v72, v22
    v_add_f32 v73, v73, v23
    v_lshlrev_b32 v22, 16, v53
    v_and_b32 v23, 0xffff0000, v53
    v_add_f32 v74, v74, v22
    v_add_f32 v75, v75, v23
    v_cvt_pk_bf16_f32 v72, v72, v73
    v_cvt_pk_bf16_f32 v73, v74, v75
    s_add_u32 s48, s86, 40960
    buffer_store_dwordx2 v[72:73], v2, s[12:15], s48 offen offset:0
    v_accvgpr_read_b32 v76, a52
    v_accvgpr_read_b32 v77, a53
    v_accvgpr_read_b32 v78, a54
    v_accvgpr_read_b32 v79, a55
    v_lshlrev_b32 v22, 16, v30
    v_and_b32 v23, 0xffff0000, v30
    v_add_f32 v76, v76, v22
    v_add_f32 v77, v77, v23
    v_lshlrev_b32 v22, 16, v31
    v_and_b32 v23, 0xffff0000, v31
    v_add_f32 v78, v78, v22
    v_add_f32 v79, v79, v23
    v_lshlrev_b32 v22, 16, v42
    v_and_b32 v23, 0xffff0000, v42
    v_add_f32 v76, v76, v22
    v_add_f32 v77, v77, v23
    v_lshlrev_b32 v22, 16, v43
    v_and_b32 v23, 0xffff0000, v43
    v_add_f32 v78, v78, v22
    v_add_f32 v79, v79, v23
    v_lshlrev_b32 v22, 16, v54
    v_and_b32 v23, 0xffff0000, v54
    v_add_f32 v76, v76, v22
    v_add_f32 v77, v77, v23
    v_lshlrev_b32 v22, 16, v55
    v_and_b32 v23, 0xffff0000, v55
    v_add_f32 v78, v78, v22
    v_add_f32 v79, v79, v23
    v_cvt_pk_bf16_f32 v76, v76, v77
    v_cvt_pk_bf16_f32 v77, v78, v79
    s_add_u32 s48, s86, 40960
    buffer_store_dwordx2 v[76:77], v2, s[12:15], s48 offen offset:32
    s_branch L_end2
L_x2_0a:
    s_cmp_lg_u32 s61, 1
    s_cbranch_scc1 L_x2_1a
    v_accvgpr_read_b32 v24, a16
    v_accvgpr_read_b32 v25, a17
    v_accvgpr_read_b32 v26, a18
    v_accvgpr_read_b32 v27, a19
    v_accvgpr_read_b32 v28, a20
    v_accvgpr_read_b32 v29, a21
    v_accvgpr_read_b32 v30, a22
    v_accvgpr_read_b32 v31, a23
    v_cvt_pk_bf16_f32 v24, v24, v25
    v_cvt_pk_bf16_f32 v25, v26, v27
    v_cvt_pk_bf16_f32 v26, v28, v29
    v_cvt_pk_bf16_f32 v27, v30, v31
    s_add_u32 s48, s85, 0
    buffer_store_dwordx4 v[24:27], v0, s[32:35], s48 offen sc1
    v_accvgpr_read_b32 v32, a48
    v_accvgpr_read_b32 v33, a49
    v_accvgpr_read_b32 v34, a50
    v_accvgpr_read_b32 v35, a51
    v_accvgpr_read_b32 v36, a52
    v_accvgpr_read_b32 v37, a53
    v_accvgpr_read_b32 v38, a54
    v_accvgpr_read_b32 v39, a55
    v_cvt_pk_bf16_f32 v32, v32, v33
    v_cvt_pk_bf16_f32 v33, v34, v35
    v_cvt_pk_bf16_f32 v34, v36, v37
    v_cvt_pk_bf16_f32 v35, v38, v39
    s_add_u32 s48, s85, 1024
    buffer_store_dwordx4 v[32:35], v0, s[32:35], s48 offen sc1
    v_accvgpr_read_b32 v40, a0
    v_accvgpr_read_b32 v41, a1
    v_accvgpr_read_b32 v42, a2
    v_accvgpr_read_b32 v43, a3
    v_accvgpr_read_b32 v44, a4
    v_accvgpr_read_b32 v45, a5
    v_accvgpr_read_b32 v46, a6
    v_accvgpr_read_b32 v47, a7
    v_cvt_pk_bf16_f32 v40, v40, v41
    v_cvt_pk_bf16_f32 v41, v42, v43
    v_cvt_pk_bf16_f32 v42, v44, v45
    v_cvt_pk_bf16_f32 v43, v46, v47
    s_add_u32 s48, s85, 6144
    buffer_store_dwordx4 v[40:43], v0, s[32:35], s48 offen sc1
    v_accvgpr_read_b32 v48, a32
    v_accvgpr_read_b32 v49, a33
    v_accvgpr_read_b32 v50, a34
    v_accvgpr_read_b32 v51, a35
    v_accvgpr_read_b32 v52, a36
    v_accvgpr_read_b32 v53, a37
    v_accvgpr_read_b32 v54, a38
    v_accvgpr_read_b32 v55, a39
    v_cvt_pk_bf16_f32 v48, v48, v49
    v_cvt_pk_bf16_f32 v49, v50, v51
    v_cvt_pk_bf16_f32 v50, v52, v53
    v_cvt_pk_bf16_f32 v51, v54, v55
    s_add_u32 s48, s85, 7168
    buffer_store_dwordx4 v[48:51], v0, s[32:35], s48 offen sc1
    v_accvgpr_read_b32 v56, a8
    v_accvgpr_read_b32 v57, a9
    v_accvgpr_read_b32 v58, a10
    v_accvgpr_read_b32 v59, a11
    v_accvgpr_read_b32 v60, a12
    v_accvgpr_read_b32 v61, a13
    v_accvgpr_read_b32 v62, a14
    v_accvgpr_read_b32 v63, a15
    v_cvt_pk_bf16_f32 v56, v56, v57
    v_cvt_pk_bf16_f32 v57, v58, v59
    v_cvt_pk_bf16_f32 v58, v60, v61
    v_cvt_pk_bf16_f32 v59, v62, v63
    s_add_u32 s48, s85, 9216
    buffer_store_dwordx4 v[56:59], v0, s[32:35], s48 offen sc1
    v_accvgpr_read_b32 v64, a40
    v_accvgpr_read_b32 v65, a41
    v_accvgpr_read_b32 v66, a42
    v_accvgpr_read_b32 v67, a43
    v_accvgpr_read_b32 v68, a44
    v_accvgpr_read_b32 v69, a45
    v_accvgpr_read_b32 v70, a46
    v_accvgpr_read_b32 v71, a47
    v_cvt_pk_bf16_f32 v64, v64, v65
    v_cvt_pk_bf16_f32 v65, v66, v67
    v_cvt_pk_bf16_f32 v66, v68, v69
    v_cvt_pk_bf16_f32 v67, v70, v71
    s_add_u32 s48, s85, 10240
    buffer_store_dwordx4 v[64:67], v0, s[32:35], s48 offen sc1
    s_mul_i32 s86, s63, 12
    s_add_u32 s86, s86, 6
    s_mul_i32 s86, s86, 40960
    s_mul_i32 s87, s62, 1280
    s_add_u32 s86, s86, s87
    s_lshl_b32 s87, s64, 8
    s_add_u32 s86, s86, s87
    s_add_u32 s86, s86, 64
    s_waitcnt vmcnt(0) lgkmcnt(0)
    s_barrier
    s_cmp_lg_u32 s7, 0
    s_cbranch_scc1 L_pub11
    s_and_b32 s48, s2, 7
    s_lshl_b32 s48, s48, 5
    s_lshr_b32 s49, s2, 3
    s_add_u32 s48, s48, s49
    v_mov_b32 v2, s48
    v_mov_b32 v3, 3
    s_mov_b64 exec, 1
    global_store_byte v2, v3, s[22:23] sc1
    s_mov_b64 exec, -1
L_pub11:
    s_mov_b32 s12, s8
    s_mov_b32 s13, s9
    s_mov_b32 s14, 2949120
    s_mov_b32 s15, 0x20000
    s_cmp_lg_u32 s7, 0
    s_cbranch_scc1 L_xp2_1a_skip
    s_lshl_b32 s48, s62, 7
    s_add_u32 s48, s48, s60
    v_and_b32 v2, 3, v1
    v_lshlrev_b32 v2, 5, v2
    v_add_u32 v2, s48, v2
    s_mov_b32 s69, 0
L_xp2_1a_poll:
    global_load_ubyte v3, v2, s[22:23] sc1
    s_add_u32 s69, s69, 1
    s_waitcnt vmcnt(0)
    v_cmp_gt_u32 vcc, 3, v3
    s_cmp_ge_u32 s69, 131072
    s_cbranch_scc1 L_xp2_1a_skip
    s_nop 2
    s_cbranch_vccz L_xp2_1a_skip
    s_sleep 1
    s_branch L_xp2_1a_poll
L_xp2_1a_skip:
    s_barrier
    s_mov_b32 s48, 3072
    buffer_load_dwordx4 v[24:27], v0, s[32:35], s48 offen sc1
    s_mov_b32 s48, 4096
    buffer_load_dwordx4 v[28:31], v0, s[32:35], s48 offen sc1
    s_mov_b32 s48, 2952192
    buffer_load_dwordx4 v[36:39], v0, s[32:35], s48 offen sc1
    s_mov_b32 s48, 2953216
    buffer_load_dwordx4 v[40:43], v0, s[32:35], s48 offen sc1
    s_mov_b32 s48, 4426752
    buffer_load_dwordx4 v[48:51], v0, s[32:35], s48 offen sc1
    s_mov_b32 s48, 4427776
    buffer_load_dwordx4 v[52:55], v0, s[32:35], s48 offen sc1
    v_and_b32 v2, 15, v1
    v_mul_u32_u24 v2, 2560, v2
    v_lshrrev_b32 v3, 4, v1
    v_lshl_add_u32 v2, v3, 3, v2
    v_accvgpr_read_b32 v64, a24
    v_accvgpr_read_b32 v65, a25
    v_accvgpr_read_b32 v66, a26
    v_accvgpr_read_b32 v67, a27
    s_waitcnt vmcnt(5)
    v_lshlrev_b32 v22, 16, v24
    v_and_b32 v23, 0xffff0000, v24
    v_add_f32 v64, v64, v22
    v_add_f32 v65, v65, v23
    v_lshlrev_b32 v22, 16, v25
    v_and_b32 v23, 0xffff0000, v25
    v_add_f32 v66, v66, v22
    v_add_f32 v67, v67, v23
    s_waitcnt vmcnt(3)
    v_lshlrev_b32 v22, 16, v36
    v_and_b32 v23, 0xffff0000, v36
    v_add_f32 v64, v64, v22
    v_add_f32 v65, v65, v23
    v_lshlrev_b32 v22, 16, v37
    v_and_b32 v23, 0xffff0000, v37
    v_add_f32 v66, v66, v22
    v_add_f32 v67, v67, v23
    s_waitcnt vmcnt(1)
    v_lshlrev_b32 v22, 16, v48
    v_and_b32 v23, 0xffff0000, v48
    v_add_f32 v64, v64, v22
    v_add_f32 v65, v65, v23
    v_lshlrev_b32 v22, 16, v49
    v_and_b32 v23, 0xffff0000, v49
    v_add_f32 v66, v66, v22
    v_add_f32 v67, v67, v23
    v_cvt_pk_bf16_f32 v64, v64, v65
    v_cvt_pk_bf16_f32 v65, v66, v67
    s_add_u32 s48, s86, 0
    buffer_store_dwordx2 v[64:65], v2, s[12:15], s48 offen offset:0
    v_accvgpr_read_b32 v68, a28
    v_accvgpr_read_b32 v69, a29
    v_accvgpr_read_b32 v70, a30
    v_accvgpr_read_b32 v71, a31
    v_lshlrev_b32 v22, 16, v26
    v_and_b32 v23, 0xffff0000, v26
    v_add_f32 v68, v68, v22
    v_add_f32 v69, v69, v23
    v_lshlrev_b32 v22, 16, v27
    v_and_b32 v23, 0xffff0000, v27
    v_add_f32 v70, v70, v22
    v_add_f32 v71, v71, v23
    v_lshlrev_b32 v22, 16, v38
    v_and_b32 v23, 0xffff0000, v38
    v_add_f32 v68, v68, v22
    v_add_f32 v69, v69, v23
    v_lshlrev_b32 v22, 16, v39
    v_and_b32 v23, 0xffff0000, v39
    v_add_f32 v70, v70, v22
    v_add_f32 v71, v71, v23
    v_lshlrev_b32 v22, 16, v50
    v_and_b32 v23, 0xffff0000, v50
    v_add_f32 v68, v68, v22
    v_add_f32 v69, v69, v23
    v_lshlrev_b32 v22, 16, v51
    v_and_b32 v23, 0xffff0000, v51
    v_add_f32 v70, v70, v22
    v_add_f32 v71, v71, v23
    v_cvt_pk_bf16_f32 v68, v68, v69
    v_cvt_pk_bf16_f32 v69, v70, v71
    s_add_u32 s48, s86, 0
    buffer_store_dwordx2 v[68:69], v2, s[12:15], s48 offen offset:32
    v_accvgpr_read_b32 v72, a56
    v_accvgpr_read_b32 v73, a57
    v_accvgpr_read_b32 v74, a58
    v_accvgpr_read_b32 v75, a59
    v_lshlrev_b32 v22, 16, v28
    v_and_b32 v23, 0xffff0000, v28
    v_add_f32 v72, v72, v22
    v_add_f32 v73, v73, v23
    v_lshlrev_b32 v22, 16, v29
    v_and_b32 v23, 0xffff0000, v29
    v_add_f32 v74, v74, v22
    v_add_f32 v75, v75, v23
    v_lshlrev_b32 v22, 16, v40
    v_and_b32 v23, 0xffff0000, v40
    v_add_f32 v72, v72, v22
    v_add_f32 v73, v73, v23
    v_lshlrev_b32 v22, 16, v41
    v_and_b32 v23, 0xffff0000, v41
    v_add_f32 v74, v74, v22
    v_add_f32 v75, v75, v23
    s_waitcnt vmcnt(2)
    v_lshlrev_b32 v22, 16, v52
    v_and_b32 v23, 0xffff0000, v52
    v_add_f32 v72, v72, v22
    v_add_f32 v73, v73, v23
    v_lshlrev_b32 v22, 16, v53
    v_and_b32 v23, 0xffff0000, v53
    v_add_f32 v74, v74, v22
    v_add_f32 v75, v75, v23
    v_cvt_pk_bf16_f32 v72, v72, v73
    v_cvt_pk_bf16_f32 v73, v74, v75
    s_add_u32 s48, s86, 40960
    buffer_store_dwordx2 v[72:73], v2, s[12:15], s48 offen offset:0
    v_accvgpr_read_b32 v76, a60
    v_accvgpr_read_b32 v77, a61
    v_accvgpr_read_b32 v78, a62
    v_accvgpr_read_b32 v79, a63
    v_lshlrev_b32 v22, 16, v30
    v_and_b32 v23, 0xffff0000, v30
    v_add_f32 v76, v76, v22
    v_add_f32 v77, v77, v23
    v_lshlrev_b32 v22, 16, v31
    v_and_b32 v23, 0xffff0000, v31
    v_add_f32 v78, v78, v22
    v_add_f32 v79, v79, v23
    v_lshlrev_b32 v22, 16, v42
    v_and_b32 v23, 0xffff0000, v42
    v_add_f32 v76, v76, v22
    v_add_f32 v77, v77, v23
    v_lshlrev_b32 v22, 16, v43
    v_and_b32 v23, 0xffff0000, v43
    v_add_f32 v78, v78, v22
    v_add_f32 v79, v79, v23
    v_lshlrev_b32 v22, 16, v54
    v_and_b32 v23, 0xffff0000, v54
    v_add_f32 v76, v76, v22
    v_add_f32 v77, v77, v23
    v_lshlrev_b32 v22, 16, v55
    v_and_b32 v23, 0xffff0000, v55
    v_add_f32 v78, v78, v22
    v_add_f32 v79, v79, v23
    v_cvt_pk_bf16_f32 v76, v76, v77
    v_cvt_pk_bf16_f32 v77, v78, v79
    s_add_u32 s48, s86, 40960
    buffer_store_dwordx2 v[76:77], v2, s[12:15], s48 offen offset:32
    s_branch L_end2
L_x2_1a:
    s_cmp_lg_u32 s61, 2
    s_cbranch_scc1 L_x2_2a
    v_accvgpr_read_b32 v24, a16
    v_accvgpr_read_b32 v25, a17
    v_accvgpr_read_b32 v26, a18
    v_accvgpr_read_b32 v27, a19
    v_accvgpr_read_b32 v28, a20
    v_accvgpr_read_b32 v29, a21
    v_accvgpr_read_b32 v30, a22
    v_accvgpr_read_b32 v31, a23
    v_cvt_pk_bf16_f32 v24, v24, v25
    v_cvt_pk_bf16_f32 v25, v26, v27
    v_cvt_pk_bf16_f32 v26, v28, v29
    v_cvt_pk_bf16_f32 v27, v30, v31
    s_add_u32 s48, s85, 0
    buffer_store_dwordx4 v[24:27], v0, s[32:35], s48 offen sc1
    v_accvgpr_read_b32 v32, a48
    v_accvgpr_read_b32 v33, a49
    v_accvgpr_read_b32 v34, a50
    v_accvgpr_read_b32 v35, a51
    v_accvgpr_read_b32 v36, a52
    v_accvgpr_read_b32 v37, a53
    v_accvgpr_read_b32 v38, a54
    v_accvgpr_read_b32 v39, a55
    v_cvt_pk_bf16_f32 v32, v32, v33
    v_cvt_pk_bf16_f32 v33, v34, v35
    v_cvt_pk_bf16_f32 v34, v36, v37
    v_cvt_pk_bf16_f32 v35, v38, v39
    s_add_u32 s48, s85, 1024
    buffer_store_dwordx4 v[32:35], v0, s[32:35], s48 offen sc1
    v_accvgpr_read_b32 v40, a24
    v_accvgpr_read_b32 v41, a25
    v_accvgpr_read_b32 v42, a26
    v_accvgpr_read_b32 v43, a27
    v_accvgpr_read_b32 v44, a28
    v_accvgpr_read_b32 v45, a29
    v_accvgpr_read_b32 v46, a30
    v_accvgpr_read_b32 v47, a31
    v_cvt_pk_bf16_f32 v40, v40, v41
    v_cvt_pk_bf16_f32 v41, v42, v43
    v_cvt_pk_bf16_f32 v42, v44, v45
    v_cvt_pk_bf16_f32 v43, v46, v47
    s_add_u32 s48, s85, 3072
    buffer_store_dwordx4 v[40:43], v0, s[32:35], s48 offen sc1
    v_accvgpr_read_b32 v48, a56
    v_accvgpr_read_b32 v49, a57
    v_accvgpr_read_b32 v50, a58
    v_accvgpr_read_b32 v51, a59
    v_accvgpr_read_b32 v52, a60
    v_accvgpr_read_b32 v53, a61
    v_accvgpr_read_b32 v54, a62
    v_accvgpr_read_b32 v55, a63
    v_cvt_pk_bf16_f32 v48, v48, v49
    v_cvt_pk_bf16_f32 v49, v50, v51
    v_cvt_pk_bf16_f32 v50, v52, v53
    v_cvt_pk_bf16_f32 v51, v54, v55
    s_add_u32 s48, s85, 4096
    buffer_store_dwordx4 v[48:51], v0, s[32:35], s48 offen sc1
    v_accvgpr_read_b32 v56, a8
    v_accvgpr_read_b32 v57, a9
    v_accvgpr_read_b32 v58, a10
    v_accvgpr_read_b32 v59, a11
    v_accvgpr_read_b32 v60, a12
    v_accvgpr_read_b32 v61, a13
    v_accvgpr_read_b32 v62, a14
    v_accvgpr_read_b32 v63, a15
    v_cvt_pk_bf16_f32 v56, v56, v57
    v_cvt_pk_bf16_f32 v57, v58, v59
    v_cvt_pk_bf16_f32 v58, v60, v61
    v_cvt_pk_bf16_f32 v59, v62, v63
    s_add_u32 s48, s85, 9216
    buffer_store_dwordx4 v[56:59], v0, s[32:35], s48 offen sc1
    v_accvgpr_read_b32 v64, a40
    v_accvgpr_read_b32 v65, a41
    v_accvgpr_read_b32 v66, a42
    v_accvgpr_read_b32 v67, a43
    v_accvgpr_read_b32 v68, a44
    v_accvgpr_read_b32 v69, a45
    v_accvgpr_read_b32 v70, a46
    v_accvgpr_read_b32 v71, a47
    v_cvt_pk_bf16_f32 v64, v64, v65
    v_cvt_pk_bf16_f32 v65, v66, v67
    v_cvt_pk_bf16_f32 v66, v68, v69
    v_cvt_pk_bf16_f32 v67, v70, v71
    s_add_u32 s48, s85, 10240
    buffer_store_dwordx4 v[64:67], v0, s[32:35], s48 offen sc1
    s_mul_i32 s86, s63, 12
    s_add_u32 s86, s86, 6
    s_mul_i32 s86, s86, 40960
    s_mul_i32 s87, s62, 1280
    s_add_u32 s86, s86, s87
    s_lshl_b32 s87, s64, 8
    s_add_u32 s86, s86, s87
    s_add_u32 s86, s86, 128
    s_waitcnt vmcnt(0) lgkmcnt(0)
    s_barrier
    s_cmp_lg_u32 s7, 0
    s_cbranch_scc1 L_pub12
    s_and_b32 s48, s2, 7
    s_lshl_b32 s48, s48, 5
    s_lshr_b32 s49, s2, 3
    s_add_u32 s48, s48, s49
    v_mov_b32 v2, s48
    v_mov_b32 v3, 3
    s_mov_b64 exec, 1
    global_store_byte v2, v3, s[22:23] sc1
    s_mov_b64 exec, -1
L_pub12:
    s_mov_b32 s12, s8
    s_mov_b32 s13, s9
    s_mov_b32 s14, 2949120
    s_mov_b32 s15, 0x20000
    s_cmp_lg_u32 s7, 0
    s_cbranch_scc1 L_xp2_2a_skip
    s_lshl_b32 s48, s62, 7
    s_add_u32 s48, s48, s60
    v_and_b32 v2, 3, v1
    v_lshlrev_b32 v2, 5, v2
    v_add_u32 v2, s48, v2
    s_mov_b32 s69, 0
L_xp2_2a_poll:
    global_load_ubyte v3, v2, s[22:23] sc1
    s_add_u32 s69, s69, 1
    s_waitcnt vmcnt(0)
    v_cmp_gt_u32 vcc, 3, v3
    s_cmp_ge_u32 s69, 131072
    s_cbranch_scc1 L_xp2_2a_skip
    s_nop 2
    s_cbranch_vccz L_xp2_2a_skip
    s_sleep 1
    s_branch L_xp2_2a_poll
L_xp2_2a_skip:
    s_barrier
    s_mov_b32 s48, 6144
    buffer_load_dwordx4 v[24:27], v0, s[32:35], s48 offen sc1
    s_mov_b32 s48, 7168
    buffer_load_dwordx4 v[28:31], v0, s[32:35], s48 offen sc1
    s_mov_b32 s48, 1480704
    buffer_load_dwordx4 v[36:39], v0, s[32:35], s48 offen sc1
    s_mov_b32 s48, 1481728
    buffer_load_dwordx4 v[40:43], v0, s[32:35], s48 offen sc1
    s_mov_b32 s48, 4429824
    buffer_load_dwordx4 v[48:51], v0, s[32:35], s48 offen sc1
    s_mov_b32 s48, 4430848
    buffer_load_dwordx4 v[52:55], v0, s[32:35], s48 offen sc1
    v_and_b32 v2, 15, v1
    v_mul_u32_u24 v2, 2560, v2
    v_lshrrev_b32 v3, 4, v1
    v_lshl_add_u32 v2, v3, 3, v2
    v_accvgpr_read_b32 v64, a0
    v_accvgpr_read_b32 v65, a1
    v_accvgpr_read_b32 v66, a2
    v_accvgpr_read_b32 v67, a3
    s_waitcnt vmcnt(5)
    v_lshlrev_b32 v22, 16, v24
    v_and_b32 v23, 0xffff0000, v24
    v_add_f32 v64, v64, v22
    v_add_f32 v65, v65, v23
    v_lshlrev_b32 v22, 16, v25
    v_and_b32 v23, 0xffff0000, v25
    v_add_f32 v66, v66, v22
    v_add_f32 v67, v67, v23
    s_waitcnt vmcnt(3)
    v_lshlrev_b32 v22, 16, v36
    v_and_b32 v23, 0xffff0000, v36
    v_add_f32 v64, v64, v22
    v_add_f32 v65, v65, v23
    v_lshlrev_b32 v22, 16, v37
    v_and_b32 v23, 0xffff0000, v37
    v_add_f32 v66, v66, v22
    v_add_f32 v67, v67, v23
    s_waitcnt vmcnt(1)
    v_lshlrev_b32 v22, 16, v48
    v_and_b32 v23, 0xffff0000, v48
    v_add_f32 v64, v64, v22
    v_add_f32 v65, v65, v23
    v_lshlrev_b32 v22, 16, v49
    v_and_b32 v23, 0xffff0000, v49
    v_add_f32 v66, v66, v22
    v_add_f32 v67, v67, v23
    v_cvt_pk_bf16_f32 v64, v64, v65
    v_cvt_pk_bf16_f32 v65, v66, v67
    s_add_u32 s48, s86, 0
    buffer_store_dwordx2 v[64:65], v2, s[12:15], s48 offen offset:0
    v_accvgpr_read_b32 v68, a4
    v_accvgpr_read_b32 v69, a5
    v_accvgpr_read_b32 v70, a6
    v_accvgpr_read_b32 v71, a7
    v_lshlrev_b32 v22, 16, v26
    v_and_b32 v23, 0xffff0000, v26
    v_add_f32 v68, v68, v22
    v_add_f32 v69, v69, v23
    v_lshlrev_b32 v22, 16, v27
    v_and_b32 v23, 0xffff0000, v27
    v_add_f32 v70, v70, v22
    v_add_f32 v71, v71, v23
    v_lshlrev_b32 v22, 16, v38
    v_and_b32 v23, 0xffff0000, v38
    v_add_f32 v68, v68, v22
    v_add_f32 v69, v69, v23
    v_lshlrev_b32 v22, 16, v39
    v_and_b32 v23, 0xffff0000, v39
    v_add_f32 v70, v70, v22
    v_add_f32 v71, v71, v23
    v_lshlrev_b32 v22, 16, v50
    v_and_b32 v23, 0xffff0000, v50
    v_add_f32 v68, v68, v22
    v_add_f32 v69, v69, v23
    v_lshlrev_b32 v22, 16, v51
    v_and_b32 v23, 0xffff0000, v51
    v_add_f32 v70, v70, v22
    v_add_f32 v71, v71, v23
    v_cvt_pk_bf16_f32 v68, v68, v69
    v_cvt_pk_bf16_f32 v69, v70, v71
    s_add_u32 s48, s86, 0
    buffer_store_dwordx2 v[68:69], v2, s[12:15], s48 offen offset:32
    v_accvgpr_read_b32 v72, a32
    v_accvgpr_read_b32 v73, a33
    v_accvgpr_read_b32 v74, a34
    v_accvgpr_read_b32 v75, a35
    v_lshlrev_b32 v22, 16, v28
    v_and_b32 v23, 0xffff0000, v28
    v_add_f32 v72, v72, v22
    v_add_f32 v73, v73, v23
    v_lshlrev_b32 v22, 16, v29
    v_and_b32 v23, 0xffff0000, v29
    v_add_f32 v74, v74, v22
    v_add_f32 v75, v75, v23
    v_lshlrev_b32 v22, 16, v40
    v_and_b32 v23, 0xffff0000, v40
    v_add_f32 v72, v72, v22
    v_add_f32 v73, v73, v23
    v_lshlrev_b32 v22, 16, v41
    v_and_b32 v23, 0xffff0000, v41
    v_add_f32 v74, v74, v22
    v_add_f32 v75, v75, v23
    s_waitcnt vmcnt(2)
    v_lshlrev_b32 v22, 16, v52
    v_and_b32 v23, 0xffff0000, v52
    v_add_f32 v72, v72, v22
    v_add_f32 v73, v73, v23
    v_lshlrev_b32 v22, 16, v53
    v_and_b32 v23, 0xffff0000, v53
    v_add_f32 v74, v74, v22
    v_add_f32 v75, v75, v23
    v_cvt_pk_bf16_f32 v72, v72, v73
    v_cvt_pk_bf16_f32 v73, v74, v75
    s_add_u32 s48, s86, 40960
    buffer_store_dwordx2 v[72:73], v2, s[12:15], s48 offen offset:0
    v_accvgpr_read_b32 v76, a36
    v_accvgpr_read_b32 v77, a37
    v_accvgpr_read_b32 v78, a38
    v_accvgpr_read_b32 v79, a39
    v_lshlrev_b32 v22, 16, v30
    v_and_b32 v23, 0xffff0000, v30
    v_add_f32 v76, v76, v22
    v_add_f32 v77, v77, v23
    v_lshlrev_b32 v22, 16, v31
    v_and_b32 v23, 0xffff0000, v31
    v_add_f32 v78, v78, v22
    v_add_f32 v79, v79, v23
    v_lshlrev_b32 v22, 16, v42
    v_and_b32 v23, 0xffff0000, v42
    v_add_f32 v76, v76, v22
    v_add_f32 v77, v77, v23
    v_lshlrev_b32 v22, 16, v43
    v_and_b32 v23, 0xffff0000, v43
    v_add_f32 v78, v78, v22
    v_add_f32 v79, v79, v23
    v_lshlrev_b32 v22, 16, v54
    v_and_b32 v23, 0xffff0000, v54
    v_add_f32 v76, v76, v22
    v_add_f32 v77, v77, v23
    v_lshlrev_b32 v22, 16, v55
    v_and_b32 v23, 0xffff0000, v55
    v_add_f32 v78, v78, v22
    v_add_f32 v79, v79, v23
    v_cvt_pk_bf16_f32 v76, v76, v77
    v_cvt_pk_bf16_f32 v77, v78, v79
    s_add_u32 s48, s86, 40960
    buffer_store_dwordx2 v[76:77], v2, s[12:15], s48 offen offset:32
    s_branch L_end2
L_x2_2a:
    s_cmp_lg_u32 s61, 3
    s_cbranch_scc1 L_x2_3a
    v_accvgpr_read_b32 v24, a16
    v_accvgpr_read_b32 v25, a17
    v_accvgpr_read_b32 v26, a18
    v_accvgpr_read_b32 v27, a19
    v_accvgpr_read_b32 v28, a20
    v_accvgpr_read_b32 v29, a21
    v_accvgpr_read_b32 v30, a22
    v_accvgpr_read_b32 v31, a23
    v_cvt_pk_bf16_f32 v24, v24, v25
    v_cvt_pk_bf16_f32 v25, v26, v27
    v_cvt_pk_bf16_f32 v26, v28, v29
    v_cvt_pk_bf16_f32 v27, v30, v31
    s_add_u32 s48, s85, 0
    buffer_store_dwordx4 v[24:27], v0, s[32:35], s48 offen sc1
    v_accvgpr_read_b32 v32, a48
    v_accvgpr_read_b32 v33, a49
    v_accvgpr_read_b32 v34, a50
    v_accvgpr_read_b32 v35, a51
    v_accvgpr_read_b32 v36, a52
    v_accvgpr_read_b32 v37, a53
    v_accvgpr_read_b32 v38, a54
    v_accvgpr_read_b32 v39, a55
    v_cvt_pk_bf16_f32 v32, v32, v33
    v_cvt_pk_bf16_f32 v33, v34, v35
    v_cvt_pk_bf16_f32 v34, v36, v37
    v_cvt_pk_bf16_f32 v35, v38, v39
    s_add_u32 s48, s85, 1024
    buffer_store_dwordx4 v[32:35], v0, s[32:35], s48 offen sc1
    v_accvgpr_read_b32 v40, a24
    v_accvgpr_read_b32 v41, a25
    v_accvgpr_read_b32 v42, a26
    v_accvgpr_read_b32 v43, a27
    v_accvgpr_read_b32 v44, a28
    v_accvgpr_read_b32 v45, a29
    v_accvgpr_read_b32 v46, a30
    v_accvgpr_read_b32 v47, a31
    v_cvt_pk_bf16_f32 v40, v40, v41
    v_cvt_pk_bf16_f32 v41, v42, v43
    v_cvt_pk_bf16_f32 v42, v44, v45
    v_cvt_pk_bf16_f32 v43, v46, v47
    s_add_u32 s48, s85, 3072
    buffer_store_dwordx4 v[40:43], v0, s[32:35], s48 offen sc1
    v_accvgpr_read_b32 v48, a56
    v_accvgpr_read_b32 v49, a57
    v_accvgpr_read_b32 v50, a58
    v_accvgpr_read_b32 v51, a59
    v_accvgpr_read_b32 v52, a60
    v_accvgpr_read_b32 v53, a61
    v_accvgpr_read_b32 v54, a62
    v_accvgpr_read_b32 v55, a63
    v_cvt_pk_bf16_f32 v48, v48, v49
    v_cvt_pk_bf16_f32 v49, v50, v51
    v_cvt_pk_bf16_f32 v50, v52, v53
    v_cvt_pk_bf16_f32 v51, v54, v55
    s_add_u32 s48, s85, 4096
    buffer_store_dwordx4 v[48:51], v0, s[32:35], s48 offen sc1
    v_accvgpr_read_b32 v56, a0
    v_accvgpr_read_b32 v57, a1
    v_accvgpr_read_b32 v58, a2
    v_accvgpr_read_b32 v59, a3
    v_accvgpr_read_b32 v60, a4
    v_accvgpr_read_b32 v61, a5
    v_accvgpr_read_b32 v62, a6
    v_accvgpr_read_b32 v63, a7
    v_cvt_pk_bf16_f32 v56, v56, v57
    v_cvt_pk_bf16_f32 v57, v58, v59
    v_cvt_pk_bf16_f32 v58, v60, v61
    v_cvt_pk_bf16_f32 v59, v62, v63
    s_add_u32 s48, s85, 6144
    buffer_store_dwordx4 v[56:59], v0, s[32:35], s48 offen sc1
    v_accvgpr_read_b32 v64, a32
    v_accvgpr_read_b32 v65, a33
    v_accvgpr_read_b32 v66, a34
    v_accvgpr_read_b32 v67, a35
    v_accvgpr_read_b32 v68, a36
    v_accvgpr_read_b32 v69, a37
    v_accvgpr_read_b32 v70, a38
    v_accvgpr_read_b32 v71, a39
    v_cvt_pk_bf16_f32 v64, v64, v65
    v_cvt_pk_bf16_f32 v65, v66, v67
    v_cvt_pk_bf16_f32 v66, v68, v69
    v_cvt_pk_bf16_f32 v67, v70, v71
    s_add_u32 s48, s85, 7168
    buffer_store_dwordx4 v[64:67], v0, s[32:35], s48 offen sc1
    s_mul_i32 s86, s63, 12
    s_add_u32 s86, s86, 6
    s_mul_i32 s86, s86, 40960
    s_mul_i32 s87, s62, 1280
    s_add_u32 s86, s86, s87
    s_lshl_b32 s87, s64, 8
    s_add_u32 s86, s86, s87
    s_add_u32 s86, s86, 192
    s_waitcnt vmcnt(0) lgkmcnt(0)
    s_barrier
    s_cmp_lg_u32 s7, 0
    s_cbranch_scc1 L_pub13
    s_and_b32 s48, s2, 7
    s_lshl_b32 s48, s48, 5
    s_lshr_b32 s49, s2, 3
    s_add_u32 s48, s48, s49
    v_mov_b32 v2, s48
    v_mov_b32 v3, 3
    s_mov_b64 exec, 1
    global_store_byte v2, v3, s[22:23] sc1
    s_mov_b64 exec, -1
L_pub13:
    s_mov_b32 s12, s8
    s_mov_b32 s13, s9
    s_mov_b32 s14, 2949120
    s_mov_b32 s15, 0x20000
    s_cmp_lg_u32 s7, 0
    s_cbranch_scc1 L_xp2_3a_skip
    s_lshl_b32 s48, s62, 7
    s_add_u32 s48, s48, s60
    v_and_b32 v2, 3, v1
    v_lshlrev_b32 v2, 5, v2
    v_add_u32 v2, s48, v2
    s_mov_b32 s69, 0
L_xp2_3a_poll:
    global_load_ubyte v3, v2, s[22:23] sc1
    s_add_u32 s69, s69, 1
    s_waitcnt vmcnt(0)
    v_cmp_gt_u32 vcc, 3, v3
    s_cmp_ge_u32 s69, 131072
    s_cbranch_scc1 L_xp2_3a_skip
    s_nop 2
    s_cbranch_vccz L_xp2_3a_skip
    s_sleep 1
    s_branch L_xp2_3a_poll
L_xp2_3a_skip:
    s_barrier
    s_mov_b32 s48, 9216
    buffer_load_dwordx4 v[24:27], v0, s[32:35], s48 offen sc1
    s_mov_b32 s48, 10240
    buffer_load_dwordx4 v[28:31], v0, s[32:35], s48 offen sc1
    s_mov_b32 s48, 1483776
    buffer_load_dwordx4 v[36:39], v0, s[32:35], s48 offen sc1
    s_mov_b32 s48, 1484800
    buffer_load_dwordx4 v[40:43], v0, s[32:35], s48 offen sc1
    s_mov_b32 s48, 2958336
    buffer_load_dwordx4 v[48:51], v0, s[32:35], s48 offen sc1
    s_mov_b32 s48, 2959360
    buffer_load_dwordx4 v[52:55], v0, s[32:35], s48 offen sc1
    v_and_b32 v2, 15, v1
    v_mul_u32_u24 v2, 2560, v2
    v_lshrrev_b32 v3, 4, v1
    v_lshl_add_u32 v2, v3, 3, v2
    v_accvgpr_read_b32 v64, a8
    v_accvgpr_read_b32 v65, a9
    v_accvgpr_read_b32 v66, a10
    v_accvgpr_read_b32 v67, a11
    s_waitcnt vmcnt(5)
    v_lshlrev_b32 v22, 16, v24
    v_and_b32 v23, 0xffff0000, v24
    v_add_f32 v64, v64, v22
    v_add_f32 v65, v65, v23
    v_lshlrev_b32 v22, 16, v25
    v_and_b32 v23, 0xffff0000, v25
    v_add_f32 v66, v66, v22
    v_add_f32 v67, v67, v23
    s_waitcnt vmcnt(3)
    v_lshlrev_b32 v22, 16, v36
    v_and_b32 v23, 0xffff0000, v36
    v_add_f32 v64, v64, v22
    v_add_f32 v65, v65, v23
    v_lshlrev_b32 v22, 16, v37
    v_and_b32 v23, 0xffff0000, v37
    v_add_f32 v66, v66, v22
    v_add_f32 v67, v67, v23
    s_waitcnt vmcnt(1)
    v_lshlrev_b32 v22, 16, v48
    v_and_b32 v23, 0xffff0000, v48
    v_add_f32 v64, v64, v22
    v_add_f32 v65, v65, v23
    v_lshlrev_b32 v22, 16, v49
    v_and_b32 v23, 0xffff0000, v49
    v_add_f32 v66, v66, v22
    v_add_f32 v67, v67, v23
    v_cvt_pk_bf16_f32 v64, v64, v65
    v_cvt_pk_bf16_f32 v65, v66, v67
    s_add_u32 s48, s86, 0
    buffer_store_dwordx2 v[64:65], v2, s[12:15], s48 offen offset:0
    v_accvgpr_read_b32 v68, a12
    v_accvgpr_read_b32 v69, a13
    v_accvgpr_read_b32 v70, a14
    v_accvgpr_read_b32 v71, a15
    v_lshlrev_b32 v22, 16, v26
    v_and_b32 v23, 0xffff0000, v26
    v_add_f32 v68, v68, v22
    v_add_f32 v69, v69, v23
    v_lshlrev_b32 v22, 16, v27
    v_and_b32 v23, 0xffff0000, v27
    v_add_f32 v70, v70, v22
    v_add_f32 v71, v71, v23
    v_lshlrev_b32 v22, 16, v38
    v_and_b32 v23, 0xffff0000, v38
    v_add_f32 v68, v68, v22
    v_add_f32 v69, v69, v23
    v_lshlrev_b32 v22, 16, v39
    v_and_b32 v23, 0xffff0000, v39
    v_add_f32 v70, v70, v22
    v_add_f32 v71, v71, v23
    v_lshlrev_b32 v22, 16, v50
    v_and_b32 v23, 0xffff0000, v50
    v_add_f32 v68, v68, v22
    v_add_f32 v69, v69, v23
    v_lshlrev_b32 v22, 16, v51
    v_and_b32 v23, 0xffff0000, v51
    v_add_f32 v70, v70, v22
    v_add_f32 v71, v71, v23
    v_cvt_pk_bf16_f32 v68, v68, v69
    v_cvt_pk_bf16_f32 v69, v70, v71
    s_add_u32 s48, s86, 0
    buffer_store_dwordx2 v[68:69], v2, s[12:15], s48 offen offset:32
    v_accvgpr_read_b32 v72, a40
    v_accvgpr_read_b32 v73, a41
    v_accvgpr_read_b32 v74, a42
    v_accvgpr_read_b32 v75, a43
    v_lshlrev_b32 v22, 16, v28
    v_and_b32 v23, 0xffff0000, v28
    v_add_f32 v72, v72, v22
    v_add_f32 v73, v73, v23
    v_lshlrev_b32 v22, 16, v29
    v_and_b32 v23, 0xffff0000, v29
    v_add_f32 v74, v74, v22
    v_add_f32 v75, v75, v23
    v_lshlrev_b32 v22, 16, v40
    v_and_b32 v23, 0xffff0000, v40
    v_add_f32 v72, v72, v22
    v_add_f32 v73, v73, v23
    v_lshlrev_b32 v22, 16, v41
    v_and_b32 v23, 0xffff0000, v41
    v_add_f32 v74, v74, v22
    v_add_f32 v75, v75, v23
    s_waitcnt vmcnt(2)
    v_lshlrev_b32 v22, 16, v52
    v_and_b32 v23, 0xffff0000, v52
    v_add_f32 v72, v72, v22
    v_add_f32 v73, v73, v23
    v_lshlrev_b32 v22, 16, v53
    v_and_b32 v23, 0xffff0000, v53
    v_add_f32 v74, v74, v22
    v_add_f32 v75, v75, v23
    v_cvt_pk_bf16_f32 v72, v72, v73
    v_cvt_pk_bf16_f32 v73, v74, v75
    s_add_u32 s48, s86, 40960
    buffer_store_dwordx2 v[72:73], v2, s[12:15], s48 offen offset:0
    v_accvgpr_read_b32 v76, a44
    v_accvgpr_read_b32 v77, a45
    v_accvgpr_read_b32 v78, a46
    v_accvgpr_read_b32 v79, a47
    v_lshlrev_b32 v22, 16, v30
    v_and_b32 v23, 0xffff0000, v30
    v_add_f32 v76, v76, v22
    v_add_f32 v77, v77, v23
    v_lshlrev_b32 v22, 16, v31
    v_and_b32 v23, 0xffff0000, v31
    v_add_f32 v78, v78, v22
    v_add_f32 v79, v79, v23
    v_lshlrev_b32 v22, 16, v42
    v_and_b32 v23, 0xffff0000, v42
    v_add_f32 v76, v76, v22
    v_add_f32 v77, v77, v23
    v_lshlrev_b32 v22, 16, v43
    v_and_b32 v23, 0xffff0000, v43
    v_add_f32 v78, v78, v22
    v_add_f32 v79, v79, v23
    v_lshlrev_b32 v22, 16, v54
    v_and_b32 v23, 0xffff0000, v54
    v_add_f32 v76, v76, v22
    v_add_f32 v77, v77, v23
    v_lshlrev_b32 v22, 16, v55
    v_and_b32 v23, 0xffff0000, v55
    v_add_f32 v78, v78, v22
    v_add_f32 v79, v79, v23
    v_cvt_pk_bf16_f32 v76, v76, v77
    v_cvt_pk_bf16_f32 v77, v78, v79
    s_add_u32 s48, s86, 40960
    buffer_store_dwordx2 v[76:77], v2, s[12:15], s48 offen offset:32
    s_branch L_end2
L_x2_3a:
L_xw3a:
    s_lshl_b32 s84, s62, 2
    s_mul_i32 s84, s84, 30
    s_add_u32 s84, s84, s60
    s_lshl_b32 s84, s84, 2
    s_add_u32 s84, s84, s3
    s_mul_i32 s84, s84, 12288
    s_add_u32 s84, s84, 18874368
    s_add_u32 s32, s4, s84
    s_addc_u32 s33, s5, 0
    s_mov_b32 s34, 4435968
    s_mov_b32 s35, 0x20000
    s_mul_i32 s85, s61, 1474560
    s_load_dwordx2 s[8:9], s[0:1], 80
    s_nop 7
    s_cmp_lg_u32 s61, 0
    s_cbranch_scc1 L_x3_0a
    v_accvgpr_read_b32 v24, a16
    v_accvgpr_read_b32 v25, a17
    v_accvgpr_read_b32 v26, a18
    v_accvgpr_read_b32 v27, a19
    v_accvgpr_read_b32 v28, a20
    v_accvgpr_read_b32 v29, a21
    v_accvgpr_read_b32 v30, a22
    v_accvgpr_read_b32 v31, a23
    v_cvt_pk_bf16_f32 v24, v24, v25
    v_cvt_pk_bf16_f32 v25, v26, v27
    v_cvt_pk_bf16_f32 v26, v28, v29
    v_cvt_pk_bf16_f32 v27, v30, v31
    s_add_u32 s48, s85, 3072
    buffer_store_dwordx4 v[24:27], v0, s[32:35], s48 offen sc1
    v_accvgpr_read_b32 v32, a48
    v_accvgpr_read_b32 v33, a49
    v_accvgpr_read_b32 v34, a50
    v_accvgpr_read_b32 v35, a51
    v_accvgpr_read_b32 v36, a52
    v_accvgpr_read_b32 v37, a53
    v_accvgpr_read_b32 v38, a54
    v_accvgpr_read_b32 v39, a55
    v_cvt_pk_bf16_f32 v32, v32, v33
    v_cvt_pk_bf16_f32 v33, v34, v35
    v_cvt_pk_bf16_f32 v34, v36, v37
    v_cvt_pk_bf16_f32 v35, v38, v39
    s_add_u32 s48, s85, 4096
    buffer_store_dwordx4 v[32:35], v0, s[32:35], s48 offen sc1
    v_accvgpr_read_b32 v40, a24
    v_accvgpr_read_b32 v41, a25
    v_accvgpr_read_b32 v42, a26
    v_accvgpr_read_b32 v43, a27
    v_accvgpr_read_b32 v44, a28
    v_accvgpr_read_b32 v45, a29
    v_accvgpr_read_b32 v46, a30
    v_accvgpr_read_b32 v47, a31
    v_cvt_pk_bf16_f32 v40, v40, v41
    v_cvt_pk_bf16_f32 v41, v42, v43
    v_cvt_pk_bf16_f32 v42, v44, v45
    v_cvt_pk_bf16_f32 v43, v46, v47
    s_add_u32 s48, s85, 6144
    buffer_store_dwordx4 v[40:43], v0, s[32:35], s48 offen sc1
    v_accvgpr_read_b32 v48, a56
    v_accvgpr_read_b32 v49, a57
    v_accvgpr_read_b32 v50, a58
    v_accvgpr_read_b32 v51, a59
    v_accvgpr_read_b32 v52, a60
    v_accvgpr_read_b32 v53, a61
    v_accvgpr_read_b32 v54, a62
    v_accvgpr_read_b32 v55, a63
    v_cvt_pk_bf16_f32 v48, v48, v49
    v_cvt_pk_bf16_f32 v49, v50, v51
    v_cvt_pk_bf16_f32 v50, v52, v53
    v_cvt_pk_bf16_f32 v51, v54, v55
    s_add_u32 s48, s85, 7168
    buffer_store_dwordx4 v[48:51], v0, s[32:35], s48 offen sc1
    v_accvgpr_read_b32 v56, a0
    v_accvgpr_read_b32 v57, a1
    v_accvgpr_read_b32 v58, a2
    v_accvgpr_read_b32 v59, a3
    v_accvgpr_read_b32 v60, a4
    v_accvgpr_read_b32 v61, a5
    v_accvgpr_read_b32 v62, a6
    v_accvgpr_read_b32 v63, a7
    v_cvt_pk_bf16_f32 v56, v56, v57
    v_cvt_pk_bf16_f32 v57, v58, v59
    v_cvt_pk_bf16_f32 v58, v60, v61
    v_cvt_pk_bf16_f32 v59, v62, v63
    s_add_u32 s48, s85, 9216
    buffer_store_dwordx4 v[56:59], v0, s[32:35], s48 offen sc1
    v_accvgpr_read_b32 v64, a32
    v_accvgpr_read_b32 v65, a33
    v_accvgpr_read_b32 v66, a34
    v_accvgpr_read_b32 v67, a35
    v_accvgpr_read_b32 v68, a36
    v_accvgpr_read_b32 v69, a37
    v_accvgpr_read_b32 v70, a38
    v_accvgpr_read_b32 v71, a39
    v_cvt_pk_bf16_f32 v64, v64, v65
    v_cvt_pk_bf16_f32 v65, v66, v67
    v_cvt_pk_bf16_f32 v66, v68, v69
    v_cvt_pk_bf16_f32 v67, v70, v71
    s_add_u32 s48, s85, 10240
    buffer_store_dwordx4 v[64:67], v0, s[32:35], s48 offen sc1
    s_mul_i32 s86, s63, 12
    s_add_u32 s86, s86, 9
    s_mul_i32 s86, s86, 40960
    s_mul_i32 s87, s62, 1280
    s_add_u32 s86, s86, s87
    s_lshl_b32 s87, s64, 8
    s_add_u32 s86, s86, s87
    s_add_u32 s86, s86, 0
    s_waitcnt vmcnt(0) lgkmcnt(0)
    s_barrier
    s_cmp_lg_u32 s7, 0
    s_cbranch_scc1 L_pub14
    s_and_b32 s48, s2, 7
    s_lshl_b32 s48, s48, 5
    s_lshr_b32 s49, s2, 3
    s_add_u32 s48, s48, s49
    v_mov_b32 v2, s48
    v_mov_b32 v3, 3
    s_mov_b64 exec, 1
    global_store_byte v2, v3, s[22:23] sc1
    s_mov_b64 exec, -1
L_pub14:
    s_mov_b32 s12, s8
    s_mov_b32 s13, s9
    s_mov_b32 s14, 2949120
    s_mov_b32 s15, 0x20000
    s_cmp_lg_u32 s7, 0
    s_cbranch_scc1 L_xp3_0a_skip
    s_lshl_b32 s48, s62, 7
    s_add_u32 s48, s48, s60
    v_and_b32 v2, 3, v1
    v_lshlrev_b32 v2, 5, v2
    v_add_u32 v2, s48, v2
    s_mov_b32 s69, 0
L_xp3_0a_poll:
    global_load_ubyte v3, v2, s[22:23] sc1
    s_add_u32 s69, s69, 1
    s_waitcnt vmcnt(0)
    v_cmp_gt_u32 vcc, 3, v3
    s_cmp_ge_u32 s69, 131072
    s_cbranch_scc1 L_xp3_0a_skip
    s_nop 2
    s_cbranch_vccz L_xp3_0a_skip
    s_sleep 1
    s_branch L_xp3_0a_poll
L_xp3_0a_skip:
    s_barrier
    s_mov_b32 s48, 1474560
    buffer_load_dwordx4 v[24:27], v0, s[32:35], s48 offen sc1
    s_mov_b32 s48, 1475584
    buffer_load_dwordx4 v[28:31], v0, s[32:35], s48 offen sc1
    s_mov_b32 s48, 2949120
    buffer_load_dwordx4 v[36:39], v0, s[32:35], s48 offen sc1
    s_mov_b32 s48, 2950144
    buffer_load_dwordx4 v[40:43], v0, s[32:35], s48 offen sc1
    s_mov_b32 s48, 4423680
    buffer_load_dwordx4 v[48:51], v0, s[32:35], s48 offen sc1
    s_mov_b32 s48, 4424704
    buffer_load_dwordx4 v[52:55], v0, s[32:35], s48 offen sc1
    v_and_b32 v2, 15, v1
    v_mul_u32_u24 v2, 2560, v2
    v_lshrrev_b32 v3, 4, v1
    v_lshl_add_u32 v2, v3, 3, v2
    v_accvgpr_read_b32 v64, a8
    v_accvgpr_read_b32 v65, a9
    v_accvgpr_read_b32 v66, a10
    v_accvgpr_read_b32 v67, a11
    s_waitcnt vmcnt(5)
    v_lshlrev_b32 v22, 16, v24
    v_and_b32 v23, 0xffff0000, v24
    v_add_f32 v64, v64, v22
    v_add_f32 v65, v65, v23
    v_lshlrev_b32 v22, 16, v25
    v_and_b32 v23, 0xffff0000, v25
    v_add_f32 v66, v66, v22
    v_add_f32 v67, v67, v23
    s_waitcnt vmcnt(3)
    v_lshlrev_b32 v22, 16, v36
    v_and_b32 v23, 0xffff0000, v36
    v_add_f32 v64, v64, v22
    v_add_f32 v65, v65, v23
    v_lshlrev_b32 v22, 16, v37
    v_and_b32 v23, 0xffff0000, v37
    v_add_f32 v66, v66, v22
    v_add_f32 v67, v67, v23
    s_waitcnt vmcnt(1)
    v_lshlrev_b32 v22, 16, v48
    v_and_b32 v23, 0xffff0000, v48
    v_add_f32 v64, v64, v22
    v_add_f32 v65, v65, v23
    v_lshlrev_b32 v22, 16, v49
    v_and_b32 v23, 0xffff0000, v49
    v_add_f32 v66, v66, v22
    v_add_f32 v67, v67, v23
    v_cvt_pk_bf16_f32 v64, v64, v65
    v_cvt_pk_bf16_f32 v65, v66, v67
    s_add_u32 s48, s86, 0
    buffer_store_dwordx2 v[64:65], v2, s[12:15], s48 offen offset:0
    v_accvgpr_read_b32 v68, a12
    v_accvgpr_read_b32 v69, a13
    v_accvgpr_read_b32 v70, a14
    v_accvgpr_read_b32 v71, a15
    v_lshlrev_b32 v22, 16, v26
    v_and_b32 v23, 0xffff0000, v26
    v_add_f32 v68, v68, v22
    v_add_f32 v69, v69, v23
    v_lshlrev_b32 v22, 16, v27
    v_and_b32 v23, 0xffff0000, v27
    v_add_f32 v70, v70, v22
    v_add_f32 v71, v71, v23
    v_lshlrev_b32 v22, 16, v38
    v_and_b32 v23, 0xffff0000, v38
    v_add_f32 v68, v68, v22
    v_add_f32 v69, v69, v23
    v_lshlrev_b32 v22, 16, v39
    v_and_b32 v23, 0xffff0000, v39
    v_add_f32 v70, v70, v22
    v_add_f32 v71, v71, v23
    v_lshlrev_b32 v22, 16, v50
    v_and_b32 v23, 0xffff0000, v50
    v_add_f32 v68, v68, v22
    v_add_f32 v69, v69, v23
    v_lshlrev_b32 v22, 16, v51
    v_and_b32 v23, 0xffff0000, v51
    v_add_f32 v70, v70, v22
    v_add_f32 v71, v71, v23
    v_cvt_pk_bf16_f32 v68, v68, v69
    v_cvt_pk_bf16_f32 v69, v70, v71
    s_add_u32 s48, s86, 0
    buffer_store_dwordx2 v[68:69], v2, s[12:15], s48 offen offset:32
    v_accvgpr_read_b32 v72, a40
    v_accvgpr_read_b32 v73, a41
    v_accvgpr_read_b32 v74, a42
    v_accvgpr_read_b32 v75, a43
    v_lshlrev_b32 v22, 16, v28
    v_and_b32 v23, 0xffff0000, v28
    v_add_f32 v72, v72, v22
    v_add_f32 v73, v73, v23
    v_lshlrev_b32 v22, 16, v29
    v_and_b32 v23, 0xffff0000, v29
    v_add_f32 v74, v74, v22
    v_add_f32 v75, v75, v23
    v_lshlrev_b32 v22, 16, v40
    v_and_b32 v23, 0xffff0000, v40
    v_add_f32 v72, v72, v22
    v_add_f32 v73, v73, v23
    v_lshlrev_b32 v22, 16, v41
    v_and_b32 v23, 0xffff0000, v41
    v_add_f32 v74, v74, v22
    v_add_f32 v75, v75, v23
    s_waitcnt vmcnt(2)
    v_lshlrev_b32 v22, 16, v52
    v_and_b32 v23, 0xffff0000, v52
    v_add_f32 v72, v72, v22
    v_add_f32 v73, v73, v23
    v_lshlrev_b32 v22, 16, v53
    v_and_b32 v23, 0xffff0000, v53
    v_add_f32 v74, v74, v22
    v_add_f32 v75, v75, v23
    v_cvt_pk_bf16_f32 v72, v72, v73
    v_cvt_pk_bf16_f32 v73, v74, v75
    s_add_u32 s48, s86, 40960
    buffer_store_dwordx2 v[72:73], v2, s[12:15], s48 offen offset:0
    v_accvgpr_read_b32 v76, a44
    v_accvgpr_read_b32 v77, a45
    v_accvgpr_read_b32 v78, a46
    v_accvgpr_read_b32 v79, a47
    v_lshlrev_b32 v22, 16, v30
    v_and_b32 v23, 0xffff0000, v30
    v_add_f32 v76, v76, v22
    v_add_f32 v77, v77, v23
    v_lshlrev_b32 v22, 16, v31
    v_and_b32 v23, 0xffff0000, v31
    v_add_f32 v78, v78, v22
    v_add_f32 v79, v79, v23
    v_lshlrev_b32 v22, 16, v42
    v_and_b32 v23, 0xffff0000, v42
    v_add_f32 v76, v76, v22
    v_add_f32 v77, v77, v23
    v_lshlrev_b32 v22, 16, v43
    v_and_b32 v23, 0xffff0000, v43
    v_add_f32 v78, v78, v22
    v_add_f32 v79, v79, v23
    v_lshlrev_b32 v22, 16, v54
    v_and_b32 v23, 0xffff0000, v54
    v_add_f32 v76, v76, v22
    v_add_f32 v77, v77, v23
    v_lshlrev_b32 v22, 16, v55
    v_and_b32 v23, 0xffff0000, v55
    v_add_f32 v78, v78, v22
    v_add_f32 v79, v79, v23
    v_cvt_pk_bf16_f32 v76, v76, v77
    v_cvt_pk_bf16_f32 v77, v78, v79
    s_add_u32 s48, s86, 40960
    buffer_store_dwordx2 v[76:77], v2, s[12:15], s48 offen offset:32
    s_branch L_end2
L_x3_0a:
    s_cmp_lg_u32 s61, 1
    s_cbranch_scc1 L_x3_1a
    v_accvgpr_read_b32 v24, a8
    v_accvgpr_read_b32 v25, a9
    v_accvgpr_read_b32 v26, a10
    v_accvgpr_read_b32 v27, a11
    v_accvgpr_read_b32 v28, a12
    v_accvgpr_read_b32 v29, a13
    v_accvgpr_read_b32 v30, a14
    v_accvgpr_read_b32 v31, a15
    v_cvt_pk_bf16_f32 v24, v24, v25
    v_cvt_pk_bf16_f32 v25, v26, v27
    v_cvt_pk_bf16_f32 v26, v28, v29
    v_cvt_pk_bf16_f32 v27, v30, v31
    s_add_u32 s48, s85, 0
    buffer_store_dwordx4 v[24:27], v0, s[32:35], s48 offen sc1
    v_accvgpr_read_b32 v32, a40
    v_accvgpr_read_b32 v33, a41
    v_accvgpr_read_b32 v34, a42
    v_accvgpr_read_b32 v35, a43
    v_accvgpr_read_b32 v36, a44
    v_accvgpr_read_b32 v37, a45
    v_accvgpr_read_b32 v38, a46
    v_accvgpr_read_b32 v39, a47
    v_cvt_pk_bf16_f32 v32, v32, v33
    v_cvt_pk_bf16_f32 v33, v34, v35
    v_cvt_pk_bf16_f32 v34, v36, v37
    v_cvt_pk_bf16_f32 v35, v38, v39
    s_add_u32 s48, s85, 1024
    buffer_store_dwordx4 v[32:35], v0, s[32:35], s48 offen sc1
    v_accvgpr_read_b32 v40, a24
    v_accvgpr_read_b32 v41, a25
    v_accvgpr_read_b32 v42, a26
    v_accvgpr_read_b32 v43, a27
    v_accvgpr_read_b32 v44, a28
    v_accvgpr_read_b32 v45, a29
    v_accvgpr_read_b32 v46, a30
    v_accvgpr_read_b32 v47, a31
    v_cvt_pk_bf16_f32 v40, v40, v41
    v_cvt_pk_bf16_f32 v41, v42, v43
    v_cvt_pk_bf16_f32 v42, v44, v45
    v_cvt_pk_bf16_f32 v43, v46, v47
    s_add_u32 s48, s85, 6144
    buffer_store_dwordx4 v[40:43], v0, s[32:35], s48 offen sc1
    v_accvgpr_read_b32 v48, a56
    v_accvgpr_read_b32 v49, a57
    v_accvgpr_read_b32 v50, a58
    v_accvgpr_read_b32 v51, a59
    v_accvgpr_read_b32 v52, a60
    v_accvgpr_read_b32 v53, a61
    v_accvgpr_read_b32 v54, a62
    v_accvgpr_read_b32 v55, a63
    v_cvt_pk_bf16_f32 v48, v48, v49
    v_cvt_pk_bf16_f32 v49, v50, v51
    v_cvt_pk_bf16_f32 v50, v52, v53
    v_cvt_pk_bf16_f32 v51, v54, v55
    s_add_u32 s48, s85, 7168
    buffer_store_dwordx4 v[48:51], v0, s[32:35], s48 offen sc1
    v_accvgpr_read_b32 v56, a0
    v_accvgpr_read_b32 v57, a1
    v_accvgpr_read_b32 v58, a2
    v_accvgpr_read_b32 v59, a3
    v_accvgpr_read_b32 v60, a4
    v_accvgpr_read_b32 v61, a5
    v_accvgpr_read_b32 v62, a6
    v_accvgpr_read_b32 v63, a7
    v_cvt_pk_bf16_f32 v56, v56, v57
    v_cvt_pk_bf16_f32 v57, v58, v59
    v_cvt_pk_bf16_f32 v58, v60, v61
    v_cvt_pk_bf16_f32 v59, v62, v63
    s_add_u32 s48, s85, 9216
    buffer_store_dwordx4 v[56:59], v0, s[32:35], s48 offen sc1
    v_accvgpr_read_b32 v64, a32
    v_accvgpr_read_b32 v65, a33
    v_accvgpr_read_b32 v66, a34
    v_accvgpr_read_b32 v67, a35
    v_accvgpr_read_b32 v68, a36
    v_accvgpr_read_b32 v69, a37
    v_accvgpr_read_b32 v70, a38
    v_accvgpr_read_b32 v71, a39
    v_cvt_pk_bf16_f32 v64, v64, v65
    v_cvt_pk_bf16_f32 v65, v66, v67
    v_cvt_pk_bf16_f32 v66, v68, v69
    v_cvt_pk_bf16_f32 v67, v70, v71
    s_add_u32 s48, s85, 10240
    buffer_store_dwordx4 v[64:67], v0, s[32:35], s48 offen sc1
    s_mul_i32 s86, s63, 12
    s_add_u32 s86, s86, 9
    s_mul_i32 s86, s86, 40960
    s_mul_i32 s87, s62, 1280
    s_add_u32 s86, s86, s87
    s_lshl_b32 s87, s64, 8
    s_add_u32 s86, s86, s87
    s_add_u32 s86, s86, 64
    s_waitcnt vmcnt(0) lgkmcnt(0)
    s_barrier
    s_cmp_lg_u32 s7, 0
    s_cbranch_scc1 L_pub15
    s_and_b32 s48, s2, 7
    s_lshl_b32 s48, s48, 5
    s_lshr_b32 s49, s2, 3
    s_add_u32 s48, s48, s49
    v_mov_b32 v2, s48
    v_mov_b32 v3, 3
    s_mov_b64 exec, 1
    global_store_byte v2, v3, s[22:23] sc1
    s_mov_b64 exec, -1
L_pub15:
    s_mov_b32 s12, s8
    s_mov_b32 s13, s9
    s_mov_b32 s14, 2949120
    s_mov_b32 s15, 0x20000
    s_cmp_lg_u32 s7, 0
    s_cbranch_scc1 L_xp3_1a_skip
    s_lshl_b32 s48, s62, 7
    s_add_u32 s48, s48, s60
    v_and_b32 v2, 3, v1
    v_lshlrev_b32 v2, 5, v2
    v_add_u32 v2, s48, v2
    s_mov_b32 s69, 0
L_xp3_1a_poll:
    global_load_ubyte v3, v2, s[22:23] sc1
    s_add_u32 s69, s69, 1
    s_waitcnt vmcnt(0)
    v_cmp_gt_u32 vcc, 3, v3
    s_cmp_ge_u32 s69, 131072
    s_cbranch_scc1 L_xp3_1a_skip
    s_nop 2
    s_cbranch_vccz L_xp3_1a_skip
    s_sleep 1
    s_branch L_xp3_1a_poll
L_xp3_1a_skip:
    s_barrier
    s_mov_b32 s48, 3072
    buffer_load_dwordx4 v[24:27], v0, s[32:35], s48 offen sc1
    s_mov_b32 s48, 4096
    buffer_load_dwordx4 v[28:31], v0, s[32:35], s48 offen sc1
    s_mov_b32 s48, 2952192
    buffer_load_dwordx4 v[36:39], v0, s[32:35], s48 offen sc1
    s_mov_b32 s48, 2953216
    buffer_load_dwordx4 v[40:43], v0, s[32:35], s48 offen sc1
    s_mov_b32 s48, 4426752
    buffer_load_dwordx4 v[48:51], v0, s[32:35], s48 offen sc1
    s_mov_b32 s48, 4427776
    buffer_load_dwordx4 v[52:55], v0, s[32:35], s48 offen sc1
    v_and_b32 v2, 15, v1
    v_mul_u32_u24 v2, 2560, v2
    v_lshrrev_b32 v3, 4, v1
    v_lshl_add_u32 v2, v3, 3, v2
    v_accvgpr_read_b32 v64, a16
    v_accvgpr_read_b32 v65, a17
    v_accvgpr_read_b32 v66, a18
    v_accvgpr_read_b32 v67, a19
    s_waitcnt vmcnt(5)
    v_lshlrev_b32 v22, 16, v24
    v_and_b32 v23, 0xffff0000, v24
    v_add_f32 v64, v64, v22
    v_add_f32 v65, v65, v23
    v_lshlrev_b32 v22, 16, v25
    v_and_b32 v23, 0xffff0000, v25
    v_add_f32 v66, v66, v22
    v_add_f32 v67, v67, v23
    s_waitcnt vmcnt(3)
    v_lshlrev_b32 v22, 16, v36
    v_and_b32 v23, 0xffff0000, v36
    v_add_f32 v64, v64, v22
    v_add_f32 v65, v65, v23
    v_lshlrev_b32 v22, 16, v37
    v_and_b32 v23, 0xffff0000, v37
    v_add_f32 v66, v66, v22
    v_add_f32 v67, v67, v23
    s_waitcnt vmcnt(1)
    v_lshlrev_b32 v22, 16, v48
    v_and_b32 v23, 0xffff0000, v48
    v_add_f32 v64, v64, v22
    v_add_f32 v65, v65, v23
    v_lshlrev_b32 v22, 16, v49
    v_and_b32 v23, 0xffff0000, v49
    v_add_f32 v66, v66, v22
    v_add_f32 v67, v67, v23
    v_cvt_pk_bf16_f32 v64, v64, v65
    v_cvt_pk_bf16_f32 v65, v66, v67
    s_add_u32 s48, s86, 0
    buffer_store_dwordx2 v[64:65], v2, s[12:15], s48 offen offset:0
    v_accvgpr_read_b32 v68, a20
    v_accvgpr_read_b32 v69, a21
    v_accvgpr_read_b32 v70, a22
    v_accvgpr_read_b32 v71, a23
    v_lshlrev_b32 v22, 16, v26
    v_and_b32 v23, 0xffff0000, v26
    v_add_f32 v68, v68, v22
    v_add_f32 v69, v69, v23
    v_lshlrev_b32 v22, 16, v27
    v_and_b32 v23, 0xffff0000, v27
    v_add_f32 v70, v70, v22
    v_add_f32 v71, v71, v23
    v_lshlrev_b32 v22, 16, v38
    v_and_b32 v23, 0xffff0000, v38
    v_add_f32 v68, v68, v22
    v_add_f32 v69, v69, v23
    v_lshlrev_b32 v22, 16, v39
    v_and_b32 v23, 0xffff0000, v39
    v_add_f32 v70, v70, v22
    v_add_f32 v71, v71, v23
    v_lshlrev_b32 v22, 16, v50
    v_and_b32 v23, 0xffff0000, v50
    v_add_f32 v68, v68, v22
    v_add_f32 v69, v69, v23
    v_lshlrev_b32 v22, 16, v51
    v_and_b32 v23, 0xffff0000, v51
    v_add_f32 v70, v70, v22
    v_add_f32 v71, v71, v23
    v_cvt_pk_bf16_f32 v68, v68, v69
    v_cvt_pk_bf16_f32 v69, v70, v71
    s_add_u32 s48, s86, 0
    buffer_store_dwordx2 v[68:69], v2, s[12:15], s48 offen offset:32
    v_accvgpr_read_b32 v72, a48
    v_accvgpr_read_b32 v73, a49
    v_accvgpr_read_b32 v74, a50
    v_accvgpr_read_b32 v75, a51
    v_lshlrev_b32 v22, 16, v28
    v_and_b32 v23, 0xffff0000, v28
    v_add_f32 v72, v72, v22
    v_add_f32 v73, v73, v23
    v_lshlrev_b32 v22, 16, v29
    v_and_b32 v23, 0xffff0000, v29
    v_add_f32 v74, v74, v22
    v_add_f32 v75, v75, v23
    v_lshlrev_b32 v22, 16, v40
    v_and_b32 v23, 0xffff0000, v40
    v_add_f32 v72, v72, v22
    v_add_f32 v73, v73, v23
    v_lshlrev_b32 v22, 16, v41
    v_and_b32 v23, 0xffff0000, v41
    v_add_f32 v74, v74, v22
    v_add_f32 v75, v75, v23
    s_waitcnt vmcnt(2)
    v_lshlrev_b32 v22, 16, v52
    v_and_b32 v23, 0xffff0000, v52
    v_add_f32 v72, v72, v22
    v_add_f32 v73, v73, v23
    v_lshlrev_b32 v22, 16, v53
    v_and_b32 v23, 0xffff0000, v53
    v_add_f32 v74, v74, v22
    v_add_f32 v75, v75, v23
    v_cvt_pk_bf16_f32 v72, v72, v73
    v_cvt_pk_bf16_f32 v73, v74, v75
    s_add_u32 s48, s86, 40960
    buffer_store_dwordx2 v[72:73], v2, s[12:15], s48 offen offset:0
    v_accvgpr_read_b32 v76, a52
    v_accvgpr_read_b32 v77, a53
    v_accvgpr_read_b32 v78, a54
    v_accvgpr_read_b32 v79, a55
    v_lshlrev_b32 v22, 16, v30
    v_and_b32 v23, 0xffff0000, v30
    v_add_f32 v76, v76, v22
    v_add_f32 v77, v77, v23
    v_lshlrev_b32 v22, 16, v31
    v_and_b32 v23, 0xffff0000, v31
    v_add_f32 v78, v78, v22
    v_add_f32 v79, v79, v23
    v_lshlrev_b32 v22, 16, v42
    v_and_b32 v23, 0xffff0000, v42
    v_add_f32 v76, v76, v22
    v_add_f32 v77, v77, v23
    v_lshlrev_b32 v22, 16, v43
    v_and_b32 v23, 0xffff0000, v43
    v_add_f32 v78, v78, v22
    v_add_f32 v79, v79, v23
    v_lshlrev_b32 v22, 16, v54
    v_and_b32 v23, 0xffff0000, v54
    v_add_f32 v76, v76, v22
    v_add_f32 v77, v77, v23
    v_lshlrev_b32 v22, 16, v55
    v_and_b32 v23, 0xffff0000, v55
    v_add_f32 v78, v78, v22
    v_add_f32 v79, v79, v23
    v_cvt_pk_bf16_f32 v76, v76, v77
    v_cvt_pk_bf16_f32 v77, v78, v79
    s_add_u32 s48, s86, 40960
    buffer_store_dwordx2 v[76:77], v2, s[12:15], s48 offen offset:32
    s_branch L_end2
L_x3_1a:
    s_cmp_lg_u32 s61, 2
    s_cbranch_scc1 L_x3_2a
    v_accvgpr_read_b32 v24, a8
    v_accvgpr_read_b32 v25, a9
    v_accvgpr_read_b32 v26, a10
    v_accvgpr_read_b32 v27, a11
    v_accvgpr_read_b32 v28, a12
    v_accvgpr_read_b32 v29, a13
    v_accvgpr_read_b32 v30, a14
    v_accvgpr_read_b32 v31, a15
    v_cvt_pk_bf16_f32 v24, v24, v25
    v_cvt_pk_bf16_f32 v25, v26, v27
    v_cvt_pk_bf16_f32 v26, v28, v29
    v_cvt_pk_bf16_f32 v27, v30, v31
    s_add_u32 s48, s85, 0
    buffer_store_dwordx4 v[24:27], v0, s[32:35], s48 offen sc1
    v_accvgpr_read_b32 v32, a40
    v_accvgpr_read_b32 v33, a41
    v_accvgpr_read_b32 v34, a42
    v_accvgpr_read_b32 v35, a43
    v_accvgpr_read_b32 v36, a44
    v_accvgpr_read_b32 v37, a45
    v_accvgpr_read_b32 v38, a46
    v_accvgpr_read_b32 v39, a47
    v_cvt_pk_bf16_f32 v32, v32, v33
    v_cvt_pk_bf16_f32 v33, v34, v35
    v_cvt_pk_bf16_f32 v34, v36, v37
    v_cvt_pk_bf16_f32 v35, v38, v39
    s_add_u32 s48, s85, 1024
    buffer_store_dwordx4 v[32:35], v0, s[32:35], s48 offen sc1
    v_accvgpr_read_b32 v40, a16
    v_accvgpr_read_b32 v41, a17
    v_accvgpr_read_b32 v42, a18
    v_accvgpr_read_b32 v43, a19
    v_accvgpr_read_b32 v44, a20
    v_accvgpr_read_b32 v45, a21
    v_accvgpr_read_b32 v46, a22
    v_accvgpr_read_b32 v47, a23
    v_cvt_pk_bf16_f32 v40, v40, v41
    v_cvt_pk_bf16_f32 v41, v42, v43
    v_cvt_pk_bf16_f32 v42, v44, v45
    v_cvt_pk_bf16_f32 v43, v46, v47
    s_add_u32 s48, s85, 3072
    buffer_store_dwordx4 v[40:43], v0, s[32:35], s48 offen sc1
    v_accvgpr_read_b32 v48, a48
    v_accvgpr_read_b32 v49, a49
    v_accvgpr_read_b32 v50, a50
    v_accvgpr_read_b32 v51, a51
    v_accvgpr_read_b32 v52, a52
    v_accvgpr_read_b32 v53, a53
    v_accvgpr_read_b32 v54, a54
    v_accvgpr_read_b32 v55, a55
    v_cvt_pk_bf16_f32 v48, v48, v49
    v_cvt_pk_bf16_f32 v49, v50, v51
    v_cvt_pk_bf16_f32 v50, v52, v53
    v_cvt_pk_bf16_f32 v51, v54, v55
    s_add_u32 s48, s85, 4096
    buffer_store_dwordx4 v[48:51], v0, s[32:35], s48 offen sc1
    v_accvgpr_read_b32 v56, a0
    v_accvgpr_read_b32 v57, a1
    v_accvgpr_read_b32 v58, a2
    v_accvgpr_read_b32 v59, a3
    v_accvgpr_read_b32 v60, a4
    v_accvgpr_read_b32 v61, a5
    v_accvgpr_read_b32 v62, a6
    v_accvgpr_read_b32 v63, a7
    v_cvt_pk_bf16_f32 v56, v56, v57
    v_cvt_pk_bf16_f32 v57, v58, v59
    v_cvt_pk_bf16_f32 v58, v60, v61
    v_cvt_pk_bf16_f32 v59, v62, v63
    s_add_u32 s48, s85, 9216
    buffer_store_dwordx4 v[56:59], v0, s[32:35], s48 offen sc1
    v_accvgpr_read_b32 v64, a32
    v_accvgpr_read_b32 v65, a33
    v_accvgpr_read_b32 v66, a34
    v_accvgpr_read_b32 v67, a35
    v_accvgpr_read_b32 v68, a36
    v_accvgpr_read_b32 v69, a37
    v_accvgpr_read_b32 v70, a38
    v_accvgpr_read_b32 v71, a39
    v_cvt_pk_bf16_f32 v64, v64, v65
    v_cvt_pk_bf16_f32 v65, v66, v67
    v_cvt_pk_bf16_f32 v66, v68, v69
    v_cvt_pk_bf16_f32 v67, v70, v71
    s_add_u32 s48, s85, 10240
    buffer_store_dwordx4 v[64:67], v0, s[32:35], s48 offen sc1
    s_mul_i32 s86, s63, 12
    s_add_u32 s86, s86, 9
    s_mul_i32 s86, s86, 40960
    s_mul_i32 s87, s62, 1280
    s_add_u32 s86, s86, s87
    s_lshl_b32 s87, s64, 8
    s_add_u32 s86, s86, s87
    s_add_u32 s86, s86, 128
    s_waitcnt vmcnt(0) lgkmcnt(0)
    s_barrier
    s_cmp_lg_u32 s7, 0
    s_cbranch_scc1 L_pub16
    s_and_b32 s48, s2, 7
    s_lshl_b32 s48, s48, 5
    s_lshr_b32 s49, s2, 3
    s_add_u32 s48, s48, s49
    v_mov_b32 v2, s48
    v_mov_b32 v3, 3
    s_mov_b64 exec, 1
    global_store_byte v2, v3, s[22:23] sc1
    s_mov_b64 exec, -1
L_pub16:
    s_mov_b32 s12, s8
    s_mov_b32 s13, s9
    s_mov_b32 s14, 2949120
    s_mov_b32 s15, 0x20000
    s_cmp_lg_u32 s7, 0
    s_cbranch_scc1 L_xp3_2a_skip
    s_lshl_b32 s48, s62, 7
    s_add_u32 s48, s48, s60
    v_and_b32 v2, 3, v1
    v_lshlrev_b32 v2, 5, v2
    v_add_u32 v2, s48, v2
    s_mov_b32 s69, 0
L_xp3_2a_poll:
    global_load_ubyte v3, v2, s[22:23] sc1
    s_add_u32 s69, s69, 1
    s_waitcnt vmcnt(0)
    v_cmp_gt_u32 vcc, 3, v3
    s_cmp_ge_u32 s69, 131072
    s_cbranch_scc1 L_xp3_2a_skip
    s_nop 2
    s_cbranch_vccz L_xp3_2a_skip
    s_sleep 1
    s_branch L_xp3_2a_poll
L_xp3_2a_skip:
    s_barrier
    s_mov_b32 s48, 6144
    buffer_load_dwordx4 v[24:27], v0, s[32:35], s48 offen sc1
    s_mov_b32 s48, 7168
    buffer_load_dwordx4 v[28:31], v0, s[32:35], s48 offen sc1
    s_mov_b32 s48, 1480704
    buffer_load_dwordx4 v[36:39], v0, s[32:35], s48 offen sc1
    s_mov_b32 s48, 1481728
    buffer_load_dwordx4 v[40:43], v0, s[32:35], s48 offen sc1
    s_mov_b32 s48, 4429824
    buffer_load_dwordx4 v[48:51], v0, s[32:35], s48 offen sc1
    s_mov_b32 s48, 4430848
    buffer_load_dwordx4 v[52:55], v0, s[32:35], s48 offen sc1
    v_and_b32 v2, 15, v1
    v_mul_u32_u24 v2, 2560, v2
    v_lshrrev_b32 v3, 4, v1
    v_lshl_add_u32 v2, v3, 3, v2
    v_accvgpr_read_b32 v64, a24
    v_accvgpr_read_b32 v65, a25
    v_accvgpr_read_b32 v66, a26
    v_accvgpr_read_b32 v67, a27
    s_waitcnt vmcnt(5)
    v_lshlrev_b32 v22, 16, v24
    v_and_b32 v23, 0xffff0000, v24
    v_add_f32 v64, v64, v22
    v_add_f32 v65, v65, v23
    v_lshlrev_b32 v22, 16, v25
    v_and_b32 v23, 0xffff0000, v25
    v_add_f32 v66, v66, v22
    v_add_f32 v67, v67, v23
    s_waitcnt vmcnt(3)
    v_lshlrev_b32 v22, 16, v36
    v_and_b32 v23, 0xffff0000, v36
    v_add_f32 v64, v64, v22
    v_add_f32 v65, v65, v23
    v_lshlrev_b32 v22, 16, v37
    v_and_b32 v23, 0xffff0000, v37
    v_add_f32 v66, v66, v22
    v_add_f32 v67, v67, v23
    s_waitcnt vmcnt(1)
    v_lshlrev_b32 v22, 16, v48
    v_and_b32 v23, 0xffff0000, v48
    v_add_f32 v64, v64, v22
    v_add_f32 v65, v65, v23
    v_lshlrev_b32 v22, 16, v49
    v_and_b32 v23, 0xffff0000, v49
    v_add_f32 v66, v66, v22
    v_add_f32 v67, v67, v23
    v_cvt_pk_bf16_f32 v64, v64, v65
    v_cvt_pk_bf16_f32 v65, v66, v67
    s_add_u32 s48, s86, 0
    buffer_store_dwordx2 v[64:65], v2, s[12:15], s48 offen offset:0
    v_accvgpr_read_b32 v68, a28
    v_accvgpr_read_b32 v69, a29
    v_accvgpr_read_b32 v70, a30
    v_accvgpr_read_b32 v71, a31
    v_lshlrev_b32 v22, 16, v26
    v_and_b32 v23, 0xffff0000, v26
    v_add_f32 v68, v68, v22
    v_add_f32 v69, v69, v23
    v_lshlrev_b32 v22, 16, v27
    v_and_b32 v23, 0xffff0000, v27
    v_add_f32 v70, v70, v22
    v_add_f32 v71, v71, v23
    v_lshlrev_b32 v22, 16, v38
    v_and_b32 v23, 0xffff0000, v38
    v_add_f32 v68, v68, v22
    v_add_f32 v69, v69, v23
    v_lshlrev_b32 v22, 16, v39
    v_and_b32 v23, 0xffff0000, v39
    v_add_f32 v70, v70, v22
    v_add_f32 v71, v71, v23
    v_lshlrev_b32 v22, 16, v50
    v_and_b32 v23, 0xffff0000, v50
    v_add_f32 v68, v68, v22
    v_add_f32 v69, v69, v23
    v_lshlrev_b32 v22, 16, v51
    v_and_b32 v23, 0xffff0000, v51
    v_add_f32 v70, v70, v22
    v_add_f32 v71, v71, v23
    v_cvt_pk_bf16_f32 v68, v68, v69
    v_cvt_pk_bf16_f32 v69, v70, v71
    s_add_u32 s48, s86, 0
    buffer_store_dwordx2 v[68:69], v2, s[12:15], s48 offen offset:32
    v_accvgpr_read_b32 v72, a56
    v_accvgpr_read_b32 v73, a57
    v_accvgpr_read_b32 v74, a58
    v_accvgpr_read_b32 v75, a59
    v_lshlrev_b32 v22, 16, v28
    v_and_b32 v23, 0xffff0000, v28
    v_add_f32 v72, v72, v22
    v_add_f32 v73, v73, v23
    v_lshlrev_b32 v22, 16, v29
    v_and_b32 v23, 0xffff0000, v29
    v_add_f32 v74, v74, v22
    v_add_f32 v75, v75, v23
    v_lshlrev_b32 v22, 16, v40
    v_and_b32 v23, 0xffff0000, v40
    v_add_f32 v72, v72, v22
    v_add_f32 v73, v73, v23
    v_lshlrev_b32 v22, 16, v41
    v_and_b32 v23, 0xffff0000, v41
    v_add_f32 v74, v74, v22
    v_add_f32 v75, v75, v23
    s_waitcnt vmcnt(2)
    v_lshlrev_b32 v22, 16, v52
    v_and_b32 v23, 0xffff0000, v52
    v_add_f32 v72, v72, v22
    v_add_f32 v73, v73, v23
    v_lshlrev_b32 v22, 16, v53
    v_and_b32 v23, 0xffff0000, v53
    v_add_f32 v74, v74, v22
    v_add_f32 v75, v75, v23
    v_cvt_pk_bf16_f32 v72, v72, v73
    v_cvt_pk_bf16_f32 v73, v74, v75
    s_add_u32 s48, s86, 40960
    buffer_store_dwordx2 v[72:73], v2, s[12:15], s48 offen offset:0
    v_accvgpr_read_b32 v76, a60
    v_accvgpr_read_b32 v77, a61
    v_accvgpr_read_b32 v78, a62
    v_accvgpr_read_b32 v79, a63
    v_lshlrev_b32 v22, 16, v30
    v_and_b32 v23, 0xffff0000, v30
    v_add_f32 v76, v76, v22
    v_add_f32 v77, v77, v23
    v_lshlrev_b32 v22, 16, v31
    v_and_b32 v23, 0xffff0000, v31
    v_add_f32 v78, v78, v22
    v_add_f32 v79, v79, v23
    v_lshlrev_b32 v22, 16, v42
    v_and_b32 v23, 0xffff0000, v42
    v_add_f32 v76, v76, v22
    v_add_f32 v77, v77, v23
    v_lshlrev_b32 v22, 16, v43
    v_and_b32 v23, 0xffff0000, v43
    v_add_f32 v78, v78, v22
    v_add_f32 v79, v79, v23
    v_lshlrev_b32 v22, 16, v54
    v_and_b32 v23, 0xffff0000, v54
    v_add_f32 v76, v76, v22
    v_add_f32 v77, v77, v23
    v_lshlrev_b32 v22, 16, v55
    v_and_b32 v23, 0xffff0000, v55
    v_add_f32 v78, v78, v22
    v_add_f32 v79, v79, v23
    v_cvt_pk_bf16_f32 v76, v76, v77
    v_cvt_pk_bf16_f32 v77, v78, v79
    s_add_u32 s48, s86, 40960
    buffer_store_dwordx2 v[76:77], v2, s[12:15], s48 offen offset:32
    s_branch L_end2
L_x3_2a:
    s_cmp_lg_u32 s61, 3
    s_cbranch_scc1 L_x3_3a
    v_accvgpr_read_b32 v24, a8
    v_accvgpr_read_b32 v25, a9
    v_accvgpr_read_b32 v26, a10
    v_accvgpr_read_b32 v27, a11
    v_accvgpr_read_b32 v28, a12
    v_accvgpr_read_b32 v29, a13
    v_accvgpr_read_b32 v30, a14
    v_accvgpr_read_b32 v31, a15
    v_cvt_pk_bf16_f32 v24, v24, v25
    v_cvt_pk_bf16_f32 v25, v26, v27
    v_cvt_pk_bf16_f32 v26, v28, v29
    v_cvt_pk_bf16_f32 v27, v30, v31
    s_add_u32 s48, s85, 0
    buffer_store_dwordx4 v[24:27], v0, s[32:35], s48 offen sc1
    v_accvgpr_read_b32 v32, a40
    v_accvgpr_read_b32 v33, a41
    v_accvgpr_read_b32 v34, a42
    v_accvgpr_read_b32 v35, a43
    v_accvgpr_read_b32 v36, a44
    v_accvgpr_read_b32 v37, a45
    v_accvgpr_read_b32 v38, a46
    v_accvgpr_read_b32 v39, a47
    v_cvt_pk_bf16_f32 v32, v32, v33
    v_cvt_pk_bf16_f32 v33, v34, v35
    v_cvt_pk_bf16_f32 v34, v36, v37
    v_cvt_pk_bf16_f32 v35, v38, v39
    s_add_u32 s48, s85, 1024
    buffer_store_dwordx4 v[32:35], v0, s[32:35], s48 offen sc1
    v_accvgpr_read_b32 v40, a16
    v_accvgpr_read_b32 v41, a17
    v_accvgpr_read_b32 v42, a18
    v_accvgpr_read_b32 v43, a19
    v_accvgpr_read_b32 v44, a20
    v_accvgpr_read_b32 v45, a21
    v_accvgpr_read_b32 v46, a22
    v_accvgpr_read_b32 v47, a23
    v_cvt_pk_bf16_f32 v40, v40, v41
    v_cvt_pk_bf16_f32 v41, v42, v43
    v_cvt_pk_bf16_f32 v42, v44, v45
    v_cvt_pk_bf16_f32 v43, v46, v47
    s_add_u32 s48, s85, 3072
    buffer_store_dwordx4 v[40:43], v0, s[32:35], s48 offen sc1
    v_accvgpr_read_b32 v48, a48
    v_accvgpr_read_b32 v49, a49
    v_accvgpr_read_b32 v50, a50
    v_accvgpr_read_b32 v51, a51
    v_accvgpr_read_b32 v52, a52
    v_accvgpr_read_b32 v53, a53
    v_accvgpr_read_b32 v54, a54
    v_accvgpr_read_b32 v55, a55
    v_cvt_pk_bf16_f32 v48, v48, v49
    v_cvt_pk_bf16_f32 v49, v50, v51
    v_cvt_pk_bf16_f32 v50, v52, v53
    v_cvt_pk_bf16_f32 v51, v54, v55
    s_add_u32 s48, s85, 4096
    buffer_store_dwordx4 v[48:51], v0, s[32:35], s48 offen sc1
    v_accvgpr_read_b32 v56, a24
    v_accvgpr_read_b32 v57, a25
    v_accvgpr_read_b32 v58, a26
    v_accvgpr_read_b32 v59, a27
    v_accvgpr_read_b32 v60, a28
    v_accvgpr_read_b32 v61, a29
    v_accvgpr_read_b32 v62, a30
    v_accvgpr_read_b32 v63, a31
    v_cvt_pk_bf16_f32 v56, v56, v57
    v_cvt_pk_bf16_f32 v57, v58, v59
    v_cvt_pk_bf16_f32 v58, v60, v61
    v_cvt_pk_bf16_f32 v59, v62, v63
    s_add_u32 s48, s85, 6144
    buffer_store_dwordx4 v[56:59], v0, s[32:35], s48 offen sc1
    v_accvgpr_read_b32 v64, a56
    v_accvgpr_read_b32 v65, a57
    v_accvgpr_read_b32 v66, a58
    v_accvgpr_read_b32 v67, a59
    v_accvgpr_read_b32 v68, a60
    v_accvgpr_read_b32 v69, a61
    v_accvgpr_read_b32 v70, a62
    v_accvgpr_read_b32 v71, a63
    v_cvt_pk_bf16_f32 v64, v64, v65
    v_cvt_pk_bf16_f32 v65, v66, v67
    v_cvt_pk_bf16_f32 v66, v68, v69
    v_cvt_pk_bf16_f32 v67, v70, v71
    s_add_u32 s48, s85, 7168
    buffer_store_dwordx4 v[64:67], v0, s[32:35], s48 offen sc1
    s_mul_i32 s86, s63, 12
    s_add_u32 s86, s86, 9
    s_mul_i32 s86, s86, 40960
    s_mul_i32 s87, s62, 1280
    s_add_u32 s86, s86, s87
    s_lshl_b32 s87, s64, 8
    s_add_u32 s86, s86, s87
    s_add_u32 s86, s86, 192
    s_waitcnt vmcnt(0) lgkmcnt(0)
    s_barrier
    s_cmp_lg_u32 s7, 0
    s_cbranch_scc1 L_pub17
    s_and_b32 s48, s2, 7
    s_lshl_b32 s48, s48, 5
    s_lshr_b32 s49, s2, 3
    s_add_u32 s48, s48, s49
    v_mov_b32 v2, s48
    v_mov_b32 v3, 3
    s_mov_b64 exec, 1
    global_store_byte v2, v3, s[22:23] sc1
    s_mov_b64 exec, -1
L_pub17:
    s_mov_b32 s12, s8
    s_mov_b32 s13, s9
    s_mov_b32 s14, 2949120
    s_mov_b32 s15, 0x20000
    s_cmp_lg_u32 s7, 0
    s_cbranch_scc1 L_xp3_3a_skip
    s_lshl_b32 s48, s62, 7
    s_add_u32 s48, s48, s60
    v_and_b32 v2, 3, v1
    v_lshlrev_b32 v2, 5, v2
    v_add_u32 v2, s48, v2
    s_mov_b32 s69, 0
L_xp3_3a_poll:
    global_load_ubyte v3, v2, s[22:23] sc1
    s_add_u32 s69, s69, 1
    s_waitcnt vmcnt(0)
    v_cmp_gt_u32 vcc, 3, v3
    s_cmp_ge_u32 s69, 131072
    s_cbranch_scc1 L_xp3_3a_skip
    s_nop 2
    s_cbranch_vccz L_xp3_3a_skip
    s_sleep 1
    s_branch L_xp3_3a_poll
L_xp3_3a_skip:
    s_barrier
    s_mov_b32 s48, 9216
    buffer_load_dwordx4 v[24:27], v0, s[32:35], s48 offen sc1
    s_mov_b32 s48, 10240
    buffer_load_dwordx4 v[28:31], v0, s[32:35], s48 offen sc1
    s_mov_b32 s48, 1483776
    buffer_load_dwordx4 v[36:39], v0, s[32:35], s48 offen sc1
    s_mov_b32 s48, 1484800
    buffer_load_dwordx4 v[40:43], v0, s[32:35], s48 offen sc1
    s_mov_b32 s48, 2958336
    buffer_load_dwordx4 v[48:51], v0, s[32:35], s48 offen sc1
    s_mov_b32 s48, 2959360
    buffer_load_dwordx4 v[52:55], v0, s[32:35], s48 offen sc1
    v_and_b32 v2, 15, v1
    v_mul_u32_u24 v2, 2560, v2
    v_lshrrev_b32 v3, 4, v1
    v_lshl_add_u32 v2, v3, 3, v2
    v_accvgpr_read_b32 v64, a0
    v_accvgpr_read_b32 v65, a1
    v_accvgpr_read_b32 v66, a2
    v_accvgpr_read_b32 v67, a3
    s_waitcnt vmcnt(5)
    v_lshlrev_b32 v22, 16, v24
    v_and_b32 v23, 0xffff0000, v24
    v_add_f32 v64, v64, v22
    v_add_f32 v65, v65, v23
    v_lshlrev_b32 v22, 16, v25
    v_and_b32 v23, 0xffff0000, v25
    v_add_f32 v66, v66, v22
    v_add_f32 v67, v67, v23
    s_waitcnt vmcnt(3)
    v_lshlrev_b32 v22, 16, v36
    v_and_b32 v23, 0xffff0000, v36
    v_add_f32 v64, v64, v22
    v_add_f32 v65, v65, v23
    v_lshlrev_b32 v22, 16, v37
    v_and_b32 v23, 0xffff0000, v37
    v_add_f32 v66, v66, v22
    v_add_f32 v67, v67, v23
    s_waitcnt vmcnt(1)
    v_lshlrev_b32 v22, 16, v48
    v_and_b32 v23, 0xffff0000, v48
    v_add_f32 v64, v64, v22
    v_add_f32 v65, v65, v23
    v_lshlrev_b32 v22, 16, v49
    v_and_b32 v23, 0xffff0000, v49
    v_add_f32 v66, v66, v22
    v_add_f32 v67, v67, v23
    v_cvt_pk_bf16_f32 v64, v64, v65
    v_cvt_pk_bf16_f32 v65, v66, v67
    s_add_u32 s48, s86, 0
    buffer_store_dwordx2 v[64:65], v2, s[12:15], s48 offen offset:0
    v_accvgpr_read_b32 v68, a4
    v_accvgpr_read_b32 v69, a5
    v_accvgpr_read_b32 v70, a6
    v_accvgpr_read_b32 v71, a7
    v_lshlrev_b32 v22, 16, v26
    v_and_b32 v23, 0xffff0000, v26
    v_add_f32 v68, v68, v22
    v_add_f32 v69, v69, v23
    v_lshlrev_b32 v22, 16, v27
    v_and_b32 v23, 0xffff0000, v27
    v_add_f32 v70, v70, v22
    v_add_f32 v71, v71, v23
    v_lshlrev_b32 v22, 16, v38
    v_and_b32 v23, 0xffff0000, v38
    v_add_f32 v68, v68, v22
    v_add_f32 v69, v69, v23
    v_lshlrev_b32 v22, 16, v39
    v_and_b32 v23, 0xffff0000, v39
    v_add_f32 v70, v70, v22
    v_add_f32 v71, v71, v23
    v_lshlrev_b32 v22, 16, v50
    v_and_b32 v23, 0xffff0000, v50
    v_add_f32 v68, v68, v22
    v_add_f32 v69, v69, v23
    v_lshlrev_b32 v22, 16, v51
    v_and_b32 v23, 0xffff0000, v51
    v_add_f32 v70, v70, v22
    v_add_f32 v71, v71, v23
    v_cvt_pk_bf16_f32 v68, v68, v69
    v_cvt_pk_bf16_f32 v69, v70, v71
    s_add_u32 s48, s86, 0
    buffer_store_dwordx2 v[68:69], v2, s[12:15], s48 offen offset:32
    v_accvgpr_read_b32 v72, a32
    v_accvgpr_read_b32 v73, a33
    v_accvgpr_read_b32 v74, a34
    v_accvgpr_read_b32 v75, a35
    v_lshlrev_b32 v22, 16, v28
    v_and_b32 v23, 0xffff0000, v28
    v_add_f32 v72, v72, v22
    v_add_f32 v73, v73, v23
    v_lshlrev_b32 v22, 16, v29
    v_and_b32 v23, 0xffff0000, v29
    v_add_f32 v74, v74, v22
    v_add_f32 v75, v75, v23
    v_lshlrev_b32 v22, 16, v40
    v_and_b32 v23, 0xffff0000, v40
    v_add_f32 v72, v72, v22
    v_add_f32 v73, v73, v23
    v_lshlrev_b32 v22, 16, v41
    v_and_b32 v23, 0xffff0000, v41
    v_add_f32 v74, v74, v22
    v_add_f32 v75, v75, v23
    s_waitcnt vmcnt(2)
    v_lshlrev_b32 v22, 16, v52
    v_and_b32 v23, 0xffff0000, v52
    v_add_f32 v72, v72, v22
    v_add_f32 v73, v73, v23
    v_lshlrev_b32 v22, 16, v53
    v_and_b32 v23, 0xffff0000, v53
    v_add_f32 v74, v74, v22
    v_add_f32 v75, v75, v23
    v_cvt_pk_bf16_f32 v72, v72, v73
    v_cvt_pk_bf16_f32 v73, v74, v75
    s_add_u32 s48, s86, 40960
    buffer_store_dwordx2 v[72:73], v2, s[12:15], s48 offen offset:0
    v_accvgpr_read_b32 v76, a36
    v_accvgpr_read_b32 v77, a37
    v_accvgpr_read_b32 v78, a38
    v_accvgpr_read_b32 v79, a39
    v_lshlrev_b32 v22, 16, v30
    v_and_b32 v23, 0xffff0000, v30
    v_add_f32 v76, v76, v22
    v_add_f32 v77, v77, v23
    v_lshlrev_b32 v22, 16, v31
    v_and_b32 v23, 0xffff0000, v31
    v_add_f32 v78, v78, v22
    v_add_f32 v79, v79, v23
    v_lshlrev_b32 v22, 16, v42
    v_and_b32 v23, 0xffff0000, v42
    v_add_f32 v76, v76, v22
    v_add_f32 v77, v77, v23
    v_lshlrev_b32 v22, 16, v43
    v_and_b32 v23, 0xffff0000, v43
    v_add_f32 v78, v78, v22
    v_add_f32 v79, v79, v23
    v_lshlrev_b32 v22, 16, v54
    v_and_b32 v23, 0xffff0000, v54
    v_add_f32 v76, v76, v22
    v_add_f32 v77, v77, v23
    v_lshlrev_b32 v22, 16, v55
    v_and_b32 v23, 0xffff0000, v55
    v_add_f32 v78, v78, v22
    v_add_f32 v79, v79, v23
    v_cvt_pk_bf16_f32 v76, v76, v77
    v_cvt_pk_bf16_f32 v77, v78, v79
    s_add_u32 s48, s86, 40960
    buffer_store_dwordx2 v[76:77], v2, s[12:15], s48 offen offset:32
    s_branch L_end2
L_x3_3a:
L_g1op:
    s_sub_u32 s47, s99, 1
    s_mov_b32 s51, s99
    s_lshr_b32 s52, s51, 1
    s_mul_i32 s52, s52, 36864
    s_and_b32 s48, s51, 1
    s_lshl_b32 s48, s48, 11
    s_add_u32 s52, s52, s48
    s_add_u32 s51, s51, 1
    s_and_b32 s51, s51, 7
    s_add_u32 s48, s98, s52
    buffer_load_dwordx4 a[104:107], v0, s[28:31], s48 offen offset:0 sc1
    s_add_u32 s48, s98, s52
    buffer_load_dwordx4 a[116:119], v0, s[28:31], s48 offen offset:1024 sc1
    s_lshr_b32 s52, s51, 1
    s_mul_i32 s52, s52, 36864
    s_and_b32 s48, s51, 1
    s_lshl_b32 s48, s48, 11
    s_add_u32 s52, s52, s48
    s_add_u32 s51, s51, 1
    s_and_b32 s51, s51, 7
    s_add_u32 s48, s98, s52
    buffer_load_dwordx4 a[128:131], v0, s[28:31], s48 offen offset:0 sc1
    s_add_u32 s48, s98, s52
    buffer_load_dwordx4 a[140:143], v0, s[28:31], s48 offen offset:1024 sc1
    s_lshr_b32 s52, s51, 1
    s_mul_i32 s52, s52, 36864
    s_and_b32 s48, s51, 1
    s_lshl_b32 s48, s48, 11
    s_add_u32 s52, s52, s48
    s_add_u32 s51, s51, 1
    s_and_b32 s51, s51, 7
    s_add_u32 s48, s98, s52
    buffer_load_dwordx4 v[32:35], v0, s[28:31], s48 offen offset:0 sc1
    s_add_u32 s48, s98, s52
    buffer_load_dwordx4 v[44:47], v0, s[28:31], s48 offen offset:1024 sc1
    s_lshr_b32 s52, s51, 1
    s_mul_i32 s52, s52, 36864
    s_and_b32 s48, s51, 1
    s_lshl_b32 s48, s48, 11
    s_add_u32 s52, s52, s48
    s_add_u32 s51, s51, 1
    s_and_b32 s51, s51, 7
    s_add_u32 s48, s98, s52
    buffer_load_dwordx4 v[56:59], v0, s[28:31], s48 offen offset:0 sc1
    s_add_u32 s48, s98, s52
    buffer_load_dwordx4 v[68:71], v0, s[28:31], s48 offen offset:1024 sc1
    s_waitcnt vmcnt(6)
    ds_read_b64_tr_b16 v[72:73], v4 offset:0
    ds_read_b64_tr_b16 v[74:75], v4 offset:4096
    ds_read_b64_tr_b16 v[76:77], v5 offset:0
    ds_read_b64_tr_b16 v[78:79], v5 offset:4096
    ds_read_b64_tr_b16 v[80:81], v6 offset:0
    ds_read_b64_tr_b16 v[82:83], v6 offset:4096
    s_waitcnt lgkmcnt(4)
    v_mfma_f32_16x16x32_bf16 a[64:67], v[72:75], a[104:107], 0
    ds_read_b64_tr_b16 v[84:85], v7 offset:0
    ds_read_b64_tr_b16 v[86:87], v7 offset:4096
    ds_read_b64_tr_b16 v[88:89], v8 offset:0
    s_waitcnt lgkmcnt(5)
    v_mfma_f32_16x16x32_bf16 a[68:71], v[76:79], a[104:107], 0
    ds_read_b64_tr_b16 v[90:91], v8 offset:4096
    ds_read_b64_tr_b16 v[92:93], v9 offset:0
    ds_read_b64_tr_b16 v[94:95], v9 offset:4096
    s_waitcnt lgkmcnt(6)
    v_mfma_f32_16x16x32_bf16 a[72:75], v[80:83], a[104:107], 0
    ds_read_b64_tr_b16 v[72:73], v10 offset:0
    ds_read_b64_tr_b16 v[74:75], v10 offset:4096
    s_waitcnt lgkmcnt(6)
    v_mfma_f32_16x16x32_bf16 a[76:79], v[84:87], a[104:107], 0
    ds_read_b64_tr_b16 v[76:77], v11 offset:0
    ds_read_b64_tr_b16 v[78:79], v11 offset:4096
    s_waitcnt lgkmcnt(6)
    v_mfma_f32_16x16x32_bf16 a[80:83], v[88:91], a[104:107], 0
    ds_read_b64_tr_b16 v[80:81], v4 offset:8192
    ds_read_b64_tr_b16 v[82:83], v4 offset:12288
    s_waitcnt lgkmcnt(6)
    v_mfma_f32_16x16x32_bf16 a[84:87], v[92:95], a[104:107], 0
    ds_read_b64_tr_b16 v[84:85], v5 offset:8192
    ds_read_b64_tr_b16 v[86:87], v5 offset:12288
    s_waitcnt lgkmcnt(6)
    v_mfma_f32_16x16x32_bf16 a[88:91], v[72:75], a[104:107], 0
    ds_read_b64_tr_b16 v[88:89], v6 offset:8192
    ds_read_b64_tr_b16 v[90:91], v6 offset:12288
    s_waitcnt lgkmcnt(6)
    v_mfma_f32_16x16x32_bf16 a[92:95], v[76:79], a[104:107], 0
    ds_read_b64_tr_b16 v[92:93], v7 offset:8192
    ds_read_b64_tr_b16 v[94:95], v7 offset:12288
    s_waitcnt lgkmcnt(6)
    v_mfma_f32_16x16x32_bf16 a[64:67], v[80:83], a[116:119], a[64:67]
    ds_read_b64_tr_b16 v[72:73], v8 offset:8192
    ds_read_b64_tr_b16 v[74:75], v8 offset:12288
    s_waitcnt lgkmcnt(6)
    v_mfma_f32_16x16x32_bf16 a[68:71], v[84:87], a[116:119], a[68:71]
    ds_read_b64_tr_b16 v[76:77], v9 offset:8192
    ds_read_b64_tr_b16 v[78:79], v9 offset:12288
    s_waitcnt lgkmcnt(6)
    v_mfma_f32_16x16x32_bf16 a[72:75], v[88:91], a[116:119], a[72:75]
    ds_read_b64_tr_b16 v[80:81], v10 offset:8192
    ds_read_b64_tr_b16 v[82:83], v10 offset:12288
    s_waitcnt lgkmcnt(6)
    v_mfma_f32_16x16x32_bf16 a[76:79], v[92:95], a[116:119], a[76:79]
    ds_read_b64_tr_b16 v[84:85], v11 offset:8192
    ds_read_b64_tr_b16 v[86:87], v11 offset:12288
    s_waitcnt vmcnt(4)
    s_waitcnt lgkmcnt(6)
    v_mfma_f32_16x16x32_bf16 a[80:83], v[72:75], a[116:119], a[80:83]
    ds_read_b64_tr_b16 v[88:89], v4 offset:16384
    ds_read_b64_tr_b16 v[90:91], v4 offset:20480
    s_waitcnt lgkmcnt(6)
    v_mfma_f32_16x16x32_bf16 a[84:87], v[76:79], a[116:119], a[84:87]
    ds_read_b64_tr_b16 v[92:93], v5 offset:16384
    ds_read_b64_tr_b16 v[94:95], v5 offset:20480
    s_waitcnt lgkmcnt(6)
    v_mfma_f32_16x16x32_bf16 a[88:91], v[80:83], a[116:119], a[88:91]
    ds_read_b64_tr_b16 v[72:73], v6 offset:16384
    ds_read_b64_tr_b16 v[74:75], v6 offset:20480
    s_waitcnt lgkmcnt(6)
    v_mfma_f32_16x16x32_bf16 a[92:95], v[84:87], a[116:119], a[92:95]
    ds_read_b64_tr_b16 v[76:77], v7 offset:16384
    ds_read_b64_tr_b16 v[78:79], v7 offset:20480
    s_lshr_b32 s52, s51, 1
    s_mul_i32 s52, s52, 36864
    s_and_b32 s48, s51, 1
    s_lshl_b32 s48, s48, 11
    s_add_u32 s52, s52, s48
    s_add_u32 s51, s51, 1
    s_and_b32 s51, s51, 7
    s_add_u32 s48, s98, s52
    buffer_load_dwordx4 a[104:107], v0, s[28:31], s48 offen offset:0 sc1
    s_add_u32 s48, s98, s52
    buffer_load_dwordx4 a[116:119], v0, s[28:31], s48 offen offset:1024 sc1
    s_waitcnt lgkmcnt(6)
    v_mfma_f32_16x16x32_bf16 a[64:67], v[88:91], a[128:131], a[64:67]
    ds_read_b64_tr_b16 v[80:81], v8 offset:16384
    ds_read_b64_tr_b16 v[82:83], v8 offset:20480
    s_waitcnt lgkmcnt(6)
    v_mfma_f32_16x16x32_bf16 a[68:71], v[92:95], a[128:131], a[68:71]
    ds_read_b64_tr_b16 v[84:85], v9 offset:16384
    ds_read_b64_tr_b16 v[86:87], v9 offset:20480
    s_waitcnt lgkmcnt(6)
    v_mfma_f32_16x16x32_bf16 a[72:75], v[72:75], a[128:131], a[72:75]
    ds_read_b64_tr_b16 v[88:89], v10 offset:16384
    ds_read_b64_tr_b16 v[90:91], v10 offset:20480
    s_waitcnt lgkmcnt(6)
    v_mfma_f32_16x16x32_bf16 a[76:79], v[76:79], a[128:131], a[76:79]
    ds_read_b64_tr_b16 v[92:93], v11 offset:16384
    ds_read_b64_tr_b16 v[94:95], v11 offset:20480
    s_waitcnt lgkmcnt(6)
    v_mfma_f32_16x16x32_bf16 a[80:83], v[80:83], a[128:131], a[80:83]
    ds_read_b64_tr_b16 v[72:73], v4 offset:24576
    ds_read_b64_tr_b16 v[74:75], v4 offset:28672
    s_waitcnt lgkmcnt(6)
    v_mfma_f32_16x16x32_bf16 a[84:87], v[84:87], a[128:131], a[84:87]
    ds_read_b64_tr_b16 v[76:77], v5 offset:24576
    ds_read_b64_tr_b16 v[78:79], v5 offset:28672
    s_waitcnt lgkmcnt(6)
    v_mfma_f32_16x16x32_bf16 a[88:91], v[88:91], a[128:131], a[88:91]
    ds_read_b64_tr_b16 v[80:81], v6 offset:24576
    ds_read_b64_tr_b16 v[82:83], v6 offset:28672
    s_waitcnt lgkmcnt(6)
    v_mfma_f32_16x16x32_bf16 a[92:95], v[92:95], a[128:131], a[92:95]
    ds_read_b64_tr_b16 v[84:85], v7 offset:24576
    ds_read_b64_tr_b16 v[86:87], v7 offset:28672
    s_waitcnt lgkmcnt(6)
    v_mfma_f32_16x16x32_bf16 a[64:67], v[72:75], a[140:143], a[64:67]
    ds_read_b64_tr_b16 v[88:89], v8 offset:24576
    ds_read_b64_tr_b16 v[90:91], v8 offset:28672
    s_waitcnt lgkmcnt(6)
    v_mfma_f32_16x16x32_bf16 a[68:71], v[76:79], a[140:143], a[68:71]
    ds_read_b64_tr_b16 v[92:93], v9 offset:24576
    ds_read_b64_tr_b16 v[94:95], v9 offset:28672
    s_waitcnt lgkmcnt(6)
    v_mfma_f32_16x16x32_bf16 a[72:75], v[80:83], a[140:143], a[72:75]
    ds_read_b64_tr_b16 v[72:73], v10 offset:24576
    ds_read_b64_tr_b16 v[74:75], v10 offset:28672
    s_waitcnt lgkmcnt(6)
    v_mfma_f32_16x16x32_bf16 a[76:79], v[84:87], a[140:143], a[76:79]
    ds_read_b64_tr_b16 v[76:77], v11 offset:24576
    ds_read_b64_tr_b16 v[78:79], v11 offset:28672
    s_waitcnt vmcnt(4)
    s_waitcnt lgkmcnt(6)
    v_mfma_f32_16x16x32_bf16 a[80:83], v[88:91], a[140:143], a[80:83]
    ds_read_b64_tr_b16 v[80:81], v4 offset:32768
    ds_read_b64_tr_b16 v[82:83], v4 offset:36864
    s_waitcnt lgkmcnt(6)
    v_mfma_f32_16x16x32_bf16 a[84:87], v[92:95], a[140:143], a[84:87]
    ds_read_b64_tr_b16 v[84:85], v5 offset:32768
    ds_read_b64_tr_b16 v[86:87], v5 offset:36864
    s_waitcnt lgkmcnt(6)
    v_mfma_f32_16x16x32_bf16 a[88:91], v[72:75], a[140:143], a[88:91]
    ds_read_b64_tr_b16 v[88:89], v6 offset:32768
    ds_read_b64_tr_b16 v[90:91], v6 offset:36864
    s_waitcnt lgkmcnt(6)
    v_mfma_f32_16x16x32_bf16 a[92:95], v[76:79], a[140:143], a[92:95]
    ds_read_b64_tr_b16 v[92:93], v7 offset:32768
    ds_read_b64_tr_b16 v[94:95], v7 offset:36864
    s_lshr_b32 s52, s51, 1
    s_mul_i32 s52, s52, 36864
    s_and_b32 s48, s51, 1
    s_lshl_b32 s48, s48, 11
    s_add_u32 s52, s52, s48
    s_add_u32 s51, s51, 1
    s_and_b32 s51, s51, 7
    s_add_u32 s48, s98, s52
    buffer_load_dwordx4 a[128:131], v0, s[28:31], s48 offen offset:0 sc1
    s_add_u32 s48, s98, s52
    buffer_load_dwordx4 a[140:143], v0, s[28:31], s48 offen offset:1024 sc1
    s_waitcnt lgkmcnt(6)
    v_mfma_f32_16x16x32_bf16 a[64:67], v[80:83], v[32:35], a[64:67]
    ds_read_b64_tr_b16 v[72:73], v8 offset:32768
    ds_read_b64_tr_b16 v[74:75], v8 offset:36864
    s_waitcnt lgkmcnt(6)
    v_mfma_f32_16x16x32_bf16 a[68:71], v[84:87], v[32:35], a[68:71]
    ds_read_b64_tr_b16 v[76:77], v9 offset:32768
    ds_read_b64_tr_b16 v[78:79], v9 offset:36864
    s_waitcnt lgkmcnt(6)
    v_mfma_f32_16x16x32_bf16 a[72:75], v[88:91], v[32:35], a[72:75]
    ds_read_b64_tr_b16 v[80:81], v10 offset:32768
    ds_read_b64_tr_b16 v[82:83], v10 offset:36864
    s_waitcnt lgkmcnt(6)
    v_mfma_f32_16x16x32_bf16 a[76:79], v[92:95], v[32:35], a[76:79]
    ds_read_b64_tr_b16 v[84:85], v11 offset:32768
    ds_read_b64_tr_b16 v[86:87], v11 offset:36864
    s_waitcnt lgkmcnt(6)
    v_mfma_f32_16x16x32_bf16 a[80:83], v[72:75], v[32:35], a[80:83]
    ds_read_b64_tr_b16 v[88:89], v4 offset:40960
    ds_read_b64_tr_b16 v[90:91], v4 offset:45056
    s_waitcnt lgkmcnt(6)
    v_mfma_f32_16x16x32_bf16 a[84:87], v[76:79], v[32:35], a[84:87]
    ds_read_b64_tr_b16 v[92:93], v5 offset:40960
    ds_read_b64_tr_b16 v[94:95], v5 offset:45056
    s_waitcnt lgkmcnt(6)
    v_mfma_f32_16x16x32_bf16 a[88:91], v[80:83], v[32:35], a[88:91]
    ds_read_b64_tr_b16 v[72:73], v6 offset:40960
    ds_read_b64_tr_b16 v[74:75], v6 offset:45056
    s_waitcnt lgkmcnt(6)
    v_mfma_f32_16x16x32_bf16 a[92:95], v[84:87], v[32:35], a[92:95]
    ds_read_b64_tr_b16 v[76:77], v7 offset:40960
    ds_read_b64_tr_b16 v[78:79], v7 offset:45056
    s_waitcnt lgkmcnt(6)
    v_mfma_f32_16x16x32_bf16 a[64:67], v[88:91], v[44:47], a[64:67]
    ds_read_b64_tr_b16 v[80:81], v8 offset:40960
    ds_read_b64_tr_b16 v[82:83], v8 offset:45056
    s_waitcnt lgkmcnt(6)
    v_mfma_f32_16x16x32_bf16 a[68:71], v[92:95], v[44:47], a[68:71]
    ds_read_b64_tr_b16 v[84:85], v9 offset:40960
    ds_read_b64_tr_b16 v[86:87], v9 offset:45056
    s_waitcnt lgkmcnt(6)
    v_mfma_f32_16x16x32_bf16 a[72:75], v[72:75], v[44:47], a[72:75]
    ds_read_b64_tr_b16 v[88:89], v10 offset:40960
    ds_read_b64_tr_b16 v[90:91], v10 offset:45056
    s_waitcnt lgkmcnt(6)
    v_mfma_f32_16x16x32_bf16 a[76:79], v[76:79], v[44:47], a[76:79]
    ds_read_b64_tr_b16 v[92:93], v11 offset:40960
    ds_read_b64_tr_b16 v[94:95], v11 offset:45056
    s_waitcnt vmcnt(4)
    s_waitcnt lgkmcnt(6)
    v_mfma_f32_16x16x32_bf16 a[80:83], v[80:83], v[44:47], a[80:83]
    ds_read_b64_tr_b16 v[72:73], v4 offset:49152
    ds_read_b64_tr_b16 v[74:75], v4 offset:53248
    s_waitcnt lgkmcnt(6)
    v_mfma_f32_16x16x32_bf16 a[84:87], v[84:87], v[44:47], a[84:87]
    ds_read_b64_tr_b16 v[76:77], v5 offset:49152
    ds_read_b64_tr_b16 v[78:79], v5 offset:53248
    s_waitcnt lgkmcnt(6)
    v_mfma_f32_16x16x32_bf16 a[88:91], v[88:91], v[44:47], a[88:91]
    ds_read_b64_tr_b16 v[80:81], v6 offset:49152
    ds_read_b64_tr_b16 v[82:83], v6 offset:53248
    s_waitcnt lgkmcnt(6)
    v_mfma_f32_16x16x32_bf16 a[92:95], v[92:95], v[44:47], a[92:95]
    ds_read_b64_tr_b16 v[84:85], v7 offset:49152
    ds_read_b64_tr_b16 v[86:87], v7 offset:53248
    s_lshr_b32 s52, s51, 1
    s_mul_i32 s52, s52, 36864
    s_and_b32 s48, s51, 1
    s_lshl_b32 s48, s48, 11
    s_add_u32 s52, s52, s48
    s_add_u32 s51, s51, 1
    s_and_b32 s51, s51, 7
    s_add_u32 s48, s98, s52
    buffer_load_dwordx4 v[32:35], v0, s[28:31], s48 offen offset:0 sc1
    s_add_u32 s48, s98, s52
    buffer_load_dwordx4 v[44:47], v0, s[28:31], s48 offen offset:1024 sc1
    s_waitcnt lgkmcnt(6)
    v_mfma_f32_16x16x32_bf16 a[64:67], v[72:75], v[56:59], a[64:67]
    ds_read_b64_tr_b16 v[88:89], v8 offset:49152
    ds_read_b64_tr_b16 v[90:91], v8 offset:53248
    s_waitcnt lgkmcnt(6)
    v_mfma_f32_16x16x32_bf16 a[68:71], v[76:79], v[56:59], a[68:71]
    ds_read_b64_tr_b16 v[92:93], v9 offset:49152
    ds_read_b64_tr_b16 v[94:95], v9 offset:53248
    s_waitcnt lgkmcnt(6)
    v_mfma_f32_16x16x32_bf16 a[72:75], v[80:83], v[56:59], a[72:75]
    ds_read_b64_tr_b16 v[72:73], v10 offset:49152
    ds_read_b64_tr_b16 v[74:75], v10 offset:53248
    s_waitcnt lgkmcnt(6)
    v_mfma_f32_16x16x32_bf16 a[76:79], v[84:87], v[56:59], a[76:79]
    ds_read_b64_tr_b16 v[76:77], v11 offset:49152
    ds_read_b64_tr_b16 v[78:79], v11 offset:53248
    s_waitcnt lgkmcnt(6)
    v_mfma_f32_16x16x32_bf16 a[80:83], v[88:91], v[56:59], a[80:83]
    ds_read_b64_tr_b16 v[80:81], v4 offset:57344
    ds_read_b64_tr_b16 v[82:83], v4 offset:61440
    s_waitcnt lgkmcnt(6)
    v_mfma_f32_16x16x32_bf16 a[84:87], v[92:95], v[56:59], a[84:87]
    ds_read_b64_tr_b16 v[84:85], v5 offset:57344
    ds_read_b64_tr_b16 v[86:87], v5 offset:61440
    s_waitcnt lgkmcnt(6)
    v_mfma_f32_16x16x32_bf16 a[88:91], v[72:75], v[56:59], a[88:91]
    ds_read_b64_tr_b16 v[88:89], v6 offset:57344
    ds_read_b64_tr_b16 v[90:91], v6 offset:61440
    s_waitcnt lgkmcnt(6)
    v_mfma_f32_16x16x32_bf16 a[92:95], v[76:79], v[56:59], a[92:95]
    ds_read_b64_tr_b16 v[92:93], v7 offset:57344
    ds_read_b64_tr_b16 v[94:95], v7 offset:61440
    s_waitcnt lgkmcnt(6)
    v_mfma_f32_16x16x32_bf16 a[64:67], v[80:83], v[68:71], a[64:67]
    ds_read_b64_tr_b16 v[72:73], v8 offset:57344
    ds_read_b64_tr_b16 v[74:75], v8 offset:61440
    s_waitcnt lgkmcnt(6)
    v_mfma_f32_16x16x32_bf16 a[68:71], v[84:87], v[68:71], a[68:71]
    ds_read_b64_tr_b16 v[76:77], v9 offset:57344
    ds_read_b64_tr_b16 v[78:79], v9 offset:61440
    s_waitcnt lgkmcnt(6)
    v_mfma_f32_16x16x32_bf16 a[72:75], v[88:91], v[68:71], a[72:75]
    ds_read_b64_tr_b16 v[80:81], v10 offset:57344
    ds_read_b64_tr_b16 v[82:83], v10 offset:61440
    s_waitcnt lgkmcnt(6)
    v_mfma_f32_16x16x32_bf16 a[76:79], v[92:95], v[68:71], a[76:79]
    ds_read_b64_tr_b16 v[84:85], v11 offset:57344
    ds_read_b64_tr_b16 v[86:87], v11 offset:61440
    s_waitcnt vmcnt(4)
    s_waitcnt lgkmcnt(0)
    s_barrier
    v_mfma_f32_16x16x32_bf16 a[80:83], v[72:75], v[68:71], a[80:83]
    ds_read_b64_tr_b16 v[88:89], v12 offset:0
    ds_read_b64_tr_b16 v[90:91], v12 offset:4096
    v_mfma_f32_16x16x32_bf16 a[84:87], v[76:79], v[68:71], a[84:87]
    ds_read_b64_tr_b16 v[92:93], v13 offset:0
    ds_read_b64_tr_b16 v[94:95], v13 offset:4096
    s_add_u32 s47, s47, 1
    s_and_b32 s47, s47, 7
    s_mul_i32 s66, s47, 81920
    s_add_u32 s66, s66, 655360
    s_mov_b32 s67, 0
    v_mfma_f32_16x16x32_bf16 a[88:91], v[80:83], v[68:71], a[88:91]
    ds_read_b64_tr_b16 v[72:73], v14 offset:0
    ds_read_b64_tr_b16 v[74:75], v14 offset:4096
    s_add_u32 m0, s67, s20
    s_add_u32 s48, s66, s59
    s_add_u32 m0, m0, 0
    s_add_u32 s48, s48, 0
    buffer_load_dwordx4 v20, s[24:27], s48 offen lds
    v_mfma_f32_16x16x32_bf16 a[92:95], v[84:87], v[68:71], a[92:95]
    ds_read_b64_tr_b16 v[76:77], v15 offset:0
    ds_read_b64_tr_b16 v[78:79], v15 offset:4096
    s_add_u32 m0, s67, s20
    s_add_u32 s48, s66, s59
    s_add_u32 m0, m0, 1024
    s_add_u32 s48, s48, 5120
    buffer_load_dwordx4 v21, s[24:27], s48 offen lds
    s_lshr_b32 s52, s51, 1
    s_mul_i32 s52, s52, 36864
    s_and_b32 s48, s51, 1
    s_lshl_b32 s48, s48, 11
    s_add_u32 s52, s52, s48
    s_add_u32 s51, s51, 1
    s_and_b32 s51, s51, 7
    s_add_u32 s48, s98, s52
    buffer_load_dwordx4 v[56:59], v0, s[28:31], s48 offen offset:0 sc1
    s_add_u32 s48, s98, s52
    buffer_load_dwordx4 v[68:71], v0, s[28:31], s48 offen offset:1024 sc1
    s_waitcnt lgkmcnt(6)
    v_mfma_f32_16x16x32_bf16 a[64:67], v[88:91], a[104:107], a[64:67]
    ds_read_b64_tr_b16 v[80:81], v16 offset:0
    ds_read_b64_tr_b16 v[82:83], v16 offset:4096
    s_add_u32 s47, s47, 1
    s_and_b32 s47, s47, 7
    s_mul_i32 s66, s47, 81920
    s_add_u32 s66, s66, 655360
    s_mov_b32 s67, 16384
    s_waitcnt lgkmcnt(6)
    v_mfma_f32_16x16x32_bf16 a[68:71], v[92:95], a[104:107], a[68:71]
    ds_read_b64_tr_b16 v[84:85], v17 offset:0
    ds_read_b64_tr_b16 v[86:87], v17 offset:4096
    s_add_u32 m0, s67, s20
    s_add_u32 s48, s66, s59
    s_add_u32 m0, m0, 0
    s_add_u32 s48, s48, 0
    buffer_load_dwordx4 v20, s[24:27], s48 offen lds
    s_waitcnt lgkmcnt(6)
    v_mfma_f32_16x16x32_bf16 a[72:75], v[72:75], a[104:107], a[72:75]
    ds_read_b64_tr_b16 v[88:89], v18 offset:0
    ds_read_b64_tr_b16 v[90:91], v18 offset:4096
    s_add_u32 m0, s67, s20
    s_add_u32 s48, s66, s59
    s_add_u32 m0, m0, 1024
    s_add_u32 s48, s48, 5120
    buffer_load_dwordx4 v21, s[24:27], s48 offen lds
    s_waitcnt lgkmcnt(6)
    v_mfma_f32_16x16x32_bf16 a[76:79], v[76:79], a[104:107], a[76:79]
    ds_read_b64_tr_b16 v[92:93], v19 offset:0
    ds_read_b64_tr_b16 v[94:95], v19 offset:4096
    s_add_u32 s47, s47, 1
    s_and_b32 s47, s47, 7
    s_mul_i32 s66, s47, 81920
    s_add_u32 s66, s66, 655360
    s_mov_b32 s67, 32768
    s_waitcnt lgkmcnt(6)
    v_mfma_f32_16x16x32_bf16 a[80:83], v[80:83], a[104:107], a[80:83]
    ds_read_b64_tr_b16 v[72:73], v12 offset:8192
    ds_read_b64_tr_b16 v[74:75], v12 offset:12288
    s_add_u32 m0, s67, s20
    s_add_u32 s48, s66, s59
    s_add_u32 m0, m0, 0
    s_add_u32 s48, s48, 0
    buffer_load_dwordx4 v20, s[24:27], s48 offen lds
    s_waitcnt lgkmcnt(6)
    v_mfma_f32_16x16x32_bf16 a[84:87], v[84:87], a[104:107], a[84:87]
    ds_read_b64_tr_b16 v[76:77], v13 offset:8192
    ds_read_b64_tr_b16 v[78:79], v13 offset:12288
    s_add_u32 m0, s67, s20
    s_add_u32 s48, s66, s59
    s_add_u32 m0, m0, 1024
    s_add_u32 s48, s48, 5120
    buffer_load_dwordx4 v21, s[24:27], s48 offen lds
    s_waitcnt lgkmcnt(6)
    v_mfma_f32_16x16x32_bf16 a[88:91], v[88:91], a[104:107], a[88:91]
    ds_read_b64_tr_b16 v[80:81], v14 offset:8192
    ds_read_b64_tr_b16 v[82:83], v14 offset:12288
    s_add_u32 s47, s47, 1
    s_and_b32 s47, s47, 7
    s_mul_i32 s66, s47, 81920
    s_add_u32 s66, s66, 655360
    s_mov_b32 s67, 49152
    s_waitcnt lgkmcnt(6)
    v_mfma_f32_16x16x32_bf16 a[92:95], v[92:95], a[104:107], a[92:95]
    ds_read_b64_tr_b16 v[84:85], v15 offset:8192
    ds_read_b64_tr_b16 v[86:87], v15 offset:12288
    s_add_u32 m0, s67, s20
    s_add_u32 s48, s66, s59
    s_add_u32 m0, m0, 0
    s_add_u32 s48, s48, 0
    buffer_load_dwordx4 v20, s[24:27], s48 offen lds
    s_waitcnt lgkmcnt(6)
    v_mfma_f32_16x16x32_bf16 a[64:67], v[72:75], a[116:119], a[64:67]
    ds_read_b64_tr_b16 v[88:89], v16 offset:8192
    ds_read_b64_tr_b16 v[90:91], v16 offset:12288
    s_add_u32 m0, s67, s20
    s_add_u32 s48, s66, s59
    s_add_u32 m0, m0, 1024
    s_add_u32 s48, s48, 5120
    buffer_load_dwordx4 v21, s[24:27], s48 offen lds
    s_waitcnt lgkmcnt(6)
    v_mfma_f32_16x16x32_bf16 a[68:71], v[76:79], a[116:119], a[68:71]
    ds_read_b64_tr_b16 v[92:93], v17 offset:8192
    ds_read_b64_tr_b16 v[94:95], v17 offset:12288
    s_waitcnt lgkmcnt(6)
    v_mfma_f32_16x16x32_bf16 a[72:75], v[80:83], a[116:119], a[72:75]
    ds_read_b64_tr_b16 v[72:73], v18 offset:8192
    ds_read_b64_tr_b16 v[74:75], v18 offset:12288
    s_waitcnt lgkmcnt(6)
    v_mfma_f32_16x16x32_bf16 a[76:79], v[84:87], a[116:119], a[76:79]
    ds_read_b64_tr_b16 v[76:77], v19 offset:8192
    ds_read_b64_tr_b16 v[78:79], v19 offset:12288
    s_waitcnt vmcnt(12)
    s_mov_b32 s51, 2
    s_cmp_lg_u32 s7, 0
    s_cbranch_scc1 L_pg1b_skip
    s_and_b32 s48, s2, 7
    s_lshl_b32 s48, s48, 5
    v_and_b32 v2, 31, v1
    v_add_u32 v2, s48, v2
    s_mov_b32 s69, 0
L_pg1b_poll:
    global_load_ubyte v3, v2, s[22:23] sc1
    s_add_u32 s69, s69, 1
    s_waitcnt vmcnt(0)
    v_cmp_gt_u32 vcc, s51, v3
    s_cmp_ge_u32 s69, 131072
    s_cbranch_scc1 L_pg1b_skip
    s_nop 2
    s_cbranch_vccz L_pg1b_skip
    s_sleep 2
    s_branch L_pg1b_poll
L_pg1b_skip:
    s_waitcnt lgkmcnt(0)
    s_barrier
    s_mov_b32 s51, s99
    s_add_u32 s96, s96, 147456
    s_add_u32 s97, s97, 147456
    s_add_u32 s98, s98, 147456
    v_mfma_f32_16x16x32_bf16 a[80:83], v[88:91], a[116:119], a[80:83]
    ds_read_b64_tr_b16 v[80:81], v12 offset:16384
    ds_read_b64_tr_b16 v[82:83], v12 offset:20480
    v_mfma_f32_16x16x32_bf16 a[84:87], v[92:95], a[116:119], a[84:87]
    ds_read_b64_tr_b16 v[84:85], v13 offset:16384
    ds_read_b64_tr_b16 v[86:87], v13 offset:20480
    v_mfma_f32_16x16x32_bf16 a[88:91], v[72:75], a[116:119], a[88:91]
    ds_read_b64_tr_b16 v[88:89], v14 offset:16384
    ds_read_b64_tr_b16 v[90:91], v14 offset:20480
    v_mfma_f32_16x16x32_bf16 a[92:95], v[76:79], a[116:119], a[92:95]
    ds_read_b64_tr_b16 v[92:93], v15 offset:16384
    ds_read_b64_tr_b16 v[94:95], v15 offset:20480
    s_lshr_b32 s52, s51, 1
    s_mul_i32 s52, s52, 36864
    s_and_b32 s48, s51, 1
    s_lshl_b32 s48, s48, 11
    s_add_u32 s52, s52, s48
    s_add_u32 s51, s51, 1
    s_and_b32 s51, s51, 7
    s_add_u32 s48, s98, s52
    buffer_load_dwordx4 a[104:107], v0, s[28:31], s48 offen offset:0 sc1
    s_add_u32 s48, s98, s52
    buffer_load_dwordx4 a[116:119], v0, s[28:31], s48 offen offset:1024 sc1
    s_waitcnt lgkmcnt(6)
    v_mfma_f32_16x16x32_bf16 a[64:67], v[80:83], a[128:131], a[64:67]
    ds_read_b64_tr_b16 v[72:73], v16 offset:16384
    ds_read_b64_tr_b16 v[74:75], v16 offset:20480
    s_waitcnt lgkmcnt(6)
    v_mfma_f32_16x16x32_bf16 a[68:71], v[84:87], a[128:131], a[68:71]
    ds_read_b64_tr_b16 v[76:77], v17 offset:16384
    ds_read_b64_tr_b16 v[78:79], v17 offset:20480
    s_waitcnt lgkmcnt(6)
    v_mfma_f32_16x16x32_bf16 a[72:75], v[88:91], a[128:131], a[72:75]
    ds_read_b64_tr_b16 v[80:81], v18 offset:16384
    ds_read_b64_tr_b16 v[82:83], v18 offset:20480
    s_waitcnt lgkmcnt(6)
    v_mfma_f32_16x16x32_bf16 a[76:79], v[92:95], a[128:131], a[76:79]
    ds_read_b64_tr_b16 v[84:85], v19 offset:16384
    ds_read_b64_tr_b16 v[86:87], v19 offset:20480
    s_waitcnt lgkmcnt(6)
    v_mfma_f32_16x16x32_bf16 a[80:83], v[72:75], a[128:131], a[80:83]
    ds_read_b64_tr_b16 v[88:89], v12 offset:24576
    ds_read_b64_tr_b16 v[90:91], v12 offset:28672
    s_waitcnt lgkmcnt(6)
    v_mfma_f32_16x16x32_bf16 a[84:87], v[76:79], a[128:131], a[84:87]
    ds_read_b64_tr_b16 v[92:93], v13 offset:24576
    ds_read_b64_tr_b16 v[94:95], v13 offset:28672
    s_waitcnt lgkmcnt(6)
    v_mfma_f32_16x16x32_bf16 a[88:91], v[80:83], a[128:131], a[88:91]
    ds_read_b64_tr_b16 v[72:73], v14 offset:24576
    ds_read_b64_tr_b16 v[74:75], v14 offset:28672
    s_waitcnt lgkmcnt(6)
    v_mfma_f32_16x16x32_bf16 a[92:95], v[84:87], a[128:131], a[92:95]
    ds_read_b64_tr_b16 v[76:77], v15 offset:24576
    ds_read_b64_tr_b16 v[78:79], v15 offset:28672
    s_waitcnt lgkmcnt(6)
    v_mfma_f32_16x16x32_bf16 a[64:67], v[88:91], a[140:143], a[64:67]
    ds_read_b64_tr_b16 v[80:81], v16 offset:24576
    ds_read_b64_tr_b16 v[82:83], v16 offset:28672
    s_waitcnt lgkmcnt(6)
    v_mfma_f32_16x16x32_bf16 a[68:71], v[92:95], a[140:143], a[68:71]
    ds_read_b64_tr_b16 v[84:85], v17 offset:24576
    ds_read_b64_tr_b16 v[86:87], v17 offset:28672
    s_waitcnt lgkmcnt(6)
    v_mfma_f32_16x16x32_bf16 a[72:75], v[72:75], a[140:143], a[72:75]
    ds_read_b64_tr_b16 v[88:89], v18 offset:24576
    ds_read_b64_tr_b16 v[90:91], v18 offset:28672
    s_waitcnt lgkmcnt(6)
    v_mfma_f32_16x16x32_bf16 a[76:79], v[76:79], a[140:143], a[76:79]
    ds_read_b64_tr_b16 v[92:93], v19 offset:24576
    ds_read_b64_tr_b16 v[94:95], v19 offset:28672
    s_waitcnt vmcnt(12)
    s_waitcnt lgkmcnt(6)
    v_mfma_f32_16x16x32_bf16 a[80:83], v[80:83], a[140:143], a[80:83]
    ds_read_b64_tr_b16 v[72:73], v12 offset:32768
    ds_read_b64_tr_b16 v[74:75], v12 offset:36864
    s_waitcnt lgkmcnt(6)
    v_mfma_f32_16x16x32_bf16 a[84:87], v[84:87], a[140:143], a[84:87]
    ds_read_b64_tr_b16 v[76:77], v13 offset:32768
    ds_read_b64_tr_b16 v[78:79], v13 offset:36864
    s_waitcnt lgkmcnt(6)
    v_mfma_f32_16x16x32_bf16 a[88:91], v[88:91], a[140:143], a[88:91]
    ds_read_b64_tr_b16 v[80:81], v14 offset:32768
    ds_read_b64_tr_b16 v[82:83], v14 offset:36864
    s_waitcnt lgkmcnt(6)
    v_mfma_f32_16x16x32_bf16 a[92:95], v[92:95], a[140:143], a[92:95]
    ds_read_b64_tr_b16 v[84:85], v15 offset:32768
    ds_read_b64_tr_b16 v[86:87], v15 offset:36864
    s_lshr_b32 s52, s51, 1
    s_mul_i32 s52, s52, 36864
    s_and_b32 s48, s51, 1
    s_lshl_b32 s48, s48, 11
    s_add_u32 s52, s52, s48
    s_add_u32 s51, s51, 1
    s_and_b32 s51, s51, 7
    s_add_u32 s48, s98, s52
    buffer_load_dwordx4 a[128:131], v0, s[28:31], s48 offen offset:0 sc1
    s_add_u32 s48, s98, s52
    buffer_load_dwordx4 a[140:143], v0, s[28:31], s48 offen offset:1024 sc1
    s_waitcnt lgkmcnt(6)
    v_mfma_f32_16x16x32_bf16 a[64:67], v[72:75], v[32:35], a[64:67]
    ds_read_b64_tr_b16 v[88:89], v16 offset:32768
    ds_read_b64_tr_b16 v[90:91], v16 offset:36864
    s_waitcnt lgkmcnt(6)
    v_mfma_f32_16x16x32_bf16 a[68:71], v[76:79], v[32:35], a[68:71]
    ds_read_b64_tr_b16 v[92:93], v17 offset:32768
    ds_read_b64_tr_b16 v[94:95], v17 offset:36864
    s_waitcnt lgkmcnt(6)
    v_mfma_f32_16x16x32_bf16 a[72:75], v[80:83], v[32:35], a[72:75]
    ds_read_b64_tr_b16 v[72:73], v18 offset:32768
    ds_read_b64_tr_b16 v[74:75], v18 offset:36864
    s_waitcnt lgkmcnt(6)
    v_mfma_f32_16x16x32_bf16 a[76:79], v[84:87], v[32:35], a[76:79]
    ds_read_b64_tr_b16 v[76:77], v19 offset:32768
    ds_read_b64_tr_b16 v[78:79], v19 offset:36864
    s_waitcnt lgkmcnt(6)
    v_mfma_f32_16x16x32_bf16 a[80:83], v[88:91], v[32:35], a[80:83]
    ds_read_b64_tr_b16 v[80:81], v12 offset:40960
    ds_read_b64_tr_b16 v[82:83], v12 offset:45056
    s_waitcnt lgkmcnt(6)
    v_mfma_f32_16x16x32_bf16 a[84:87], v[92:95], v[32:35], a[84:87]
    ds_read_b64_tr_b16 v[84:85], v13 offset:40960
    ds_read_b64_tr_b16 v[86:87], v13 offset:45056
    s_waitcnt lgkmcnt(6)
    v_mfma_f32_16x16x32_bf16 a[88:91], v[72:75], v[32:35], a[88:91]
    ds_read_b64_tr_b16 v[88:89], v14 offset:40960
    ds_read_b64_tr_b16 v[90:91], v14 offset:45056
    s_waitcnt lgkmcnt(6)
    v_mfma_f32_16x16x32_bf16 a[92:95], v[76:79], v[32:35], a[92:95]
    ds_read_b64_tr_b16 v[92:93], v15 offset:40960
    ds_read_b64_tr_b16 v[94:95], v15 offset:45056
    s_waitcnt lgkmcnt(6)
    v_mfma_f32_16x16x32_bf16 a[64:67], v[80:83], v[44:47], a[64:67]
    ds_read_b64_tr_b16 v[72:73], v16 offset:40960
    ds_read_b64_tr_b16 v[74:75], v16 offset:45056
    s_waitcnt lgkmcnt(6)
    v_mfma_f32_16x16x32_bf16 a[68:71], v[84:87], v[44:47], a[68:71]
    ds_read_b64_tr_b16 v[76:77], v17 offset:40960
    ds_read_b64_tr_b16 v[78:79], v17 offset:45056
    s_waitcnt lgkmcnt(6)
    v_mfma_f32_16x16x32_bf16 a[72:75], v[88:91], v[44:47], a[72:75]
    ds_read_b64_tr_b16 v[80:81], v18 offset:40960
    ds_read_b64_tr_b16 v[82:83], v18 offset:45056
    s_waitcnt lgkmcnt(6)
    v_mfma_f32_16x16x32_bf16 a[76:79], v[92:95], v[44:47], a[76:79]
    ds_read_b64_tr_b16 v[84:85], v19 offset:40960
    ds_read_b64_tr_b16 v[86:87], v19 offset:45056
    s_waitcnt vmcnt(10)
    s_waitcnt lgkmcnt(6)
    v_mfma_f32_16x16x32_bf16 a[80:83], v[72:75], v[44:47], a[80:83]
    ds_read_b64_tr_b16 v[88:89], v12 offset:49152
    ds_read_b64_tr_b16 v[90:91], v12 offset:53248
    s_waitcnt lgkmcnt(6)
    v_mfma_f32_16x16x32_bf16 a[84:87], v[76:79], v[44:47], a[84:87]
    ds_read_b64_tr_b16 v[92:93], v13 offset:49152
    ds_read_b64_tr_b16 v[94:95], v13 offset:53248
    s_waitcnt lgkmcnt(6)
    v_mfma_f32_16x16x32_bf16 a[88:91], v[80:83], v[44:47], a[88:91]
    ds_read_b64_tr_b16 v[72:73], v14 offset:49152
    ds_read_b64_tr_b16 v[74:75], v14 offset:53248
    s_waitcnt lgkmcnt(6)
    v_mfma_f32_16x16x32_bf16 a[92:95], v[84:87], v[44:47], a[92:95]
    ds_read_b64_tr_b16 v[76:77], v15 offset:49152
    ds_read_b64_tr_b16 v[78:79], v15 offset:53248
    s_lshr_b32 s52, s51, 1
    s_mul_i32 s52, s52, 36864
    s_and_b32 s48, s51, 1
    s_lshl_b32 s48, s48, 11
    s_add_u32 s52, s52, s48
    s_add_u32 s51, s51, 1
    s_and_b32 s51, s51, 7
    s_add_u32 s48, s98, s52
    buffer_load_dwordx4 v[32:35], v0, s[28:31], s48 offen offset:0 sc1
    s_add_u32 s48, s98, s52
    buffer_load_dwordx4 v[44:47], v0, s[28:31], s48 offen offset:1024 sc1
    s_waitcnt lgkmcnt(6)
    v_mfma_f32_16x16x32_bf16 a[64:67], v[88:91], v[56:59], a[64:67]
    ds_read_b64_tr_b16 v[80:81], v16 offset:49152
    ds_read_b64_tr_b16 v[82:83], v16 offset:53248
    s_waitcnt lgkmcnt(6)
    v_mfma_f32_16x16x32_bf16 a[68:71], v[92:95], v[56:59], a[68:71]
    ds_read_b64_tr_b16 v[84:85], v17 offset:49152
    ds_read_b64_tr_b16 v[86:87], v17 offset:53248
    s_waitcnt lgkmcnt(6)
    v_mfma_f32_16x16x32_bf16 a[72:75], v[72:75], v[56:59], a[72:75]
    ds_read_b64_tr_b16 v[88:89], v18 offset:49152
    ds_read_b64_tr_b16 v[90:91], v18 offset:53248
    s_waitcnt lgkmcnt(6)
    v_mfma_f32_16x16x32_bf16 a[76:79], v[76:79], v[56:59], a[76:79]
    ds_read_b64_tr_b16 v[92:93], v19 offset:49152
    ds_read_b64_tr_b16 v[94:95], v19 offset:53248
    s_waitcnt lgkmcnt(6)
    v_mfma_f32_16x16x32_bf16 a[80:83], v[80:83], v[56:59], a[80:83]
    ds_read_b64_tr_b16 v[72:73], v12 offset:57344
    ds_read_b64_tr_b16 v[74:75], v12 offset:61440
    s_waitcnt lgkmcnt(6)
    v_mfma_f32_16x16x32_bf16 a[84:87], v[84:87], v[56:59], a[84:87]
    ds_read_b64_tr_b16 v[76:77], v13 offset:57344
    ds_read_b64_tr_b16 v[78:79], v13 offset:61440
    s_waitcnt lgkmcnt(6)
    v_mfma_f32_16x16x32_bf16 a[88:91], v[88:91], v[56:59], a[88:91]
    ds_read_b64_tr_b16 v[80:81], v14 offset:57344
    ds_read_b64_tr_b16 v[82:83], v14 offset:61440
    s_waitcnt lgkmcnt(6)
    v_mfma_f32_16x16x32_bf16 a[92:95], v[92:95], v[56:59], a[92:95]
    ds_read_b64_tr_b16 v[84:85], v15 offset:57344
    ds_read_b64_tr_b16 v[86:87], v15 offset:61440
    s_waitcnt lgkmcnt(6)
    v_mfma_f32_16x16x32_bf16 a[64:67], v[72:75], v[68:71], a[64:67]
    ds_read_b64_tr_b16 v[88:89], v16 offset:57344
    ds_read_b64_tr_b16 v[90:91], v16 offset:61440
    s_waitcnt lgkmcnt(6)
    v_mfma_f32_16x16x32_bf16 a[68:71], v[76:79], v[68:71], a[68:71]
    ds_read_b64_tr_b16 v[92:93], v17 offset:57344
    ds_read_b64_tr_b16 v[94:95], v17 offset:61440
    s_waitcnt lgkmcnt(6)
    v_mfma_f32_16x16x32_bf16 a[72:75], v[80:83], v[68:71], a[72:75]
    ds_read_b64_tr_b16 v[72:73], v18 offset:57344
    ds_read_b64_tr_b16 v[74:75], v18 offset:61440
    s_waitcnt lgkmcnt(6)
    v_mfma_f32_16x16x32_bf16 a[76:79], v[84:87], v[68:71], a[76:79]
    ds_read_b64_tr_b16 v[76:77], v19 offset:57344
    ds_read_b64_tr_b16 v[78:79], v19 offset:61440
    s_waitcnt vmcnt(4)
    s_waitcnt lgkmcnt(0)
    s_barrier
    v_mfma_f32_16x16x32_bf16 a[80:83], v[88:91], v[68:71], a[80:83]
    ds_read_b64_tr_b16 v[80:81], v4 offset:0
    ds_read_b64_tr_b16 v[82:83], v4 offset:4096
    v_mfma_f32_16x16x32_bf16 a[84:87], v[92:95], v[68:71], a[84:87]
    ds_read_b64_tr_b16 v[84:85], v5 offset:0
    ds_read_b64_tr_b16 v[86:87], v5 offset:4096
    s_add_u32 s47, s47, 1
    s_and_b32 s47, s47, 7
    s_mul_i32 s66, s47, 81920
    s_add_u32 s66, s66, 655360
    s_mov_b32 s67, 65536
    v_mfma_f32_16x16x32_bf16 a[88:91], v[72:75], v[68:71], a[88:91]
    ds_read_b64_tr_b16 v[88:89], v6 offset:0
    ds_read_b64_tr_b16 v[90:91], v6 offset:4096
    s_add_u32 m0, s67, s20
    s_add_u32 s48, s66, s59
    s_add_u32 m0, m0, 0
    s_add_u32 s48, s48, 0
    buffer_load_dwordx4 v20, s[24:27], s48 offen lds
    v_mfma_f32_16x16x32_bf16 a[92:95], v[76:79], v[68:71], a[92:95]
    ds_read_b64_tr_b16 v[92:93], v7 offset:0
    ds_read_b64_tr_b16 v[94:95], v7 offset:4096
    s_add_u32 m0, s67, s20
    s_add_u32 s48, s66, s59
    s_add_u32 m0, m0, 1024
    s_add_u32 s48, s48, 5120
    buffer_load_dwordx4 v21, s[24:27], s48 offen lds
    s_lshr_b32 s52, s51, 1
    s_mul_i32 s52, s52, 36864
    s_and_b32 s48, s51, 1
    s_lshl_b32 s48, s48, 11
    s_add_u32 s52, s52, s48
    s_add_u32 s51, s51, 1
    s_and_b32 s51, s51, 7
    s_add_u32 s48, s98, s52
    buffer_load_dwordx4 v[56:59], v0, s[28:31], s48 offen offset:0 sc1
    s_add_u32 s48, s98, s52
    buffer_load_dwordx4 v[68:71], v0, s[28:31], s48 offen offset:1024 sc1
    s_waitcnt lgkmcnt(6)
    v_mfma_f32_16x16x32_bf16 a[64:67], v[80:83], a[104:107], a[64:67]
    ds_read_b64_tr_b16 v[72:73], v8 offset:0
    ds_read_b64_tr_b16 v[74:75], v8 offset:4096
    s_add_u32 s47, s47, 1
    s_and_b32 s47, s47, 7
    s_mul_i32 s66, s47, 81920
    s_add_u32 s66, s66, 655360
    s_mov_b32 s67, 81920
    s_waitcnt lgkmcnt(6)
    v_mfma_f32_16x16x32_bf16 a[68:71], v[84:87], a[104:107], a[68:71]
    ds_read_b64_tr_b16 v[76:77], v9 offset:0
    ds_read_b64_tr_b16 v[78:79], v9 offset:4096
    s_add_u32 m0, s67, s20
    s_add_u32 s48, s66, s59
    s_add_u32 m0, m0, 0
    s_add_u32 s48, s48, 0
    buffer_load_dwordx4 v20, s[24:27], s48 offen lds
    s_waitcnt lgkmcnt(6)
    v_mfma_f32_16x16x32_bf16 a[72:75], v[88:91], a[104:107], a[72:75]
    ds_read_b64_tr_b16 v[80:81], v10 offset:0
    ds_read_b64_tr_b16 v[82:83], v10 offset:4096
    s_add_u32 m0, s67, s20
    s_add_u32 s48, s66, s59
    s_add_u32 m0, m0, 1024
    s_add_u32 s48, s48, 5120
    buffer_load_dwordx4 v21, s[24:27], s48 offen lds
    s_waitcnt lgkmcnt(6)
    v_mfma_f32_16x16x32_bf16 a[76:79], v[92:95], a[104:107], a[76:79]
    ds_read_b64_tr_b16 v[84:85], v11 offset:0
    ds_read_b64_tr_b16 v[86:87], v11 offset:4096
    s_add_u32 s47, s47, 1
    s_and_b32 s47, s47, 7
    s_mul_i32 s66, s47, 81920
    s_add_u32 s66, s66, 655360
    s_mov_b32 s67, 98304
    s_waitcnt lgkmcnt(6)
    v_mfma_f32_16x16x32_bf16 a[80:83], v[72:75], a[104:107], a[80:83]
    ds_read_b64_tr_b16 v[88:89], v4 offset:8192
    ds_read_b64_tr_b16 v[90:91], v4 offset:12288
    s_add_u32 m0, s67, s20
    s_add_u32 s48, s66, s59
    s_add_u32 m0, m0, 0
    s_add_u32 s48, s48, 0
    buffer_load_dwordx4 v20, s[24:27], s48 offen lds
    s_waitcnt lgkmcnt(6)
    v_mfma_f32_16x16x32_bf16 a[84:87], v[76:79], a[104:107], a[84:87]
    ds_read_b64_tr_b16 v[92:93], v5 offset:8192
    ds_read_b64_tr_b16 v[94:95], v5 offset:12288
    s_add_u32 m0, s67, s20
    s_add_u32 s48, s66, s59
    s_add_u32 m0, m0, 1024
    s_add_u32 s48, s48, 5120
    buffer_load_dwordx4 v21, s[24:27], s48 offen lds
    s_waitcnt lgkmcnt(6)
    v_mfma_f32_16x16x32_bf16 a[88:91], v[80:83], a[104:107], a[88:91]
    ds_read_b64_tr_b16 v[72:73], v6 offset:8192
    ds_read_b64_tr_b16 v[74:75], v6 offset:12288
    s_add_u32 s47, s47, 1
    s_and_b32 s47, s47, 7
    s_mul_i32 s66, s47, 81920
    s_add_u32 s66, s66, 655360
    s_mov_b32 s67, 114688
    s_waitcnt lgkmcnt(6)
    v_mfma_f32_16x16x32_bf16 a[92:95], v[84:87], a[104:107], a[92:95]
    ds_read_b64_tr_b16 v[76:77], v7 offset:8192
    ds_read_b64_tr_b16 v[78:79], v7 offset:12288
    s_add_u32 m0, s67, s20
    s_add_u32 s48, s66, s59
    s_add_u32 m0, m0, 0
    s_add_u32 s48, s48, 0
    buffer_load_dwordx4 v20, s[24:27], s48 offen lds
    s_waitcnt lgkmcnt(6)
    v_mfma_f32_16x16x32_bf16 a[64:67], v[88:91], a[116:119], a[64:67]
    ds_read_b64_tr_b16 v[80:81], v8 offset:8192
    ds_read_b64_tr_b16 v[82:83], v8 offset:12288
    s_add_u32 m0, s67, s20
    s_add_u32 s48, s66, s59
    s_add_u32 m0, m0, 1024
    s_add_u32 s48, s48, 5120
    buffer_load_dwordx4 v21, s[24:27], s48 offen lds
    s_waitcnt lgkmcnt(6)
    v_mfma_f32_16x16x32_bf16 a[68:71], v[92:95], a[116:119], a[68:71]
    ds_read_b64_tr_b16 v[84:85], v9 offset:8192
    ds_read_b64_tr_b16 v[86:87], v9 offset:12288
    s_waitcnt lgkmcnt(6)
    v_mfma_f32_16x16x32_bf16 a[72:75], v[72:75], a[116:119], a[72:75]
    ds_read_b64_tr_b16 v[88:89], v10 offset:8192
    ds_read_b64_tr_b16 v[90:91], v10 offset:12288
    s_waitcnt lgkmcnt(6)
    v_mfma_f32_16x16x32_bf16 a[76:79], v[76:79], a[116:119], a[76:79]
    ds_read_b64_tr_b16 v[92:93], v11 offset:8192
    ds_read_b64_tr_b16 v[94:95], v11 offset:12288
    s_waitcnt vmcnt(12)
    s_waitcnt lgkmcnt(6)
    v_mfma_f32_16x16x32_bf16 a[80:83], v[80:83], a[116:119], a[80:83]
    ds_read_b64_tr_b16 v[72:73], v4 offset:16384
    ds_read_b64_tr_b16 v[74:75], v4 offset:20480
    s_waitcnt lgkmcnt(6)
    v_mfma_f32_16x16x32_bf16 a[84:87], v[84:87], a[116:119], a[84:87]
    ds_read_b64_tr_b16 v[76:77], v5 offset:16384
    ds_read_b64_tr_b16 v[78:79], v5 offset:20480
    s_waitcnt lgkmcnt(6)
    v_mfma_f32_16x16x32_bf16 a[88:91], v[88:91], a[116:119], a[88:91]
    ds_read_b64_tr_b16 v[80:81], v6 offset:16384
    ds_read_b64_tr_b16 v[82:83], v6 offset:20480
    s_waitcnt lgkmcnt(6)
    v_mfma_f32_16x16x32_bf16 a[92:95], v[92:95], a[116:119], a[92:95]
    ds_read_b64_tr_b16 v[84:85], v7 offset:16384
    ds_read_b64_tr_b16 v[86:87], v7 offset:20480
    s_lshr_b32 s52, s51, 1
    s_mul_i32 s52, s52, 36864
    s_and_b32 s48, s51, 1
    s_lshl_b32 s48, s48, 11
    s_add_u32 s52, s52, s48
    s_add_u32 s51, s51, 1
    s_and_b32 s51, s51, 7
    s_add_u32 s48, s98, s52
    buffer_load_dwordx4 a[104:107], v0, s[28:31], s48 offen offset:0 sc1
    s_add_u32 s48, s98, s52
    buffer_load_dwordx4 a[116:119], v0, s[28:31], s48 offen offset:1024 sc1
    s_waitcnt lgkmcnt(6)
    v_mfma_f32_16x16x32_bf16 a[64:67], v[72:75], a[128:131], a[64:67]
    ds_read_b64_tr_b16 v[88:89], v8 offset:16384
    ds_read_b64_tr_b16 v[90:91], v8 offset:20480
    s_waitcnt lgkmcnt(6)
    v_mfma_f32_16x16x32_bf16 a[68:71], v[76:79], a[128:131], a[68:71]
    ds_read_b64_tr_b16 v[92:93], v9 offset:16384
    ds_read_b64_tr_b16 v[94:95], v9 offset:20480
    s_waitcnt lgkmcnt(6)
    v_mfma_f32_16x16x32_bf16 a[72:75], v[80:83], a[128:131], a[72:75]
    ds_read_b64_tr_b16 v[72:73], v10 offset:16384
    ds_read_b64_tr_b16 v[74:75], v10 offset:20480
    s_waitcnt lgkmcnt(6)
    v_mfma_f32_16x16x32_bf16 a[76:79], v[84:87], a[128:131], a[76:79]
    ds_read_b64_tr_b16 v[76:77], v11 offset:16384
    ds_read_b64_tr_b16 v[78:79], v11 offset:20480
    s_waitcnt lgkmcnt(6)
    v_mfma_f32_16x16x32_bf16 a[80:83], v[88:91], a[128:131], a[80:83]
    ds_read_b64_tr_b16 v[80:81], v4 offset:24576
    ds_read_b64_tr_b16 v[82:83], v4 offset:28672
    s_waitcnt lgkmcnt(6)
    v_mfma_f32_16x16x32_bf16 a[84:87], v[92:95], a[128:131], a[84:87]
    ds_read_b64_tr_b16 v[84:85], v5 offset:24576
    ds_read_b64_tr_b16 v[86:87], v5 offset:28672
    s_waitcnt lgkmcnt(6)
    v_mfma_f32_16x16x32_bf16 a[88:91], v[72:75], a[128:131], a[88:91]
    ds_read_b64_tr_b16 v[88:89], v6 offset:24576
    ds_read_b64_tr_b16 v[90:91], v6 offset:28672
    s_waitcnt lgkmcnt(6)
    v_mfma_f32_16x16x32_bf16 a[92:95], v[76:79], a[128:131], a[92:95]
    ds_read_b64_tr_b16 v[92:93], v7 offset:24576
    ds_read_b64_tr_b16 v[94:95], v7 offset:28672
    s_waitcnt lgkmcnt(6)
    v_mfma_f32_16x16x32_bf16 a[64:67], v[80:83], a[140:143], a[64:67]
    ds_read_b64_tr_b16 v[72:73], v8 offset:24576
    ds_read_b64_tr_b16 v[74:75], v8 offset:28672
    s_waitcnt lgkmcnt(6)
    v_mfma_f32_16x16x32_bf16 a[68:71], v[84:87], a[140:143], a[68:71]
    ds_read_b64_tr_b16 v[76:77], v9 offset:24576
    ds_read_b64_tr_b16 v[78:79], v9 offset:28672
    s_waitcnt lgkmcnt(6)
    v_mfma_f32_16x16x32_bf16 a[72:75], v[88:91], a[140:143], a[72:75]
    ds_read_b64_tr_b16 v[80:81], v10 offset:24576
    ds_read_b64_tr_b16 v[82:83], v10 offset:28672
    s_waitcnt lgkmcnt(6)
    v_mfma_f32_16x16x32_bf16 a[76:79], v[92:95], a[140:143], a[76:79]
    ds_read_b64_tr_b16 v[84:85], v11 offset:24576
    ds_read_b64_tr_b16 v[86:87], v11 offset:28672
    s_waitcnt vmcnt(12)
    s_waitcnt lgkmcnt(6)
    v_mfma_f32_16x16x32_bf16 a[80:83], v[72:75], a[140:143], a[80:83]
    ds_read_b64_tr_b16 v[88:89], v4 offset:32768
    ds_read_b64_tr_b16 v[90:91], v4 offset:36864
    s_waitcnt lgkmcnt(6)
    v_mfma_f32_16x16x32_bf16 a[84:87], v[76:79], a[140:143], a[84:87]
    ds_read_b64_tr_b16 v[92:93], v5 offset:32768
    ds_read_b64_tr_b16 v[94:95], v5 offset:36864
    s_waitcnt lgkmcnt(6)
    v_mfma_f32_16x16x32_bf16 a[88:91], v[80:83], a[140:143], a[88:91]
    ds_read_b64_tr_b16 v[72:73], v6 offset:32768
    ds_read_b64_tr_b16 v[74:75], v6 offset:36864
    s_waitcnt lgkmcnt(6)
    v_mfma_f32_16x16x32_bf16 a[92:95], v[84:87], a[140:143], a[92:95]
    ds_read_b64_tr_b16 v[76:77], v7 offset:32768
    ds_read_b64_tr_b16 v[78:79], v7 offset:36864
    s_lshr_b32 s52, s51, 1
    s_mul_i32 s52, s52, 36864
    s_and_b32 s48, s51, 1
    s_lshl_b32 s48, s48, 11
    s_add_u32 s52, s52, s48
    s_add_u32 s51, s51, 1
    s_and_b32 s51, s51, 7
    s_add_u32 s48, s98, s52
    buffer_load_dwordx4 a[128:131], v0, s[28:31], s48 offen offset:0 sc1
    s_add_u32 s48, s98, s52
    buffer_load_dwordx4 a[140:143], v0, s[28:31], s48 offen offset:1024 sc1
    s_waitcnt lgkmcnt(6)
    v_mfma_f32_16x16x32_bf16 a[64:67], v[88:91], v[32:35], a[64:67]
    ds_read_b64_tr_b16 v[80:81], v8 offset:32768
    ds_read_b64_tr_b16 v[82:83], v8 offset:36864
    s_waitcnt lgkmcnt(6)
    v_mfma_f32_16x16x32_bf16 a[68:71], v[92:95], v[32:35], a[68:71]
    ds_read_b64_tr_b16 v[84:85], v9 offset:32768
    ds_read_b64_tr_b16 v[86:87], v9 offset:36864
    s_waitcnt lgkmcnt(6)
    v_mfma_f32_16x16x32_bf16 a[72:75], v[72:75], v[32:35], a[72:75]
    ds_read_b64_tr_b16 v[88:89], v10 offset:32768
    ds_read_b64_tr_b16 v[90:91], v10 offset:36864
    s_waitcnt lgkmcnt(6)
    v_mfma_f32_16x16x32_bf16 a[76:79], v[76:79], v[32:35], a[76:79]
    ds_read_b64_tr_b16 v[92:93], v11 offset:32768
    ds_read_b64_tr_b16 v[94:95], v11 offset:36864
    s_waitcnt lgkmcnt(6)
    v_mfma_f32_16x16x32_bf16 a[80:83], v[80:83], v[32:35], a[80:83]
    ds_read_b64_tr_b16 v[72:73], v4 offset:40960
    ds_read_b64_tr_b16 v[74:75], v4 offset:45056
    s_waitcnt lgkmcnt(6)
    v_mfma_f32_16x16x32_bf16 a[84:87], v[84:87], v[32:35], a[84:87]
    ds_read_b64_tr_b16 v[76:77], v5 offset:40960
    ds_read_b64_tr_b16 v[78:79], v5 offset:45056
    s_waitcnt lgkmcnt(6)
    v_mfma_f32_16x16x32_bf16 a[88:91], v[88:91], v[32:35], a[88:91]
    ds_read_b64_tr_b16 v[80:81], v6 offset:40960
    ds_read_b64_tr_b16 v[82:83], v6 offset:45056
    s_waitcnt lgkmcnt(6)
    v_mfma_f32_16x16x32_bf16 a[92:95], v[92:95], v[32:35], a[92:95]
    ds_read_b64_tr_b16 v[84:85], v7 offset:40960
    ds_read_b64_tr_b16 v[86:87], v7 offset:45056
    s_waitcnt lgkmcnt(6)
    v_mfma_f32_16x16x32_bf16 a[64:67], v[72:75], v[44:47], a[64:67]
    ds_read_b64_tr_b16 v[88:89], v8 offset:40960
    ds_read_b64_tr_b16 v[90:91], v8 offset:45056
    s_waitcnt lgkmcnt(6)
    v_mfma_f32_16x16x32_bf16 a[68:71], v[76:79], v[44:47], a[68:71]
    ds_read_b64_tr_b16 v[92:93], v9 offset:40960
    ds_read_b64_tr_b16 v[94:95], v9 offset:45056
    s_waitcnt lgkmcnt(6)
    v_mfma_f32_16x16x32_bf16 a[72:75], v[80:83], v[44:47], a[72:75]
    ds_read_b64_tr_b16 v[72:73], v10 offset:40960
    ds_read_b64_tr_b16 v[74:75], v10 offset:45056
    s_waitcnt lgkmcnt(6)
    v_mfma_f32_16x16x32_bf16 a[76:79], v[84:87], v[44:47], a[76:79]
    ds_read_b64_tr_b16 v[76:77], v11 offset:40960
    ds_read_b64_tr_b16 v[78:79], v11 offset:45056
    s_waitcnt vmcnt(10)
    s_waitcnt lgkmcnt(6)
    v_mfma_f32_16x16x32_bf16 a[80:83], v[88:91], v[44:47], a[80:83]
    ds_read_b64_tr_b16 v[80:81], v4 offset:49152
    ds_read_b64_tr_b16 v[82:83], v4 offset:53248
    s_waitcnt lgkmcnt(6)
    v_mfma_f32_16x16x32_bf16 a[84:87], v[92:95], v[44:47], a[84:87]
    ds_read_b64_tr_b16 v[84:85], v5 offset:49152
    ds_read_b64_tr_b16 v[86:87], v5 offset:53248
    s_waitcnt lgkmcnt(6)
    v_mfma_f32_16x16x32_bf16 a[88:91], v[72:75], v[44:47], a[88:91]
    ds_read_b64_tr_b16 v[88:89], v6 offset:49152
    ds_read_b64_tr_b16 v[90:91], v6 offset:53248
    s_waitcnt lgkmcnt(6)
    v_mfma_f32_16x16x32_bf16 a[92:95], v[76:79], v[44:47], a[92:95]
    ds_read_b64_tr_b16 v[92:93], v7 offset:49152
    ds_read_b64_tr_b16 v[94:95], v7 offset:53248
    s_lshr_b32 s52, s51, 1
    s_mul_i32 s52, s52, 36864
    s_and_b32 s48, s51, 1
    s_lshl_b32 s48, s48, 11
    s_add_u32 s52, s52, s48
    s_add_u32 s51, s51, 1
    s_and_b32 s51, s51, 7
    s_add_u32 s48, s98, s52
    buffer_load_dwordx4 v[32:35], v0, s[28:31], s48 offen offset:0 sc1
    s_add_u32 s48, s98, s52
    buffer_load_dwordx4 v[44:47], v0, s[28:31], s48 offen offset:1024 sc1
    s_waitcnt lgkmcnt(6)
    v_mfma_f32_16x16x32_bf16 a[64:67], v[80:83], v[56:59], a[64:67]
    ds_read_b64_tr_b16 v[72:73], v8 offset:49152
    ds_read_b64_tr_b16 v[74:75], v8 offset:53248
    s_waitcnt lgkmcnt(6)
    v_mfma_f32_16x16x32_bf16 a[68:71], v[84:87], v[56:59], a[68:71]
    ds_read_b64_tr_b16 v[76:77], v9 offset:49152
    ds_read_b64_tr_b16 v[78:79], v9 offset:53248
    s_waitcnt lgkmcnt(6)
    v_mfma_f32_16x16x32_bf16 a[72:75], v[88:91], v[56:59], a[72:75]
    ds_read_b64_tr_b16 v[80:81], v10 offset:49152
    ds_read_b64_tr_b16 v[82:83], v10 offset:53248
    s_waitcnt lgkmcnt(6)
    v_mfma_f32_16x16x32_bf16 a[76:79], v[92:95], v[56:59], a[76:79]
    ds_read_b64_tr_b16 v[84:85], v11 offset:49152
    ds_read_b64_tr_b16 v[86:87], v11 offset:53248
    s_waitcnt lgkmcnt(6)
    v_mfma_f32_16x16x32_bf16 a[80:83], v[72:75], v[56:59], a[80:83]
    ds_read_b64_tr_b16 v[88:89], v4 offset:57344
    ds_read_b64_tr_b16 v[90:91], v4 offset:61440
    s_waitcnt lgkmcnt(6)
    v_mfma_f32_16x16x32_bf16 a[84:87], v[76:79], v[56:59], a[84:87]
    ds_read_b64_tr_b16 v[92:93], v5 offset:57344
    ds_read_b64_tr_b16 v[94:95], v5 offset:61440
    s_waitcnt lgkmcnt(6)
    v_mfma_f32_16x16x32_bf16 a[88:91], v[80:83], v[56:59], a[88:91]
    ds_read_b64_tr_b16 v[72:73], v6 offset:57344
    ds_read_b64_tr_b16 v[74:75], v6 offset:61440
    s_waitcnt lgkmcnt(6)
    v_mfma_f32_16x16x32_bf16 a[92:95], v[84:87], v[56:59], a[92:95]
    ds_read_b64_tr_b16 v[76:77], v7 offset:57344
    ds_read_b64_tr_b16 v[78:79], v7 offset:61440
    s_waitcnt lgkmcnt(6)
    v_mfma_f32_16x16x32_bf16 a[64:67], v[88:91], v[68:71], a[64:67]
    ds_read_b64_tr_b16 v[80:81], v8 offset:57344
    ds_read_b64_tr_b16 v[82:83], v8 offset:61440
    s_waitcnt lgkmcnt(6)
    v_mfma_f32_16x16x32_bf16 a[68:71], v[92:95], v[68:71], a[68:71]
    ds_read_b64_tr_b16 v[84:85], v9 offset:57344
    ds_read_b64_tr_b16 v[86:87], v9 offset:61440
    s_waitcnt lgkmcnt(6)
    v_mfma_f32_16x16x32_bf16 a[72:75], v[72:75], v[68:71], a[72:75]
    ds_read_b64_tr_b16 v[88:89], v10 offset:57344
    ds_read_b64_tr_b16 v[90:91], v10 offset:61440
    s_waitcnt lgkmcnt(6)
    v_mfma_f32_16x16x32_bf16 a[76:79], v[76:79], v[68:71], a[76:79]
    ds_read_b64_tr_b16 v[92:93], v11 offset:57344
    ds_read_b64_tr_b16 v[94:95], v11 offset:61440
    s_waitcnt vmcnt(4)
    s_waitcnt lgkmcnt(0)
    s_barrier
    v_mfma_f32_16x16x32_bf16 a[80:83], v[80:83], v[68:71], a[80:83]
    ds_read_b64_tr_b16 v[72:73], v12 offset:0
    ds_read_b64_tr_b16 v[74:75], v12 offset:4096
    v_mfma_f32_16x16x32_bf16 a[84:87], v[84:87], v[68:71], a[84:87]
    ds_read_b64_tr_b16 v[76:77], v13 offset:0
    ds_read_b64_tr_b16 v[78:79], v13 offset:4096
    v_mfma_f32_16x16x32_bf16 a[88:91], v[88:91], v[68:71], a[88:91]
    ds_read_b64_tr_b16 v[80:81], v14 offset:0
    ds_read_b64_tr_b16 v[82:83], v14 offset:4096
    v_mfma_f32_16x16x32_bf16 a[92:95], v[92:95], v[68:71], a[92:95]
    ds_read_b64_tr_b16 v[84:85], v15 offset:0
    ds_read_b64_tr_b16 v[86:87], v15 offset:4096
    s_lshr_b32 s52, s51, 1
    s_mul_i32 s52, s52, 36864
    s_and_b32 s48, s51, 1
    s_lshl_b32 s48, s48, 11
    s_add_u32 s52, s52, s48
    s_add_u32 s51, s51, 1
    s_and_b32 s51, s51, 7
    s_add_u32 s48, s98, s52
    buffer_load_dwordx4 v[56:59], v0, s[28:31], s48 offen offset:0 sc1
    s_add_u32 s48, s98, s52
    buffer_load_dwordx4 v[68:71], v0, s[28:31], s48 offen offset:1024 sc1
    s_waitcnt lgkmcnt(6)
    v_mfma_f32_16x16x32_bf16 a[64:67], v[72:75], a[104:107], a[64:67]
    ds_read_b64_tr_b16 v[88:89], v16 offset:0
    ds_read_b64_tr_b16 v[90:91], v16 offset:4096
    s_waitcnt lgkmcnt(6)
    v_mfma_f32_16x16x32_bf16 a[68:71], v[76:79], a[104:107], a[68:71]
    ds_read_b64_tr_b16 v[92:93], v17 offset:0
    ds_read_b64_tr_b16 v[94:95], v17 offset:4096
    s_waitcnt lgkmcnt(6)
    v_mfma_f32_16x16x32_bf16 a[72:75], v[80:83], a[104:107], a[72:75]
    ds_read_b64_tr_b16 v[72:73], v18 offset:0
    ds_read_b64_tr_b16 v[74:75], v18 offset:4096
    s_waitcnt lgkmcnt(6)
    v_mfma_f32_16x16x32_bf16 a[76:79], v[84:87], a[104:107], a[76:79]
    ds_read_b64_tr_b16 v[76:77], v19 offset:0
    ds_read_b64_tr_b16 v[78:79], v19 offset:4096
    s_waitcnt lgkmcnt(6)
    v_mfma_f32_16x16x32_bf16 a[80:83], v[88:91], a[104:107], a[80:83]
    ds_read_b64_tr_b16 v[80:81], v12 offset:8192
    ds_read_b64_tr_b16 v[82:83], v12 offset:12288
    s_waitcnt lgkmcnt(6)
    v_mfma_f32_16x16x32_bf16 a[84:87], v[92:95], a[104:107], a[84:87]
    ds_read_b64_tr_b16 v[84:85], v13 offset:8192
    ds_read_b64_tr_b16 v[86:87], v13 offset:12288
    s_waitcnt lgkmcnt(6)
    v_mfma_f32_16x16x32_bf16 a[88:91], v[72:75], a[104:107], a[88:91]
    ds_read_b64_tr_b16 v[88:89], v14 offset:8192
    ds_read_b64_tr_b16 v[90:91], v14 offset:12288
    s_waitcnt lgkmcnt(6)
    v_mfma_f32_16x16x32_bf16 a[92:95], v[76:79], a[104:107], a[92:95]
    ds_read_b64_tr_b16 v[92:93], v15 offset:8192
    ds_read_b64_tr_b16 v[94:95], v15 offset:12288
    s_waitcnt lgkmcnt(6)
    v_mfma_f32_16x16x32_bf16 a[64:67], v[80:83], a[116:119], a[64:67]
    ds_read_b64_tr_b16 v[72:73], v16 offset:8192
    ds_read_b64_tr_b16 v[74:75], v16 offset:12288
    s_waitcnt lgkmcnt(6)
    v_mfma_f32_16x16x32_bf16 a[68:71], v[84:87], a[116:119], a[68:71]
    ds_read_b64_tr_b16 v[76:77], v17 offset:8192
    ds_read_b64_tr_b16 v[78:79], v17 offset:12288
    s_waitcnt lgkmcnt(6)
    v_mfma_f32_16x16x32_bf16 a[72:75], v[88:91], a[116:119], a[72:75]
    ds_read_b64_tr_b16 v[80:81], v18 offset:8192
    ds_read_b64_tr_b16 v[82:83], v18 offset:12288
    s_waitcnt lgkmcnt(6)
    v_mfma_f32_16x16x32_bf16 a[76:79], v[92:95], a[116:119], a[76:79]
    ds_read_b64_tr_b16 v[84:85], v19 offset:8192
    ds_read_b64_tr_b16 v[86:87], v19 offset:12288
    s_waitcnt vmcnt(4)
    s_waitcnt lgkmcnt(6)
    v_mfma_f32_16x16x32_bf16 a[80:83], v[72:75], a[116:119], a[80:83]
    ds_read_b64_tr_b16 v[88:89], v12 offset:16384
    ds_read_b64_tr_b16 v[90:91], v12 offset:20480
    s_waitcnt lgkmcnt(6)
    v_mfma_f32_16x16x32_bf16 a[84:87], v[76:79], a[116:119], a[84:87]
    ds_read_b64_tr_b16 v[92:93], v13 offset:16384
    ds_read_b64_tr_b16 v[94:95], v13 offset:20480
    s_waitcnt lgkmcnt(6)
    v_mfma_f32_16x16x32_bf16 a[88:91], v[80:83], a[116:119], a[88:91]
    ds_read_b64_tr_b16 v[72:73], v14 offset:16384
    ds_read_b64_tr_b16 v[74:75], v14 offset:20480
    s_waitcnt lgkmcnt(6)
    v_mfma_f32_16x16x32_bf16 a[92:95], v[84:87], a[116:119], a[92:95]
    ds_read_b64_tr_b16 v[76:77], v15 offset:16384
    ds_read_b64_tr_b16 v[78:79], v15 offset:20480
    s_waitcnt lgkmcnt(6)
    v_mfma_f32_16x16x32_bf16 a[64:67], v[88:91], a[128:131], a[64:67]
    ds_read_b64_tr_b16 v[80:81], v16 offset:16384
    ds_read_b64_tr_b16 v[82:83], v16 offset:20480
    s_waitcnt lgkmcnt(6)
    v_mfma_f32_16x16x32_bf16 a[68:71], v[92:95], a[128:131], a[68:71]
    ds_read_b64_tr_b16 v[84:85], v17 offset:16384
    ds_read_b64_tr_b16 v[86:87], v17 offset:20480
    s_waitcnt lgkmcnt(6)
    v_mfma_f32_16x16x32_bf16 a[72:75], v[72:75], a[128:131], a[72:75]
    ds_read_b64_tr_b16 v[88:89], v18 offset:16384
    ds_read_b64_tr_b16 v[90:91], v18 offset:20480
    s_waitcnt lgkmcnt(6)
    v_mfma_f32_16x16x32_bf16 a[76:79], v[76:79], a[128:131], a[76:79]
    ds_read_b64_tr_b16 v[92:93], v19 offset:16384
    ds_read_b64_tr_b16 v[94:95], v19 offset:20480
    s_waitcnt lgkmcnt(6)
    v_mfma_f32_16x16x32_bf16 a[80:83], v[80:83], a[128:131], a[80:83]
    ds_read_b64_tr_b16 v[72:73], v12 offset:24576
    ds_read_b64_tr_b16 v[74:75], v12 offset:28672
    s_waitcnt lgkmcnt(6)
    v_mfma_f32_16x16x32_bf16 a[84:87], v[84:87], a[128:131], a[84:87]
    ds_read_b64_tr_b16 v[76:77], v13 offset:24576
    ds_read_b64_tr_b16 v[78:79], v13 offset:28672
    s_waitcnt lgkmcnt(6)
    v_mfma_f32_16x16x32_bf16 a[88:91], v[88:91], a[128:131], a[88:91]
    ds_read_b64_tr_b16 v[80:81], v14 offset:24576
    ds_read_b64_tr_b16 v[82:83], v14 offset:28672
    s_waitcnt lgkmcnt(6)
    v_mfma_f32_16x16x32_bf16 a[92:95], v[92:95], a[128:131], a[92:95]
    ds_read_b64_tr_b16 v[84:85], v15 offset:24576
    ds_read_b64_tr_b16 v[86:87], v15 offset:28672
    s_waitcnt lgkmcnt(6)
    v_mfma_f32_16x16x32_bf16 a[64:67], v[72:75], a[140:143], a[64:67]
    ds_read_b64_tr_b16 v[88:89], v16 offset:24576
    ds_read_b64_tr_b16 v[90:91], v16 offset:28672
    s_waitcnt lgkmcnt(6)
    v_mfma_f32_16x16x32_bf16 a[68:71], v[76:79], a[140:143], a[68:71]
    ds_read_b64_tr_b16 v[92:93], v17 offset:24576
    ds_read_b64_tr_b16 v[94:95], v17 offset:28672
    s_waitcnt lgkmcnt(6)
    v_mfma_f32_16x16x32_bf16 a[72:75], v[80:83], a[140:143], a[72:75]
    ds_read_b64_tr_b16 v[72:73], v18 offset:24576
    ds_read_b64_tr_b16 v[74:75], v18 offset:28672
    s_waitcnt lgkmcnt(6)
    v_mfma_f32_16x16x32_bf16 a[76:79], v[84:87], a[140:143], a[76:79]
    ds_read_b64_tr_b16 v[76:77], v19 offset:24576
    ds_read_b64_tr_b16 v[78:79], v19 offset:28672
    s_waitcnt vmcnt(2)
    s_waitcnt lgkmcnt(6)
    v_mfma_f32_16x16x32_bf16 a[80:83], v[88:91], a[140:143], a[80:83]
    ds_read_b64_tr_b16 v[80:81], v12 offset:32768
    ds_read_b64_tr_b16 v[82:83], v12 offset:36864
    s_waitcnt lgkmcnt(6)
    v_mfma_f32_16x16x32_bf16 a[84:87], v[92:95], a[140:143], a[84:87]
    ds_read_b64_tr_b16 v[84:85], v13 offset:32768
    ds_read_b64_tr_b16 v[86:87], v13 offset:36864
    s_waitcnt lgkmcnt(6)
    v_mfma_f32_16x16x32_bf16 a[88:91], v[72:75], a[140:143], a[88:91]
    ds_read_b64_tr_b16 v[88:89], v14 offset:32768
    ds_read_b64_tr_b16 v[90:91], v14 offset:36864
    s_waitcnt lgkmcnt(6)
    v_mfma_f32_16x16x32_bf16 a[92:95], v[76:79], a[140:143], a[92:95]
    ds_read_b64_tr_b16 v[92:93], v15 offset:32768
    ds_read_b64_tr_b16 v[94:95], v15 offset:36864
    s_waitcnt lgkmcnt(6)
    v_mfma_f32_16x16x32_bf16 a[64:67], v[80:83], v[32:35], a[64:67]
    ds_read_b64_tr_b16 v[72:73], v16 offset:32768
    ds_read_b64_tr_b16 v[74:75], v16 offset:36864
    s_waitcnt lgkmcnt(6)
    v_mfma_f32_16x16x32_bf16 a[68:71], v[84:87], v[32:35], a[68:71]
    ds_read_b64_tr_b16 v[76:77], v17 offset:32768
    ds_read_b64_tr_b16 v[78:79], v17 offset:36864
    s_waitcnt lgkmcnt(6)
    v_mfma_f32_16x16x32_bf16 a[72:75], v[88:91], v[32:35], a[72:75]
    ds_read_b64_tr_b16 v[80:81], v18 offset:32768
    ds_read_b64_tr_b16 v[82:83], v18 offset:36864
    s_waitcnt lgkmcnt(6)
    v_mfma_f32_16x16x32_bf16 a[76:79], v[92:95], v[32:35], a[76:79]
    ds_read_b64_tr_b16 v[84:85], v19 offset:32768
    ds_read_b64_tr_b16 v[86:87], v19 offset:36864
    s_waitcnt lgkmcnt(6)
    v_mfma_f32_16x16x32_bf16 a[80:83], v[72:75], v[32:35], a[80:83]
    ds_read_b64_tr_b16 v[88:89], v12 offset:40960
    ds_read_b64_tr_b16 v[90:91], v12 offset:45056
    s_waitcnt lgkmcnt(6)
    v_mfma_f32_16x16x32_bf16 a[84:87], v[76:79], v[32:35], a[84:87]
    ds_read_b64_tr_b16 v[92:93], v13 offset:40960
    ds_read_b64_tr_b16 v[94:95], v13 offset:45056
    s_waitcnt lgkmcnt(6)
    v_mfma_f32_16x16x32_bf16 a[88:91], v[80:83], v[32:35], a[88:91]
    ds_read_b64_tr_b16 v[72:73], v14 offset:40960
    ds_read_b64_tr_b16 v[74:75], v14 offset:45056
    s_waitcnt lgkmcnt(6)
    v_mfma_f32_16x16x32_bf16 a[92:95], v[84:87], v[32:35], a[92:95]
    ds_read_b64_tr_b16 v[76:77], v15 offset:40960
    ds_read_b64_tr_b16 v[78:79], v15 offset:45056
    s_waitcnt lgkmcnt(6)
    v_mfma_f32_16x16x32_bf16 a[64:67], v[88:91], v[44:47], a[64:67]
    ds_read_b64_tr_b16 v[80:81], v16 offset:40960
    ds_read_b64_tr_b16 v[82:83], v16 offset:45056
    s_waitcnt lgkmcnt(6)
    v_mfma_f32_16x16x32_bf16 a[68:71], v[92:95], v[44:47], a[68:71]
    ds_read_b64_tr_b16 v[84:85], v17 offset:40960
    ds_read_b64_tr_b16 v[86:87], v17 offset:45056
    s_waitcnt lgkmcnt(6)
    v_mfma_f32_16x16x32_bf16 a[72:75], v[72:75], v[44:47], a[72:75]
    ds_read_b64_tr_b16 v[88:89], v18 offset:40960
    ds_read_b64_tr_b16 v[90:91], v18 offset:45056
    s_waitcnt lgkmcnt(6)
    v_mfma_f32_16x16x32_bf16 a[76:79], v[76:79], v[44:47], a[76:79]
    ds_read_b64_tr_b16 v[92:93], v19 offset:40960
    ds_read_b64_tr_b16 v[94:95], v19 offset:45056
    s_waitcnt vmcnt(0)
    s_waitcnt lgkmcnt(6)
    v_mfma_f32_16x16x32_bf16 a[80:83], v[80:83], v[44:47], a[80:83]
    ds_read_b64_tr_b16 v[72:73], v12 offset:49152
    ds_read_b64_tr_b16 v[74:75], v12 offset:53248
    s_waitcnt lgkmcnt(6)
    v_mfma_f32_16x16x32_bf16 a[84:87], v[84:87], v[44:47], a[84:87]
    ds_read_b64_tr_b16 v[76:77], v13 offset:49152
    ds_read_b64_tr_b16 v[78:79], v13 offset:53248
    s_waitcnt lgkmcnt(6)
    v_mfma_f32_16x16x32_bf16 a[88:91], v[88:91], v[44:47], a[88:91]
    ds_read_b64_tr_b16 v[80:81], v14 offset:49152
    ds_read_b64_tr_b16 v[82:83], v14 offset:53248
    s_waitcnt lgkmcnt(6)
    v_mfma_f32_16x16x32_bf16 a[92:95], v[92:95], v[44:47], a[92:95]
    ds_read_b64_tr_b16 v[84:85], v15 offset:49152
    ds_read_b64_tr_b16 v[86:87], v15 offset:53248
    s_waitcnt lgkmcnt(6)
    v_mfma_f32_16x16x32_bf16 a[64:67], v[72:75], v[56:59], a[64:67]
    ds_read_b64_tr_b16 v[88:89], v16 offset:49152
    ds_read_b64_tr_b16 v[90:91], v16 offset:53248
    s_waitcnt lgkmcnt(6)
    v_mfma_f32_16x16x32_bf16 a[68:71], v[76:79], v[56:59], a[68:71]
    ds_read_b64_tr_b16 v[92:93], v17 offset:49152
    ds_read_b64_tr_b16 v[94:95], v17 offset:53248
    s_waitcnt lgkmcnt(6)
    v_mfma_f32_16x16x32_bf16 a[72:75], v[80:83], v[56:59], a[72:75]
    ds_read_b64_tr_b16 v[72:73], v18 offset:49152
    ds_read_b64_tr_b16 v[74:75], v18 offset:53248
    s_waitcnt lgkmcnt(6)
    v_mfma_f32_16x16x32_bf16 a[76:79], v[84:87], v[56:59], a[76:79]
    ds_read_b64_tr_b16 v[76:77], v19 offset:49152
    ds_read_b64_tr_b16 v[78:79], v19 offset:53248
    s_waitcnt lgkmcnt(6)
    v_mfma_f32_16x16x32_bf16 a[80:83], v[88:91], v[56:59], a[80:83]
    ds_read_b64_tr_b16 v[80:81], v12 offset:57344
    ds_read_b64_tr_b16 v[82:83], v12 offset:61440
    s_waitcnt lgkmcnt(6)
    v_mfma_f32_16x16x32_bf16 a[84:87], v[92:95], v[56:59], a[84:87]
    ds_read_b64_tr_b16 v[84:85], v13 offset:57344
    ds_read_b64_tr_b16 v[86:87], v13 offset:61440
    s_waitcnt lgkmcnt(6)
    v_mfma_f32_16x16x32_bf16 a[88:91], v[72:75], v[56:59], a[88:91]
    ds_read_b64_tr_b16 v[88:89], v14 offset:57344
    ds_read_b64_tr_b16 v[90:91], v14 offset:61440
    s_waitcnt lgkmcnt(6)
    v_mfma_f32_16x16x32_bf16 a[92:95], v[76:79], v[56:59], a[92:95]
    ds_read_b64_tr_b16 v[92:93], v15 offset:57344
    ds_read_b64_tr_b16 v[94:95], v15 offset:61440
    s_waitcnt lgkmcnt(6)
    v_mfma_f32_16x16x32_bf16 a[64:67], v[80:83], v[68:71], a[64:67]
    ds_read_b64_tr_b16 v[72:73], v16 offset:57344
    ds_read_b64_tr_b16 v[74:75], v16 offset:61440
    s_waitcnt lgkmcnt(6)
    v_mfma_f32_16x16x32_bf16 a[68:71], v[84:87], v[68:71], a[68:71]
    ds_read_b64_tr_b16 v[76:77], v17 offset:57344
    ds_read_b64_tr_b16 v[78:79], v17 offset:61440
    s_waitcnt lgkmcnt(6)
    v_mfma_f32_16x16x32_bf16 a[72:75], v[88:91], v[68:71], a[72:75]
    ds_read_b64_tr_b16 v[80:81], v18 offset:57344
    ds_read_b64_tr_b16 v[82:83], v18 offset:61440
    s_waitcnt lgkmcnt(6)
    v_mfma_f32_16x16x32_bf16 a[76:79], v[92:95], v[68:71], a[76:79]
    ds_read_b64_tr_b16 v[84:85], v19 offset:57344
    ds_read_b64_tr_b16 v[86:87], v19 offset:61440
    s_waitcnt lgkmcnt(6)
    v_mfma_f32_16x16x32_bf16 a[80:83], v[72:75], v[68:71], a[80:83]
    s_waitcnt lgkmcnt(4)
    v_mfma_f32_16x16x32_bf16 a[84:87], v[76:79], v[68:71], a[84:87]
    s_waitcnt lgkmcnt(2)
    v_mfma_f32_16x16x32_bf16 a[88:91], v[80:83], v[68:71], a[88:91]
    s_waitcnt lgkmcnt(0)
    v_mfma_f32_16x16x32_bf16 a[92:95], v[84:87], v[68:71], a[92:95]
    s_cmp_eq_u32 s3, 1
    s_cbranch_scc1 L_xw1b
    s_cmp_eq_u32 s3, 2
    s_cbranch_scc1 L_xw2b
    s_cmp_eq_u32 s3, 3
    s_cbranch_scc1 L_xw3b
L_xw0b:
    s_lshl_b32 s84, s62, 2
    s_mul_i32 s84, s84, 30
    s_add_u32 s84, s84, s60
    s_lshl_b32 s84, s84, 2
    s_add_u32 s84, s84, s3
    s_mul_i32 s84, s84, 12288
    s_add_u32 s84, s84, 18874368
    s_add_u32 s32, s4, s84
    s_addc_u32 s33, s5, 0
    s_mov_b32 s34, 4435968
    s_mov_b32 s35, 0x20000
    s_mul_i32 s85, s61, 1474560
    s_load_dwordx2 s[8:9], s[0:1], 80
    s_nop 7
    s_cmp_lg_u32 s61, 0
    s_cbranch_scc1 L_x0_0b
    v_accvgpr_read_b32 v24, a72
    v_accvgpr_read_b32 v25, a73
    v_accvgpr_read_b32 v26, a74
    v_accvgpr_read_b32 v27, a75
    v_accvgpr_read_b32 v28, a76
    v_accvgpr_read_b32 v29, a77
    v_accvgpr_read_b32 v30, a78
    v_accvgpr_read_b32 v31, a79
    v_cvt_pk_bf16_f32 v24, v24, v25
    v_cvt_pk_bf16_f32 v25, v26, v27
    v_cvt_pk_bf16_f32 v26, v28, v29
    v_cvt_pk_bf16_f32 v27, v30, v31
    s_add_u32 s48, s85, 5120
    buffer_store_dwordx4 v[24:27], v0, s[32:35], s48 offen sc1
    v_accvgpr_read_b32 v32, a80
    v_accvgpr_read_b32 v33, a81
    v_accvgpr_read_b32 v34, a82
    v_accvgpr_read_b32 v35, a83
    v_accvgpr_read_b32 v36, a84
    v_accvgpr_read_b32 v37, a85
    v_accvgpr_read_b32 v38, a86
    v_accvgpr_read_b32 v39, a87
    v_cvt_pk_bf16_f32 v32, v32, v33
    v_cvt_pk_bf16_f32 v33, v34, v35
    v_cvt_pk_bf16_f32 v34, v36, v37
    v_cvt_pk_bf16_f32 v35, v38, v39
    s_add_u32 s48, s85, 8192
    buffer_store_dwordx4 v[32:35], v0, s[32:35], s48 offen sc1
    v_accvgpr_read_b32 v40, a88
    v_accvgpr_read_b32 v41, a89
    v_accvgpr_read_b32 v42, a90
    v_accvgpr_read_b32 v43, a91
    v_accvgpr_read_b32 v44, a92
    v_accvgpr_read_b32 v45, a93
    v_accvgpr_read_b32 v46, a94
    v_accvgpr_read_b32 v47, a95
    v_cvt_pk_bf16_f32 v40, v40, v41
    v_cvt_pk_bf16_f32 v41, v42, v43
    v_cvt_pk_bf16_f32 v42, v44, v45
    v_cvt_pk_bf16_f32 v43, v46, v47
    s_add_u32 s48, s85, 11264
    buffer_store_dwordx4 v[40:43], v0, s[32:35], s48 offen sc1
    s_mul_i32 s86, s63, 12
    s_add_u32 s86, s86, 0
    s_mul_i32 s86, s86, 40960
    s_mul_i32 s87, s62, 1280
    s_add_u32 s86, s86, s87
    s_lshl_b32 s87, s64, 8
    s_add_u32 s86, s86, s87
    s_add_u32 s86, s86, 0
    s_waitcnt vmcnt(0) lgkmcnt(0)
    s_barrier
    s_cmp_lg_u32 s7, 0
    s_cbranch_scc1 L_pub18
    s_and_b32 s48, s2, 7
    s_lshl_b32 s48, s48, 5
    s_lshr_b32 s49, s2, 3
    s_add_u32 s48, s48, s49
    v_mov_b32 v2, s48
    v_mov_b32 v3, 3
    s_mov_b64 exec, 1
    global_store_byte v2, v3, s[22:23] sc1
    s_mov_b64 exec, -1
L_pub18:
    s_mov_b32 s12, s8
    s_mov_b32 s13, s9
    s_mov_b32 s14, 2949120
    s_mov_b32 s15, 0x20000
    s_cmp_lg_u32 s7, 0
    s_cbranch_scc1 L_xp0_0b_skip
    s_lshl_b32 s48, s62, 7
    s_add_u32 s48, s48, s60
    v_and_b32 v2, 3, v1
    v_lshlrev_b32 v2, 5, v2
    v_add_u32 v2, s48, v2
    s_mov_b32 s69, 0
L_xp0_0b_poll:
    global_load_ubyte v3, v2, s[22:23] sc1
    s_add_u32 s69, s69, 1
    s_waitcnt vmcnt(0)
    v_cmp_gt_u32 vcc, 3, v3
    s_cmp_ge_u32 s69, 131072
    s_cbranch_scc1 L_xp0_0b_skip
    s_nop 2
    s_cbranch_vccz L_xp0_0b_skip
    s_sleep 1
    s_branch L_xp0_0b_poll
L_xp0_0b_skip:
    s_barrier
    s_mov_b32 s48, 1476608
    buffer_load_dwordx4 v[32:35], v0, s[32:35], s48 offen sc1
    s_mov_b32 s48, 2951168
    buffer_load_dwordx4 v[44:47], v0, s[32:35], s48 offen sc1
    s_mov_b32 s48, 4425728
    buffer_load_dwordx4 v[56:59], v0, s[32:35], s48 offen sc1
    v_and_b32 v2, 15, v1
    v_mul_u32_u24 v2, 2560, v2
    v_lshrrev_b32 v3, 4, v1
    v_lshl_add_u32 v2, v3, 3, v2
    v_accvgpr_read_b32 v80, a64
    v_accvgpr_read_b32 v81, a65
    v_accvgpr_read_b32 v82, a66
    v_accvgpr_read_b32 v83, a67
    s_waitcnt vmcnt(2)
    v_lshlrev_b32 v22, 16, v32
    v_and_b32 v23, 0xffff0000, v32
    v_add_f32 v80, v80, v22
    v_add_f32 v81, v81, v23
    v_lshlrev_b32 v22, 16, v33
    v_and_b32 v23, 0xffff0000, v33
    v_add_f32 v82, v82, v22
    v_add_f32 v83, v83, v23
    s_waitcnt vmcnt(1)
    v_lshlrev_b32 v22, 16, v44
    v_and_b32 v23, 0xffff0000, v44
    v_add_f32 v80, v80, v22
    v_add_f32 v81, v81, v23
    v_lshlrev_b32 v22, 16, v45
    v_and_b32 v23, 0xffff0000, v45
    v_add_f32 v82, v82, v22
    v_add_f32 v83, v83, v23
    s_waitcnt vmcnt(0)
    v_lshlrev_b32 v22, 16, v56
    v_and_b32 v23, 0xffff0000, v56
    v_add_f32 v80, v80, v22
    v_add_f32 v81, v81, v23
    v_lshlrev_b32 v22, 16, v57
    v_and_b32 v23, 0xffff0000, v57
    v_add_f32 v82, v82, v22
    v_add_f32 v83, v83, v23
    v_cvt_pk_bf16_f32 v80, v80, v81
    v_cvt_pk_bf16_f32 v81, v82, v83
    s_add_u32 s48, s86, 81920
    buffer_store_dwordx2 v[80:81], v2, s[12:15], s48 offen offset:0
    v_accvgpr_read_b32 v84, a68
    v_accvgpr_read_b32 v85, a69
    v_accvgpr_read_b32 v86, a70
    v_accvgpr_read_b32 v87, a71
    v_lshlrev_b32 v22, 16, v34
    v_and_b32 v23, 0xffff0000, v34
    v_add_f32 v84, v84, v22
    v_add_f32 v85, v85, v23
    v_lshlrev_b32 v22, 16, v35
    v_and_b32 v23, 0xffff0000, v35
    v_add_f32 v86, v86, v22
    v_add_f32 v87, v87, v23
    v_lshlrev_b32 v22, 16, v46
    v_and_b32 v23, 0xffff0000, v46
    v_add_f32 v84, v84, v22
    v_add_f32 v85, v85, v23
    v_lshlrev_b32 v22, 16, v47
    v_and_b32 v23, 0xffff0000, v47
    v_add_f32 v86, v86, v22
    v_add_f32 v87, v87, v23
    v_lshlrev_b32 v22, 16, v58
    v_and_b32 v23, 0xffff0000, v58
    v_add_f32 v84, v84, v22
    v_add_f32 v85, v85, v23
    v_lshlrev_b32 v22, 16, v59
    v_and_b32 v23, 0xffff0000, v59
    v_add_f32 v86, v86, v22
    v_add_f32 v87, v87, v23
    v_cvt_pk_bf16_f32 v84, v84, v85
    v_cvt_pk_bf16_f32 v85, v86, v87
    s_add_u32 s48, s86, 81920
    buffer_store_dwordx2 v[84:85], v2, s[12:15], s48 offen offset:32
    s_branch L_end2
L_x0_0b:
    s_cmp_lg_u32 s61, 1
    s_cbranch_scc1 L_x0_1b
    v_accvgpr_read_b32 v24, a64
    v_accvgpr_read_b32 v25, a65
    v_accvgpr_read_b32 v26, a66
    v_accvgpr_read_b32 v27, a67
    v_accvgpr_read_b32 v28, a68
    v_accvgpr_read_b32 v29, a69
    v_accvgpr_read_b32 v30, a70
    v_accvgpr_read_b32 v31, a71
    v_cvt_pk_bf16_f32 v24, v24, v25
    v_cvt_pk_bf16_f32 v25, v26, v27
    v_cvt_pk_bf16_f32 v26, v28, v29
    v_cvt_pk_bf16_f32 v27, v30, v31
    s_add_u32 s48, s85, 2048
    buffer_store_dwordx4 v[24:27], v0, s[32:35], s48 offen sc1
    v_accvgpr_read_b32 v32, a80
    v_accvgpr_read_b32 v33, a81
    v_accvgpr_read_b32 v34, a82
    v_accvgpr_read_b32 v35, a83
    v_accvgpr_read_b32 v36, a84
    v_accvgpr_read_b32 v37, a85
    v_accvgpr_read_b32 v38, a86
    v_accvgpr_read_b32 v39, a87
    v_cvt_pk_bf16_f32 v32, v32, v33
    v_cvt_pk_bf16_f32 v33, v34, v35
    v_cvt_pk_bf16_f32 v34, v36, v37
    v_cvt_pk_bf16_f32 v35, v38, v39
    s_add_u32 s48, s85, 8192
    buffer_store_dwordx4 v[32:35], v0, s[32:35], s48 offen sc1
    v_accvgpr_read_b32 v40, a88
    v_accvgpr_read_b32 v41, a89
    v_accvgpr_read_b32 v42, a90
    v_accvgpr_read_b32 v43, a91
    v_accvgpr_read_b32 v44, a92
    v_accvgpr_read_b32 v45, a93
    v_accvgpr_read_b32 v46, a94
    v_accvgpr_read_b32 v47, a95
    v_cvt_pk_bf16_f32 v40, v40, v41
    v_cvt_pk_bf16_f32 v41, v42, v43
    v_cvt_pk_bf16_f32 v42, v44, v45
    v_cvt_pk_bf16_f32 v43, v46, v47
    s_add_u32 s48, s85, 11264
    buffer_store_dwordx4 v[40:43], v0, s[32:35], s48 offen sc1
    s_mul_i32 s86, s63, 12
    s_add_u32 s86, s86, 0
    s_mul_i32 s86, s86, 40960
    s_mul_i32 s87, s62, 1280
    s_add_u32 s86, s86, s87
    s_lshl_b32 s87, s64, 8
    s_add_u32 s86, s86, s87
    s_add_u32 s86, s86, 64
    s_waitcnt vmcnt(0) lgkmcnt(0)
    s_barrier
    s_cmp_lg_u32 s7, 0
    s_cbranch_scc1 L_pub19
    s_and_b32 s48, s2, 7
    s_lshl_b32 s48, s48, 5
    s_lshr_b32 s49, s2, 3
    s_add_u32 s48, s48, s49
    v_mov_b32 v2, s48
    v_mov_b32 v3, 3
    s_mov_b64 exec, 1
    global_store_byte v2, v3, s[22:23] sc1
    s_mov_b64 exec, -1
L_pub19:
    s_mov_b32 s12, s8
    s_mov_b32 s13, s9
    s_mov_b32 s14, 2949120
    s_mov_b32 s15, 0x20000
    s_cmp_lg_u32 s7, 0
    s_cbranch_scc1 L_xp0_1b_skip
    s_lshl_b32 s48, s62, 7
    s_add_u32 s48, s48, s60
    v_and_b32 v2, 3, v1
    v_lshlrev_b32 v2, 5, v2
    v_add_u32 v2, s48, v2
    s_mov_b32 s69, 0
L_xp0_1b_poll:
    global_load_ubyte v3, v2, s[22:23] sc1
    s_add_u32 s69, s69, 1
    s_waitcnt vmcnt(0)
    v_cmp_gt_u32 vcc, 3, v3
    s_cmp_ge_u32 s69, 131072
    s_cbranch_scc1 L_xp0_1b_skip
    s_nop 2
    s_cbranch_vccz L_xp0_1b_skip
    s_sleep 1
    s_branch L_xp0_1b_poll
L_xp0_1b_skip:
    s_barrier
    s_mov_b32 s48, 5120
    buffer_load_dwordx4 v[32:35], v0, s[32:35], s48 offen sc1
    s_mov_b32 s48, 2954240
    buffer_load_dwordx4 v[44:47], v0, s[32:35], s48 offen sc1
    s_mov_b32 s48, 4428800
    buffer_load_dwordx4 v[56:59], v0, s[32:35], s48 offen sc1
    v_and_b32 v2, 15, v1
    v_mul_u32_u24 v2, 2560, v2
    v_lshrrev_b32 v3, 4, v1
    v_lshl_add_u32 v2, v3, 3, v2
    v_accvgpr_read_b32 v80, a72
    v_accvgpr_read_b32 v81, a73
    v_accvgpr_read_b32 v82, a74
    v_accvgpr_read_b32 v83, a75
    s_waitcnt vmcnt(2)
    v_lshlrev_b32 v22, 16, v32
    v_and_b32 v23, 0xffff0000, v32
    v_add_f32 v80, v80, v22
    v_add_f32 v81, v81, v23
    v_lshlrev_b32 v22, 16, v33
    v_and_b32 v23, 0xffff0000, v33
    v_add_f32 v82, v82, v22
    v_add_f32 v83, v83, v23
    s_waitcnt vmcnt(1)
    v_lshlrev_b32 v22, 16, v44
    v_and_b32 v23, 0xffff0000, v44
    v_add_f32 v80, v80, v22
    v_add_f32 v81, v81, v23
    v_lshlrev_b32 v22, 16, v45
    v_and_b32 v23, 0xffff0000, v45
    v_add_f32 v82, v82, v22
    v_add_f32 v83, v83, v23
    s_waitcnt vmcnt(0)
    v_lshlrev_b32 v22, 16, v56
    v_and_b32 v23, 0xffff0000, v56
    v_add_f32 v80, v80, v22
    v_add_f32 v81, v81, v23
    v_lshlrev_b32 v22, 16, v57
    v_and_b32 v23, 0xffff0000, v57
    v_add_f32 v82, v82, v22
    v_add_f32 v83, v83, v23
    v_cvt_pk_bf16_f32 v80, v80, v81
    v_cvt_pk_bf16_f32 v81, v82, v83
    s_add_u32 s48, s86, 81920
    buffer_store_dwordx2 v[80:81], v2, s[12:15], s48 offen offset:0
    v_accvgpr_read_b32 v84, a76
    v_accvgpr_read_b32 v85, a77
    v_accvgpr_read_b32 v86, a78
    v_accvgpr_read_b32 v87, a79
    v_lshlrev_b32 v22, 16, v34
    v_and_b32 v23, 0xffff0000, v34
    v_add_f32 v84, v84, v22
    v_add_f32 v85, v85, v23
    v_lshlrev_b32 v22, 16, v35
    v_and_b32 v23, 0xffff0000, v35
    v_add_f32 v86, v86, v22
    v_add_f32 v87, v87, v23
    v_lshlrev_b32 v22, 16, v46
    v_and_b32 v23, 0xffff0000, v46
    v_add_f32 v84, v84, v22
    v_add_f32 v85, v85, v23
    v_lshlrev_b32 v22, 16, v47
    v_and_b32 v23, 0xffff0000, v47
    v_add_f32 v86, v86, v22
    v_add_f32 v87, v87, v23
    v_lshlrev_b32 v22, 16, v58
    v_and_b32 v23, 0xffff0000, v58
    v_add_f32 v84, v84, v22
    v_add_f32 v85, v85, v23
    v_lshlrev_b32 v22, 16, v59
    v_and_b32 v23, 0xffff0000, v59
    v_add_f32 v86, v86, v22
    v_add_f32 v87, v87, v23
    v_cvt_pk_bf16_f32 v84, v84, v85
    v_cvt_pk_bf16_f32 v85, v86, v87
    s_add_u32 s48, s86, 81920
    buffer_store_dwordx2 v[84:85], v2, s[12:15], s48 offen offset:32
    s_branch L_end2
L_x0_1b:
    s_cmp_lg_u32 s61, 2
    s_cbranch_scc1 L_x0_2b
    v_accvgpr_read_b32 v24, a64
    v_accvgpr_read_b32 v25, a65
    v_accvgpr_read_b32 v26, a66
    v_accvgpr_read_b32 v27, a67
    v_accvgpr_read_b32 v28, a68
    v_accvgpr_read_b32 v29, a69
    v_accvgpr_read_b32 v30, a70
    v_accvgpr_read_b32 v31, a71
    v_cvt_pk_bf16_f32 v24, v24, v25
    v_cvt_pk_bf16_f32 v25, v26, v27
    v_cvt_pk_bf16_f32 v26, v28, v29
    v_cvt_pk_bf16_f32 v27, v30, v31
    s_add_u32 s48, s85, 2048
    buffer_store_dwordx4 v[24:27], v0, s[32:35], s48 offen sc1
    v_accvgpr_read_b32 v32, a72
    v_accvgpr_read_b32 v33, a73
    v_accvgpr_read_b32 v34, a74
    v_accvgpr_read_b32 v35, a75
    v_accvgpr_read_b32 v36, a76
    v_accvgpr_read_b32 v37, a77
    v_accvgpr_read_b32 v38, a78
    v_accvgpr_read_b32 v39, a79
    v_cvt_pk_bf16_f32 v32, v32, v33
    v_cvt_pk_bf16_f32 v33, v34, v35
    v_cvt_pk_bf16_f32 v34, v36, v37
    v_cvt_pk_bf16_f32 v35, v38, v39
    s_add_u32 s48, s85, 5120
    buffer_store_dwordx4 v[32:35], v0, s[32:35], s48 offen sc1
    v_accvgpr_read_b32 v40, a88
    v_accvgpr_read_b32 v41, a89
    v_accvgpr_read_b32 v42, a90
    v_accvgpr_read_b32 v43, a91
    v_accvgpr_read_b32 v44, a92
    v_accvgpr_read_b32 v45, a93
    v_accvgpr_read_b32 v46, a94
    v_accvgpr_read_b32 v47, a95
    v_cvt_pk_bf16_f32 v40, v40, v41
    v_cvt_pk_bf16_f32 v41, v42, v43
    v_cvt_pk_bf16_f32 v42, v44, v45
    v_cvt_pk_bf16_f32 v43, v46, v47
    s_add_u32 s48, s85, 11264
    buffer_store_dwordx4 v[40:43], v0, s[32:35], s48 offen sc1
    s_mul_i32 s86, s63, 12
    s_add_u32 s86, s86, 0
    s_mul_i32 s86, s86, 40960
    s_mul_i32 s87, s62, 1280
    s_add_u32 s86, s86, s87
    s_lshl_b32 s87, s64, 8
    s_add_u32 s86, s86, s87
    s_add_u32 s86, s86, 128
    s_waitcnt vmcnt(0) lgkmcnt(0)
    s_barrier
    s_cmp_lg_u32 s7, 0
    s_cbranch_scc1 L_pub20
    s_and_b32 s48, s2, 7
    s_lshl_b32 s48, s48, 5
    s_lshr_b32 s49, s2, 3
    s_add_u32 s48, s48, s49
    v_mov_b32 v2, s48
    v_mov_b32 v3, 3
    s_mov_b64 exec, 1
    global_store_byte v2, v3, s[22:23] sc1
    s_mov_b64 exec, -1
L_pub20:
    s_mov_b32 s12, s8
    s_mov_b32 s13, s9
    s_mov_b32 s14, 2949120
    s_mov_b32 s15, 0x20000
    s_cmp_lg_u32 s7, 0
    s_cbranch_scc1 L_xp0_2b_skip
    s_lshl_b32 s48, s62, 7
    s_add_u32 s48, s48, s60
    v_and_b32 v2, 3, v1
    v_lshlrev_b32 v2, 5, v2
    v_add_u32 v2, s48, v2
    s_mov_b32 s69, 0
L_xp0_2b_poll:
    global_load_ubyte v3, v2, s[22:23] sc1
    s_add_u32 s69, s69, 1
    s_waitcnt vmcnt(0)
    v_cmp_gt_u32 vcc, 3, v3
    s_cmp_ge_u32 s69, 131072
    s_cbranch_scc1 L_xp0_2b_skip
    s_nop 2
    s_cbranch_vccz L_xp0_2b_skip
    s_sleep 1
    s_branch L_xp0_2b_poll
L_xp0_2b_skip:
    s_barrier
    s_mov_b32 s48, 8192
    buffer_load_dwordx4 v[32:35], v0, s[32:35], s48 offen sc1
    s_mov_b32 s48, 1482752
    buffer_load_dwordx4 v[44:47], v0, s[32:35], s48 offen sc1
    s_mov_b32 s48, 4431872
    buffer_load_dwordx4 v[56:59], v0, s[32:35], s48 offen sc1
    v_and_b32 v2, 15, v1
    v_mul_u32_u24 v2, 2560, v2
    v_lshrrev_b32 v3, 4, v1
    v_lshl_add_u32 v2, v3, 3, v2
    v_accvgpr_read_b32 v80, a80
    v_accvgpr_read_b32 v81, a81
    v_accvgpr_read_b32 v82, a82
    v_accvgpr_read_b32 v83, a83
    s_waitcnt vmcnt(2)
    v_lshlrev_b32 v22, 16, v32
    v_and_b32 v23, 0xffff0000, v32
    v_add_f32 v80, v80, v22
    v_add_f32 v81, v81, v23
    v_lshlrev_b32 v22, 16, v33
    v_and_b32 v23, 0xffff0000, v33
    v_add_f32 v82, v82, v22
    v_add_f32 v83, v83, v23
    s_waitcnt vmcnt(1)
    v_lshlrev_b32 v22, 16, v44
    v_and_b32 v23, 0xffff0000, v44
    v_add_f32 v80, v80, v22
    v_add_f32 v81, v81, v23
    v_lshlrev_b32 v22, 16, v45
    v_and_b32 v23, 0xffff0000, v45
    v_add_f32 v82, v82, v22
    v_add_f32 v83, v83, v23
    s_waitcnt vmcnt(0)
    v_lshlrev_b32 v22, 16, v56
    v_and_b32 v23, 0xffff0000, v56
    v_add_f32 v80, v80, v22
    v_add_f32 v81, v81, v23
    v_lshlrev_b32 v22, 16, v57
    v_and_b32 v23, 0xffff0000, v57
    v_add_f32 v82, v82, v22
    v_add_f32 v83, v83, v23
    v_cvt_pk_bf16_f32 v80, v80, v81
    v_cvt_pk_bf16_f32 v81, v82, v83
    s_add_u32 s48, s86, 81920
    buffer_store_dwordx2 v[80:81], v2, s[12:15], s48 offen offset:0
    v_accvgpr_read_b32 v84, a84
    v_accvgpr_read_b32 v85, a85
    v_accvgpr_read_b32 v86, a86
    v_accvgpr_read_b32 v87, a87
    v_lshlrev_b32 v22, 16, v34
    v_and_b32 v23, 0xffff0000, v34
    v_add_f32 v84, v84, v22
    v_add_f32 v85, v85, v23
    v_lshlrev_b32 v22, 16, v35
    v_and_b32 v23, 0xffff0000, v35
    v_add_f32 v86, v86, v22
    v_add_f32 v87, v87, v23
    v_lshlrev_b32 v22, 16, v46
    v_and_b32 v23, 0xffff0000, v46
    v_add_f32 v84, v84, v22
    v_add_f32 v85, v85, v23
    v_lshlrev_b32 v22, 16, v47
    v_and_b32 v23, 0xffff0000, v47
    v_add_f32 v86, v86, v22
    v_add_f32 v87, v87, v23
    v_lshlrev_b32 v22, 16, v58
    v_and_b32 v23, 0xffff0000, v58
    v_add_f32 v84, v84, v22
    v_add_f32 v85, v85, v23
    v_lshlrev_b32 v22, 16, v59
    v_and_b32 v23, 0xffff0000, v59
    v_add_f32 v86, v86, v22
    v_add_f32 v87, v87, v23
    v_cvt_pk_bf16_f32 v84, v84, v85
    v_cvt_pk_bf16_f32 v85, v86, v87
    s_add_u32 s48, s86, 81920
    buffer_store_dwordx2 v[84:85], v2, s[12:15], s48 offen offset:32
    s_branch L_end2
L_x0_2b:
    s_cmp_lg_u32 s61, 3
    s_cbranch_scc1 L_x0_3b
    v_accvgpr_read_b32 v24, a64
    v_accvgpr_read_b32 v25, a65
    v_accvgpr_read_b32 v26, a66
    v_accvgpr_read_b32 v27, a67
    v_accvgpr_read_b32 v28, a68
    v_accvgpr_read_b32 v29, a69
    v_accvgpr_read_b32 v30, a70
    v_accvgpr_read_b32 v31, a71
    v_cvt_pk_bf16_f32 v24, v24, v25
    v_cvt_pk_bf16_f32 v25, v26, v27
    v_cvt_pk_bf16_f32 v26, v28, v29
    v_cvt_pk_bf16_f32 v27, v30, v31
    s_add_u32 s48, s85, 2048
    buffer_store_dwordx4 v[24:27], v0, s[32:35], s48 offen sc1
    v_accvgpr_read_b32 v32, a72
    v_accvgpr_read_b32 v33, a73
    v_accvgpr_read_b32 v34, a74
    v_accvgpr_read_b32 v35, a75
    v_accvgpr_read_b32 v36, a76
    v_accvgpr_read_b32 v37, a77
    v_accvgpr_read_b32 v38, a78
    v_accvgpr_read_b32 v39, a79
    v_cvt_pk_bf16_f32 v32, v32, v33
    v_cvt_pk_bf16_f32 v33, v34, v35
    v_cvt_pk_bf16_f32 v34, v36, v37
    v_cvt_pk_bf16_f32 v35, v38, v39
    s_add_u32 s48, s85, 5120
    buffer_store_dwordx4 v[32:35], v0, s[32:35], s48 offen sc1
    v_accvgpr_read_b32 v40, a80
    v_accvgpr_read_b32 v41, a81
    v_accvgpr_read_b32 v42, a82
    v_accvgpr_read_b32 v43, a83
    v_accvgpr_read_b32 v44, a84
    v_accvgpr_read_b32 v45, a85
    v_accvgpr_read_b32 v46, a86
    v_accvgpr_read_b32 v47, a87
    v_cvt_pk_bf16_f32 v40, v40, v41
    v_cvt_pk_bf16_f32 v41, v42, v43
    v_cvt_pk_bf16_f32 v42, v44, v45
    v_cvt_pk_bf16_f32 v43, v46, v47
    s_add_u32 s48, s85, 8192
    buffer_store_dwordx4 v[40:43], v0, s[32:35], s48 offen sc1
    s_mul_i32 s86, s63, 12
    s_add_u32 s86, s86, 0
    s_mul_i32 s86, s86, 40960
    s_mul_i32 s87, s62, 1280
    s_add_u32 s86, s86, s87
    s_lshl_b32 s87, s64, 8
    s_add_u32 s86, s86, s87
    s_add_u32 s86, s86, 192
    s_waitcnt vmcnt(0) lgkmcnt(0)
    s_barrier
    s_cmp_lg_u32 s7, 0
    s_cbranch_scc1 L_pub21
    s_and_b32 s48, s2, 7
    s_lshl_b32 s48, s48, 5
    s_lshr_b32 s49, s2, 3
    s_add_u32 s48, s48, s49
    v_mov_b32 v2, s48
    v_mov_b32 v3, 3
    s_mov_b64 exec, 1
    global_store_byte v2, v3, s[22:23] sc1
    s_mov_b64 exec, -1
L_pub21:
    s_mov_b32 s12, s8
    s_mov_b32 s13, s9
    s_mov_b32 s14, 2949120
    s_mov_b32 s15, 0x20000
    s_cmp_lg_u32 s7, 0
    s_cbranch_scc1 L_xp0_3b_skip
    s_lshl_b32 s48, s62, 7
    s_add_u32 s48, s48, s60
    v_and_b32 v2, 3, v1
    v_lshlrev_b32 v2, 5, v2
    v_add_u32 v2, s48, v2
    s_mov_b32 s69, 0
L_xp0_3b_poll:
    global_load_ubyte v3, v2, s[22:23] sc1
    s_add_u32 s69, s69, 1
    s_waitcnt vmcnt(0)
    v_cmp_gt_u32 vcc, 3, v3
    s_cmp_ge_u32 s69, 131072
    s_cbranch_scc1 L_xp0_3b_skip
    s_nop 2
    s_cbranch_vccz L_xp0_3b_skip
    s_sleep 1
    s_branch L_xp0_3b_poll
L_xp0_3b_skip:
    s_barrier
    s_mov_b32 s48, 11264
    buffer_load_dwordx4 v[32:35], v0, s[32:35], s48 offen sc1
    s_mov_b32 s48, 1485824
    buffer_load_dwordx4 v[44:47], v0, s[32:35], s48 offen sc1
    s_mov_b32 s48, 2960384
    buffer_load_dwordx4 v[56:59], v0, s[32:35], s48 offen sc1
    v_and_b32 v2, 15, v1
    v_mul_u32_u24 v2, 2560, v2
    v_lshrrev_b32 v3, 4, v1
    v_lshl_add_u32 v2, v3, 3, v2
    v_accvgpr_read_b32 v80, a88
    v_accvgpr_read_b32 v81, a89
    v_accvgpr_read_b32 v82, a90
    v_accvgpr_read_b32 v83, a91
    s_waitcnt vmcnt(2)
    v_lshlrev_b32 v22, 16, v32
    v_and_b32 v23, 0xffff0000, v32
    v_add_f32 v80, v80, v22
    v_add_f32 v81, v81, v23
    v_lshlrev_b32 v22, 16, v33
    v_and_b32 v23, 0xffff0000, v33
    v_add_f32 v82, v82, v22
    v_add_f32 v83, v83, v23
    s_waitcnt vmcnt(1)
    v_lshlrev_b32 v22, 16, v44
    v_and_b32 v23, 0xffff0000, v44
    v_add_f32 v80, v80, v22
    v_add_f32 v81, v81, v23
    v_lshlrev_b32 v22, 16, v45
    v_and_b32 v23, 0xffff0000, v45
    v_add_f32 v82, v82, v22
    v_add_f32 v83, v83, v23
    s_waitcnt vmcnt(0)
    v_lshlrev_b32 v22, 16, v56
    v_and_b32 v23, 0xffff0000, v56
    v_add_f32 v80, v80, v22
    v_add_f32 v81, v81, v23
    v_lshlrev_b32 v22, 16, v57
    v_and_b32 v23, 0xffff0000, v57
    v_add_f32 v82, v82, v22
    v_add_f32 v83, v83, v23
    v_cvt_pk_bf16_f32 v80, v80, v81
    v_cvt_pk_bf16_f32 v81, v82, v83
    s_add_u32 s48, s86, 81920
    buffer_store_dwordx2 v[80:81], v2, s[12:15], s48 offen offset:0
    v_accvgpr_read_b32 v84, a92
    v_accvgpr_read_b32 v85, a93
    v_accvgpr_read_b32 v86, a94
    v_accvgpr_read_b32 v87, a95
    v_lshlrev_b32 v22, 16, v34
    v_and_b32 v23, 0xffff0000, v34
    v_add_f32 v84, v84, v22
    v_add_f32 v85, v85, v23
    v_lshlrev_b32 v22, 16, v35
    v_and_b32 v23, 0xffff0000, v35
    v_add_f32 v86, v86, v22
    v_add_f32 v87, v87, v23
    v_lshlrev_b32 v22, 16, v46
    v_and_b32 v23, 0xffff0000, v46
    v_add_f32 v84, v84, v22
    v_add_f32 v85, v85, v23
    v_lshlrev_b32 v22, 16, v47
    v_and_b32 v23, 0xffff0000, v47
    v_add_f32 v86, v86, v22
    v_add_f32 v87, v87, v23
    v_lshlrev_b32 v22, 16, v58
    v_and_b32 v23, 0xffff0000, v58
    v_add_f32 v84, v84, v22
    v_add_f32 v85, v85, v23
    v_lshlrev_b32 v22, 16, v59
    v_and_b32 v23, 0xffff0000, v59
    v_add_f32 v86, v86, v22
    v_add_f32 v87, v87, v23
    v_cvt_pk_bf16_f32 v84, v84, v85
    v_cvt_pk_bf16_f32 v85, v86, v87
    s_add_u32 s48, s86, 81920
    buffer_store_dwordx2 v[84:85], v2, s[12:15], s48 offen offset:32
    s_branch L_end2
L_x0_3b:
L_xw1b:
    s_lshl_b32 s84, s62, 2
    s_mul_i32 s84, s84, 30
    s_add_u32 s84, s84, s60
    s_lshl_b32 s84, s84, 2
    s_add_u32 s84, s84, s3
    s_mul_i32 s84, s84, 12288
    s_add_u32 s84, s84, 18874368
    s_add_u32 s32, s4, s84
    s_addc_u32 s33, s5, 0
    s_mov_b32 s34, 4435968
    s_mov_b32 s35, 0x20000
    s_mul_i32 s85, s61, 1474560
    s_load_dwordx2 s[8:9], s[0:1], 80
    s_nop 7
    s_cmp_lg_u32 s61, 0
    s_cbranch_scc1 L_x1_0b
    v_accvgpr_read_b32 v24, a64
    v_accvgpr_read_b32 v25, a65
    v_accvgpr_read_b32 v26, a66
    v_accvgpr_read_b32 v27, a67
    v_accvgpr_read_b32 v28, a68
    v_accvgpr_read_b32 v29, a69
    v_accvgpr_read_b32 v30, a70
    v_accvgpr_read_b32 v31, a71
    v_cvt_pk_bf16_f32 v24, v24, v25
    v_cvt_pk_bf16_f32 v25, v26, v27
    v_cvt_pk_bf16_f32 v26, v28, v29
    v_cvt_pk_bf16_f32 v27, v30, v31
    s_add_u32 s48, s85, 5120
    buffer_store_dwordx4 v[24:27], v0, s[32:35], s48 offen sc1
    v_accvgpr_read_b32 v32, a72
    v_accvgpr_read_b32 v33, a73
    v_accvgpr_read_b32 v34, a74
    v_accvgpr_read_b32 v35, a75
    v_accvgpr_read_b32 v36, a76
    v_accvgpr_read_b32 v37, a77
    v_accvgpr_read_b32 v38, a78
    v_accvgpr_read_b32 v39, a79
    v_cvt_pk_bf16_f32 v32, v32, v33
    v_cvt_pk_bf16_f32 v33, v34, v35
    v_cvt_pk_bf16_f32 v34, v36, v37
    v_cvt_pk_bf16_f32 v35, v38, v39
    s_add_u32 s48, s85, 8192
    buffer_store_dwordx4 v[32:35], v0, s[32:35], s48 offen sc1
    v_accvgpr_read_b32 v40, a80
    v_accvgpr_read_b32 v41, a81
    v_accvgpr_read_b32 v42, a82
    v_accvgpr_read_b32 v43, a83
    v_accvgpr_read_b32 v44, a84
    v_accvgpr_read_b32 v45, a85
    v_accvgpr_read_b32 v46, a86
    v_accvgpr_read_b32 v47, a87
    v_cvt_pk_bf16_f32 v40, v40, v41
    v_cvt_pk_bf16_f32 v41, v42, v43
    v_cvt_pk_bf16_f32 v42, v44, v45
    v_cvt_pk_bf16_f32 v43, v46, v47
    s_add_u32 s48, s85, 11264
    buffer_store_dwordx4 v[40:43], v0, s[32:35], s48 offen sc1
    s_mul_i32 s86, s63, 12
    s_add_u32 s86, s86, 3
    s_mul_i32 s86, s86, 40960
    s_mul_i32 s87, s62, 1280
    s_add_u32 s86, s86, s87
    s_lshl_b32 s87, s64, 8
    s_add_u32 s86, s86, s87
    s_add_u32 s86, s86, 0
    s_waitcnt vmcnt(0) lgkmcnt(0)
    s_barrier
    s_cmp_lg_u32 s7, 0
    s_cbranch_scc1 L_pub22
    s_and_b32 s48, s2, 7
    s_lshl_b32 s48, s48, 5
    s_lshr_b32 s49, s2, 3
    s_add_u32 s48, s48, s49
    v_mov_b32 v2, s48
    v_mov_b32 v3, 3
    s_mov_b64 exec, 1
    global_store_byte v2, v3, s[22:23] sc1
    s_mov_b64 exec, -1
L_pub22:
    s_mov_b32 s12, s8
    s_mov_b32 s13, s9
    s_mov_b32 s14, 2949120
    s_mov_b32 s15, 0x20000
    s_cmp_lg_u32 s7, 0
    s_cbranch_scc1 L_xp1_0b_skip
    s_lshl_b32 s48, s62, 7
    s_add_u32 s48, s48, s60
    v_and_b32 v2, 3, v1
    v_lshlrev_b32 v2, 5, v2
    v_add_u32 v2, s48, v2
    s_mov_b32 s69, 0
L_xp1_0b_poll:
    global_load_ubyte v3, v2, s[22:23] sc1
    s_add_u32 s69, s69, 1
    s_waitcnt vmcnt(0)
    v_cmp_gt_u32 vcc, 3, v3
    s_cmp_ge_u32 s69, 131072
    s_cbranch_scc1 L_xp1_0b_skip
    s_nop 2
    s_cbranch_vccz L_xp1_0b_skip
    s_sleep 1
    s_branch L_xp1_0b_poll
L_xp1_0b_skip:
    s_barrier
    s_mov_b32 s48, 1476608
    buffer_load_dwordx4 v[32:35], v0, s[32:35], s48 offen sc1
    s_mov_b32 s48, 2951168
    buffer_load_dwordx4 v[44:47], v0, s[32:35], s48 offen sc1
    s_mov_b32 s48, 4425728
    buffer_load_dwordx4 v[56:59], v0, s[32:35], s48 offen sc1
    v_and_b32 v2, 15, v1
    v_mul_u32_u24 v2, 2560, v2
    v_lshrrev_b32 v3, 4, v1
    v_lshl_add_u32 v2, v3, 3, v2
    v_accvgpr_read_b32 v80, a88
    v_accvgpr_read_b32 v81, a89
    v_accvgpr_read_b32 v82, a90
    v_accvgpr_read_b32 v83, a91
    s_waitcnt vmcnt(2)
    v_lshlrev_b32 v22, 16, v32
    v_and_b32 v23, 0xffff0000, v32
    v_add_f32 v80, v80, v22
    v_add_f32 v81, v81, v23
    v_lshlrev_b32 v22, 16, v33
    v_and_b32 v23, 0xffff0000, v33
    v_add_f32 v82, v82, v22
    v_add_f32 v83, v83, v23
    s_waitcnt vmcnt(1)
    v_lshlrev_b32 v22, 16, v44
    v_and_b32 v23, 0xffff0000, v44
    v_add_f32 v80, v80, v22
    v_add_f32 v81, v81, v23
    v_lshlrev_b32 v22, 16, v45
    v_and_b32 v23, 0xffff0000, v45
    v_add_f32 v82, v82, v22
    v_add_f32 v83, v83, v23
    s_waitcnt vmcnt(0)
    v_lshlrev_b32 v22, 16, v56
    v_and_b32 v23, 0xffff0000, v56
    v_add_f32 v80, v80, v22
    v_add_f32 v81, v81, v23
    v_lshlrev_b32 v22, 16, v57
    v_and_b32 v23, 0xffff0000, v57
    v_add_f32 v82, v82, v22
    v_add_f32 v83, v83, v23
    v_cvt_pk_bf16_f32 v80, v80, v81
    v_cvt_pk_bf16_f32 v81, v82, v83
    s_add_u32 s48, s86, 81920
    buffer_store_dwordx2 v[80:81], v2, s[12:15], s48 offen offset:0
    v_accvgpr_read_b32 v84, a92
    v_accvgpr_read_b32 v85, a93
    v_accvgpr_read_b32 v86, a94
    v_accvgpr_read_b32 v87, a95
    v_lshlrev_b32 v22, 16, v34
    v_and_b32 v23, 0xffff0000, v34
    v_add_f32 v84, v84, v22
    v_add_f32 v85, v85, v23
    v_lshlrev_b32 v22, 16, v35
    v_and_b32 v23, 0xffff0000, v35
    v_add_f32 v86, v86, v22
    v_add_f32 v87, v87, v23
    v_lshlrev_b32 v22, 16, v46
    v_and_b32 v23, 0xffff0000, v46
    v_add_f32 v84, v84, v22
    v_add_f32 v85, v85, v23
    v_lshlrev_b32 v22, 16, v47
    v_and_b32 v23, 0xffff0000, v47
    v_add_f32 v86, v86, v22
    v_add_f32 v87, v87, v23
    v_lshlrev_b32 v22, 16, v58
    v_and_b32 v23, 0xffff0000, v58
    v_add_f32 v84, v84, v22
    v_add_f32 v85, v85, v23
    v_lshlrev_b32 v22, 16, v59
    v_and_b32 v23, 0xffff0000, v59
    v_add_f32 v86, v86, v22
    v_add_f32 v87, v87, v23
    v_cvt_pk_bf16_f32 v84, v84, v85
    v_cvt_pk_bf16_f32 v85, v86, v87
    s_add_u32 s48, s86, 81920
    buffer_store_dwordx2 v[84:85], v2, s[12:15], s48 offen offset:32
    s_branch L_end2
L_x1_0b:
    s_cmp_lg_u32 s61, 1
    s_cbranch_scc1 L_x1_1b
    v_accvgpr_read_b32 v24, a88
    v_accvgpr_read_b32 v25, a89
    v_accvgpr_read_b32 v26, a90
    v_accvgpr_read_b32 v27, a91
    v_accvgpr_read_b32 v28, a92
    v_accvgpr_read_b32 v29, a93
    v_accvgpr_read_b32 v30, a94
    v_accvgpr_read_b32 v31, a95
    v_cvt_pk_bf16_f32 v24, v24, v25
    v_cvt_pk_bf16_f32 v25, v26, v27
    v_cvt_pk_bf16_f32 v26, v28, v29
    v_cvt_pk_bf16_f32 v27, v30, v31
    s_add_u32 s48, s85, 2048
    buffer_store_dwordx4 v[24:27], v0, s[32:35], s48 offen sc1
    v_accvgpr_read_b32 v32, a72
    v_accvgpr_read_b32 v33, a73
    v_accvgpr_read_b32 v34, a74
    v_accvgpr_read_b32 v35, a75
    v_accvgpr_read_b32 v36, a76
    v_accvgpr_read_b32 v37, a77
    v_accvgpr_read_b32 v38, a78
    v_accvgpr_read_b32 v39, a79
    v_cvt_pk_bf16_f32 v32, v32, v33
    v_cvt_pk_bf16_f32 v33, v34, v35
    v_cvt_pk_bf16_f32 v34, v36, v37
    v_cvt_pk_bf16_f32 v35, v38, v39
    s_add_u32 s48, s85, 8192
    buffer_store_dwordx4 v[32:35], v0, s[32:35], s48 offen sc1
    v_accvgpr_read_b32 v40, a80
    v_accvgpr_read_b32 v41, a81
    v_accvgpr_read_b32 v42, a82
    v_accvgpr_read_b32 v43, a83
    v_accvgpr_read_b32 v44, a84
    v_accvgpr_read_b32 v45, a85
    v_accvgpr_read_b32 v46, a86
    v_accvgpr_read_b32 v47, a87
    v_cvt_pk_bf16_f32 v40, v40, v41
    v_cvt_pk_bf16_f32 v41, v42, v43
    v_cvt_pk_bf16_f32 v42, v44, v45
    v_cvt_pk_bf16_f32 v43, v46, v47
    s_add_u32 s48, s85, 11264
    buffer_store_dwordx4 v[40:43], v0, s[32:35], s48 offen sc1
    s_mul_i32 s86, s63, 12
    s_add_u32 s86, s86, 3
    s_mul_i32 s86, s86, 40960
    s_mul_i32 s87, s62, 1280
    s_add_u32 s86, s86, s87
    s_lshl_b32 s87, s64, 8
    s_add_u32 s86, s86, s87
    s_add_u32 s86, s86, 64
    s_waitcnt vmcnt(0) lgkmcnt(0)
    s_barrier
    s_cmp_lg_u32 s7, 0
    s_cbranch_scc1 L_pub23
    s_and_b32 s48, s2, 7
    s_lshl_b32 s48, s48, 5
    s_lshr_b32 s49, s2, 3
    s_add_u32 s48, s48, s49
    v_mov_b32 v2, s48
    v_mov_b32 v3, 3
    s_mov_b64 exec, 1
    global_store_byte v2, v3, s[22:23] sc1
    s_mov_b64 exec, -1
L_pub23:
    s_mov_b32 s12, s8
    s_mov_b32 s13, s9
    s_mov_b32 s14, 2949120
    s_mov_b32 s15, 0x20000
    s_cmp_lg_u32 s7, 0
    s_cbranch_scc1 L_xp1_1b_skip
    s_lshl_b32 s48, s62, 7
    s_add_u32 s48, s48, s60
    v_and_b32 v2, 3, v1
    v_lshlrev_b32 v2, 5, v2
    v_add_u32 v2, s48, v2
    s_mov_b32 s69, 0
L_xp1_1b_poll:
    global_load_ubyte v3, v2, s[22:23] sc1
    s_add_u32 s69, s69, 1
    s_waitcnt vmcnt(0)
    v_cmp_gt_u32 vcc, 3, v3
    s_cmp_ge_u32 s69, 131072
    s_cbranch_scc1 L_xp1_1b_skip
    s_nop 2
    s_cbranch_vccz L_xp1_1b_skip
    s_sleep 1
    s_branch L_xp1_1b_poll
L_xp1_1b_skip:
    s_barrier
    s_mov_b32 s48, 5120
    buffer_load_dwordx4 v[32:35], v0, s[32:35], s48 offen sc1
    s_mov_b32 s48, 2954240
    buffer_load_dwordx4 v[44:47], v0, s[32:35], s48 offen sc1
    s_mov_b32 s48, 4428800
    buffer_load_dwordx4 v[56:59], v0, s[32:35], s48 offen sc1
    v_and_b32 v2, 15, v1
    v_mul_u32_u24 v2, 2560, v2
    v_lshrrev_b32 v3, 4, v1
    v_lshl_add_u32 v2, v3, 3, v2
    v_accvgpr_read_b32 v80, a64
    v_accvgpr_read_b32 v81, a65
    v_accvgpr_read_b32 v82, a66
    v_accvgpr_read_b32 v83, a67
    s_waitcnt vmcnt(2)
    v_lshlrev_b32 v22, 16, v32
    v_and_b32 v23, 0xffff0000, v32
    v_add_f32 v80, v80, v22
    v_add_f32 v81, v81, v23
    v_lshlrev_b32 v22, 16, v33
    v_and_b32 v23, 0xffff0000, v33
    v_add_f32 v82, v82, v22
    v_add_f32 v83, v83, v23
    s_waitcnt vmcnt(1)
    v_lshlrev_b32 v22, 16, v44
    v_and_b32 v23, 0xffff0000, v44
    v_add_f32 v80, v80, v22
    v_add_f32 v81, v81, v23
    v_lshlrev_b32 v22, 16, v45
    v_and_b32 v23, 0xffff0000, v45
    v_add_f32 v82, v82, v22
    v_add_f32 v83, v83, v23
    s_waitcnt vmcnt(0)
    v_lshlrev_b32 v22, 16, v56
    v_and_b32 v23, 0xffff0000, v56
    v_add_f32 v80, v80, v22
    v_add_f32 v81, v81, v23
    v_lshlrev_b32 v22, 16, v57
    v_and_b32 v23, 0xffff0000, v57
    v_add_f32 v82, v82, v22
    v_add_f32 v83, v83, v23
    v_cvt_pk_bf16_f32 v80, v80, v81
    v_cvt_pk_bf16_f32 v81, v82, v83
    s_add_u32 s48, s86, 81920
    buffer_store_dwordx2 v[80:81], v2, s[12:15], s48 offen offset:0
    v_accvgpr_read_b32 v84, a68
    v_accvgpr_read_b32 v85, a69
    v_accvgpr_read_b32 v86, a70
    v_accvgpr_read_b32 v87, a71
    v_lshlrev_b32 v22, 16, v34
    v_and_b32 v23, 0xffff0000, v34
    v_add_f32 v84, v84, v22
    v_add_f32 v85, v85, v23
    v_lshlrev_b32 v22, 16, v35
    v_and_b32 v23, 0xffff0000, v35
    v_add_f32 v86, v86, v22
    v_add_f32 v87, v87, v23
    v_lshlrev_b32 v22, 16, v46
    v_and_b32 v23, 0xffff0000, v46
    v_add_f32 v84, v84, v22
    v_add_f32 v85, v85, v23
    v_lshlrev_b32 v22, 16, v47
    v_and_b32 v23, 0xffff0000, v47
    v_add_f32 v86, v86, v22
    v_add_f32 v87, v87, v23
    v_lshlrev_b32 v22, 16, v58
    v_and_b32 v23, 0xffff0000, v58
    v_add_f32 v84, v84, v22
    v_add_f32 v85, v85, v23
    v_lshlrev_b32 v22, 16, v59
    v_and_b32 v23, 0xffff0000, v59
    v_add_f32 v86, v86, v22
    v_add_f32 v87, v87, v23
    v_cvt_pk_bf16_f32 v84, v84, v85
    v_cvt_pk_bf16_f32 v85, v86, v87
    s_add_u32 s48, s86, 81920
    buffer_store_dwordx2 v[84:85], v2, s[12:15], s48 offen offset:32
    s_branch L_end2
L_x1_1b:
    s_cmp_lg_u32 s61, 2
    s_cbranch_scc1 L_x1_2b
    v_accvgpr_read_b32 v24, a88
    v_accvgpr_read_b32 v25, a89
    v_accvgpr_read_b32 v26, a90
    v_accvgpr_read_b32 v27, a91
    v_accvgpr_read_b32 v28, a92
    v_accvgpr_read_b32 v29, a93
    v_accvgpr_read_b32 v30, a94
    v_accvgpr_read_b32 v31, a95
    v_cvt_pk_bf16_f32 v24, v24, v25
    v_cvt_pk_bf16_f32 v25, v26, v27
    v_cvt_pk_bf16_f32 v26, v28, v29
    v_cvt_pk_bf16_f32 v27, v30, v31
    s_add_u32 s48, s85, 2048
    buffer_store_dwordx4 v[24:27], v0, s[32:35], s48 offen sc1
    v_accvgpr_read_b32 v32, a64
    v_accvgpr_read_b32 v33, a65
    v_accvgpr_read_b32 v34, a66
    v_accvgpr_read_b32 v35, a67
    v_accvgpr_read_b32 v36, a68
    v_accvgpr_read_b32 v37, a69
    v_accvgpr_read_b32 v38, a70
    v_accvgpr_read_b32 v39, a71
    v_cvt_pk_bf16_f32 v32, v32, v33
    v_cvt_pk_bf16_f32 v33, v34, v35
    v_cvt_pk_bf16_f32 v34, v36, v37
    v_cvt_pk_bf16_f32 v35, v38, v39
    s_add_u32 s48, s85, 5120
    buffer_store_dwordx4 v[32:35], v0, s[32:35], s48 offen sc1
    v_accvgpr_read_b32 v40, a80
    v_accvgpr_read_b32 v41, a81
    v_accvgpr_read_b32 v42, a82
    v_accvgpr_read_b32 v43, a83
    v_accvgpr_read_b32 v44, a84
    v_accvgpr_read_b32 v45, a85
    v_accvgpr_read_b32 v46, a86
    v_accvgpr_read_b32 v47, a87
    v_cvt_pk_bf16_f32 v40, v40, v41
    v_cvt_pk_bf16_f32 v41, v42, v43
    v_cvt_pk_bf16_f32 v42, v44, v45
    v_cvt_pk_bf16_f32 v43, v46, v47
    s_add_u32 s48, s85, 11264
    buffer_store_dwordx4 v[40:43], v0, s[32:35], s48 offen sc1
    s_mul_i32 s86, s63, 12
    s_add_u32 s86, s86, 3
    s_mul_i32 s86, s86, 40960
    s_mul_i32 s87, s62, 1280
    s_add_u32 s86, s86, s87
    s_lshl_b32 s87, s64, 8
    s_add_u32 s86, s86, s87
    s_add_u32 s86, s86, 128
    s_waitcnt vmcnt(0) lgkmcnt(0)
    s_barrier
    s_cmp_lg_u32 s7, 0
    s_cbranch_scc1 L_pub24
    s_and_b32 s48, s2, 7
    s_lshl_b32 s48, s48, 5
    s_lshr_b32 s49, s2, 3
    s_add_u32 s48, s48, s49
    v_mov_b32 v2, s48
    v_mov_b32 v3, 3
    s_mov_b64 exec, 1
    global_store_byte v2, v3, s[22:23] sc1
    s_mov_b64 exec, -1
L_pub24:
    s_mov_b32 s12, s8
    s_mov_b32 s13, s9
    s_mov_b32 s14, 2949120
    s_mov_b32 s15, 0x20000
    s_cmp_lg_u32 s7, 0
    s_cbranch_scc1 L_xp1_2b_skip
    s_lshl_b32 s48, s62, 7
    s_add_u32 s48, s48, s60
    v_and_b32 v2, 3, v1
    v_lshlrev_b32 v2, 5, v2
    v_add_u32 v2, s48, v2
    s_mov_b32 s69, 0
L_xp1_2b_poll:
    global_load_ubyte v3, v2, s[22:23] sc1
    s_add_u32 s69, s69, 1
    s_waitcnt vmcnt(0)
    v_cmp_gt_u32 vcc, 3, v3
    s_cmp_ge_u32 s69, 131072
    s_cbranch_scc1 L_xp1_2b_skip
    s_nop 2
    s_cbranch_vccz L_xp1_2b_skip
    s_sleep 1
    s_branch L_xp1_2b_poll
L_xp1_2b_skip:
    s_barrier
    s_mov_b32 s48, 8192
    buffer_load_dwordx4 v[32:35], v0, s[32:35], s48 offen sc1
    s_mov_b32 s48, 1482752
    buffer_load_dwordx4 v[44:47], v0, s[32:35], s48 offen sc1
    s_mov_b32 s48, 4431872
    buffer_load_dwordx4 v[56:59], v0, s[32:35], s48 offen sc1
    v_and_b32 v2, 15, v1
    v_mul_u32_u24 v2, 2560, v2
    v_lshrrev_b32 v3, 4, v1
    v_lshl_add_u32 v2, v3, 3, v2
    v_accvgpr_read_b32 v80, a72
    v_accvgpr_read_b32 v81, a73
    v_accvgpr_read_b32 v82, a74
    v_accvgpr_read_b32 v83, a75
    s_waitcnt vmcnt(2)
    v_lshlrev_b32 v22, 16, v32
    v_and_b32 v23, 0xffff0000, v32
    v_add_f32 v80, v80, v22
    v_add_f32 v81, v81, v23
    v_lshlrev_b32 v22, 16, v33
    v_and_b32 v23, 0xffff0000, v33
    v_add_f32 v82, v82, v22
    v_add_f32 v83, v83, v23
    s_waitcnt vmcnt(1)
    v_lshlrev_b32 v22, 16, v44
    v_and_b32 v23, 0xffff0000, v44
    v_add_f32 v80, v80, v22
    v_add_f32 v81, v81, v23
    v_lshlrev_b32 v22, 16, v45
    v_and_b32 v23, 0xffff0000, v45
    v_add_f32 v82, v82, v22
    v_add_f32 v83, v83, v23
    s_waitcnt vmcnt(0)
    v_lshlrev_b32 v22, 16, v56
    v_and_b32 v23, 0xffff0000, v56
    v_add_f32 v80, v80, v22
    v_add_f32 v81, v81, v23
    v_lshlrev_b32 v22, 16, v57
    v_and_b32 v23, 0xffff0000, v57
    v_add_f32 v82, v82, v22
    v_add_f32 v83, v83, v23
    v_cvt_pk_bf16_f32 v80, v80, v81
    v_cvt_pk_bf16_f32 v81, v82, v83
    s_add_u32 s48, s86, 81920
    buffer_store_dwordx2 v[80:81], v2, s[12:15], s48 offen offset:0
    v_accvgpr_read_b32 v84, a76
    v_accvgpr_read_b32 v85, a77
    v_accvgpr_read_b32 v86, a78
    v_accvgpr_read_b32 v87, a79
    v_lshlrev_b32 v22, 16, v34
    v_and_b32 v23, 0xffff0000, v34
    v_add_f32 v84, v84, v22
    v_add_f32 v85, v85, v23
    v_lshlrev_b32 v22, 16, v35
    v_and_b32 v23, 0xffff0000, v35
    v_add_f32 v86, v86, v22
    v_add_f32 v87, v87, v23
    v_lshlrev_b32 v22, 16, v46
    v_and_b32 v23, 0xffff0000, v46
    v_add_f32 v84, v84, v22
    v_add_f32 v85, v85, v23
    v_lshlrev_b32 v22, 16, v47
    v_and_b32 v23, 0xffff0000, v47
    v_add_f32 v86, v86, v22
    v_add_f32 v87, v87, v23
    v_lshlrev_b32 v22, 16, v58
    v_and_b32 v23, 0xffff0000, v58
    v_add_f32 v84, v84, v22
    v_add_f32 v85, v85, v23
    v_lshlrev_b32 v22, 16, v59
    v_and_b32 v23, 0xffff0000, v59
    v_add_f32 v86, v86, v22
    v_add_f32 v87, v87, v23
    v_cvt_pk_bf16_f32 v84, v84, v85
    v_cvt_pk_bf16_f32 v85, v86, v87
    s_add_u32 s48, s86, 81920
    buffer_store_dwordx2 v[84:85], v2, s[12:15], s48 offen offset:32
    s_branch L_end2
L_x1_2b:
    s_cmp_lg_u32 s61, 3
    s_cbranch_scc1 L_x1_3b
    v_accvgpr_read_b32 v24, a88
    v_accvgpr_read_b32 v25, a89
    v_accvgpr_read_b32 v26, a90
    v_accvgpr_read_b32 v27, a91
    v_accvgpr_read_b32 v28, a92
    v_accvgpr_read_b32 v29, a93
    v_accvgpr_read_b32 v30, a94
    v_accvgpr_read_b32 v31, a95
    v_cvt_pk_bf16_f32 v24, v24, v25
    v_cvt_pk_bf16_f32 v25, v26, v27
    v_cvt_pk_bf16_f32 v26, v28, v29
    v_cvt_pk_bf16_f32 v27, v30, v31
    s_add_u32 s48, s85, 2048
    buffer_store_dwordx4 v[24:27], v0, s[32:35], s48 offen sc1
    v_accvgpr_read_b32 v32, a64
    v_accvgpr_read_b32 v33, a65
    v_accvgpr_read_b32 v34, a66
    v_accvgpr_read_b32 v35, a67
    v_accvgpr_read_b32 v36, a68
    v_accvgpr_read_b32 v37, a69
    v_accvgpr_read_b32 v38, a70
    v_accvgpr_read_b32 v39, a71
    v_cvt_pk_bf16_f32 v32, v32, v33
    v_cvt_pk_bf16_f32 v33, v34, v35
    v_cvt_pk_bf16_f32 v34, v36, v37
    v_cvt_pk_bf16_f32 v35, v38, v39
    s_add_u32 s48, s85, 5120
    buffer_store_dwordx4 v[32:35], v0, s[32:35], s48 offen sc1
    v_accvgpr_read_b32 v40, a72
    v_accvgpr_read_b32 v41, a73
    v_accvgpr_read_b32 v42, a74
    v_accvgpr_read_b32 v43, a75
    v_accvgpr_read_b32 v44, a76
    v_accvgpr_read_b32 v45, a77
    v_accvgpr_read_b32 v46, a78
    v_accvgpr_read_b32 v47, a79
    v_cvt_pk_bf16_f32 v40, v40, v41
    v_cvt_pk_bf16_f32 v41, v42, v43
    v_cvt_pk_bf16_f32 v42, v44, v45
    v_cvt_pk_bf16_f32 v43, v46, v47
    s_add_u32 s48, s85, 8192
    buffer_store_dwordx4 v[40:43], v0, s[32:35], s48 offen sc1
    s_mul_i32 s86, s63, 12
    s_add_u32 s86, s86, 3
    s_mul_i32 s86, s86, 40960
    s_mul_i32 s87, s62, 1280
    s_add_u32 s86, s86, s87
    s_lshl_b32 s87, s64, 8
    s_add_u32 s86, s86, s87
    s_add_u32 s86, s86, 192
    s_waitcnt vmcnt(0) lgkmcnt(0)
    s_barrier
    s_cmp_lg_u32 s7, 0
    s_cbranch_scc1 L_pub25
    s_and_b32 s48, s2, 7
    s_lshl_b32 s48, s48, 5
    s_lshr_b32 s49, s2, 3
    s_add_u32 s48, s48, s49
    v_mov_b32 v2, s48
    v_mov_b32 v3, 3
    s_mov_b64 exec, 1
    global_store_byte v2, v3, s[22:23] sc1
    s_mov_b64 exec, -1
L_pub25:
    s_mov_b32 s12, s8
    s_mov_b32 s13, s9
    s_mov_b32 s14, 2949120
    s_mov_b32 s15, 0x20000
    s_cmp_lg_u32 s7, 0
    s_cbranch_scc1 L_xp1_3b_skip
    s_lshl_b32 s48, s62, 7
    s_add_u32 s48, s48, s60
    v_and_b32 v2, 3, v1
    v_lshlrev_b32 v2, 5, v2
    v_add_u32 v2, s48, v2
    s_mov_b32 s69, 0
L_xp1_3b_poll:
    global_load_ubyte v3, v2, s[22:23] sc1
    s_add_u32 s69, s69, 1
    s_waitcnt vmcnt(0)
    v_cmp_gt_u32 vcc, 3, v3
    s_cmp_ge_u32 s69, 131072
    s_cbranch_scc1 L_xp1_3b_skip
    s_nop 2
    s_cbranch_vccz L_xp1_3b_skip
    s_sleep 1
    s_branch L_xp1_3b_poll
L_xp1_3b_skip:
    s_barrier
    s_mov_b32 s48, 11264
    buffer_load_dwordx4 v[32:35], v0, s[32:35], s48 offen sc1
    s_mov_b32 s48, 1485824
    buffer_load_dwordx4 v[44:47], v0, s[32:35], s48 offen sc1
    s_mov_b32 s48, 2960384
    buffer_load_dwordx4 v[56:59], v0, s[32:35], s48 offen sc1
    v_and_b32 v2, 15, v1
    v_mul_u32_u24 v2, 2560, v2
    v_lshrrev_b32 v3, 4, v1
    v_lshl_add_u32 v2, v3, 3, v2
    v_accvgpr_read_b32 v80, a80
    v_accvgpr_read_b32 v81, a81
    v_accvgpr_read_b32 v82, a82
    v_accvgpr_read_b32 v83, a83
    s_waitcnt vmcnt(2)
    v_lshlrev_b32 v22, 16, v32
    v_and_b32 v23, 0xffff0000, v32
    v_add_f32 v80, v80, v22
    v_add_f32 v81, v81, v23
    v_lshlrev_b32 v22, 16, v33
    v_and_b32 v23, 0xffff0000, v33
    v_add_f32 v82, v82, v22
    v_add_f32 v83, v83, v23
    s_waitcnt vmcnt(1)
    v_lshlrev_b32 v22, 16, v44
    v_and_b32 v23, 0xffff0000, v44
    v_add_f32 v80, v80, v22
    v_add_f32 v81, v81, v23
    v_lshlrev_b32 v22, 16, v45
    v_and_b32 v23, 0xffff0000, v45
    v_add_f32 v82, v82, v22
    v_add_f32 v83, v83, v23
    s_waitcnt vmcnt(0)
    v_lshlrev_b32 v22, 16, v56
    v_and_b32 v23, 0xffff0000, v56
    v_add_f32 v80, v80, v22
    v_add_f32 v81, v81, v23
    v_lshlrev_b32 v22, 16, v57
    v_and_b32 v23, 0xffff0000, v57
    v_add_f32 v82, v82, v22
    v_add_f32 v83, v83, v23
    v_cvt_pk_bf16_f32 v80, v80, v81
    v_cvt_pk_bf16_f32 v81, v82, v83
    s_add_u32 s48, s86, 81920
    buffer_store_dwordx2 v[80:81], v2, s[12:15], s48 offen offset:0
    v_accvgpr_read_b32 v84, a84
    v_accvgpr_read_b32 v85, a85
    v_accvgpr_read_b32 v86, a86
    v_accvgpr_read_b32 v87, a87
    v_lshlrev_b32 v22, 16, v34
    v_and_b32 v23, 0xffff0000, v34
    v_add_f32 v84, v84, v22
    v_add_f32 v85, v85, v23
    v_lshlrev_b32 v22, 16, v35
    v_and_b32 v23, 0xffff0000, v35
    v_add_f32 v86, v86, v22
    v_add_f32 v87, v87, v23
    v_lshlrev_b32 v22, 16, v46
    v_and_b32 v23, 0xffff0000, v46
    v_add_f32 v84, v84, v22
    v_add_f32 v85, v85, v23
    v_lshlrev_b32 v22, 16, v47
    v_and_b32 v23, 0xffff0000, v47
    v_add_f32 v86, v86, v22
    v_add_f32 v87, v87, v23
    v_lshlrev_b32 v22, 16, v58
    v_and_b32 v23, 0xffff0000, v58
    v_add_f32 v84, v84, v22
    v_add_f32 v85, v85, v23
    v_lshlrev_b32 v22, 16, v59
    v_and_b32 v23, 0xffff0000, v59
    v_add_f32 v86, v86, v22
    v_add_f32 v87, v87, v23
    v_cvt_pk_bf16_f32 v84, v84, v85
    v_cvt_pk_bf16_f32 v85, v86, v87
    s_add_u32 s48, s86, 81920
    buffer_store_dwordx2 v[84:85], v2, s[12:15], s48 offen offset:32
    s_branch L_end2
L_x1_3b:
L_xw2b:
    s_lshl_b32 s84, s62, 2
    s_mul_i32 s84, s84, 30
    s_add_u32 s84, s84, s60
    s_lshl_b32 s84, s84, 2
    s_add_u32 s84, s84, s3
    s_mul_i32 s84, s84, 12288
    s_add_u32 s84, s84, 18874368
    s_add_u32 s32, s4, s84
    s_addc_u32 s33, s5, 0
    s_mov_b32 s34, 4435968
    s_mov_b32 s35, 0x20000
    s_mul_i32 s85, s61, 1474560
    s_load_dwordx2 s[8:9], s[0:1], 80
    s_nop 7
    s_cmp_lg_u32 s61, 0
    s_cbranch_scc1 L_x2_0b
    v_accvgpr_read_b32 v24, a88
    v_accvgpr_read_b32 v25, a89
    v_accvgpr_read_b32 v26, a90
    v_accvgpr_read_b32 v27, a91
    v_accvgpr_read_b32 v28, a92
    v_accvgpr_read_b32 v29, a93
    v_accvgpr_read_b32 v30, a94
    v_accvgpr_read_b32 v31, a95
    v_cvt_pk_bf16_f32 v24, v24, v25
    v_cvt_pk_bf16_f32 v25, v26, v27
    v_cvt_pk_bf16_f32 v26, v28, v29
    v_cvt_pk_bf16_f32 v27, v30, v31
    s_add_u32 s48, s85, 5120
    buffer_store_dwordx4 v[24:27], v0, s[32:35], s48 offen sc1
    v_accvgpr_read_b32 v32, a64
    v_accvgpr_read_b32 v33, a65
    v_accvgpr_read_b32 v34, a66
    v_accvgpr_read_b32 v35, a67
    v_accvgpr_read_b32 v36, a68
    v_accvgpr_read_b32 v37, a69
    v_accvgpr_read_b32 v38, a70
    v_accvgpr_read_b32 v39, a71
    v_cvt_pk_bf16_f32 v32, v32, v33
    v_cvt_pk_bf16_f32 v33, v34, v35
    v_cvt_pk_bf16_f32 v34, v36, v37
    v_cvt_pk_bf16_f32 v35, v38, v39
    s_add_u32 s48, s85, 8192
    buffer_store_dwordx4 v[32:35], v0, s[32:35], s48 offen sc1
    v_accvgpr_read_b32 v40, a72
    v_accvgpr_read_b32 v41, a73
    v_accvgpr_read_b32 v42, a74
    v_accvgpr_read_b32 v43, a75
    v_accvgpr_read_b32 v44, a76
    v_accvgpr_read_b32 v45, a77
    v_accvgpr_read_b32 v46, a78
    v_accvgpr_read_b32 v47, a79
    v_cvt_pk_bf16_f32 v40, v40, v41
    v_cvt_pk_bf16_f32 v41, v42, v43
    v_cvt_pk_bf16_f32 v42, v44, v45
    v_cvt_pk_bf16_f32 v43, v46, v47
    s_add_u32 s48, s85, 11264
    buffer_store_dwordx4 v[40:43], v0, s[32:35], s48 offen sc1
    s_mul_i32 s86, s63, 12
    s_add_u32 s86, s86, 6
    s_mul_i32 s86, s86, 40960
    s_mul_i32 s87, s62, 1280
    s_add_u32 s86, s86, s87
    s_lshl_b32 s87, s64, 8
    s_add_u32 s86, s86, s87
    s_add_u32 s86, s86, 0
    s_waitcnt vmcnt(0) lgkmcnt(0)
    s_barrier
    s_cmp_lg_u32 s7, 0
    s_cbranch_scc1 L_pub26
    s_and_b32 s48, s2, 7
    s_lshl_b32 s48, s48, 5
    s_lshr_b32 s49, s2, 3
    s_add_u32 s48, s48, s49
    v_mov_b32 v2, s48
    v_mov_b32 v3, 3
    s_mov_b64 exec, 1
    global_store_byte v2, v3, s[22:23] sc1
    s_mov_b64 exec, -1
L_pub26:
    s_mov_b32 s12, s8
    s_mov_b32 s13, s9
    s_mov_b32 s14, 2949120
    s_mov_b32 s15, 0x20000
    s_cmp_lg_u32 s7, 0
    s_cbranch_scc1 L_xp2_0b_skip
    s_lshl_b32 s48, s62, 7
    s_add_u32 s48, s48, s60
    v_and_b32 v2, 3, v1
    v_lshlrev_b32 v2, 5, v2
    v_add_u32 v2, s48, v2
    s_mov_b32 s69, 0
L_xp2_0b_poll:
    global_load_ubyte v3, v2, s[22:23] sc1
    s_add_u32 s69, s69, 1
    s_waitcnt vmcnt(0)
    v_cmp_gt_u32 vcc, 3, v3
    s_cmp_ge_u32 s69, 131072
    s_cbranch_scc1 L_xp2_0b_skip
    s_nop 2
    s_cbranch_vccz L_xp2_0b_skip
    s_sleep 1
    s_branch L_xp2_0b_poll
L_xp2_0b_skip:
    s_barrier
    s_mov_b32 s48, 1476608
    buffer_load_dwordx4 v[32:35], v0, s[32:35], s48 offen sc1
    s_mov_b32 s48, 2951168
    buffer_load_dwordx4 v[44:47], v0, s[32:35], s48 offen sc1
    s_mov_b32 s48, 4425728
    buffer_load_dwordx4 v[56:59], v0, s[32:35], s48 offen sc1
    v_and_b32 v2, 15, v1
    v_mul_u32_u24 v2, 2560, v2
    v_lshrrev_b32 v3, 4, v1
    v_lshl_add_u32 v2, v3, 3, v2
    v_accvgpr_read_b32 v80, a80
    v_accvgpr_read_b32 v81, a81
    v_accvgpr_read_b32 v82, a82
    v_accvgpr_read_b32 v83, a83
    s_waitcnt vmcnt(2)
    v_lshlrev_b32 v22, 16, v32
    v_and_b32 v23, 0xffff0000, v32
    v_add_f32 v80, v80, v22
    v_add_f32 v81, v81, v23
    v_lshlrev_b32 v22, 16, v33
    v_and_b32 v23, 0xffff0000, v33
    v_add_f32 v82, v82, v22
    v_add_f32 v83, v83, v23
    s_waitcnt vmcnt(1)
    v_lshlrev_b32 v22, 16, v44
    v_and_b32 v23, 0xffff0000, v44
    v_add_f32 v80, v80, v22
    v_add_f32 v81, v81, v23
    v_lshlrev_b32 v22, 16, v45
    v_and_b32 v23, 0xffff0000, v45
    v_add_f32 v82, v82, v22
    v_add_f32 v83, v83, v23
    s_waitcnt vmcnt(0)
    v_lshlrev_b32 v22, 16, v56
    v_and_b32 v23, 0xffff0000, v56
    v_add_f32 v80, v80, v22
    v_add_f32 v81, v81, v23
    v_lshlrev_b32 v22, 16, v57
    v_and_b32 v23, 0xffff0000, v57
    v_add_f32 v82, v82, v22
    v_add_f32 v83, v83, v23
    v_cvt_pk_bf16_f32 v80, v80, v81
    v_cvt_pk_bf16_f32 v81, v82, v83
    s_add_u32 s48, s86, 81920
    buffer_store_dwordx2 v[80:81], v2, s[12:15], s48 offen offset:0
    v_accvgpr_read_b32 v84, a84
    v_accvgpr_read_b32 v85, a85
    v_accvgpr_read_b32 v86, a86
    v_accvgpr_read_b32 v87, a87
    v_lshlrev_b32 v22, 16, v34
    v_and_b32 v23, 0xffff0000, v34
    v_add_f32 v84, v84, v22
    v_add_f32 v85, v85, v23
    v_lshlrev_b32 v22, 16, v35
    v_and_b32 v23, 0xffff0000, v35
    v_add_f32 v86, v86, v22
    v_add_f32 v87, v87, v23
    v_lshlrev_b32 v22, 16, v46
    v_and_b32 v23, 0xffff0000, v46
    v_add_f32 v84, v84, v22
    v_add_f32 v85, v85, v23
    v_lshlrev_b32 v22, 16, v47
    v_and_b32 v23, 0xffff0000, v47
    v_add_f32 v86, v86, v22
    v_add_f32 v87, v87, v23
    v_lshlrev_b32 v22, 16, v58
    v_and_b32 v23, 0xffff0000, v58
    v_add_f32 v84, v84, v22
    v_add_f32 v85, v85, v23
    v_lshlrev_b32 v22, 16, v59
    v_and_b32 v23, 0xffff0000, v59
    v_add_f32 v86, v86, v22
    v_add_f32 v87, v87, v23
    v_cvt_pk_bf16_f32 v84, v84, v85
    v_cvt_pk_bf16_f32 v85, v86, v87
    s_add_u32 s48, s86, 81920
    buffer_store_dwordx2 v[84:85], v2, s[12:15], s48 offen offset:32
    s_branch L_end2
L_x2_0b:
    s_cmp_lg_u32 s61, 1
    s_cbranch_scc1 L_x2_1b
    v_accvgpr_read_b32 v24, a80
    v_accvgpr_read_b32 v25, a81
    v_accvgpr_read_b32 v26, a82
    v_accvgpr_read_b32 v27, a83
    v_accvgpr_read_b32 v28, a84
    v_accvgpr_read_b32 v29, a85
    v_accvgpr_read_b32 v30, a86
    v_accvgpr_read_b32 v31, a87
    v_cvt_pk_bf16_f32 v24, v24, v25
    v_cvt_pk_bf16_f32 v25, v26, v27
    v_cvt_pk_bf16_f32 v26, v28, v29
    v_cvt_pk_bf16_f32 v27, v30, v31
    s_add_u32 s48, s85, 2048
    buffer_store_dwordx4 v[24:27], v0, s[32:35], s48 offen sc1
    v_accvgpr_read_b32 v32, a64
    v_accvgpr_read_b32 v33, a65
    v_accvgpr_read_b32 v34, a66
    v_accvgpr_read_b32 v35, a67
    v_accvgpr_read_b32 v36, a68
    v_accvgpr_read_b32 v37, a69
    v_accvgpr_read_b32 v38, a70
    v_accvgpr_read_b32 v39, a71
    v_cvt_pk_bf16_f32 v32, v32, v33
    v_cvt_pk_bf16_f32 v33, v34, v35
    v_cvt_pk_bf16_f32 v34, v36, v37
    v_cvt_pk_bf16_f32 v35, v38, v39
    s_add_u32 s48, s85, 8192
    buffer_store_dwordx4 v[32:35], v0, s[32:35], s48 offen sc1
    v_accvgpr_read_b32 v40, a72
    v_accvgpr_read_b32 v41, a73
    v_accvgpr_read_b32 v42, a74
    v_accvgpr_read_b32 v43, a75
    v_accvgpr_read_b32 v44, a76
    v_accvgpr_read_b32 v45, a77
    v_accvgpr_read_b32 v46, a78
    v_accvgpr_read_b32 v47, a79
    v_cvt_pk_bf16_f32 v40, v40, v41
    v_cvt_pk_bf16_f32 v41, v42, v43
    v_cvt_pk_bf16_f32 v42, v44, v45
    v_cvt_pk_bf16_f32 v43, v46, v47
    s_add_u32 s48, s85, 11264
    buffer_store_dwordx4 v[40:43], v0, s[32:35], s48 offen sc1
    s_mul_i32 s86, s63, 12
    s_add_u32 s86, s86, 6
    s_mul_i32 s86, s86, 40960
    s_mul_i32 s87, s62, 1280
    s_add_u32 s86, s86, s87
    s_lshl_b32 s87, s64, 8
    s_add_u32 s86, s86, s87
    s_add_u32 s86, s86, 64
    s_waitcnt vmcnt(0) lgkmcnt(0)
    s_barrier
    s_cmp_lg_u32 s7, 0
    s_cbranch_scc1 L_pub27
    s_and_b32 s48, s2, 7
    s_lshl_b32 s48, s48, 5
    s_lshr_b32 s49, s2, 3
    s_add_u32 s48, s48, s49
    v_mov_b32 v2, s48
    v_mov_b32 v3, 3
    s_mov_b64 exec, 1
    global_store_byte v2, v3, s[22:23] sc1
    s_mov_b64 exec, -1
L_pub27:
    s_mov_b32 s12, s8
    s_mov_b32 s13, s9
    s_mov_b32 s14, 2949120
    s_mov_b32 s15, 0x20000
    s_cmp_lg_u32 s7, 0
    s_cbranch_scc1 L_xp2_1b_skip
    s_lshl_b32 s48, s62, 7
    s_add_u32 s48, s48, s60
    v_and_b32 v2, 3, v1
    v_lshlrev_b32 v2, 5, v2
    v_add_u32 v2, s48, v2
    s_mov_b32 s69, 0
L_xp2_1b_poll:
    global_load_ubyte v3, v2, s[22:23] sc1
    s_add_u32 s69, s69, 1
    s_waitcnt vmcnt(0)
    v_cmp_gt_u32 vcc, 3, v3
    s_cmp_ge_u32 s69, 131072
    s_cbranch_scc1 L_xp2_1b_skip
    s_nop 2
    s_cbranch_vccz L_xp2_1b_skip
    s_sleep 1
    s_branch L_xp2_1b_poll
L_xp2_1b_skip:
    s_barrier
    s_mov_b32 s48, 5120
    buffer_load_dwordx4 v[32:35], v0, s[32:35], s48 offen sc1
    s_mov_b32 s48, 2954240
    buffer_load_dwordx4 v[44:47], v0, s[32:35], s48 offen sc1
    s_mov_b32 s48, 4428800
    buffer_load_dwordx4 v[56:59], v0, s[32:35], s48 offen sc1
    v_and_b32 v2, 15, v1
    v_mul_u32_u24 v2, 2560, v2
    v_lshrrev_b32 v3, 4, v1
    v_lshl_add_u32 v2, v3, 3, v2
    v_accvgpr_read_b32 v80, a88
    v_accvgpr_read_b32 v81, a89
    v_accvgpr_read_b32 v82, a90
    v_accvgpr_read_b32 v83, a91
    s_waitcnt vmcnt(2)
    v_lshlrev_b32 v22, 16, v32
    v_and_b32 v23, 0xffff0000, v32
    v_add_f32 v80, v80, v22
    v_add_f32 v81, v81, v23
    v_lshlrev_b32 v22, 16, v33
    v_and_b32 v23, 0xffff0000, v33
    v_add_f32 v82, v82, v22
    v_add_f32 v83, v83, v23
    s_waitcnt vmcnt(1)
    v_lshlrev_b32 v22, 16, v44
    v_and_b32 v23, 0xffff0000, v44
    v_add_f32 v80, v80, v22
    v_add_f32 v81, v81, v23
    v_lshlrev_b32 v22, 16, v45
    v_and_b32 v23, 0xffff0000, v45
    v_add_f32 v82, v82, v22
    v_add_f32 v83, v83, v23
    s_waitcnt vmcnt(0)
    v_lshlrev_b32 v22, 16, v56
    v_and_b32 v23, 0xffff0000, v56
    v_add_f32 v80, v80, v22
    v_add_f32 v81, v81, v23
    v_lshlrev_b32 v22, 16, v57
    v_and_b32 v23, 0xffff0000, v57
    v_add_f32 v82, v82, v22
    v_add_f32 v83, v83, v23
    v_cvt_pk_bf16_f32 v80, v80, v81
    v_cvt_pk_bf16_f32 v81, v82, v83
    s_add_u32 s48, s86, 81920
    buffer_store_dwordx2 v[80:81], v2, s[12:15], s48 offen offset:0
    v_accvgpr_read_b32 v84, a92
    v_accvgpr_read_b32 v85, a93
    v_accvgpr_read_b32 v86, a94
    v_accvgpr_read_b32 v87, a95
    v_lshlrev_b32 v22, 16, v34
    v_and_b32 v23, 0xffff0000, v34
    v_add_f32 v84, v84, v22
    v_add_f32 v85, v85, v23
    v_lshlrev_b32 v22, 16, v35
    v_and_b32 v23, 0xffff0000, v35
    v_add_f32 v86, v86, v22
    v_add_f32 v87, v87, v23
    v_lshlrev_b32 v22, 16, v46
    v_and_b32 v23, 0xffff0000, v46
    v_add_f32 v84, v84, v22
    v_add_f32 v85, v85, v23
    v_lshlrev_b32 v22, 16, v47
    v_and_b32 v23, 0xffff0000, v47
    v_add_f32 v86, v86, v22
    v_add_f32 v87, v87, v23
    v_lshlrev_b32 v22, 16, v58
    v_and_b32 v23, 0xffff0000, v58
    v_add_f32 v84, v84, v22
    v_add_f32 v85, v85, v23
    v_lshlrev_b32 v22, 16, v59
    v_and_b32 v23, 0xffff0000, v59
    v_add_f32 v86, v86, v22
    v_add_f32 v87, v87, v23
    v_cvt_pk_bf16_f32 v84, v84, v85
    v_cvt_pk_bf16_f32 v85, v86, v87
    s_add_u32 s48, s86, 81920
    buffer_store_dwordx2 v[84:85], v2, s[12:15], s48 offen offset:32
    s_branch L_end2
L_x2_1b:
    s_cmp_lg_u32 s61, 2
    s_cbranch_scc1 L_x2_2b
    v_accvgpr_read_b32 v24, a80
    v_accvgpr_read_b32 v25, a81
    v_accvgpr_read_b32 v26, a82
    v_accvgpr_read_b32 v27, a83
    v_accvgpr_read_b32 v28, a84
    v_accvgpr_read_b32 v29, a85
    v_accvgpr_read_b32 v30, a86
    v_accvgpr_read_b32 v31, a87
    v_cvt_pk_bf16_f32 v24, v24, v25
    v_cvt_pk_bf16_f32 v25, v26, v27
    v_cvt_pk_bf16_f32 v26, v28, v29
    v_cvt_pk_bf16_f32 v27, v30, v31
    s_add_u32 s48, s85, 2048
    buffer_store_dwordx4 v[24:27], v0, s[32:35], s48 offen sc1
    v_accvgpr_read_b32 v32, a88
    v_accvgpr_read_b32 v33, a89
    v_accvgpr_read_b32 v34, a90
    v_accvgpr_read_b32 v35, a91
    v_accvgpr_read_b32 v36, a92
    v_accvgpr_read_b32 v37, a93
    v_accvgpr_read_b32 v38, a94
    v_accvgpr_read_b32 v39, a95
    v_cvt_pk_bf16_f32 v32, v32, v33
    v_cvt_pk_bf16_f32 v33, v34, v35
    v_cvt_pk_bf16_f32 v34, v36, v37
    v_cvt_pk_bf16_f32 v35, v38, v39
    s_add_u32 s48, s85, 5120
    buffer_store_dwordx4 v[32:35], v0, s[32:35], s48 offen sc1
    v_accvgpr_read_b32 v40, a72
    v_accvgpr_read_b32 v41, a73
    v_accvgpr_read_b32 v42, a74
    v_accvgpr_read_b32 v43, a75
    v_accvgpr_read_b32 v44, a76
    v_accvgpr_read_b32 v45, a77
    v_accvgpr_read_b32 v46, a78
    v_accvgpr_read_b32 v47, a79
    v_cvt_pk_bf16_f32 v40, v40, v41
    v_cvt_pk_bf16_f32 v41, v42, v43
    v_cvt_pk_bf16_f32 v42, v44, v45
    v_cvt_pk_bf16_f32 v43, v46, v47
    s_add_u32 s48, s85, 11264
    buffer_store_dwordx4 v[40:43], v0, s[32:35], s48 offen sc1
    s_mul_i32 s86, s63, 12
    s_add_u32 s86, s86, 6
    s_mul_i32 s86, s86, 40960
    s_mul_i32 s87, s62, 1280
    s_add_u32 s86, s86, s87
    s_lshl_b32 s87, s64, 8
    s_add_u32 s86, s86, s87
    s_add_u32 s86, s86, 128
    s_waitcnt vmcnt(0) lgkmcnt(0)
    s_barrier
    s_cmp_lg_u32 s7, 0
    s_cbranch_scc1 L_pub28
    s_and_b32 s48, s2, 7
    s_lshl_b32 s48, s48, 5
    s_lshr_b32 s49, s2, 3
    s_add_u32 s48, s48, s49
    v_mov_b32 v2, s48
    v_mov_b32 v3, 3
    s_mov_b64 exec, 1
    global_store_byte v2, v3, s[22:23] sc1
    s_mov_b64 exec, -1
L_pub28:
    s_mov_b32 s12, s8
    s_mov_b32 s13, s9
    s_mov_b32 s14, 2949120
    s_mov_b32 s15, 0x20000
    s_cmp_lg_u32 s7, 0
    s_cbranch_scc1 L_xp2_2b_skip
    s_lshl_b32 s48, s62, 7
    s_add_u32 s48, s48, s60
    v_and_b32 v2, 3, v1
    v_lshlrev_b32 v2, 5, v2
    v_add_u32 v2, s48, v2
    s_mov_b32 s69, 0
L_xp2_2b_poll:
    global_load_ubyte v3, v2, s[22:23] sc1
    s_add_u32 s69, s69, 1
    s_waitcnt vmcnt(0)
    v_cmp_gt_u32 vcc, 3, v3
    s_cmp_ge_u32 s69, 131072
    s_cbranch_scc1 L_xp2_2b_skip
    s_nop 2
    s_cbranch_vccz L_xp2_2b_skip
    s_sleep 1
    s_branch L_xp2_2b_poll
L_xp2_2b_skip:
    s_barrier
    s_mov_b32 s48, 8192
    buffer_load_dwordx4 v[32:35], v0, s[32:35], s48 offen sc1
    s_mov_b32 s48, 1482752
    buffer_load_dwordx4 v[44:47], v0, s[32:35], s48 offen sc1
    s_mov_b32 s48, 4431872
    buffer_load_dwordx4 v[56:59], v0, s[32:35], s48 offen sc1
    v_and_b32 v2, 15, v1
    v_mul_u32_u24 v2, 2560, v2
    v_lshrrev_b32 v3, 4, v1
    v_lshl_add_u32 v2, v3, 3, v2
    v_accvgpr_read_b32 v80, a64
    v_accvgpr_read_b32 v81, a65
    v_accvgpr_read_b32 v82, a66
    v_accvgpr_read_b32 v83, a67
    s_waitcnt vmcnt(2)
    v_lshlrev_b32 v22, 16, v32
    v_and_b32 v23, 0xffff0000, v32
    v_add_f32 v80, v80, v22
    v_add_f32 v81, v81, v23
    v_lshlrev_b32 v22, 16, v33
    v_and_b32 v23, 0xffff0000, v33
    v_add_f32 v82, v82, v22
    v_add_f32 v83, v83, v23
    s_waitcnt vmcnt(1)
    v_lshlrev_b32 v22, 16, v44
    v_and_b32 v23, 0xffff0000, v44
    v_add_f32 v80, v80, v22
    v_add_f32 v81, v81, v23
    v_lshlrev_b32 v22, 16, v45
    v_and_b32 v23, 0xffff0000, v45
    v_add_f32 v82, v82, v22
    v_add_f32 v83, v83, v23
    s_waitcnt vmcnt(0)
    v_lshlrev_b32 v22, 16, v56
    v_and_b32 v23, 0xffff0000, v56
    v_add_f32 v80, v80, v22
    v_add_f32 v81, v81, v23
    v_lshlrev_b32 v22, 16, v57
    v_and_b32 v23, 0xffff0000, v57
    v_add_f32 v82, v82, v22
    v_add_f32 v83, v83, v23
    v_cvt_pk_bf16_f32 v80, v80, v81
    v_cvt_pk_bf16_f32 v81, v82, v83
    s_add_u32 s48, s86, 81920
    buffer_store_dwordx2 v[80:81], v2, s[12:15], s48 offen offset:0
    v_accvgpr_read_b32 v84, a68
    v_accvgpr_read_b32 v85, a69
    v_accvgpr_read_b32 v86, a70
    v_accvgpr_read_b32 v87, a71
    v_lshlrev_b32 v22, 16, v34
    v_and_b32 v23, 0xffff0000, v34
    v_add_f32 v84, v84, v22
    v_add_f32 v85, v85, v23
    v_lshlrev_b32 v22, 16, v35
    v_and_b32 v23, 0xffff0000, v35
    v_add_f32 v86, v86, v22
    v_add_f32 v87, v87, v23
    v_lshlrev_b32 v22, 16, v46
    v_and_b32 v23, 0xffff0000, v46
    v_add_f32 v84, v84, v22
    v_add_f32 v85, v85, v23
    v_lshlrev_b32 v22, 16, v47
    v_and_b32 v23, 0xffff0000, v47
    v_add_f32 v86, v86, v22
    v_add_f32 v87, v87, v23
    v_lshlrev_b32 v22, 16, v58
    v_and_b32 v23, 0xffff0000, v58
    v_add_f32 v84, v84, v22
    v_add_f32 v85, v85, v23
    v_lshlrev_b32 v22, 16, v59
    v_and_b32 v23, 0xffff0000, v59
    v_add_f32 v86, v86, v22
    v_add_f32 v87, v87, v23
    v_cvt_pk_bf16_f32 v84, v84, v85
    v_cvt_pk_bf16_f32 v85, v86, v87
    s_add_u32 s48, s86, 81920
    buffer_store_dwordx2 v[84:85], v2, s[12:15], s48 offen offset:32
    s_branch L_end2
L_x2_2b:
    s_cmp_lg_u32 s61, 3
    s_cbranch_scc1 L_x2_3b
    v_accvgpr_read_b32 v24, a80
    v_accvgpr_read_b32 v25, a81
    v_accvgpr_read_b32 v26, a82
    v_accvgpr_read_b32 v27, a83
    v_accvgpr_read_b32 v28, a84
    v_accvgpr_read_b32 v29, a85
    v_accvgpr_read_b32 v30, a86
    v_accvgpr_read_b32 v31, a87
    v_cvt_pk_bf16_f32 v24, v24, v25
    v_cvt_pk_bf16_f32 v25, v26, v27
    v_cvt_pk_bf16_f32 v26, v28, v29
    v_cvt_pk_bf16_f32 v27, v30, v31
    s_add_u32 s48, s85, 2048
    buffer_store_dwordx4 v[24:27], v0, s[32:35], s48 offen sc1
    v_accvgpr_read_b32 v32, a88
    v_accvgpr_read_b32 v33, a89
    v_accvgpr_read_b32 v34, a90
    v_accvgpr_read_b32 v35, a91
    v_accvgpr_read_b32 v36, a92
    v_accvgpr_read_b32 v37, a93
    v_accvgpr_read_b32 v38, a94
    v_accvgpr_read_b32 v39, a95
    v_cvt_pk_bf16_f32 v32, v32, v33
    v_cvt_pk_bf16_f32 v33, v34, v35
    v_cvt_pk_bf16_f32 v34, v36, v37
    v_cvt_pk_bf16_f32 v35, v38, v39
    s_add_u32 s48, s85, 5120
    buffer_store_dwordx4 v[32:35], v0, s[32:35], s48 offen sc1
    v_accvgpr_read_b32 v40, a64
    v_accvgpr_read_b32 v41, a65
    v_accvgpr_read_b32 v42, a66
    v_accvgpr_read_b32 v43, a67
    v_accvgpr_read_b32 v44, a68
    v_accvgpr_read_b32 v45, a69
    v_accvgpr_read_b32 v46, a70
    v_accvgpr_read_b32 v47, a71
    v_cvt_pk_bf16_f32 v40, v40, v41
    v_cvt_pk_bf16_f32 v41, v42, v43
    v_cvt_pk_bf16_f32 v42, v44, v45
    v_cvt_pk_bf16_f32 v43, v46, v47
    s_add_u32 s48, s85, 8192
    buffer_store_dwordx4 v[40:43], v0, s[32:35], s48 offen sc1
    s_mul_i32 s86, s63, 12
    s_add_u32 s86, s86, 6
    s_mul_i32 s86, s86, 40960
    s_mul_i32 s87, s62, 1280
    s_add_u32 s86, s86, s87
    s_lshl_b32 s87, s64, 8
    s_add_u32 s86, s86, s87
    s_add_u32 s86, s86, 192
    s_waitcnt vmcnt(0) lgkmcnt(0)
    s_barrier
    s_cmp_lg_u32 s7, 0
    s_cbranch_scc1 L_pub29
    s_and_b32 s48, s2, 7
    s_lshl_b32 s48, s48, 5
    s_lshr_b32 s49, s2, 3
    s_add_u32 s48, s48, s49
    v_mov_b32 v2, s48
    v_mov_b32 v3, 3
    s_mov_b64 exec, 1
    global_store_byte v2, v3, s[22:23] sc1
    s_mov_b64 exec, -1
L_pub29:
    s_mov_b32 s12, s8
    s_mov_b32 s13, s9
    s_mov_b32 s14, 2949120
    s_mov_b32 s15, 0x20000
    s_cmp_lg_u32 s7, 0
    s_cbranch_scc1 L_xp2_3b_skip
    s_lshl_b32 s48, s62, 7
    s_add_u32 s48, s48, s60
    v_and_b32 v2, 3, v1
    v_lshlrev_b32 v2, 5, v2
    v_add_u32 v2, s48, v2
    s_mov_b32 s69, 0
L_xp2_3b_poll:
    global_load_ubyte v3, v2, s[22:23] sc1
    s_add_u32 s69, s69, 1
    s_waitcnt vmcnt(0)
    v_cmp_gt_u32 vcc, 3, v3
    s_cmp_ge_u32 s69, 131072
    s_cbranch_scc1 L_xp2_3b_skip
    s_nop 2
    s_cbranch_vccz L_xp2_3b_skip
    s_sleep 1
    s_branch L_xp2_3b_poll
L_xp2_3b_skip:
    s_barrier
    s_mov_b32 s48, 11264
    buffer_load_dwordx4 v[32:35], v0, s[32:35], s48 offen sc1
    s_mov_b32 s48, 1485824
    buffer_load_dwordx4 v[44:47], v0, s[32:35], s48 offen sc1
    s_mov_b32 s48, 2960384
    buffer_load_dwordx4 v[56:59], v0, s[32:35], s48 offen sc1
    v_and_b32 v2, 15, v1
    v_mul_u32_u24 v2, 2560, v2
    v_lshrrev_b32 v3, 4, v1
    v_lshl_add_u32 v2, v3, 3, v2
    v_accvgpr_read_b32 v80, a72
    v_accvgpr_read_b32 v81, a73
    v_accvgpr_read_b32 v82, a74
    v_accvgpr_read_b32 v83, a75
    s_waitcnt vmcnt(2)
    v_lshlrev_b32 v22, 16, v32
    v_and_b32 v23, 0xffff0000, v32
    v_add_f32 v80, v80, v22
    v_add_f32 v81, v81, v23
    v_lshlrev_b32 v22, 16, v33
    v_and_b32 v23, 0xffff0000, v33
    v_add_f32 v82, v82, v22
    v_add_f32 v83, v83, v23
    s_waitcnt vmcnt(1)
    v_lshlrev_b32 v22, 16, v44
    v_and_b32 v23, 0xffff0000, v44
    v_add_f32 v80, v80, v22
    v_add_f32 v81, v81, v23
    v_lshlrev_b32 v22, 16, v45
    v_and_b32 v23, 0xffff0000, v45
    v_add_f32 v82, v82, v22
    v_add_f32 v83, v83, v23
    s_waitcnt vmcnt(0)
    v_lshlrev_b32 v22, 16, v56
    v_and_b32 v23, 0xffff0000, v56
    v_add_f32 v80, v80, v22
    v_add_f32 v81, v81, v23
    v_lshlrev_b32 v22, 16, v57
    v_and_b32 v23, 0xffff0000, v57
    v_add_f32 v82, v82, v22
    v_add_f32 v83, v83, v23
    v_cvt_pk_bf16_f32 v80, v80, v81
    v_cvt_pk_bf16_f32 v81, v82, v83
    s_add_u32 s48, s86, 81920
    buffer_store_dwordx2 v[80:81], v2, s[12:15], s48 offen offset:0
    v_accvgpr_read_b32 v84, a76
    v_accvgpr_read_b32 v85, a77
    v_accvgpr_read_b32 v86, a78
    v_accvgpr_read_b32 v87, a79
    v_lshlrev_b32 v22, 16, v34
    v_and_b32 v23, 0xffff0000, v34
    v_add_f32 v84, v84, v22
    v_add_f32 v85, v85, v23
    v_lshlrev_b32 v22, 16, v35
    v_and_b32 v23, 0xffff0000, v35
    v_add_f32 v86, v86, v22
    v_add_f32 v87, v87, v23
    v_lshlrev_b32 v22, 16, v46
    v_and_b32 v23, 0xffff0000, v46
    v_add_f32 v84, v84, v22
    v_add_f32 v85, v85, v23
    v_lshlrev_b32 v22, 16, v47
    v_and_b32 v23, 0xffff0000, v47
    v_add_f32 v86, v86, v22
    v_add_f32 v87, v87, v23
    v_lshlrev_b32 v22, 16, v58
    v_and_b32 v23, 0xffff0000, v58
    v_add_f32 v84, v84, v22
    v_add_f32 v85, v85, v23
    v_lshlrev_b32 v22, 16, v59
    v_and_b32 v23, 0xffff0000, v59
    v_add_f32 v86, v86, v22
    v_add_f32 v87, v87, v23
    v_cvt_pk_bf16_f32 v84, v84, v85
    v_cvt_pk_bf16_f32 v85, v86, v87
    s_add_u32 s48, s86, 81920
    buffer_store_dwordx2 v[84:85], v2, s[12:15], s48 offen offset:32
    s_branch L_end2
L_x2_3b:
L_xw3b:
    s_lshl_b32 s84, s62, 2
    s_mul_i32 s84, s84, 30
    s_add_u32 s84, s84, s60
    s_lshl_b32 s84, s84, 2
    s_add_u32 s84, s84, s3
    s_mul_i32 s84, s84, 12288
    s_add_u32 s84, s84, 18874368
    s_add_u32 s32, s4, s84
    s_addc_u32 s33, s5, 0
    s_mov_b32 s34, 4435968
    s_mov_b32 s35, 0x20000
    s_mul_i32 s85, s61, 1474560
    s_load_dwordx2 s[8:9], s[0:1], 80
    s_nop 7
    s_cmp_lg_u32 s61, 0
    s_cbranch_scc1 L_x3_0b
    v_accvgpr_read_b32 v24, a80
    v_accvgpr_read_b32 v25, a81
    v_accvgpr_read_b32 v26, a82
    v_accvgpr_read_b32 v27, a83
    v_accvgpr_read_b32 v28, a84
    v_accvgpr_read_b32 v29, a85
    v_accvgpr_read_b32 v30, a86
    v_accvgpr_read_b32 v31, a87
    v_cvt_pk_bf16_f32 v24, v24, v25
    v_cvt_pk_bf16_f32 v25, v26, v27
    v_cvt_pk_bf16_f32 v26, v28, v29
    v_cvt_pk_bf16_f32 v27, v30, v31
    s_add_u32 s48, s85, 5120
    buffer_store_dwordx4 v[24:27], v0, s[32:35], s48 offen sc1
    v_accvgpr_read_b32 v32, a88
    v_accvgpr_read_b32 v33, a89
    v_accvgpr_read_b32 v34, a90
    v_accvgpr_read_b32 v35, a91
    v_accvgpr_read_b32 v36, a92
    v_accvgpr_read_b32 v37, a93
    v_accvgpr_read_b32 v38, a94
    v_accvgpr_read_b32 v39, a95
    v_cvt_pk_bf16_f32 v32, v32, v33
    v_cvt_pk_bf16_f32 v33, v34, v35
    v_cvt_pk_bf16_f32 v34, v36, v37
    v_cvt_pk_bf16_f32 v35, v38, v39
    s_add_u32 s48, s85, 8192
    buffer_store_dwordx4 v[32:35], v0, s[32:35], s48 offen sc1
    v_accvgpr_read_b32 v40, a64
    v_accvgpr_read_b32 v41, a65
    v_accvgpr_read_b32 v42, a66
    v_accvgpr_read_b32 v43, a67
    v_accvgpr_read_b32 v44, a68
    v_accvgpr_read_b32 v45, a69
    v_accvgpr_read_b32 v46, a70
    v_accvgpr_read_b32 v47, a71
    v_cvt_pk_bf16_f32 v40, v40, v41
    v_cvt_pk_bf16_f32 v41, v42, v43
    v_cvt_pk_bf16_f32 v42, v44, v45
    v_cvt_pk_bf16_f32 v43, v46, v47
    s_add_u32 s48, s85, 11264
    buffer_store_dwordx4 v[40:43], v0, s[32:35], s48 offen sc1
    s_mul_i32 s86, s63, 12
    s_add_u32 s86, s86, 9
    s_mul_i32 s86, s86, 40960
    s_mul_i32 s87, s62, 1280
    s_add_u32 s86, s86, s87
    s_lshl_b32 s87, s64, 8
    s_add_u32 s86, s86, s87
    s_add_u32 s86, s86, 0
    s_waitcnt vmcnt(0) lgkmcnt(0)
    s_barrier
    s_cmp_lg_u32 s7, 0
    s_cbranch_scc1 L_pub30
    s_and_b32 s48, s2, 7
    s_lshl_b32 s48, s48, 5
    s_lshr_b32 s49, s2, 3
    s_add_u32 s48, s48, s49
    v_mov_b32 v2, s48
    v_mov_b32 v3, 3
    s_mov_b64 exec, 1
    global_store_byte v2, v3, s[22:23] sc1
    s_mov_b64 exec, -1
L_pub30:
    s_mov_b32 s12, s8
    s_mov_b32 s13, s9
    s_mov_b32 s14, 2949120
    s_mov_b32 s15, 0x20000
    s_cmp_lg_u32 s7, 0
    s_cbranch_scc1 L_xp3_0b_skip
    s_lshl_b32 s48, s62, 7
    s_add_u32 s48, s48, s60
    v_and_b32 v2, 3, v1
    v_lshlrev_b32 v2, 5, v2
    v_add_u32 v2, s48, v2
    s_mov_b32 s69, 0
L_xp3_0b_poll:
    global_load_ubyte v3, v2, s[22:23] sc1
    s_add_u32 s69, s69, 1
    s_waitcnt vmcnt(0)
    v_cmp_gt_u32 vcc, 3, v3
    s_cmp_ge_u32 s69, 131072
    s_cbranch_scc1 L_xp3_0b_skip
    s_nop 2
    s_cbranch_vccz L_xp3_0b_skip
    s_sleep 1
    s_branch L_xp3_0b_poll
L_xp3_0b_skip:
    s_barrier
    s_mov_b32 s48, 1476608
    buffer_load_dwordx4 v[32:35], v0, s[32:35], s48 offen sc1
    s_mov_b32 s48, 2951168
    buffer_load_dwordx4 v[44:47], v0, s[32:35], s48 offen sc1
    s_mov_b32 s48, 4425728
    buffer_load_dwordx4 v[56:59], v0, s[32:35], s48 offen sc1
    v_and_b32 v2, 15, v1
    v_mul_u32_u24 v2, 2560, v2
    v_lshrrev_b32 v3, 4, v1
    v_lshl_add_u32 v2, v3, 3, v2
    v_accvgpr_read_b32 v80, a72
    v_accvgpr_read_b32 v81, a73
    v_accvgpr_read_b32 v82, a74
    v_accvgpr_read_b32 v83, a75
    s_waitcnt vmcnt(2)
    v_lshlrev_b32 v22, 16, v32
    v_and_b32 v23, 0xffff0000, v32
    v_add_f32 v80, v80, v22
    v_add_f32 v81, v81, v23
    v_lshlrev_b32 v22, 16, v33
    v_and_b32 v23, 0xffff0000, v33
    v_add_f32 v82, v82, v22
    v_add_f32 v83, v83, v23
    s_waitcnt vmcnt(1)
    v_lshlrev_b32 v22, 16, v44
    v_and_b32 v23, 0xffff0000, v44
    v_add_f32 v80, v80, v22
    v_add_f32 v81, v81, v23
    v_lshlrev_b32 v22, 16, v45
    v_and_b32 v23, 0xffff0000, v45
    v_add_f32 v82, v82, v22
    v_add_f32 v83, v83, v23
    s_waitcnt vmcnt(0)
    v_lshlrev_b32 v22, 16, v56
    v_and_b32 v23, 0xffff0000, v56
    v_add_f32 v80, v80, v22
    v_add_f32 v81, v81, v23
    v_lshlrev_b32 v22, 16, v57
    v_and_b32 v23, 0xffff0000, v57
    v_add_f32 v82, v82, v22
    v_add_f32 v83, v83, v23
    v_cvt_pk_bf16_f32 v80, v80, v81
    v_cvt_pk_bf16_f32 v81, v82, v83
    s_add_u32 s48, s86, 81920
    buffer_store_dwordx2 v[80:81], v2, s[12:15], s48 offen offset:0
    v_accvgpr_read_b32 v84, a76
    v_accvgpr_read_b32 v85, a77
    v_accvgpr_read_b32 v86, a78
    v_accvgpr_read_b32 v87, a79
    v_lshlrev_b32 v22, 16, v34
    v_and_b32 v23, 0xffff0000, v34
    v_add_f32 v84, v84, v22
    v_add_f32 v85, v85, v23
    v_lshlrev_b32 v22, 16, v35
    v_and_b32 v23, 0xffff0000, v35
    v_add_f32 v86, v86, v22
    v_add_f32 v87, v87, v23
    v_lshlrev_b32 v22, 16, v46
    v_and_b32 v23, 0xffff0000, v46
    v_add_f32 v84, v84, v22
    v_add_f32 v85, v85, v23
    v_lshlrev_b32 v22, 16, v47
    v_and_b32 v23, 0xffff0000, v47
    v_add_f32 v86, v86, v22
    v_add_f32 v87, v87, v23
    v_lshlrev_b32 v22, 16, v58
    v_and_b32 v23, 0xffff0000, v58
    v_add_f32 v84, v84, v22
    v_add_f32 v85, v85, v23
    v_lshlrev_b32 v22, 16, v59
    v_and_b32 v23, 0xffff0000, v59
    v_add_f32 v86, v86, v22
    v_add_f32 v87, v87, v23
    v_cvt_pk_bf16_f32 v84, v84, v85
    v_cvt_pk_bf16_f32 v85, v86, v87
    s_add_u32 s48, s86, 81920
    buffer_store_dwordx2 v[84:85], v2, s[12:15], s48 offen offset:32
    s_branch L_end2
L_x3_0b:
    s_cmp_lg_u32 s61, 1
    s_cbranch_scc1 L_x3_1b
    v_accvgpr_read_b32 v24, a72
    v_accvgpr_read_b32 v25, a73
    v_accvgpr_read_b32 v26, a74
    v_accvgpr_read_b32 v27, a75
    v_accvgpr_read_b32 v28, a76
    v_accvgpr_read_b32 v29, a77
    v_accvgpr_read_b32 v30, a78
    v_accvgpr_read_b32 v31, a79
    v_cvt_pk_bf16_f32 v24, v24, v25
    v_cvt_pk_bf16_f32 v25, v26, v27
    v_cvt_pk_bf16_f32 v26, v28, v29
    v_cvt_pk_bf16_f32 v27, v30, v31
    s_add_u32 s48, s85, 2048
    buffer_store_dwordx4 v[24:27], v0, s[32:35], s48 offen sc1
    v_accvgpr_read_b32 v32, a88
    v_accvgpr_read_b32 v33, a89
    v_accvgpr_read_b32 v34, a90
    v_accvgpr_read_b32 v35, a91
    v_accvgpr_read_b32 v36, a92
    v_accvgpr_read_b32 v37, a93
    v_accvgpr_read_b32 v38, a94
    v_accvgpr_read_b32 v39, a95
    v_cvt_pk_bf16_f32 v32, v32, v33
    v_cvt_pk_bf16_f32 v33, v34, v35
    v_cvt_pk_bf16_f32 v34, v36, v37
    v_cvt_pk_bf16_f32 v35, v38, v39
    s_add_u32 s48, s85, 8192
    buffer_store_dwordx4 v[32:35], v0, s[32:35], s48 offen sc1
    v_accvgpr_read_b32 v40, a64
    v_accvgpr_read_b32 v41, a65
    v_accvgpr_read_b32 v42, a66
    v_accvgpr_read_b32 v43, a67
    v_accvgpr_read_b32 v44, a68
    v_accvgpr_read_b32 v45, a69
    v_accvgpr_read_b32 v46, a70
    v_accvgpr_read_b32 v47, a71
    v_cvt_pk_bf16_f32 v40, v40, v41
    v_cvt_pk_bf16_f32 v41, v42, v43
    v_cvt_pk_bf16_f32 v42, v44, v45
    v_cvt_pk_bf16_f32 v43, v46, v47
    s_add_u32 s48, s85, 11264
    buffer_store_dwordx4 v[40:43], v0, s[32:35], s48 offen sc1
    s_mul_i32 s86, s63, 12
    s_add_u32 s86, s86, 9
    s_mul_i32 s86, s86, 40960
    s_mul_i32 s87, s62, 1280
    s_add_u32 s86, s86, s87
    s_lshl_b32 s87, s64, 8
    s_add_u32 s86, s86, s87
    s_add_u32 s86, s86, 64
    s_waitcnt vmcnt(0) lgkmcnt(0)
    s_barrier
    s_cmp_lg_u32 s7, 0
    s_cbranch_scc1 L_pub31
    s_and_b32 s48, s2, 7
    s_lshl_b32 s48, s48, 5
    s_lshr_b32 s49, s2, 3
    s_add_u32 s48, s48, s49
    v_mov_b32 v2, s48
    v_mov_b32 v3, 3
    s_mov_b64 exec, 1
    global_store_byte v2, v3, s[22:23] sc1
    s_mov_b64 exec, -1
L_pub31:
    s_mov_b32 s12, s8
    s_mov_b32 s13, s9
    s_mov_b32 s14, 2949120
    s_mov_b32 s15, 0x20000
    s_cmp_lg_u32 s7, 0
    s_cbranch_scc1 L_xp3_1b_skip
    s_lshl_b32 s48, s62, 7
    s_add_u32 s48, s48, s60
    v_and_b32 v2, 3, v1
    v_lshlrev_b32 v2, 5, v2
    v_add_u32 v2, s48, v2
    s_mov_b32 s69, 0
L_xp3_1b_poll:
    global_load_ubyte v3, v2, s[22:23] sc1
    s_add_u32 s69, s69, 1
    s_waitcnt vmcnt(0)
    v_cmp_gt_u32 vcc, 3, v3
    s_cmp_ge_u32 s69, 131072
    s_cbranch_scc1 L_xp3_1b_skip
    s_nop 2
    s_cbranch_vccz L_xp3_1b_skip
    s_sleep 1
    s_branch L_xp3_1b_poll
L_xp3_1b_skip:
    s_barrier
    s_mov_b32 s48, 5120
    buffer_load_dwordx4 v[32:35], v0, s[32:35], s48 offen sc1
    s_mov_b32 s48, 2954240
    buffer_load_dwordx4 v[44:47], v0, s[32:35], s48 offen sc1
    s_mov_b32 s48, 4428800
    buffer_load_dwordx4 v[56:59], v0, s[32:35], s48 offen sc1
    v_and_b32 v2, 15, v1
    v_mul_u32_u24 v2, 2560, v2
    v_lshrrev_b32 v3, 4, v1
    v_lshl_add_u32 v2, v3, 3, v2
    v_accvgpr_read_b32 v80, a80
    v_accvgpr_read_b32 v81, a81
    v_accvgpr_read_b32 v82, a82
    v_accvgpr_read_b32 v83, a83
    s_waitcnt vmcnt(2)
    v_lshlrev_b32 v22, 16, v32
    v_and_b32 v23, 0xffff0000, v32
    v_add_f32 v80, v80, v22
    v_add_f32 v81, v81, v23
    v_lshlrev_b32 v22, 16, v33
    v_and_b32 v23, 0xffff0000, v33
    v_add_f32 v82, v82, v22
    v_add_f32 v83, v83, v23
    s_waitcnt vmcnt(1)
    v_lshlrev_b32 v22, 16, v44
    v_and_b32 v23, 0xffff0000, v44
    v_add_f32 v80, v80, v22
    v_add_f32 v81, v81, v23
    v_lshlrev_b32 v22, 16, v45
    v_and_b32 v23, 0xffff0000, v45
    v_add_f32 v82, v82, v22
    v_add_f32 v83, v83, v23
    s_waitcnt vmcnt(0)
    v_lshlrev_b32 v22, 16, v56
    v_and_b32 v23, 0xffff0000, v56
    v_add_f32 v80, v80, v22
    v_add_f32 v81, v81, v23
    v_lshlrev_b32 v22, 16, v57
    v_and_b32 v23, 0xffff0000, v57
    v_add_f32 v82, v82, v22
    v_add_f32 v83, v83, v23
    v_cvt_pk_bf16_f32 v80, v80, v81
    v_cvt_pk_bf16_f32 v81, v82, v83
    s_add_u32 s48, s86, 81920
    buffer_store_dwordx2 v[80:81], v2, s[12:15], s48 offen offset:0
    v_accvgpr_read_b32 v84, a84
    v_accvgpr_read_b32 v85, a85
    v_accvgpr_read_b32 v86, a86
    v_accvgpr_read_b32 v87, a87
    v_lshlrev_b32 v22, 16, v34
    v_and_b32 v23, 0xffff0000, v34
    v_add_f32 v84, v84, v22
    v_add_f32 v85, v85, v23
    v_lshlrev_b32 v22, 16, v35
    v_and_b32 v23, 0xffff0000, v35
    v_add_f32 v86, v86, v22
    v_add_f32 v87, v87, v23
    v_lshlrev_b32 v22, 16, v46
    v_and_b32 v23, 0xffff0000, v46
    v_add_f32 v84, v84, v22
    v_add_f32 v85, v85, v23
    v_lshlrev_b32 v22, 16, v47
    v_and_b32 v23, 0xffff0000, v47
    v_add_f32 v86, v86, v22
    v_add_f32 v87, v87, v23
    v_lshlrev_b32 v22, 16, v58
    v_and_b32 v23, 0xffff0000, v58
    v_add_f32 v84, v84, v22
    v_add_f32 v85, v85, v23
    v_lshlrev_b32 v22, 16, v59
    v_and_b32 v23, 0xffff0000, v59
    v_add_f32 v86, v86, v22
    v_add_f32 v87, v87, v23
    v_cvt_pk_bf16_f32 v84, v84, v85
    v_cvt_pk_bf16_f32 v85, v86, v87
    s_add_u32 s48, s86, 81920
    buffer_store_dwordx2 v[84:85], v2, s[12:15], s48 offen offset:32
    s_branch L_end2
L_x3_1b:
    s_cmp_lg_u32 s61, 2
    s_cbranch_scc1 L_x3_2b
    v_accvgpr_read_b32 v24, a72
    v_accvgpr_read_b32 v25, a73
    v_accvgpr_read_b32 v26, a74
    v_accvgpr_read_b32 v27, a75
    v_accvgpr_read_b32 v28, a76
    v_accvgpr_read_b32 v29, a77
    v_accvgpr_read_b32 v30, a78
    v_accvgpr_read_b32 v31, a79
    v_cvt_pk_bf16_f32 v24, v24, v25
    v_cvt_pk_bf16_f32 v25, v26, v27
    v_cvt_pk_bf16_f32 v26, v28, v29
    v_cvt_pk_bf16_f32 v27, v30, v31
    s_add_u32 s48, s85, 2048
    buffer_store_dwordx4 v[24:27], v0, s[32:35], s48 offen sc1
    v_accvgpr_read_b32 v32, a80
    v_accvgpr_read_b32 v33, a81
    v_accvgpr_read_b32 v34, a82
    v_accvgpr_read_b32 v35, a83
    v_accvgpr_read_b32 v36, a84
    v_accvgpr_read_b32 v37, a85
    v_accvgpr_read_b32 v38, a86
    v_accvgpr_read_b32 v39, a87
    v_cvt_pk_bf16_f32 v32, v32, v33
    v_cvt_pk_bf16_f32 v33, v34, v35
    v_cvt_pk_bf16_f32 v34, v36, v37
    v_cvt_pk_bf16_f32 v35, v38, v39
    s_add_u32 s48, s85, 5120
    buffer_store_dwordx4 v[32:35], v0, s[32:35], s48 offen sc1
    v_accvgpr_read_b32 v40, a64
    v_accvgpr_read_b32 v41, a65
    v_accvgpr_read_b32 v42, a66
    v_accvgpr_read_b32 v43, a67
    v_accvgpr_read_b32 v44, a68
    v_accvgpr_read_b32 v45, a69
    v_accvgpr_read_b32 v46, a70
    v_accvgpr_read_b32 v47, a71
    v_cvt_pk_bf16_f32 v40, v40, v41
    v_cvt_pk_bf16_f32 v41, v42, v43
    v_cvt_pk_bf16_f32 v42, v44, v45
    v_cvt_pk_bf16_f32 v43, v46, v47
    s_add_u32 s48, s85, 11264
    buffer_store_dwordx4 v[40:43], v0, s[32:35], s48 offen sc1
    s_mul_i32 s86, s63, 12
    s_add_u32 s86, s86, 9
    s_mul_i32 s86, s86, 40960
    s_mul_i32 s87, s62, 1280
    s_add_u32 s86, s86, s87
    s_lshl_b32 s87, s64, 8
    s_add_u32 s86, s86, s87
    s_add_u32 s86, s86, 128
    s_waitcnt vmcnt(0) lgkmcnt(0)
    s_barrier
    s_cmp_lg_u32 s7, 0
    s_cbranch_scc1 L_pub32
    s_and_b32 s48, s2, 7
    s_lshl_b32 s48, s48, 5
    s_lshr_b32 s49, s2, 3
    s_add_u32 s48, s48, s49
    v_mov_b32 v2, s48
    v_mov_b32 v3, 3
    s_mov_b64 exec, 1
    global_store_byte v2, v3, s[22:23] sc1
    s_mov_b64 exec, -1
L_pub32:
    s_mov_b32 s12, s8
    s_mov_b32 s13, s9
    s_mov_b32 s14, 2949120
    s_mov_b32 s15, 0x20000
    s_cmp_lg_u32 s7, 0
    s_cbranch_scc1 L_xp3_2b_skip
    s_lshl_b32 s48, s62, 7
    s_add_u32 s48, s48, s60
    v_and_b32 v2, 3, v1
    v_lshlrev_b32 v2, 5, v2
    v_add_u32 v2, s48, v2
    s_mov_b32 s69, 0
L_xp3_2b_poll:
    global_load_ubyte v3, v2, s[22:23] sc1
    s_add_u32 s69, s69, 1
    s_waitcnt vmcnt(0)
    v_cmp_gt_u32 vcc, 3, v3
    s_cmp_ge_u32 s69, 131072
    s_cbranch_scc1 L_xp3_2b_skip
    s_nop 2
    s_cbranch_vccz L_xp3_2b_skip
    s_sleep 1
    s_branch L_xp3_2b_poll
L_xp3_2b_skip:
    s_barrier
    s_mov_b32 s48, 8192
    buffer_load_dwordx4 v[32:35], v0, s[32:35], s48 offen sc1
    s_mov_b32 s48, 1482752
    buffer_load_dwordx4 v[44:47], v0, s[32:35], s48 offen sc1
    s_mov_b32 s48, 4431872
    buffer_load_dwordx4 v[56:59], v0, s[32:35], s48 offen sc1
    v_and_b32 v2, 15, v1
    v_mul_u32_u24 v2, 2560, v2
    v_lshrrev_b32 v3, 4, v1
    v_lshl_add_u32 v2, v3, 3, v2
    v_accvgpr_read_b32 v80, a88
    v_accvgpr_read_b32 v81, a89
    v_accvgpr_read_b32 v82, a90
    v_accvgpr_read_b32 v83, a91
    s_waitcnt vmcnt(2)
    v_lshlrev_b32 v22, 16, v32
    v_and_b32 v23, 0xffff0000, v32
    v_add_f32 v80, v80, v22
    v_add_f32 v81, v81, v23
    v_lshlrev_b32 v22, 16, v33
    v_and_b32 v23, 0xffff0000, v33
    v_add_f32 v82, v82, v22
    v_add_f32 v83, v83, v23
    s_waitcnt vmcnt(1)
    v_lshlrev_b32 v22, 16, v44
    v_and_b32 v23, 0xffff0000, v44
    v_add_f32 v80, v80, v22
    v_add_f32 v81, v81, v23
    v_lshlrev_b32 v22, 16, v45
    v_and_b32 v23, 0xffff0000, v45
    v_add_f32 v82, v82, v22
    v_add_f32 v83, v83, v23
    s_waitcnt vmcnt(0)
    v_lshlrev_b32 v22, 16, v56
    v_and_b32 v23, 0xffff0000, v56
    v_add_f32 v80, v80, v22
    v_add_f32 v81, v81, v23
    v_lshlrev_b32 v22, 16, v57
    v_and_b32 v23, 0xffff0000, v57
    v_add_f32 v82, v82, v22
    v_add_f32 v83, v83, v23
    v_cvt_pk_bf16_f32 v80, v80, v81
    v_cvt_pk_bf16_f32 v81, v82, v83
    s_add_u32 s48, s86, 81920
    buffer_store_dwordx2 v[80:81], v2, s[12:15], s48 offen offset:0
    v_accvgpr_read_b32 v84, a92
    v_accvgpr_read_b32 v85, a93
    v_accvgpr_read_b32 v86, a94
    v_accvgpr_read_b32 v87, a95
    v_lshlrev_b32 v22, 16, v34
    v_and_b32 v23, 0xffff0000, v34
    v_add_f32 v84, v84, v22
    v_add_f32 v85, v85, v23
    v_lshlrev_b32 v22, 16, v35
    v_and_b32 v23, 0xffff0000, v35
    v_add_f32 v86, v86, v22
    v_add_f32 v87, v87, v23
    v_lshlrev_b32 v22, 16, v46
    v_and_b32 v23, 0xffff0000, v46
    v_add_f32 v84, v84, v22
    v_add_f32 v85, v85, v23
    v_lshlrev_b32 v22, 16, v47
    v_and_b32 v23, 0xffff0000, v47
    v_add_f32 v86, v86, v22
    v_add_f32 v87, v87, v23
    v_lshlrev_b32 v22, 16, v58
    v_and_b32 v23, 0xffff0000, v58
    v_add_f32 v84, v84, v22
    v_add_f32 v85, v85, v23
    v_lshlrev_b32 v22, 16, v59
    v_and_b32 v23, 0xffff0000, v59
    v_add_f32 v86, v86, v22
    v_add_f32 v87, v87, v23
    v_cvt_pk_bf16_f32 v84, v84, v85
    v_cvt_pk_bf16_f32 v85, v86, v87
    s_add_u32 s48, s86, 81920
    buffer_store_dwordx2 v[84:85], v2, s[12:15], s48 offen offset:32
    s_branch L_end2
L_x3_2b:
    s_cmp_lg_u32 s61, 3
    s_cbranch_scc1 L_x3_3b
    v_accvgpr_read_b32 v24, a72
    v_accvgpr_read_b32 v25, a73
    v_accvgpr_read_b32 v26, a74
    v_accvgpr_read_b32 v27, a75
    v_accvgpr_read_b32 v28, a76
    v_accvgpr_read_b32 v29, a77
    v_accvgpr_read_b32 v30, a78
    v_accvgpr_read_b32 v31, a79
    v_cvt_pk_bf16_f32 v24, v24, v25
    v_cvt_pk_bf16_f32 v25, v26, v27
    v_cvt_pk_bf16_f32 v26, v28, v29
    v_cvt_pk_bf16_f32 v27, v30, v31
    s_add_u32 s48, s85, 2048
    buffer_store_dwordx4 v[24:27], v0, s[32:35], s48 offen sc1
    v_accvgpr_read_b32 v32, a80
    v_accvgpr_read_b32 v33, a81
    v_accvgpr_read_b32 v34, a82
    v_accvgpr_read_b32 v35, a83
    v_accvgpr_read_b32 v36, a84
    v_accvgpr_read_b32 v37, a85
    v_accvgpr_read_b32 v38, a86
    v_accvgpr_read_b32 v39, a87
    v_cvt_pk_bf16_f32 v32, v32, v33
    v_cvt_pk_bf16_f32 v33, v34, v35
    v_cvt_pk_bf16_f32 v34, v36, v37
    v_cvt_pk_bf16_f32 v35, v38, v39
    s_add_u32 s48, s85, 5120
    buffer_store_dwordx4 v[32:35], v0, s[32:35], s48 offen sc1
    v_accvgpr_read_b32 v40, a88
    v_accvgpr_read_b32 v41, a89
    v_accvgpr_read_b32 v42, a90
    v_accvgpr_read_b32 v43, a91
    v_accvgpr_read_b32 v44, a92
    v_accvgpr_read_b32 v45, a93
    v_accvgpr_read_b32 v46, a94
    v_accvgpr_read_b32 v47, a95
    v_cvt_pk_bf16_f32 v40, v40, v41
    v_cvt_pk_bf16_f32 v41, v42, v43
    v_cvt_pk_bf16_f32 v42, v44, v45
    v_cvt_pk_bf16_f32 v43, v46, v47
    s_add_u32 s48, s85, 8192
    buffer_store_dwordx4 v[40:43], v0, s[32:35], s48 offen sc1
    s_mul_i32 s86, s63, 12
    s_add_u32 s86, s86, 9
    s_mul_i32 s86, s86, 40960
    s_mul_i32 s87, s62, 1280
    s_add_u32 s86, s86, s87
    s_lshl_b32 s87, s64, 8
    s_add_u32 s86, s86, s87
    s_add_u32 s86, s86, 192
    s_waitcnt vmcnt(0) lgkmcnt(0)
    s_barrier
    s_cmp_lg_u32 s7, 0
    s_cbranch_scc1 L_pub33
    s_and_b32 s48, s2, 7
    s_lshl_b32 s48, s48, 5
    s_lshr_b32 s49, s2, 3
    s_add_u32 s48, s48, s49
    v_mov_b32 v2, s48
    v_mov_b32 v3, 3
    s_mov_b64 exec, 1
    global_store_byte v2, v3, s[22:23] sc1
    s_mov_b64 exec, -1
L_pub33:
    s_mov_b32 s12, s8
    s_mov_b32 s13, s9
    s_mov_b32 s14, 2949120
    s_mov_b32 s15, 0x20000
    s_cmp_lg_u32 s7, 0
    s_cbranch_scc1 L_xp3_3b_skip
    s_lshl_b32 s48, s62, 7
    s_add_u32 s48, s48, s60
    v_and_b32 v2, 3, v1
    v_lshlrev_b32 v2, 5, v2
    v_add_u32 v2, s48, v2
    s_mov_b32 s69, 0
L_xp3_3b_poll:
    global_load_ubyte v3, v2, s[22:23] sc1
    s_add_u32 s69, s69, 1
    s_waitcnt vmcnt(0)
    v_cmp_gt_u32 vcc, 3, v3
    s_cmp_ge_u32 s69, 131072
    s_cbranch_scc1 L_xp3_3b_skip
    s_nop 2
    s_cbranch_vccz L_xp3_3b_skip
    s_sleep 1
    s_branch L_xp3_3b_poll
L_xp3_3b_skip:
    s_barrier
    s_mov_b32 s48, 11264
    buffer_load_dwordx4 v[32:35], v0, s[32:35], s48 offen sc1
    s_mov_b32 s48, 1485824
    buffer_load_dwordx4 v[44:47], v0, s[32:35], s48 offen sc1
    s_mov_b32 s48, 2960384
    buffer_load_dwordx4 v[56:59], v0, s[32:35], s48 offen sc1
    v_and_b32 v2, 15, v1
    v_mul_u32_u24 v2, 2560, v2
    v_lshrrev_b32 v3, 4, v1
    v_lshl_add_u32 v2, v3, 3, v2
    v_accvgpr_read_b32 v80, a64
    v_accvgpr_read_b32 v81, a65
    v_accvgpr_read_b32 v82, a66
    v_accvgpr_read_b32 v83, a67
    s_waitcnt vmcnt(2)
    v_lshlrev_b32 v22, 16, v32
    v_and_b32 v23, 0xffff0000, v32
    v_add_f32 v80, v80, v22
    v_add_f32 v81, v81, v23
    v_lshlrev_b32 v22, 16, v33
    v_and_b32 v23, 0xffff0000, v33
    v_add_f32 v82, v82, v22
    v_add_f32 v83, v83, v23
    s_waitcnt vmcnt(1)
    v_lshlrev_b32 v22, 16, v44
    v_and_b32 v23, 0xffff0000, v44
    v_add_f32 v80, v80, v22
    v_add_f32 v81, v81, v23
    v_lshlrev_b32 v22, 16, v45
    v_and_b32 v23, 0xffff0000, v45
    v_add_f32 v82, v82, v22
    v_add_f32 v83, v83, v23
    s_waitcnt vmcnt(0)
    v_lshlrev_b32 v22, 16, v56
    v_and_b32 v23, 0xffff0000, v56
    v_add_f32 v80, v80, v22
    v_add_f32 v81, v81, v23
    v_lshlrev_b32 v22, 16, v57
    v_and_b32 v23, 0xffff0000, v57
    v_add_f32 v82, v82, v22
    v_add_f32 v83, v83, v23
    v_cvt_pk_bf16_f32 v80, v80, v81
    v_cvt_pk_bf16_f32 v81, v82, v83
    s_add_u32 s48, s86, 81920
    buffer_store_dwordx2 v[80:81], v2, s[12:15], s48 offen offset:0
    v_accvgpr_read_b32 v84, a68
    v_accvgpr_read_b32 v85, a69
    v_accvgpr_read_b32 v86, a70
    v_accvgpr_read_b32 v87, a71
    v_lshlrev_b32 v22, 16, v34
    v_and_b32 v23, 0xffff0000, v34
    v_add_f32 v84, v84, v22
    v_add_f32 v85, v85, v23
    v_lshlrev_b32 v22, 16, v35
    v_and_b32 v23, 0xffff0000, v35
    v_add_f32 v86, v86, v22
    v_add_f32 v87, v87, v23
    v_lshlrev_b32 v22, 16, v46
    v_and_b32 v23, 0xffff0000, v46
    v_add_f32 v84, v84, v22
    v_add_f32 v85, v85, v23
    v_lshlrev_b32 v22, 16, v47
    v_and_b32 v23, 0xffff0000, v47
    v_add_f32 v86, v86, v22
    v_add_f32 v87, v87, v23
    v_lshlrev_b32 v22, 16, v58
    v_and_b32 v23, 0xffff0000, v58
    v_add_f32 v84, v84, v22
    v_add_f32 v85, v85, v23
    v_lshlrev_b32 v22, 16, v59
    v_and_b32 v23, 0xffff0000, v59
    v_add_f32 v86, v86, v22
    v_add_f32 v87, v87, v23
    v_cvt_pk_bf16_f32 v84, v84, v85
    v_cvt_pk_bf16_f32 v85, v86, v87
    s_add_u32 s48, s86, 81920
    buffer_store_dwordx2 v[84:85], v2, s[12:15], s48 offen offset:32
    s_branch L_end2
L_x3_3b:
L_noop:
    s_cmp_lg_u32 s6, 0
    s_cbranch_scc1 L_end2
    s_barrier
    s_barrier
    s_barrier
L_end2:
    s_waitcnt vmcnt(0)
L_end:
    s_endpgm

.section .rodata,"a"
.p2align 6
.amdhsa_kernel concat_heads__mha_block_cached__mha_block_cached__near_ridge_kernel
  .amdhsa_next_free_vgpr 256
  .amdhsa_next_free_sgpr 102
  .amdhsa_accum_offset 96
  .amdhsa_group_segment_fixed_size 0
  .amdhsa_kernarg_size 104
  .amdhsa_user_sgpr_count 2
  .amdhsa_user_sgpr_kernarg_segment_ptr 1
  .amdhsa_system_sgpr_workgroup_id_x 1
.end_amdhsa_kernel
```
